```python
import torch

def _softmax(x, axis=-1):
    return torch.softmax(x, dim=axis)
def _gelu(x):
    return torch.nn.functional.gelu(x, approximate="tanh")
def _silu(x):
    return torch.nn.functional.silu(x)
def _sigmoid(x):
    return torch.sigmoid(x)
def _layernorm(x, axis=-1, eps=1e-5):
    m = x.mean(dim=axis, keepdim=True)
    v = x.var(dim=axis, keepdim=True, unbiased=False)
    return (x - m) / torch.sqrt(v + eps)
def _scatter_add(tgt, idx, src, axis=0):
    return tgt.clone().index_add_(axis, idx, src)
def _segment_sum(src, seg, n):
    out = torch.zeros((n,) + src.shape[1:], dtype=src.dtype)
    return out.index_add_(0, seg, src)
def _pad(x, pw):
    flat = tuple(v for pair in reversed(pw) for v in pair)
    return torch.nn.functional.pad(x, flat)

kernel_name = 'interleave_layers__linear_kernel_hedgehog__mixer_channel_mlp__prompt'

def setup_inputs():

    _w = (lambda a: (lambda t: t.to(torch.bfloat16) if t.is_floating_point() else t)(torch.as_tensor(a)))
    def _A_setup():
        B, S, D, H = 1, 2048, 640, 32
        Dh = D // H
        return {
            "x": _w((lambda *s: torch.randn(*s, dtype=torch.bfloat16) * 0.05)(B, S, D)),
            "wqkv": _w((lambda *s: torch.randn(*s, dtype=torch.bfloat16) * 0.4)(D, 3 * D)),
            "w_phi": _w((lambda *s: torch.randn(*s, dtype=torch.bfloat16) * 0.4)(H, Dh, Dh) * (Dh ** -0.5)),
            "wo": _w((lambda *s: torch.randn(*s, dtype=torch.bfloat16) * 0.05)(D, D)),
        }
    _A_in = _A_setup()

    def _B_setup():
        B, S, D, F = 1, 2048, 640, 1728
        return {
            "x": _w((lambda *s: torch.randn(*s, dtype=torch.bfloat16) * 0.05)(B, S, D)),
            "w1": _w((lambda *s: torch.randn(*s, dtype=torch.bfloat16) * 3.2)(D, F) * (D ** -0.5)),
            "b1": _w((lambda *s: torch.randn(*s, dtype=torch.bfloat16) * 1.6)(F)),
            "w2": _w((lambda *s: torch.randn(*s, dtype=torch.bfloat16) * 1.6)(F, D) * (F ** -0.5)),
            "b2": _w((lambda *s: torch.randn(*s, dtype=torch.bfloat16) * 1.6)(D)),
        }
    _B_in = _B_setup()

    return {
        "A_x": _A_in["x"],
        "A_wqkv": _A_in["wqkv"],
        "A_w_phi": _A_in["w_phi"],
        "A_wo": _A_in["wo"],
        "B_x": _B_in["x"],
        "B_w1": _B_in["w1"],
        "B_b1": _B_in["b1"],
        "B_w2": _B_in["w2"],
        "B_b2": _B_in["b2"],
    }

def reference(A_x, A_wqkv, A_w_phi, A_wo, B_x, B_w1, B_b1, B_w2, B_b2):
    def _A_ref(x, wqkv, w_phi, wo):
        B, S, D = x.shape
        H = 32; Dh = D // H
        qkv = (lambda x, *d: x.permute(*d))((x @ wqkv).reshape(B, S, 3, H, Dh), 2, 0, 3, 1, 4)
        q, k, v = qkv[0], qkv[1], qkv[2]
        pq = torch.einsum("bhsd,hdf->bhsf", q, w_phi)
        pk = torch.einsum("bhsd,hdf->bhsf", k, w_phi)
        phi_q = torch.concatenate([_softmax(pq, axis=-1), _softmax(-pq, axis=-1)], axis=-1)
        phi_k = torch.concatenate([_softmax(pk, axis=-1), _softmax(-pk, axis=-1)], axis=-1)
        kv = torch.einsum("bhsf,bhsd->bhfd", phi_k, v)
        z  = torch.einsum("bhsf->bhf", phi_k)
        num = torch.einsum("bhqf,bhfd->bhqd", phi_q, kv)
        den = torch.einsum("bhqf,bhf->bhq", phi_q, z)[..., None] + 1e-6
        o = num / den
        return (lambda x, *d: x.permute(*d))(o, 0, 2, 1, 3).reshape(B, S, D) @ wo

    def _B_ref(x, w1, b1, w2, b2):
        y = _layernorm(x, axis=-1)
        h = _gelu(torch.einsum("bsd,df->bsf", y, w1) + b1)
        return torch.einsum("bsf,fd->bsd", h, w2) + b2

    x = A_x
    x = x + _A_ref(_layernorm(x, axis=-1), A_wqkv, A_w_phi, A_wo)
    x = x + _B_ref(_layernorm(x, axis=-1), B_w1, B_b1, B_w2, B_b2)
    x = x + _A_ref(_layernorm(x, axis=-1), A_wqkv, A_w_phi, A_wo)
    x = x + _B_ref(_layernorm(x, axis=-1), B_w1, B_b1, B_w2, B_b2)
    return x
```

```asm
; @launch grid=(256,1,1) block=(256,1,1) lds=163840
.amdgcn_target "amdgcn-amd-amdhsa--gfx950"
.text
.globl interleave_layers__linear_kernel_hedgehog__mixer_channel_mlp__prompt_kernel
.p2align 8
.type interleave_layers__linear_kernel_hedgehog__mixer_channel_mlp__prompt_kernel,@function
interleave_layers__linear_kernel_hedgehog__mixer_channel_mlp__prompt_kernel:
  s_cmp_ge_u32 s2, 256
  s_cbranch_scc0 main_go
  s_endpgm
main_go:
  s_load_dwordx16 s[64:79], s[0:1], 0
  s_load_dwordx8 s[48:55], s[0:1], 64
  s_getpc_b64 s[16:17]
pc_1:
  s_lshr_b32 s18, s2, 3
  s_and_b32 s18, s18, 31
  s_lshl_b32 s18, s18, 10
  v_lshrrev_b32 v248, 6, v0
  v_lshlrev_b32 v248, 15, v248
  v_and_b32 v249, 63, v0
  v_lshl_add_u32 v248, v249, 4, v248
  v_add_u32 v248, s18, v248
  v_min_u32 v248, main_end-pc_1-16, v248
  global_load_dwordx4 v[250:253], v248, s[16:17]
  v_lshrrev_b32 v6, 6, v0
  v_and_b32 v0, 63, v0
  v_readfirstlane_b32 s8, v6
  v_lshlrev_b32 v1, 4, v0
  v_and_b32 v4, 15, v0
  v_lshrrev_b32 v5, 4, v0
  s_and_b32 s28, s2, 7
  s_lshr_b32 s29, s2, 3
  s_cmp_ge_u32 s29, 20
  s_cbranch_scc1 tE_2
  s_lshl_b32 s33, s28, 2
  s_add_u32 s33, s33, s8
  v_mul_u32_u24 v69, 3840, v4
  v_lshl_add_u32 v69, v5, 4, v69
  s_lshr_b32 s18, s29, 1
  s_mul_i32 s18, s18, 5
  s_and_b32 s19, s29, 1
  s_lshl_b32 s19, s19, 1
  s_add_u32 s18, s18, s19
  s_sub_u32 s19, s29, 16
  s_mul_i32 s19, s19, 10
  s_add_u32 s19, s19, 4
  s_cmp_ge_u32 s29, 16
  s_cselect_b32 s18, s19, s18
  s_cselect_b32 s19, 5, 1
  s_add_u32 s19, s19, s18
  s_mul_i32 s34, s33, 40
  s_mul_i32 s18, s18, 61440
  s_add_u32 s18, s18, s34
  s_mul_i32 s19, s19, 61440
  s_add_u32 s19, s19, s34
  s_mul_i32 s31, s33, 800
  v_and_b32 v64, 7, v4
  v_lshrrev_b32 v65, 3, v4
  v_mul_u32_u24 v84, 10, v65
  v_add_u32 v84, v84, v64
  v_and_b32 v64, 1, v4
  v_bfe_u32 v65, v4, 1, 1
  v_mul_u32_u24 v85, 10, v65
  v_add_u32 v85, v85, v64
  v_mov_b32 v67, 0x40000000
  v_mul_u32_u24 v64, 320, v5
  v_lshl_add_u32 v56, v84, 1, v64
  v_lshl_add_u32 v58, v85, 1, v64
  v_add_u32 v58, 16, v58
  v_cmp_gt_u32 vcc, 4, v4
  s_nop 1
  v_cndmask_b32 v58, v67, v58, vcc
  v_cmp_gt_u32 vcc, 2, v5
  s_nop 1
  v_cndmask_b32 v57, v67, v56, vcc
  v_cndmask_b32 v59, v67, v58, vcc
  v_cmp_gt_u32 vcc, 3, v5
  s_nop 1
  v_cndmask_b32 v56, v67, v56, vcc
  v_cndmask_b32 v58, v67, v58, vcc
  s_waitcnt lgkmcnt(0)
  s_mov_b64 s[80:81], s[66:67]
  s_mov_b64 s[82:83], s[68:69]
  s_mov_b64 s[90:91], s[64:65]
  s_mov_b64 s[22:23], s[54:55]
  s_mov_b64 s[84:85], s[70:71]
  s_mov_b64 s[86:87], s[74:75]
  s_mov_b64 s[88:89], s[78:79]
  s_mov_b64 s[36:37], s[76:77]
  s_mov_b64 s[40:41], s[48:49]
  s_mov_b64 s[44:45], s[50:51]
  s_mov_b32 s24, s80
  s_and_b32 s25, s81, 0xffff
  s_mov_b32 s26, 0x258000
  s_mov_b32 s27, 0x20000
  buffer_load_dwordx4 v[96:99], v69, s[24:27], s18 offen offset:1280
  buffer_load_dwordx4 v[100:103], v69, s[24:27], s19 offen offset:1280
  buffer_load_dwordx4 v[104:107], v69, s[24:27], s18 offen offset:2560
  buffer_load_dwordx4 v[108:111], v69, s[24:27], s19 offen offset:2560
  buffer_load_dwordx4 v[88:91], v69, s[24:27], s18 offen offset:0
  buffer_load_dwordx4 v[92:95], v69, s[24:27], s19 offen offset:0
  s_mov_b32 s76, s82
  s_and_b32 s77, s83, 0xffff
  s_mov_b32 s78, 0x6400
  s_mov_b32 s79, 0x20000
  buffer_load_ushort v8, v56, s[76:79], s31 offen offset:0
  buffer_load_ushort v9, v56, s[76:79], s31 offen offset:40
  buffer_load_ushort v10, v56, s[76:79], s31 offen offset:80
  buffer_load_ushort v11, v56, s[76:79], s31 offen offset:120
  buffer_load_ushort v12, v57, s[76:79], s31 offen offset:160
  buffer_load_ushort v13, v57, s[76:79], s31 offen offset:200
  buffer_load_ushort v14, v57, s[76:79], s31 offen offset:240
  buffer_load_ushort v15, v57, s[76:79], s31 offen offset:280
  buffer_load_ushort v16, v58, s[76:79], s31 offen offset:0
  buffer_load_ushort v17, v58, s[76:79], s31 offen offset:40
  buffer_load_ushort v18, v58, s[76:79], s31 offen offset:80
  buffer_load_ushort v19, v58, s[76:79], s31 offen offset:120
  buffer_load_ushort v20, v59, s[76:79], s31 offen offset:160
  buffer_load_ushort v21, v59, s[76:79], s31 offen offset:200
  buffer_load_ushort v22, v59, s[76:79], s31 offen offset:240
  buffer_load_ushort v23, v59, s[76:79], s31 offen offset:280
  s_mov_b32 s60, s86
  s_and_b32 s61, s87, 0xffff
  s_mov_b32 s62, 0x21c000
  s_mov_b32 s63, 0x20000
  s_lshr_b32 s29, s2, 3
  s_and_b32 s28, s2, 7
  s_lshl_b32 s17, s29, 2
  s_add_u32 s17, s17, s8
  s_mul_i32 s17, s17, 40
  v_add_u32 v44, s17, v0
  v_mul_u32_u24 v45, 52429, v44
  v_lshrrev_b32 v45, 18, v45
  v_mul_u32_u24 v46, 5, v45
  v_sub_u32 v44, v44, v46
  v_mul_u32_u24 v45, 3456, v45
  v_lshl_add_u32 v44, v44, 7, v45
  s_lshl_b32 s17, s28, 1
  s_and_b32 s18, s17, 7
  s_mul_i32 s18, s18, 7
  s_lshr_b32 s17, s17, 3
  s_mul_i32 s17, s17, 54
  s_add_u32 s17, s17, s18
  s_lshl_b32 s17, s17, 5
  s_and_b32 s17, s17, 0xffffff80
  v_mov_b32 v45, 0x40000000
  v_cmp_gt_u32 vcc, 40, v0
  s_nop 1
  v_cndmask_b32 v44, v45, v44, vcc
  buffer_load_dword v254, v44, s[60:63], s17 offen
  s_mov_b32 s4, s22
  s_and_b32 s5, s23, 0xffff
  s_mov_b32 s6, 0x4000000
  s_mov_b32 s7, 0x20000
  s_mov_b32 s17, 0xda0000
  buffer_load_dword v87, off, s[4:7], s17
  s_cmp_lg_u32 s8, 0
  s_cbranch_scc1 noz_4
  v_mov_b32 v40, 0
  v_mov_b32 v41, 0
  v_mov_b32 v42, 0
  v_mov_b32 v43, 0
  s_mul_i32 s17, s2, 1536
  s_add_u32 s17, s17, 0x1800000
  buffer_store_dwordx4 v[40:43], v1, s[4:7], s17 offen sc1
  v_mov_b32 v62, 0x40000000
  v_cmp_gt_u32 vcc, 32, v0
  s_nop 1
  v_cndmask_b32 v63, v62, v1, vcc
  buffer_store_dwordx4 v[40:43], v63, s[4:7], s17 offen offset:1024 sc1
  v_cmp_gt_u32 vcc, 8, v0
  s_nop 1
  v_cndmask_b32 v63, v62, v1, vcc
  s_lshl_b32 s17, s2, 7
  s_add_u32 s17, s17, 0xd00000
  s_cmp_lt_u32 s2, 160
  s_cselect_b32 s17, s17, 0x40000000
  buffer_store_dwordx4 v[40:43], v63, s[4:7], s17 offen sc1
  v_cmp_gt_u32 vcc, 40, v0
  s_nop 1
  v_cndmask_b32 v63, v62, v1, vcc
  s_lshr_b32 s17, s2, 4
  s_mul_i32 s17, s17, 286720
  s_and_b32 s18, s2, 15
  s_mul_i32 s18, s18, 640
  s_add_u32 s17, s17, s18
  s_add_u32 s17, s17, 0x1543800
  s_cmp_lt_u32 s2, 128
  s_cselect_b32 s17, s17, 0x40000000
  buffer_store_dwordx4 v[40:43], v63, s[4:7], s17 offen sc1
noz_4:
  v_add_u32 v84, 2, v84
  v_lshlrev_b32 v64, 3, v5
  v_sub_u32 v64, v84, v64
  v_mov_b32 v76, 0
  v_mov_b32 v65, 0x3f80
  v_cmp_eq_u32 vcc, 0, v64
  s_nop 1
  v_cndmask_b32 v76, v76, v65, vcc
  v_mov_b32 v65, 0x3f800000
  v_cmp_eq_u32 vcc, 1, v64
  s_nop 1
  v_cndmask_b32 v76, v76, v65, vcc
  v_mov_b32 v77, 0
  v_mov_b32 v65, 0x3f80
  v_cmp_eq_u32 vcc, 2, v64
  s_nop 1
  v_cndmask_b32 v77, v77, v65, vcc
  v_mov_b32 v65, 0x3f800000
  v_cmp_eq_u32 vcc, 3, v64
  s_nop 1
  v_cndmask_b32 v77, v77, v65, vcc
  v_mov_b32 v78, 0
  v_mov_b32 v65, 0x3f80
  v_cmp_eq_u32 vcc, 4, v64
  s_nop 1
  v_cndmask_b32 v78, v78, v65, vcc
  v_mov_b32 v65, 0x3f800000
  v_cmp_eq_u32 vcc, 5, v64
  s_nop 1
  v_cndmask_b32 v78, v78, v65, vcc
  v_mov_b32 v79, 0
  v_mov_b32 v65, 0x3f80
  v_cmp_eq_u32 vcc, 6, v64
  s_nop 1
  v_cndmask_b32 v79, v79, v65, vcc
  v_mov_b32 v65, 0x3f800000
  v_cmp_eq_u32 vcc, 7, v64
  s_nop 1
  v_cndmask_b32 v79, v79, v65, vcc
  v_lshrrev_b32 v64, 2, v4
  v_cmp_eq_u32 vcc, 1, v64
  v_mov_b32 v64, 63
  s_nop 0
  v_cndmask_b32 v85, v64, v85, vcc
  v_lshlrev_b32 v64, 3, v5
  v_sub_u32 v64, v85, v64
  v_mov_b32 v80, 0
  v_mov_b32 v65, 0x3f80
  v_cmp_eq_u32 vcc, 0, v64
  s_nop 1
  v_cndmask_b32 v80, v80, v65, vcc
  v_mov_b32 v65, 0x3f800000
  v_cmp_eq_u32 vcc, 1, v64
  s_nop 1
  v_cndmask_b32 v80, v80, v65, vcc
  v_mov_b32 v81, 0
  v_mov_b32 v65, 0x3f80
  v_cmp_eq_u32 vcc, 2, v64
  s_nop 1
  v_cndmask_b32 v81, v81, v65, vcc
  v_mov_b32 v65, 0x3f800000
  v_cmp_eq_u32 vcc, 3, v64
  s_nop 1
  v_cndmask_b32 v81, v81, v65, vcc
  v_mov_b32 v82, 0
  v_mov_b32 v65, 0x3f80
  v_cmp_eq_u32 vcc, 4, v64
  s_nop 1
  v_cndmask_b32 v82, v82, v65, vcc
  v_mov_b32 v65, 0x3f800000
  v_cmp_eq_u32 vcc, 5, v64
  s_nop 1
  v_cndmask_b32 v82, v82, v65, vcc
  v_mov_b32 v83, 0
  v_mov_b32 v65, 0x3f80
  v_cmp_eq_u32 vcc, 6, v64
  s_nop 1
  v_cndmask_b32 v83, v83, v65, vcc
  v_mov_b32 v65, 0x3f800000
  v_cmp_eq_u32 vcc, 7, v64
  s_nop 1
  v_cndmask_b32 v83, v83, v65, vcc
  s_and_b32 s35, s33, 1
  s_lshl_b32 s35, s35, 1
  v_lshrrev_b32 v64, 3, v4
  v_add_u32 v64, s35, v64
  v_and_b32 v65, 3, v4
  v_lshl_add_u32 v64, v64, 2, v65
  v_lshl_add_u32 v64, v5, 4, v64
  v_lshlrev_b32 v70, 4, v64
  v_bfe_u32 v65, v4, 2, 1
  v_lshl_add_u32 v70, v65, 10, v70
  v_bfe_u32 v64, v4, 1, 1
  v_add_u32 v64, s35, v64
  v_and_b32 v65, 1, v4
  v_bfe_u32 v66, v4, 2, 1
  v_lshl_add_u32 v65, v66, 1, v65
  v_lshl_add_u32 v64, v64, 2, v65
  v_lshl_add_u32 v64, v5, 4, v64
  v_lshlrev_b32 v71, 4, v64
  v_cmp_gt_u32 vcc, 8, v4
  s_nop 1
  v_cndmask_b32 v71, v67, v71, vcc
  s_lshr_b32 s18, s33, 1
  s_mul_i32 s92, s18, 163840
  s_add_u32 s92, s92, 0xe00000
  s_mul_i32 s18, s29, 3072
  s_add_u32 s95, s92, s18
  s_add_u32 s95, s95, 102400
  s_mul_i32 s18, s29, 5120
  s_add_u32 s92, s92, s18
  s_lshr_b32 s18, s33, 1
  s_mul_i32 s43, s18, 10240
  s_lshl_b32 s18, s29, 9
  s_add_u32 s43, s43, s18
  s_and_b32 s18, s33, 1
  s_lshl_b32 s18, s18, 8
  s_add_u32 s43, s43, s18
  s_add_u32 s43, s43, 0xdd0000
  s_waitcnt vmcnt(0)
  v_lshl_or_b32 v24, v9, 16, v8
  v_lshl_or_b32 v25, v11, 16, v10
  v_lshl_or_b32 v26, v13, 16, v12
  v_lshl_or_b32 v27, v15, 16, v14
  v_lshl_or_b32 v28, v17, 16, v16
  v_lshl_or_b32 v29, v19, 16, v18
  v_lshl_or_b32 v30, v21, 16, v20
  v_lshl_or_b32 v31, v23, 16, v22
  v_mfma_f32_16x16x32_bf16 v[120:123], v[104:107], v[76:79], 0
  v_mfma_f32_16x16x32_bf16 v[124:127], v[108:111], v[76:79], 0
  v_mfma_f32_16x16x32_bf16 v[128:131], v[104:107], v[80:83], 0
  v_mfma_f32_16x16x32_bf16 v[132:135], v[108:111], v[80:83], 0
  v_mfma_f32_16x16x32_bf16 v[112:115], v[96:99], v[24:27], 0
  v_mfma_f32_16x16x32_bf16 v[116:119], v[100:103], v[24:27], 0
  v_mfma_f32_16x16x32_bf16 v[136:139], v[88:91], v[24:27], 0
  v_mfma_f32_16x16x32_bf16 v[140:143], v[92:95], v[24:27], 0
  v_mfma_f32_16x16x32_bf16 v[128:131], v[96:99], v[28:31], v[128:131]
  v_mfma_f32_16x16x32_bf16 v[132:135], v[100:103], v[28:31], v[132:135]
  v_mfma_f32_16x16x32_bf16 v[144:147], v[88:91], v[28:31], 0
  v_mfma_f32_16x16x32_bf16 v[148:151], v[92:95], v[28:31], 0
  v_cvt_pk_bf16_f32 v152, v120, v121
  v_cvt_pk_bf16_f32 v153, v122, v123
  v_cvt_pk_bf16_f32 v154, v124, v125
  v_cvt_pk_bf16_f32 v155, v126, v127
  buffer_store_dwordx4 v[152:155], v70, s[4:7], s92 offen offset:3072 sc1
  v_cvt_pk_bf16_f32 v156, v112, v113
  v_cvt_pk_bf16_f32 v157, v114, v115
  v_cvt_pk_bf16_f32 v158, v116, v117
  v_cvt_pk_bf16_f32 v159, v118, v119
  buffer_store_dwordx4 v[156:159], v70, s[4:7], s92 offen offset:0 sc1
  v_cvt_pk_bf16_f32 v160, v136, v137
  v_cvt_pk_bf16_f32 v161, v138, v139
  v_cvt_pk_bf16_f32 v162, v140, v141
  v_cvt_pk_bf16_f32 v163, v142, v143
  buffer_store_dwordx4 v[160:163], v70, s[4:7], s95 offen offset:0 sc1
  v_cvt_pk_bf16_f32 v164, v128, v129
  v_cvt_pk_bf16_f32 v165, v130, v131
  v_cvt_pk_bf16_f32 v166, v132, v133
  v_cvt_pk_bf16_f32 v167, v134, v135
  buffer_store_dwordx4 v[164:167], v71, s[4:7], s92 offen offset:2048 sc1
  v_cvt_pk_bf16_f32 v168, v144, v145
  v_cvt_pk_bf16_f32 v169, v146, v147
  v_cvt_pk_bf16_f32 v170, v148, v149
  v_cvt_pk_bf16_f32 v171, v150, v151
  buffer_store_dwordx4 v[168:171], v71, s[4:7], s95 offen offset:2048 sc1
  s_waitcnt vmcnt(0)
  s_branch tD_3
tE_2:
  s_nop 15
  s_nop 3
  s_sub_u32 s30, s29, 20
  s_lshl_b32 s30, s30, 3
  s_add_u32 s30, s30, s28
  s_lshl_b32 s30, s30, 2
  s_add_u32 s30, s30, s8
  s_mul_i32 s31, s30, 0x5556
  s_lshr_b32 s31, s31, 16
  s_mul_i32 s32, s31, 3
  s_sub_u32 s32, s30, s32
  v_mul_u32_u24 v69, 1280, v4
  v_lshl_add_u32 v69, v5, 3, v69
  s_mul_i32 s92, s31, 20480
  s_waitcnt lgkmcnt(0)
  s_mov_b64 s[80:81], s[66:67]
  s_mov_b64 s[82:83], s[68:69]
  s_mov_b64 s[90:91], s[64:65]
  s_mov_b64 s[22:23], s[54:55]
  s_mov_b64 s[84:85], s[70:71]
  s_mov_b64 s[86:87], s[74:75]
  s_mov_b64 s[88:89], s[78:79]
  s_mov_b64 s[36:37], s[76:77]
  s_mov_b64 s[40:41], s[48:49]
  s_mov_b64 s[44:45], s[50:51]
  s_mov_b32 s24, s90
  s_and_b32 s25, s91, 0xffff
  s_mov_b32 s26, 0x280000
  s_mov_b32 s27, 0x20000
  s_cmp_eq_u32 s32, 1
  s_cbranch_scc1 El_6
  s_cmp_eq_u32 s32, 2
  s_cbranch_scc1 El_7
El_5:
  buffer_load_dwordx2 v[88:89], v69, s[24:27], s92 offen offset:0
  buffer_load_dwordx2 v[90:91], v69, s[24:27], s92 offen offset:32
  buffer_load_dwordx2 v[92:93], v69, s[24:27], s92 offen offset:64
  buffer_load_dwordx2 v[94:95], v69, s[24:27], s92 offen offset:96
  buffer_load_dwordx2 v[96:97], v69, s[24:27], s92 offen offset:160
  buffer_load_dwordx2 v[98:99], v69, s[24:27], s92 offen offset:192
  buffer_load_dwordx2 v[100:101], v69, s[24:27], s92 offen offset:224
  buffer_load_dwordx2 v[102:103], v69, s[24:27], s92 offen offset:256
  buffer_load_dwordx2 v[104:105], v69, s[24:27], s92 offen offset:320
  buffer_load_dwordx2 v[106:107], v69, s[24:27], s92 offen offset:352
  buffer_load_dwordx2 v[108:109], v69, s[24:27], s92 offen offset:384
  buffer_load_dwordx2 v[110:111], v69, s[24:27], s92 offen offset:416
  buffer_load_dwordx2 v[112:113], v69, s[24:27], s92 offen offset:480
  buffer_load_dwordx2 v[114:115], v69, s[24:27], s92 offen offset:512
  s_branch Ej_8
El_6:
  buffer_load_dwordx2 v[88:89], v69, s[24:27], s92 offen offset:544
  buffer_load_dwordx2 v[90:91], v69, s[24:27], s92 offen offset:576
  buffer_load_dwordx2 v[92:93], v69, s[24:27], s92 offen offset:640
  buffer_load_dwordx2 v[94:95], v69, s[24:27], s92 offen offset:672
  buffer_load_dwordx2 v[96:97], v69, s[24:27], s92 offen offset:704
  buffer_load_dwordx2 v[98:99], v69, s[24:27], s92 offen offset:736
  buffer_load_dwordx2 v[100:101], v69, s[24:27], s92 offen offset:800
  buffer_load_dwordx2 v[102:103], v69, s[24:27], s92 offen offset:832
  buffer_load_dwordx2 v[104:105], v69, s[24:27], s92 offen offset:864
  buffer_load_dwordx2 v[106:107], v69, s[24:27], s92 offen offset:896
  buffer_load_dwordx2 v[108:109], v69, s[24:27], s92 offen offset:960
  buffer_load_dwordx2 v[110:111], v69, s[24:27], s92 offen offset:992
  buffer_load_dwordx2 v[112:113], v69, s[24:27], s92 offen offset:1024
  buffer_load_dwordx2 v[114:115], v69, s[24:27], s92 offen offset:1056
  s_branch Ej_8
El_7:
  buffer_load_dwordx2 v[88:89], v69, s[24:27], s92 offen offset:1120
  buffer_load_dwordx2 v[90:91], v69, s[24:27], s92 offen offset:1152
  buffer_load_dwordx2 v[92:93], v69, s[24:27], s92 offen offset:1184
  buffer_load_dwordx2 v[94:95], v69, s[24:27], s92 offen offset:1216
  buffer_load_dwordx2 v[96:97], v69, s[24:27], s92 offen offset:128
  buffer_load_dwordx2 v[98:99], v69, s[24:27], s92 offen offset:288
  buffer_load_dwordx2 v[100:101], v69, s[24:27], s92 offen offset:448
  buffer_load_dwordx2 v[102:103], v69, s[24:27], s92 offen offset:608
  buffer_load_dwordx2 v[104:105], v69, s[24:27], s92 offen offset:768
  buffer_load_dwordx2 v[106:107], v69, s[24:27], s92 offen offset:928
  buffer_load_dwordx2 v[108:109], v69, s[24:27], s92 offen offset:1088
  buffer_load_dwordx2 v[110:111], v69, s[24:27], s92 offen offset:1248
Ej_8:
  s_mov_b32 s4, s22
  s_and_b32 s5, s23, 0xffff
  s_mov_b32 s6, 0x4000000
  s_mov_b32 s7, 0x20000
  s_mov_b32 s17, 0xda0000
  buffer_load_dword v87, off, s[4:7], s17
  s_cmp_lg_u32 s8, 0
  s_cbranch_scc1 noz_9
  v_mov_b32 v40, 0
  v_mov_b32 v41, 0
  v_mov_b32 v42, 0
  v_mov_b32 v43, 0
  s_mul_i32 s17, s2, 1536
  s_add_u32 s17, s17, 0x1800000
  buffer_store_dwordx4 v[40:43], v1, s[4:7], s17 offen sc1
  v_mov_b32 v62, 0x40000000
  v_cmp_gt_u32 vcc, 32, v0
  s_nop 1
  v_cndmask_b32 v63, v62, v1, vcc
  buffer_store_dwordx4 v[40:43], v63, s[4:7], s17 offen offset:1024 sc1
  v_cmp_gt_u32 vcc, 8, v0
  s_nop 1
  v_cndmask_b32 v63, v62, v1, vcc
  s_lshl_b32 s17, s2, 7
  s_add_u32 s17, s17, 0xd00000
  s_cmp_lt_u32 s2, 160
  s_cselect_b32 s17, s17, 0x40000000
  buffer_store_dwordx4 v[40:43], v63, s[4:7], s17 offen sc1
  v_cmp_gt_u32 vcc, 40, v0
  s_nop 1
  v_cndmask_b32 v63, v62, v1, vcc
  s_lshr_b32 s17, s2, 4
  s_mul_i32 s17, s17, 286720
  s_and_b32 s18, s2, 15
  s_mul_i32 s18, s18, 640
  s_add_u32 s17, s17, s18
  s_add_u32 s17, s17, 0x1543800
  s_cmp_lt_u32 s2, 128
  s_cselect_b32 s17, s17, 0x40000000
  buffer_store_dwordx4 v[40:43], v63, s[4:7], s17 offen sc1
noz_9:
  v_mov_b32 v64, 0
  v_mov_b32 v65, 0
  v_mov_b32 v67, 0x3f803f80
  v_lshlrev_b32 v70, 3, v0
  s_mul_i32 s95, s32, 7168
  s_add_u32 s95, s95, s92
  s_add_u32 s95, s95, 0x0
  s_waitcnt vmcnt(0)
  s_cmp_eq_u32 s32, 2
  s_cbranch_scc1 E3_10
  buffer_store_dwordx4 v[88:91], v1, s[4:7], s95 offen offset:0 sc1
  buffer_store_dwordx4 v[92:95], v1, s[4:7], s95 offen offset:1024 sc1
  buffer_store_dwordx4 v[96:99], v1, s[4:7], s95 offen offset:2048 sc1
  buffer_store_dwordx4 v[100:103], v1, s[4:7], s95 offen offset:3072 sc1
  s_add_u32 s95, s95, 4096
  buffer_store_dwordx4 v[104:107], v1, s[4:7], s95 offen offset:0 sc1
  buffer_store_dwordx4 v[108:111], v1, s[4:7], s95 offen offset:1024 sc1
  buffer_store_dwordx4 v[112:115], v1, s[4:7], s95 offen offset:2048 sc1
  s_branch E4_11
E3_10:
  buffer_store_dwordx4 v[88:91], v1, s[4:7], s95 offen offset:0 sc1
  buffer_store_dwordx4 v[92:95], v1, s[4:7], s95 offen offset:1024 sc1
  buffer_store_dwordx2 v[96:97], v70, s[4:7], s95 offen offset:2048 sc1
  buffer_store_dwordx2 v[98:99], v70, s[4:7], s95 offen offset:2560 sc1
  buffer_store_dwordx2 v[100:101], v70, s[4:7], s95 offen offset:3072 sc1
  buffer_store_dwordx2 v[102:103], v70, s[4:7], s95 offen offset:3584 sc1
  s_add_u32 s95, s95, 4096
  buffer_store_dwordx2 v[104:105], v70, s[4:7], s95 offen offset:0 sc1
  buffer_store_dwordx2 v[106:107], v70, s[4:7], s95 offen offset:512 sc1
  buffer_store_dwordx2 v[108:109], v70, s[4:7], s95 offen offset:1024 sc1
  buffer_store_dwordx2 v[110:111], v70, s[4:7], s95 offen offset:1536 sc1
  v_mov_b32 v112, 0
  v_mov_b32 v113, 0
  v_mov_b32 v114, 0
  v_mov_b32 v115, 0
E4_11:
  v_mov_b32 v56, 0
  v_mov_b32 v60, 0
  v_mov_b32 v57, 0
  v_mov_b32 v61, 0
  v_mov_b32 v58, 0
  v_mov_b32 v62, 0
  v_mov_b32 v59, 0
  v_mov_b32 v63, 0
  v_dot2_f32_bf16 v56, v88, v67, v56
  v_dot2_f32_bf16 v60, v88, v88, v60
  v_dot2_f32_bf16 v57, v89, v67, v57
  v_dot2_f32_bf16 v61, v89, v89, v61
  v_dot2_f32_bf16 v58, v90, v67, v58
  v_dot2_f32_bf16 v62, v90, v90, v62
  v_dot2_f32_bf16 v59, v91, v67, v59
  v_dot2_f32_bf16 v63, v91, v91, v63
  v_dot2_f32_bf16 v56, v92, v67, v56
  v_dot2_f32_bf16 v60, v92, v92, v60
  v_dot2_f32_bf16 v57, v93, v67, v57
  v_dot2_f32_bf16 v61, v93, v93, v61
  v_dot2_f32_bf16 v58, v94, v67, v58
  v_dot2_f32_bf16 v62, v94, v94, v62
  v_dot2_f32_bf16 v59, v95, v67, v59
  v_dot2_f32_bf16 v63, v95, v95, v63
  v_dot2_f32_bf16 v56, v96, v67, v56
  v_dot2_f32_bf16 v60, v96, v96, v60
  v_dot2_f32_bf16 v57, v97, v67, v57
  v_dot2_f32_bf16 v61, v97, v97, v61
  v_dot2_f32_bf16 v58, v98, v67, v58
  v_dot2_f32_bf16 v62, v98, v98, v62
  v_dot2_f32_bf16 v59, v99, v67, v59
  v_dot2_f32_bf16 v63, v99, v99, v63
  v_dot2_f32_bf16 v56, v100, v67, v56
  v_dot2_f32_bf16 v60, v100, v100, v60
  v_dot2_f32_bf16 v57, v101, v67, v57
  v_dot2_f32_bf16 v61, v101, v101, v61
  v_dot2_f32_bf16 v58, v102, v67, v58
  v_dot2_f32_bf16 v62, v102, v102, v62
  v_dot2_f32_bf16 v59, v103, v67, v59
  v_dot2_f32_bf16 v63, v103, v103, v63
  v_dot2_f32_bf16 v56, v104, v67, v56
  v_dot2_f32_bf16 v60, v104, v104, v60
  v_dot2_f32_bf16 v57, v105, v67, v57
  v_dot2_f32_bf16 v61, v105, v105, v61
  v_dot2_f32_bf16 v58, v106, v67, v58
  v_dot2_f32_bf16 v62, v106, v106, v62
  v_dot2_f32_bf16 v59, v107, v67, v59
  v_dot2_f32_bf16 v63, v107, v107, v63
  v_dot2_f32_bf16 v56, v108, v67, v56
  v_dot2_f32_bf16 v60, v108, v108, v60
  v_dot2_f32_bf16 v57, v109, v67, v57
  v_dot2_f32_bf16 v61, v109, v109, v61
  v_dot2_f32_bf16 v58, v110, v67, v58
  v_dot2_f32_bf16 v62, v110, v110, v62
  v_dot2_f32_bf16 v59, v111, v67, v59
  v_dot2_f32_bf16 v63, v111, v111, v63
  v_dot2_f32_bf16 v56, v112, v67, v56
  v_dot2_f32_bf16 v60, v112, v112, v60
  v_dot2_f32_bf16 v57, v113, v67, v57
  v_dot2_f32_bf16 v61, v113, v113, v61
  v_dot2_f32_bf16 v58, v114, v67, v58
  v_dot2_f32_bf16 v62, v114, v114, v62
  v_dot2_f32_bf16 v59, v115, v67, v59
  v_dot2_f32_bf16 v63, v115, v115, v63
  v_add_f32 v56, v56, v57
  s_nop 0
  v_add_f32 v58, v58, v59
  v_add_f32 v64, v56, v58
  v_add_f32 v60, v60, v61
  v_add_f32 v62, v62, v63
  v_add_f32 v65, v60, v62
  v_mov_b32 v66, v64
  s_nop 1
  v_permlane32_swap_b32 v64, v66
  v_add_f32 v64, v64, v66
  v_mov_b32 v66, v64
  s_nop 1
  v_permlane16_swap_b32 v64, v66
  v_add_f32 v64, v64, v66
  v_mov_b32 v66, v65
  s_nop 1
  v_permlane32_swap_b32 v65, v66
  v_add_f32 v65, v65, v66
  v_mov_b32 v66, v65
  s_nop 1
  v_permlane16_swap_b32 v65, v66
  v_add_f32 v65, v65, v66
  v_cmp_eq_u32 vcc, 0, v5
  s_nop 1
  v_cndmask_b32 v64, 0, v64, vcc
  v_cndmask_b32 v65, 0, v65, vcc
  s_lshl_b32 s95, s31, 10
  s_lshl_b32 s17, s32, 8
  s_add_u32 s95, s95, s17
  s_add_u32 s95, s95, 0xc00000
  s_cmp_eq_u32 s32, 2
  s_cselect_b32 exec_hi, -1, 0
  buffer_store_dwordx2 v[64:65], v70, s[4:7], s95 offen sc1
  s_mov_b64 exec, -1
  s_waitcnt vmcnt(0)
tD_3:
  s_nop 15
  s_nop 3
  s_mov_b32 s36, s36
  s_and_b32 s37, s37, 0xffff
  s_mov_b32 s38, 0xd80
  s_mov_b32 s39, 0x20000
  s_mov_b32 s40, s40
  s_and_b32 s41, s41, 0xffff
  s_mov_b32 s42, 0x500
  s_mov_b32 s43, 0x20000
  s_mov_b32 s44, s44
  s_and_b32 s45, s45, 0xffff
  s_mov_b32 s46, 0x280000
  s_mov_b32 s47, 0x20000
  v_readfirstlane_b32 s68, v87
  s_nop 3
  s_add_u32 s68, s68, 1
  s_barrier
  s_cmp_lg_u32 s8, 0
  s_cbranch_scc1 flg_12
  s_lshl_b32 s17, s2, 2
  s_add_u32 s17, s17, 0xd80000
  s_mov_b32 s19, s68
  v_lshlrev_b32 v7, 10, v0
  v_mov_b32 v8, s19
  s_mov_b64 exec, 0xf
  buffer_store_dword v8, v7, s[4:7], s17 offen sc1
  s_mov_b64 exec, -1
flg_12:
  v_add_u32 v2, 0x10000, v1
  v_add_u32 v3, 0x20000, v1
  s_and_b32 s17, s2, 7
  s_lshr_b32 s18, s2, 3
  s_lshr_b32 s19, s17, 1
  s_and_b32 s17, s17, 1
  s_lshl_b32 s19, s19, 2
  s_and_b32 s3, s18, 3
  s_add_u32 s9, s19, s3
  s_lshr_b32 s13, s18, 2
  s_lshl_b32 s3, s17, 3
  s_add_u32 s10, s3, s13
  s_lshl_b32 s3, s9, 1
  s_add_u32 s12, s3, s17
  s_lshl_b32 s59, s9, 3
  s_lshl_b32 s3, s8, 1
  s_add_u32 s59, s59, s3
  s_lshl_b32 s60, s12, 2
  s_add_u32 s60, s60, s8
  s_lshl_b32 s61, s8, 10
  s_mov_b32 s58, 0
  s_mul_i32 s62, s13, 286720
  s_mul_i32 s17, s8, 5120
  s_add_u32 s62, s62, s17
  s_add_u32 s62, s62, 0x1500000
  v_lshlrev_b32 v64, 3, v5
  v_sub_u32 v64, v4, v64
  v_mov_b32 v76, 0
  v_mov_b32 v65, 0x3f80
  v_cmp_eq_u32 vcc, 0, v64
  s_nop 1
  v_cndmask_b32 v76, v76, v65, vcc
  v_mov_b32 v65, 0x3f800000
  v_cmp_eq_u32 vcc, 1, v64
  s_nop 1
  v_cndmask_b32 v76, v76, v65, vcc
  v_mov_b32 v77, 0
  v_mov_b32 v65, 0x3f80
  v_cmp_eq_u32 vcc, 2, v64
  s_nop 1
  v_cndmask_b32 v77, v77, v65, vcc
  v_mov_b32 v65, 0x3f800000
  v_cmp_eq_u32 vcc, 3, v64
  s_nop 1
  v_cndmask_b32 v77, v77, v65, vcc
  v_mov_b32 v78, 0
  v_mov_b32 v65, 0x3f80
  v_cmp_eq_u32 vcc, 4, v64
  s_nop 1
  v_cndmask_b32 v78, v78, v65, vcc
  v_mov_b32 v65, 0x3f800000
  v_cmp_eq_u32 vcc, 5, v64
  s_nop 1
  v_cndmask_b32 v78, v78, v65, vcc
  v_mov_b32 v79, 0
  v_mov_b32 v65, 0x3f80
  v_cmp_eq_u32 vcc, 6, v64
  s_nop 1
  v_cndmask_b32 v79, v79, v65, vcc
  v_mov_b32 v65, 0x3f800000
  v_cmp_eq_u32 vcc, 7, v64
  s_nop 1
  v_cndmask_b32 v79, v79, v65, vcc
  v_lshlrev_b32 v64, 3, v5
  v_sub_u32 v64, v4, v64
  v_add_u32 v64, 16, v64
  v_mov_b32 v80, 0
  v_mov_b32 v65, 0x3f80
  v_cmp_eq_u32 vcc, 0, v64
  s_nop 1
  v_cndmask_b32 v80, v80, v65, vcc
  v_mov_b32 v65, 0x3f800000
  v_cmp_eq_u32 vcc, 1, v64
  s_nop 1
  v_cndmask_b32 v80, v80, v65, vcc
  v_mov_b32 v81, 0
  v_mov_b32 v65, 0x3f80
  v_cmp_eq_u32 vcc, 2, v64
  s_nop 1
  v_cndmask_b32 v81, v81, v65, vcc
  v_mov_b32 v65, 0x3f800000
  v_cmp_eq_u32 vcc, 3, v64
  s_nop 1
  v_cndmask_b32 v81, v81, v65, vcc
  v_mov_b32 v82, 0
  v_mov_b32 v65, 0x3f80
  v_cmp_eq_u32 vcc, 4, v64
  s_nop 1
  v_cndmask_b32 v82, v82, v65, vcc
  v_mov_b32 v65, 0x3f800000
  v_cmp_eq_u32 vcc, 5, v64
  s_nop 1
  v_cndmask_b32 v82, v82, v65, vcc
  v_mov_b32 v83, 0
  v_mov_b32 v65, 0x3f80
  v_cmp_eq_u32 vcc, 6, v64
  s_nop 1
  v_cndmask_b32 v83, v83, v65, vcc
  v_mov_b32 v65, 0x3f800000
  v_cmp_eq_u32 vcc, 7, v64
  s_nop 1
  v_cndmask_b32 v83, v83, v65, vcc
  v_accvgpr_write_b32 a240, v76
  v_accvgpr_write_b32 a241, v77
  v_accvgpr_write_b32 a242, v78
  v_accvgpr_write_b32 a243, v79
  v_accvgpr_write_b32 a244, v80
  v_accvgpr_write_b32 a245, v81
  v_accvgpr_write_b32 a246, v82
  v_accvgpr_write_b32 a247, v83
  v_mov_b32 v64, 0x3f803f80
  v_accvgpr_write_b32 a228, v64
  v_accvgpr_write_b32 a229, v64
  v_accvgpr_write_b32 a230, v64
  v_accvgpr_write_b32 a231, v64
  s_and_b32 s28, s2, 7
  s_lshr_b32 s29, s2, 3
  s_mov_b32 s97, 0
  s_cmp_lt_u32 s29, 8
  s_cbranch_scc1 aux_13_B
  s_cmp_lt_u32 s29, 26
  s_cbranch_scc1 aux_13_C
  s_sub_u32 s30, s29, 26
  s_mul_i32 s31, s30, 43
  s_lshr_b32 s31, s31, 7
  s_mul_i32 s32, s31, 3
  s_sub_u32 s32, s30, s32
  s_and_b32 s34, s28, 6
  s_add_u32 s34, s34, s31
  s_and_b32 s33, s28, 1
  s_mov_b32 s72, s84
  s_and_b32 s73, s85, 0xffff
  s_mov_b32 s74, 0xc8000
  s_mov_b32 s75, 0x20000
  s_mul_i32 s35, s34, 160
  s_lshl_b32 s3, s32, 6
  s_add_u32 s35, s35, s3
  v_and_b32 v64, 3, v4
  v_lshrrev_b32 v65, 2, v4
  v_mul_u32_u24 v65, 10, v65
  v_add_u32 v66, v65, v64
  v_and_b32 v67, 1, v64
  v_add3_u32 v67, v67, v65, 8
  v_lshrrev_b32 v64, 1, v64
  v_mul_u32_u24 v64, 40, v64
  v_add_u32 v67, v67, v64
  v_mul_u32_u24 v66, 1280, v66
  v_lshl_add_u32 v66, v5, 4, v66
  v_mul_u32_u24 v67, 1280, v67
  v_lshl_add_u32 v67, v5, 4, v67
  s_add_u32 s18, s8, 0
  s_mul_i32 s17, s33, 10
  s_add_u32 s17, s17, s18
  s_mul_i32 s19, s17, 40
  s_add_u32 s20, s19, 4
  s_sub_u32 s3, s17, 16
  s_mul_i32 s3, s3, 160
  s_add_u32 s31, s3, 80
  s_cmp_lt_u32 s17, 16
  s_cselect_b32 s19, s19, s3
  s_cselect_b32 s20, s20, s31
  s_cselect_b64 vcc, -1, 0
  v_cndmask_b32 v84, v67, v66, vcc
  s_mul_i32 s19, s19, 1280
  s_add_u32 s19, s19, s35
  s_mul_i32 s20, s20, 1280
  s_add_u32 s20, s20, s35
  s_mul_i32 s3, s34, 102400
  s_mul_i32 s17, s17, 5120
  s_add_u32 s3, s3, s17
  s_lshl_b32 s17, s32, 11
  s_add_u32 s3, s3, s17
  s_add_u32 s3, s3, 0x1100000
  s_cmp_lt_u32 s18, 10
  s_cselect_b32 s80, s19, 0x40000000
  s_cselect_b32 s81, s20, 0x40000000
  s_cselect_b32 s76, s3, 0x40000000
  s_add_u32 s18, s8, 4
  s_mul_i32 s17, s33, 10
  s_add_u32 s17, s17, s18
  s_mul_i32 s19, s17, 40
  s_add_u32 s20, s19, 4
  s_sub_u32 s3, s17, 16
  s_mul_i32 s3, s3, 160
  s_add_u32 s31, s3, 80
  s_cmp_lt_u32 s17, 16
  s_cselect_b32 s19, s19, s3
  s_cselect_b32 s20, s20, s31
  s_cselect_b64 vcc, -1, 0
  v_cndmask_b32 v85, v67, v66, vcc
  s_mul_i32 s19, s19, 1280
  s_add_u32 s19, s19, s35
  s_mul_i32 s20, s20, 1280
  s_add_u32 s20, s20, s35
  s_mul_i32 s3, s34, 102400
  s_mul_i32 s17, s17, 5120
  s_add_u32 s3, s3, s17
  s_lshl_b32 s17, s32, 11
  s_add_u32 s3, s3, s17
  s_add_u32 s3, s3, 0x1100000
  s_cmp_lt_u32 s18, 10
  s_cselect_b32 s82, s19, 0x40000000
  s_cselect_b32 s83, s20, 0x40000000
  s_cselect_b32 s77, s3, 0x40000000
  s_add_u32 s18, s8, 8
  s_mul_i32 s17, s33, 10
  s_add_u32 s17, s17, s18
  s_mul_i32 s19, s17, 40
  s_add_u32 s20, s19, 4
  s_sub_u32 s3, s17, 16
  s_mul_i32 s3, s3, 160
  s_add_u32 s31, s3, 80
  s_cmp_lt_u32 s17, 16
  s_cselect_b32 s19, s19, s3
  s_cselect_b32 s20, s20, s31
  s_cselect_b64 vcc, -1, 0
  v_cndmask_b32 v86, v67, v66, vcc
  s_mul_i32 s19, s19, 1280
  s_add_u32 s19, s19, s35
  s_mul_i32 s20, s20, 1280
  s_add_u32 s20, s20, s35
  s_mul_i32 s3, s34, 102400
  s_mul_i32 s17, s17, 5120
  s_add_u32 s3, s3, s17
  s_lshl_b32 s17, s32, 11
  s_add_u32 s3, s3, s17
  s_add_u32 s3, s3, 0x1100000
  s_cmp_lt_u32 s18, 10
  s_cselect_b32 s84, s19, 0x40000000
  s_cselect_b32 s85, s20, 0x40000000
  s_cselect_b32 s78, s3, 0x40000000
  s_cmp_eq_u32 s32, 2
  s_cselect_b32 s95, 0x40000000, 0
  s_branch aux_13_E
aux_13_C:
  s_sub_u32 s30, s29, 8
  s_mul_i32 s31, s30, 43
  s_lshr_b32 s31, s31, 7
  s_mul_i32 s32, s31, 3
  s_sub_u32 s32, s30, s32
  s_and_b32 s34, s31, 1
  s_and_b32 s35, s28, 6
  s_add_u32 s34, s34, s35
  s_lshr_b32 s33, s31, 1
  s_and_b32 s35, s28, 1
  s_mul_i32 s35, s35, 3
  s_add_u32 s33, s33, s35
  s_mov_b32 s72, s88
  s_and_b32 s73, s89, 0xffff
  s_mov_b32 s74, 0x21c000
  s_mov_b32 s75, 0x20000
  v_mul_u32_u24 v84, 1280, v4
  v_lshl_add_u32 v84, v5, 4, v84
  v_mov_b32 v85, v84
  v_mov_b32 v86, v84
  s_mul_i32 s35, s34, 160
  s_lshl_b32 s3, s32, 6
  s_add_u32 s35, s35, s3
  s_add_u32 s18, s8, 0
  s_mul_i32 s17, s33, 9
  s_add_u32 s17, s17, s18
  s_mul_i32 s19, s17, 43
  s_lshr_b32 s19, s19, 7
  s_mul_i32 s20, s19, 3
  s_sub_u32 s20, s17, s20
  s_and_b32 s3, s19, 7
  s_mul_i32 s3, s3, 7
  s_min_u32 s3, s3, 48
  s_lshr_b32 s31, s19, 3
  s_mul_i32 s31, s31, 54
  s_add_u32 s3, s3, s31
  s_lshl_b32 s31, s20, 1
  s_add_u32 s3, s3, s31
  s_sub_u32 s31, s19, 16
  s_mul_i32 s31, s31, 54
  s_mul_i32 s20, s20, 14
  s_add_u32 s31, s31, s20
  s_add_u32 s31, s31, 6
  s_cmp_ge_u32 s17, 48
  s_cselect_b32 s19, s31, s3
  s_cselect_b32 s20, 7, 1
  s_add_u32 s20, s20, s19
  s_mul_i32 s19, s19, 20480
  s_add_u32 s19, s19, s35
  s_mul_i32 s20, s20, 20480
  s_add_u32 s20, s20, s35
  s_mul_i32 s3, s34, 286720
  s_mul_i32 s17, s17, 5120
  s_add_u32 s3, s3, s17
  s_lshl_b32 s17, s32, 11
  s_add_u32 s3, s3, s17
  s_add_u32 s3, s3, 0x1500000
  s_cmp_lt_u32 s18, 9
  s_cselect_b32 s80, s19, 0x40000000
  s_cselect_b32 s81, s20, 0x40000000
  s_cselect_b32 s76, s3, 0x40000000
  s_add_u32 s18, s8, 4
  s_mul_i32 s17, s33, 9
  s_add_u32 s17, s17, s18
  s_mul_i32 s19, s17, 43
  s_lshr_b32 s19, s19, 7
  s_mul_i32 s20, s19, 3
  s_sub_u32 s20, s17, s20
  s_and_b32 s3, s19, 7
  s_mul_i32 s3, s3, 7
  s_min_u32 s3, s3, 48
  s_lshr_b32 s31, s19, 3
  s_mul_i32 s31, s31, 54
  s_add_u32 s3, s3, s31
  s_lshl_b32 s31, s20, 1
  s_add_u32 s3, s3, s31
  s_sub_u32 s31, s19, 16
  s_mul_i32 s31, s31, 54
  s_mul_i32 s20, s20, 14
  s_add_u32 s31, s31, s20
  s_add_u32 s31, s31, 6
  s_cmp_ge_u32 s17, 48
  s_cselect_b32 s19, s31, s3
  s_cselect_b32 s20, 7, 1
  s_add_u32 s20, s20, s19
  s_mul_i32 s19, s19, 20480
  s_add_u32 s19, s19, s35
  s_mul_i32 s20, s20, 20480
  s_add_u32 s20, s20, s35
  s_mul_i32 s3, s34, 286720
  s_mul_i32 s17, s17, 5120
  s_add_u32 s3, s3, s17
  s_lshl_b32 s17, s32, 11
  s_add_u32 s3, s3, s17
  s_add_u32 s3, s3, 0x1500000
  s_cmp_lt_u32 s18, 9
  s_cselect_b32 s82, s19, 0x40000000
  s_cselect_b32 s83, s20, 0x40000000
  s_cselect_b32 s77, s3, 0x40000000
  s_add_u32 s18, s8, 8
  s_mul_i32 s17, s33, 9
  s_add_u32 s17, s17, s18
  s_mul_i32 s19, s17, 43
  s_lshr_b32 s19, s19, 7
  s_mul_i32 s20, s19, 3
  s_sub_u32 s20, s17, s20
  s_and_b32 s3, s19, 7
  s_mul_i32 s3, s3, 7
  s_min_u32 s3, s3, 48
  s_lshr_b32 s31, s19, 3
  s_mul_i32 s31, s31, 54
  s_add_u32 s3, s3, s31
  s_lshl_b32 s31, s20, 1
  s_add_u32 s3, s3, s31
  s_sub_u32 s31, s19, 16
  s_mul_i32 s31, s31, 54
  s_mul_i32 s20, s20, 14
  s_add_u32 s31, s31, s20
  s_add_u32 s31, s31, 6
  s_cmp_ge_u32 s17, 48
  s_cselect_b32 s19, s31, s3
  s_cselect_b32 s20, 7, 1
  s_add_u32 s20, s20, s19
  s_mul_i32 s19, s19, 20480
  s_add_u32 s19, s19, s35
  s_mul_i32 s20, s20, 20480
  s_add_u32 s20, s20, s35
  s_mul_i32 s3, s34, 286720
  s_mul_i32 s17, s17, 5120
  s_add_u32 s3, s3, s17
  s_lshl_b32 s17, s32, 11
  s_add_u32 s3, s3, s17
  s_add_u32 s3, s3, 0x1500000
  s_cmp_lt_u32 s18, 9
  s_cselect_b32 s84, s19, 0x40000000
  s_cselect_b32 s85, s20, 0x40000000
  s_cselect_b32 s78, s3, 0x40000000
  s_cmp_eq_u32 s32, 2
  s_cselect_b32 s95, 0x40000000, 0
  s_branch aux_13_E
aux_13_B:
  s_mov_b32 s97, 1
  s_lshr_b32 s31, s29, 2
  s_lshl_b32 s34, s28, 1
  s_add_u32 s31, s31, s34
  s_and_b32 s32, s29, 3
  s_and_b32 s34, s31, 7
  s_mul_i32 s35, s34, 7
  s_min_u32 s35, s35, 48
  s_lshr_b32 s34, s31, 3
  s_mul_i32 s34, s34, 54
  s_add_u32 s35, s35, s34
  s_lshl_b32 s34, s32, 1
  s_add_u32 s35, s35, s34
  s_lshl_b32 s35, s35, 5
  s_mov_b32 s72, s86
  s_and_b32 s73, s87, 0xffff
  s_mov_b32 s74, 0x21c000
  s_mov_b32 s75, 0x20000
  v_mul_u32_u24 v84, 3456, v4
  v_lshl_add_u32 v84, v5, 4, v84
  v_mov_b32 v85, v84
  v_mov_b32 v86, v84
  s_mul_i32 s17, s8, 5
  s_add_u32 s17, s17, 0
  s_lshr_b32 s19, s17, 1
  s_mul_i32 s19, s19, 5
  s_and_b32 s20, s17, 1
  s_lshl_b32 s20, s20, 1
  s_add_u32 s19, s19, s20
  s_sub_u32 s20, s17, 16
  s_mul_i32 s20, s20, 10
  s_add_u32 s20, s20, 4
  s_cmp_ge_u32 s17, 16
  s_cselect_b32 s19, s20, s19
  s_cselect_b32 s20, 5, 1
  s_add_u32 s20, s20, s19
  s_mul_i32 s19, s19, 55296
  s_add_u32 s80, s19, s35
  s_mul_i32 s20, s20, 55296
  s_add_u32 s81, s20, s35
  s_mul_i32 s3, s31, 143360
  s_mul_i32 s17, s17, 7168
  s_add_u32 s3, s3, s17
  s_lshl_b32 s17, s32, 11
  s_add_u32 s3, s3, s17
  s_add_u32 s76, s3, 0x1200000
  s_mul_i32 s17, s8, 5
  s_add_u32 s17, s17, 1
  s_lshr_b32 s19, s17, 1
  s_mul_i32 s19, s19, 5
  s_and_b32 s20, s17, 1
  s_lshl_b32 s20, s20, 1
  s_add_u32 s19, s19, s20
  s_sub_u32 s20, s17, 16
  s_mul_i32 s20, s20, 10
  s_add_u32 s20, s20, 4
  s_cmp_ge_u32 s17, 16
  s_cselect_b32 s19, s20, s19
  s_cselect_b32 s20, 5, 1
  s_add_u32 s20, s20, s19
  s_mul_i32 s19, s19, 55296
  s_add_u32 s82, s19, s35
  s_mul_i32 s20, s20, 55296
  s_add_u32 s83, s20, s35
  s_mul_i32 s3, s31, 143360
  s_mul_i32 s17, s17, 7168
  s_add_u32 s3, s3, s17
  s_lshl_b32 s17, s32, 11
  s_add_u32 s3, s3, s17
  s_add_u32 s77, s3, 0x1200000
  s_mul_i32 s17, s8, 5
  s_add_u32 s17, s17, 2
  s_lshr_b32 s19, s17, 1
  s_mul_i32 s19, s19, 5
  s_and_b32 s20, s17, 1
  s_lshl_b32 s20, s20, 1
  s_add_u32 s19, s19, s20
  s_sub_u32 s20, s17, 16
  s_mul_i32 s20, s20, 10
  s_add_u32 s20, s20, 4
  s_cmp_ge_u32 s17, 16
  s_cselect_b32 s19, s20, s19
  s_cselect_b32 s20, 5, 1
  s_add_u32 s20, s20, s19
  s_mul_i32 s19, s19, 55296
  s_add_u32 s84, s19, s35
  s_mul_i32 s20, s20, 55296
  s_add_u32 s85, s20, s35
  s_mul_i32 s3, s31, 143360
  s_mul_i32 s17, s17, 7168
  s_add_u32 s3, s3, s17
  s_lshl_b32 s17, s32, 11
  s_add_u32 s3, s3, s17
  s_add_u32 s78, s3, 0x1200000
  s_mul_i32 s17, s8, 5
  s_add_u32 s17, s17, 3
  s_lshr_b32 s19, s17, 1
  s_mul_i32 s19, s19, 5
  s_and_b32 s20, s17, 1
  s_lshl_b32 s20, s20, 1
  s_add_u32 s19, s19, s20
  s_sub_u32 s20, s17, 16
  s_mul_i32 s20, s20, 10
  s_add_u32 s20, s20, 4
  s_cmp_ge_u32 s17, 16
  s_cselect_b32 s19, s20, s19
  s_cselect_b32 s20, 5, 1
  s_add_u32 s20, s20, s19
  s_mul_i32 s19, s19, 55296
  s_add_u32 s86, s19, s35
  s_mul_i32 s20, s20, 55296
  s_add_u32 s87, s20, s35
  s_mul_i32 s3, s31, 143360
  s_mul_i32 s17, s17, 7168
  s_add_u32 s3, s3, s17
  s_lshl_b32 s17, s32, 11
  s_add_u32 s3, s3, s17
  s_add_u32 s79, s3, 0x1200000
  s_mul_i32 s17, s8, 5
  s_add_u32 s17, s17, 4
  s_lshr_b32 s19, s17, 1
  s_mul_i32 s19, s19, 5
  s_and_b32 s20, s17, 1
  s_lshl_b32 s20, s20, 1
  s_add_u32 s19, s19, s20
  s_sub_u32 s20, s17, 16
  s_mul_i32 s20, s20, 10
  s_add_u32 s20, s20, 4
  s_cmp_ge_u32 s17, 16
  s_cselect_b32 s19, s20, s19
  s_cselect_b32 s20, 5, 1
  s_add_u32 s20, s20, s19
  s_mul_i32 s19, s19, 55296
  s_add_u32 s88, s19, s35
  s_mul_i32 s20, s20, 55296
  s_add_u32 s89, s20, s35
  s_mul_i32 s3, s31, 143360
  s_mul_i32 s17, s17, 7168
  s_add_u32 s3, s3, s17
  s_lshl_b32 s17, s32, 11
  s_add_u32 s3, s3, s17
  s_add_u32 s92, s3, 0x1200000
  s_cmp_eq_u32 s32, 3
  s_cselect_b32 s95, 0x40000000, 0
  s_branch aux_13_F
aux_13_E:
  s_mov_b32 s86, 0x40000000
  s_mov_b32 s87, 0x40000000
  s_mov_b32 s79, 0x40000000
  s_mov_b32 s88, 0x40000000
  s_mov_b32 s89, 0x40000000
  s_mov_b32 s92, 0x40000000
aux_13_F:
  s_nop 15
  s_nop 3
  v_accvgpr_write_b32 a224, v84
  v_accvgpr_write_b32 a225, v85
  v_accvgpr_write_b32 a226, v86
  buffer_load_dwordx4 a[160:163], v84, s[72:75], s80 offen
  buffer_load_dwordx4 a[164:167], v84, s[72:75], s81 offen
  buffer_load_dwordx4 a[168:171], v85, s[72:75], s82 offen
  buffer_load_dwordx4 a[172:175], v85, s[72:75], s83 offen
  buffer_load_dwordx4 a[176:179], v86, s[72:75], s84 offen
  buffer_load_dwordx4 a[180:183], v86, s[72:75], s85 offen
  buffer_load_dwordx4 a[184:187], v84, s[72:75], s86 offen
  buffer_load_dwordx4 a[188:191], v84, s[72:75], s87 offen
  buffer_load_dwordx4 a[192:195], v84, s[72:75], s88 offen
  buffer_load_dwordx4 a[196:199], v84, s[72:75], s89 offen
  s_cmp_lg_u32 s8, 0
  s_cbranch_scc1 fw_14
  s_mov_b32 s18, 0
  s_and_b32 s17, s2, 3
  s_lshl_b32 s17, s17, 10
  s_add_u32 s17, s17, 0xd80000
fpoll_15:
  buffer_load_dwordx4 v[8:11], v1, s[4:7], s17 offen sc1
  s_waitcnt vmcnt(0)
  v_xor_b32 v8, s68, v8
  v_xor_b32 v9, s68, v9
  v_xor_b32 v10, s68, v10
  v_xor_b32 v11, s68, v11
  v_or3_b32 v8, v8, v9, v10
  v_or_b32 v8, v8, v11
  v_cmp_ne_u32 vcc, 0, v8
  s_nop 3
  s_cmp_eq_u64 vcc, 0
  s_cbranch_scc1 fdone_16
  s_add_u32 s18, s18, 1
  s_cmp_lt_u32 s18, 0x20000
  s_cbranch_scc1 fpoll_15
  s_mov_b32 s58, 1
fdone_16:
fw_14:
  s_barrier
  s_mov_b32 s48, 0x0
  s_mov_b32 s49, 0x300000
  s_mov_b32 s50, 0x600000
  s_mov_b32 s51, 0xc00000
  s_mov_b32 s52, 0xc20000
  s_mov_b32 s53, 0xc40000
  s_mov_b32 s54, 0x1900000
  s_mov_b32 s55, 0x2000000
  s_mov_b32 s56, 0x1800000
  s_mov_b32 s57, 0xd00000
  s_mul_i32 s21, s59, 20480
  s_add_u32 s21, s21, s48
  s_add_u32 s22, s21, 20480
  s_mul_i32 s33, s10, 163840
  s_add_u32 s33, s33, s61
  s_add_u32 s33, s33, 0xe00000
  s_add_u32 s17, s33, 0
  buffer_load_dwordx4 a[0:3], v1, s[4:7], s17 offen sc1
  s_add_u32 s17, s33, 4096
  buffer_load_dwordx4 a[4:7], v1, s[4:7], s17 offen sc1
  s_add_u32 s17, s33, 8192
  buffer_load_dwordx4 a[8:11], v1, s[4:7], s17 offen sc1
  s_add_u32 s17, s33, 12288
  buffer_load_dwordx4 a[12:15], v1, s[4:7], s17 offen sc1
  s_add_u32 s17, s33, 16384
  buffer_load_dwordx4 a[16:19], v1, s[4:7], s17 offen sc1
  s_add_u32 s17, s33, 20480
  buffer_load_dwordx4 a[20:23], v1, s[4:7], s17 offen sc1
  s_add_u32 s17, s33, 24576
  buffer_load_dwordx4 a[24:27], v1, s[4:7], s17 offen sc1
  s_waitcnt vmcnt(7)
  v_lshlrev_b32 v64, 2, v0
  v_accvgpr_read_b32 v24, a240
  v_accvgpr_read_b32 v25, a241
  v_accvgpr_read_b32 v26, a242
  v_accvgpr_read_b32 v27, a243
  v_accvgpr_read_b32 v28, a244
  v_accvgpr_read_b32 v29, a245
  v_accvgpr_read_b32 v30, a246
  v_accvgpr_read_b32 v31, a247
  s_cmp_eq_u32 s97, 0
  s_cbranch_scc1 nb_17
  v_add_u32 v64, 0x1a000, v64
  s_lshl_b32 s17, s8, 9
  v_add_u32 v65, s17, v64
  v_mfma_f32_16x16x32_bf16 v[32:35], a[160:163], v[24:27], 0
  v_mfma_f32_16x16x32_bf16 v[36:39], a[164:167], v[24:27], 0
  v_mfma_f32_16x16x32_bf16 v[40:43], a[160:163], v[28:31], 0
  v_mfma_f32_16x16x32_bf16 v[44:47], a[164:167], v[28:31], 0
  v_mfma_f32_16x16x32_bf16 v[32:35], a[168:171], v[24:27], v[32:35]
  v_mfma_f32_16x16x32_bf16 v[36:39], a[172:175], v[24:27], v[36:39]
  v_mfma_f32_16x16x32_bf16 v[40:43], a[168:171], v[28:31], v[40:43]
  v_mfma_f32_16x16x32_bf16 v[44:47], a[172:175], v[28:31], v[44:47]
  v_mfma_f32_16x16x32_bf16 v[32:35], a[176:179], v[24:27], v[32:35]
  v_mfma_f32_16x16x32_bf16 v[36:39], a[180:183], v[24:27], v[36:39]
  v_mfma_f32_16x16x32_bf16 v[40:43], a[176:179], v[28:31], v[40:43]
  v_mfma_f32_16x16x32_bf16 v[44:47], a[180:183], v[28:31], v[44:47]
  v_mfma_f32_16x16x32_bf16 v[32:35], a[184:187], v[24:27], v[32:35]
  v_mfma_f32_16x16x32_bf16 v[36:39], a[188:191], v[24:27], v[36:39]
  v_mfma_f32_16x16x32_bf16 v[40:43], a[184:187], v[28:31], v[40:43]
  v_mfma_f32_16x16x32_bf16 v[44:47], a[188:191], v[28:31], v[44:47]
  v_mfma_f32_16x16x32_bf16 v[32:35], a[192:195], v[24:27], v[32:35]
  v_mfma_f32_16x16x32_bf16 v[36:39], a[196:199], v[24:27], v[36:39]
  v_mfma_f32_16x16x32_bf16 v[40:43], a[192:195], v[28:31], v[40:43]
  v_mfma_f32_16x16x32_bf16 v[44:47], a[196:199], v[28:31], v[44:47]
  s_nop 4
  v_add_f32 v32, v32, v33
  v_add_f32 v34, v34, v35
  v_add_f32 v36, v36, v37
  v_add_f32 v38, v38, v39
  v_add_f32 v40, v40, v41
  v_add_f32 v42, v42, v43
  v_add_f32 v44, v44, v45
  v_add_f32 v46, v46, v47
  v_add_f32 v32, v32, v34
  v_add_f32 v36, v36, v38
  v_add_f32 v40, v40, v42
  v_add_f32 v44, v44, v46
  v_add_f32 v32, v32, v36
  v_add_f32 v40, v40, v44
  v_mov_b32 v33, v32
  v_mov_b32 v41, v40
  s_nop 0
  v_permlane32_swap_b32 v32, v33
  v_permlane32_swap_b32 v40, v41
  v_add_f32 v32, v32, v33
  v_add_f32 v40, v40, v41
  v_mov_b32 v33, v32
  v_mov_b32 v41, v40
  s_nop 0
  v_permlane16_swap_b32 v32, v33
  v_permlane16_swap_b32 v40, v41
  v_add_f32 v32, v32, v33
  v_add_f32 v40, v40, v41
  ds_write_b32 v65, v32
  ds_write_b32 v65, v40 offset:256
  s_waitcnt lgkmcnt(0)
  s_barrier
  ds_read_b32 v32, v64 offset:0
  ds_read_b32 v36, v64 offset:256
  ds_read_b32 v33, v64 offset:512
  ds_read_b32 v37, v64 offset:768
  ds_read_b32 v34, v64 offset:1024
  ds_read_b32 v38, v64 offset:1280
  ds_read_b32 v35, v64 offset:1536
  ds_read_b32 v39, v64 offset:1792
  s_waitcnt lgkmcnt(0)
  v_add_f32 v32, v32, v33
  v_add_f32 v34, v34, v35
  v_add_f32 v32, v32, v34
  v_add_f32 v36, v36, v37
  v_add_f32 v38, v38, v39
  v_add_f32 v36, v36, v38
  v_mul_f32 v56, 0xbacccccd, v32
  v_mul_f32 v60, 0xbacccccd, v36
  v_mov_b32 v57, v56
  v_mov_b32 v58, v56
  v_mov_b32 v59, v56
  v_mov_b32 v61, v60
  v_mov_b32 v62, v60
  v_mov_b32 v63, v60
  s_branch nc_18
nb_17:
  v_mov_b32 v56, 0
  v_mov_b32 v57, 0
  v_mov_b32 v58, 0
  v_mov_b32 v59, 0
  v_mov_b32 v60, 0
  v_mov_b32 v61, 0
  v_mov_b32 v62, 0
  v_mov_b32 v63, 0
nc_18:
  s_nop 15
  s_nop 3
  v_add_u32 v71, s95, v1
  s_cmp_eq_u32 s97, 0
  s_cbranch_scc1 nb_19
  v_mfma_f32_16x16x32_bf16 v[32:35], a[184:187], v[24:27], v[56:59]
  v_mfma_f32_16x16x32_bf16 v[36:39], a[188:191], v[24:27], v[56:59]
  v_mfma_f32_16x16x32_bf16 v[40:43], a[184:187], v[28:31], v[60:63]
  v_mfma_f32_16x16x32_bf16 v[44:47], a[188:191], v[28:31], v[60:63]
  v_mfma_f32_16x16x32_bf16 v[8:11], a[192:195], v[24:27], v[56:59]
  v_mfma_f32_16x16x32_bf16 v[12:15], a[196:199], v[24:27], v[56:59]
  v_mfma_f32_16x16x32_bf16 v[16:19], a[192:195], v[28:31], v[60:63]
  v_mfma_f32_16x16x32_bf16 v[20:23], a[196:199], v[28:31], v[60:63]
  s_nop 0
  v_cvt_pk_bf16_f32 v48, v32, v33
  v_cvt_pk_bf16_f32 v49, v34, v35
  v_cvt_pk_bf16_f32 v50, v36, v37
  v_cvt_pk_bf16_f32 v51, v38, v39
  v_cvt_pk_bf16_f32 v52, v40, v41
  v_cvt_pk_bf16_f32 v53, v42, v43
  v_cvt_pk_bf16_f32 v54, v44, v45
  v_cvt_pk_bf16_f32 v55, v46, v47
  buffer_store_dwordx4 v[48:51], v1, s[4:7], s79 offen sc1
  buffer_store_dwordx4 v[52:55], v71, s[4:7], s79 offen offset:1024 sc1
  v_cvt_pk_bf16_f32 v76, v8, v9
  v_cvt_pk_bf16_f32 v77, v10, v11
  v_cvt_pk_bf16_f32 v78, v12, v13
  v_cvt_pk_bf16_f32 v79, v14, v15
  v_cvt_pk_bf16_f32 v80, v16, v17
  v_cvt_pk_bf16_f32 v81, v18, v19
  v_cvt_pk_bf16_f32 v82, v20, v21
  v_cvt_pk_bf16_f32 v83, v22, v23
  buffer_store_dwordx4 v[76:79], v1, s[4:7], s92 offen sc1
  buffer_store_dwordx4 v[80:83], v71, s[4:7], s92 offen offset:1024 sc1
nb_19:
  s_nop 15
  s_nop 3
  v_mfma_f32_16x16x32_bf16 v[32:35], a[160:163], v[24:27], v[56:59]
  v_mfma_f32_16x16x32_bf16 v[36:39], a[164:167], v[24:27], v[56:59]
  v_mfma_f32_16x16x32_bf16 v[40:43], a[160:163], v[28:31], v[60:63]
  v_mfma_f32_16x16x32_bf16 v[44:47], a[164:167], v[28:31], v[60:63]
  v_mfma_f32_16x16x32_bf16 v[8:11], a[168:171], v[24:27], v[56:59]
  v_mfma_f32_16x16x32_bf16 v[12:15], a[172:175], v[24:27], v[56:59]
  v_mfma_f32_16x16x32_bf16 v[16:19], a[168:171], v[28:31], v[60:63]
  v_mfma_f32_16x16x32_bf16 v[20:23], a[172:175], v[28:31], v[60:63]
  s_nop 0
  v_cvt_pk_bf16_f32 v48, v32, v33
  v_cvt_pk_bf16_f32 v49, v34, v35
  v_cvt_pk_bf16_f32 v50, v36, v37
  v_cvt_pk_bf16_f32 v51, v38, v39
  v_cvt_pk_bf16_f32 v52, v40, v41
  v_cvt_pk_bf16_f32 v53, v42, v43
  v_cvt_pk_bf16_f32 v54, v44, v45
  v_cvt_pk_bf16_f32 v55, v46, v47
  buffer_store_dwordx4 v[48:51], v1, s[4:7], s76 offen sc1
  buffer_store_dwordx4 v[52:55], v71, s[4:7], s76 offen offset:1024 sc1
  s_add_u32 s17, s33, 28672
  buffer_load_dwordx4 a[28:31], v1, s[4:7], s17 offen sc1
  s_add_u32 s17, s33, 32768
  buffer_load_dwordx4 a[32:35], v1, s[4:7], s17 offen sc1
  s_add_u32 s17, s33, 36864
  buffer_load_dwordx4 a[36:39], v1, s[4:7], s17 offen sc1
  s_add_u32 s17, s33, 40960
  buffer_load_dwordx4 a[40:43], v1, s[4:7], s17 offen sc1
  s_add_u32 s17, s33, 45056
  buffer_load_dwordx4 a[44:47], v1, s[4:7], s17 offen sc1
  s_add_u32 s17, s33, 49152
  buffer_load_dwordx4 a[48:51], v1, s[4:7], s17 offen sc1
  v_mfma_f32_16x16x32_bf16 v[32:35], a[176:179], v[24:27], v[56:59]
  v_mfma_f32_16x16x32_bf16 v[36:39], a[180:183], v[24:27], v[56:59]
  v_mfma_f32_16x16x32_bf16 v[40:43], a[176:179], v[28:31], v[60:63]
  v_mfma_f32_16x16x32_bf16 v[44:47], a[180:183], v[28:31], v[60:63]
  v_cvt_pk_bf16_f32 v76, v8, v9
  v_cvt_pk_bf16_f32 v77, v10, v11
  v_cvt_pk_bf16_f32 v78, v12, v13
  v_cvt_pk_bf16_f32 v79, v14, v15
  v_cvt_pk_bf16_f32 v80, v16, v17
  v_cvt_pk_bf16_f32 v81, v18, v19
  v_cvt_pk_bf16_f32 v82, v20, v21
  v_cvt_pk_bf16_f32 v83, v22, v23
  buffer_store_dwordx4 v[76:79], v1, s[4:7], s77 offen sc1
  buffer_store_dwordx4 v[80:83], v71, s[4:7], s77 offen offset:1024 sc1
  s_add_u32 s17, s33, 53248
  buffer_load_dwordx4 a[52:55], v1, s[4:7], s17 offen sc1
  s_add_u32 s17, s33, 57344
  buffer_load_dwordx4 a[56:59], v1, s[4:7], s17 offen sc1
  s_add_u32 s17, s33, 61440
  buffer_load_dwordx4 a[60:63], v1, s[4:7], s17 offen sc1
  s_add_u32 s17, s33, 65536
  buffer_load_dwordx4 a[64:67], v1, s[4:7], s17 offen sc1
  s_add_u32 s17, s33, 69632
  buffer_load_dwordx4 a[68:71], v1, s[4:7], s17 offen sc1
  s_add_u32 s17, s33, 73728
  buffer_load_dwordx4 a[72:75], v1, s[4:7], s17 offen sc1
  v_cvt_pk_bf16_f32 v48, v32, v33
  v_cvt_pk_bf16_f32 v49, v34, v35
  v_cvt_pk_bf16_f32 v50, v36, v37
  v_cvt_pk_bf16_f32 v51, v38, v39
  v_cvt_pk_bf16_f32 v52, v40, v41
  v_cvt_pk_bf16_f32 v53, v42, v43
  v_cvt_pk_bf16_f32 v54, v44, v45
  v_cvt_pk_bf16_f32 v55, v46, v47
  buffer_store_dwordx4 v[48:51], v1, s[4:7], s78 offen sc1
  buffer_store_dwordx4 v[52:55], v71, s[4:7], s78 offen offset:1024 sc1
  s_add_u32 s17, s33, 77824
  buffer_load_dwordx4 a[76:79], v1, s[4:7], s17 offen sc1
  s_add_u32 s17, s33, 81920
  buffer_load_dwordx4 a[80:83], v1, s[4:7], s17 offen sc1
  s_add_u32 s17, s33, 86016
  buffer_load_dwordx4 a[84:87], v1, s[4:7], s17 offen sc1
  s_add_u32 s17, s33, 90112
  buffer_load_dwordx4 a[88:91], v1, s[4:7], s17 offen sc1
  s_add_u32 s17, s33, 94208
  buffer_load_dwordx4 a[92:95], v1, s[4:7], s17 offen sc1
  s_add_u32 s17, s33, 98304
  buffer_load_dwordx4 a[96:99], v1, s[4:7], s17 offen sc1
  v_lshlrev_b32 v7, 3, v4
  v_lshl_add_u32 v7, v5, 8, v7
  s_lshl_b32 s17, s59, 10
  s_add_u32 s17, s17, s51
  buffer_load_dwordx2 v[248:249], v7, s[4:7], s17 offen offset:0 sc1
  buffer_load_dwordx2 v[250:251], v7, s[4:7], s17 offen offset:128 sc1
  buffer_load_dwordx2 v[252:253], v7, s[4:7], s17 offen offset:1024 sc1
  buffer_load_dwordx2 v[254:255], v7, s[4:7], s17 offen offset:1152 sc1
  v_add_u32 v7, s61, v1
  v_add_u32 v86, 0x10000, v7
  v_add_u32 v87, 0x20000, v7
  buffer_load_dwordx4 v[88:91], v1, s[4:7], s21 offen offset:0 sc1
  s_waitcnt vmcnt(35)
  ds_write_b128 v7, a[0:3] offset:0
  v_mfma_f32_16x16x32_bf16 v[8:11], a[0:3], a[228:231], 0
  buffer_load_dwordx4 v[92:95], v1, s[4:7], s22 offen offset:0 sc1
  s_waitcnt vmcnt(35)
  ds_write_b128 v7, a[4:7] offset:4096
  v_mfma_f32_16x16x32_bf16 v[12:15], a[4:7], a[228:231], 0
  buffer_load_dwordx4 v[96:99], v1, s[4:7], s21 offen offset:1024 sc1
  s_waitcnt vmcnt(35)
  ds_write_b128 v7, a[8:11] offset:8192
  v_mfma_f32_16x16x32_bf16 v[16:19], a[8:11], a[228:231], 0
  buffer_load_dwordx4 v[100:103], v1, s[4:7], s22 offen offset:1024 sc1
  s_waitcnt vmcnt(35)
  ds_write_b128 v7, a[12:15] offset:12288
  v_mfma_f32_16x16x32_bf16 v[20:23], a[12:15], a[228:231], 0
  buffer_load_dwordx4 v[104:107], v1, s[4:7], s21 offen offset:2048 sc1
  s_waitcnt vmcnt(35)
  ds_write_b128 v7, a[16:19] offset:16384
  v_mfma_f32_16x16x32_bf16 v[24:27], a[16:19], a[228:231], 0
  buffer_load_dwordx4 v[108:111], v1, s[4:7], s22 offen offset:2048 sc1
  s_waitcnt vmcnt(35)
  ds_write_b128 v7, a[20:23] offset:20480
  v_mfma_f32_16x16x32_bf16 v[8:11], a[20:23], a[228:231], v[8:11]
  buffer_load_dwordx4 v[112:115], v1, s[4:7], s21 offen offset:3072 sc1
  s_waitcnt vmcnt(35)
  ds_write_b128 v7, a[24:27] offset:24576
  v_mfma_f32_16x16x32_bf16 v[12:15], a[24:27], a[228:231], v[12:15]
  buffer_load_dwordx4 v[116:119], v1, s[4:7], s22 offen offset:3072 sc1
  s_waitcnt vmcnt(33)
  ds_write_b128 v7, a[28:31] offset:28672
  v_mfma_f32_16x16x32_bf16 v[16:19], a[28:31], a[228:231], v[16:19]
  s_add_u32 s21, s21, 4096
  buffer_load_dwordx4 v[120:123], v1, s[4:7], s21 offen offset:0 sc1
  s_waitcnt vmcnt(33)
  ds_write_b128 v7, a[32:35] offset:32768
  v_mfma_f32_16x16x32_bf16 v[20:23], a[32:35], a[228:231], v[20:23]
  s_add_u32 s22, s22, 4096
  buffer_load_dwordx4 v[124:127], v1, s[4:7], s22 offen offset:0 sc1
  s_waitcnt vmcnt(33)
  ds_write_b128 v7, a[36:39] offset:36864
  v_mfma_f32_16x16x32_bf16 v[24:27], a[36:39], a[228:231], v[24:27]
  buffer_load_dwordx4 v[128:131], v1, s[4:7], s21 offen offset:1024 sc1
  s_waitcnt vmcnt(33)
  ds_write_b128 v7, a[40:43] offset:40960
  v_mfma_f32_16x16x32_bf16 v[8:11], a[40:43], a[228:231], v[8:11]
  buffer_load_dwordx4 v[132:135], v1, s[4:7], s22 offen offset:1024 sc1
  s_waitcnt vmcnt(33)
  ds_write_b128 v7, a[44:47] offset:45056
  v_mfma_f32_16x16x32_bf16 v[12:15], a[44:47], a[228:231], v[12:15]
  buffer_load_dwordx4 v[136:139], v1, s[4:7], s21 offen offset:2048 sc1
  s_waitcnt vmcnt(33)
  ds_write_b128 v7, a[48:51] offset:49152
  v_mfma_f32_16x16x32_bf16 v[16:19], a[48:51], a[228:231], v[16:19]
  buffer_load_dwordx4 v[140:143], v1, s[4:7], s22 offen offset:2048 sc1
  s_waitcnt vmcnt(31)
  ds_write_b128 v7, a[52:55] offset:53248
  v_mfma_f32_16x16x32_bf16 v[20:23], a[52:55], a[228:231], v[20:23]
  buffer_load_dwordx4 v[144:147], v1, s[4:7], s21 offen offset:3072 sc1
  s_waitcnt vmcnt(31)
  ds_write_b128 v7, a[56:59] offset:57344
  v_mfma_f32_16x16x32_bf16 v[24:27], a[56:59], a[228:231], v[24:27]
  buffer_load_dwordx4 v[148:151], v1, s[4:7], s22 offen offset:3072 sc1
  s_waitcnt vmcnt(31)
  ds_write_b128 v7, a[60:63] offset:61440
  v_mfma_f32_16x16x32_bf16 v[8:11], a[60:63], a[228:231], v[8:11]
  s_add_u32 s21, s21, 4096
  buffer_load_dwordx4 v[152:155], v1, s[4:7], s21 offen offset:0 sc1
  s_waitcnt vmcnt(31)
  ds_write_b128 v86, a[64:67] offset:0
  v_mfma_f32_16x16x32_bf16 v[12:15], a[64:67], a[228:231], v[12:15]
  s_add_u32 s22, s22, 4096
  buffer_load_dwordx4 v[156:159], v1, s[4:7], s22 offen offset:0 sc1
  s_waitcnt vmcnt(31)
  ds_write_b128 v86, a[68:71] offset:4096
  v_mfma_f32_16x16x32_bf16 v[16:19], a[68:71], a[228:231], v[16:19]
  buffer_load_dwordx4 v[160:163], v1, s[4:7], s21 offen offset:1024 sc1
  s_waitcnt vmcnt(31)
  ds_write_b128 v86, a[72:75] offset:8192
  v_mfma_f32_16x16x32_bf16 v[20:23], a[72:75], a[228:231], v[20:23]
  buffer_load_dwordx4 v[164:167], v1, s[4:7], s22 offen offset:1024 sc1
  s_waitcnt vmcnt(29)
  ds_write_b128 v86, a[76:79] offset:12288
  v_mfma_f32_16x16x32_bf16 v[24:27], a[76:79], a[228:231], v[24:27]
  s_waitcnt vmcnt(28)
  ds_write_b128 v86, a[80:83] offset:16384
  v_mfma_f32_16x16x32_bf16 v[8:11], a[80:83], a[228:231], v[8:11]
  s_waitcnt vmcnt(27)
  ds_write_b128 v86, a[84:87] offset:20480
  v_mfma_f32_16x16x32_bf16 v[12:15], a[84:87], a[228:231], v[12:15]
  s_waitcnt vmcnt(26)
  ds_write_b128 v86, a[88:91] offset:24576
  v_mfma_f32_16x16x32_bf16 v[16:19], a[88:91], a[228:231], v[16:19]
  s_waitcnt vmcnt(25)
  ds_write_b128 v86, a[92:95] offset:28672
  v_mfma_f32_16x16x32_bf16 v[20:23], a[92:95], a[228:231], v[20:23]
  s_waitcnt vmcnt(24)
  ds_write_b128 v86, a[96:99] offset:32768
  v_mfma_f32_16x16x32_bf16 v[24:27], a[96:99], a[228:231], v[24:27]
  v_lshlrev_b32 v7, 4, v5
  s_mov_b32 exec_lo, 0x00010001
  s_mov_b32 exec_hi, 0x00010001
  s_add_u32 s17, s8, 0
  s_mul_i32 s18, s17, 13108
  s_lshr_b32 s18, s18, 16
  s_mul_i32 s18, s18, 5
  s_sub_u32 s17, s17, s18
  s_lshl_b32 s17, s17, 6
  s_mul_i32 s18, s8, 320
  s_add_u32 s17, s17, s18
  s_add_u32 s17, s17, 102400
  v_add_u32 v87, s17, v7
  ds_write_b128 v87, v[8:11]
  s_add_u32 s17, s8, 4
  s_mul_i32 s18, s17, 13108
  s_lshr_b32 s18, s18, 16
  s_mul_i32 s18, s18, 5
  s_sub_u32 s17, s17, s18
  s_lshl_b32 s17, s17, 6
  s_mul_i32 s18, s8, 320
  s_add_u32 s17, s17, s18
  s_add_u32 s17, s17, 102400
  v_add_u32 v87, s17, v7
  ds_write_b128 v87, v[12:15]
  s_add_u32 s17, s8, 8
  s_mul_i32 s18, s17, 13108
  s_lshr_b32 s18, s18, 16
  s_mul_i32 s18, s18, 5
  s_sub_u32 s17, s17, s18
  s_lshl_b32 s17, s17, 6
  s_mul_i32 s18, s8, 320
  s_add_u32 s17, s17, s18
  s_add_u32 s17, s17, 102400
  v_add_u32 v87, s17, v7
  ds_write_b128 v87, v[16:19]
  s_add_u32 s17, s8, 12
  s_mul_i32 s18, s17, 13108
  s_lshr_b32 s18, s18, 16
  s_mul_i32 s18, s18, 5
  s_sub_u32 s17, s17, s18
  s_lshl_b32 s17, s17, 6
  s_mul_i32 s18, s8, 320
  s_add_u32 s17, s17, s18
  s_add_u32 s17, s17, 102400
  v_add_u32 v87, s17, v7
  ds_write_b128 v87, v[20:23]
  s_add_u32 s17, s8, 16
  s_mul_i32 s18, s17, 13108
  s_lshr_b32 s18, s18, 16
  s_mul_i32 s18, s18, 5
  s_sub_u32 s17, s17, s18
  s_lshl_b32 s17, s17, 6
  s_mul_i32 s18, s8, 320
  s_add_u32 s17, s17, s18
  s_add_u32 s17, s17, 102400
  v_add_u32 v87, s17, v7
  ds_write_b128 v87, v[24:27]
  s_mov_b64 exec, -1
  s_waitcnt vmcnt(30)
  s_waitcnt lgkmcnt(0)
  s_barrier
  s_cmp_lg_u32 s8, 0
  s_cbranch_scc1 flg_20
  s_lshl_b32 s17, s2, 2
  s_add_u32 s17, s17, 0xd90000
  s_mov_b32 s19, s68
  v_lshlrev_b32 v7, 10, v0
  v_mov_b32 v247, s19
  s_mov_b64 exec, 0xf
  buffer_store_dword v247, v7, s[4:7], s17 offen sc1
  s_mov_b64 exec, -1
flg_20:
  v_lshlrev_b32 v7, 4, v5
  v_add_u32 v7, 102400, v7
  ds_read_b128 v[68:71], v7 offset:0
  ds_read_b128 v[72:75], v7 offset:64
  ds_read_b128 v[76:79], v7 offset:128
  ds_read_b128 v[80:83], v7 offset:192
  ds_read_b128 v[84:87], v7 offset:256
  ds_read_b128 v[8:11], v7 offset:320
  ds_read_b128 v[12:15], v7 offset:384
  ds_read_b128 v[16:19], v7 offset:448
  ds_read_b128 v[20:23], v7 offset:512
  ds_read_b128 v[24:27], v7 offset:576
  ds_read_b128 v[28:31], v7 offset:640
  ds_read_b128 v[32:35], v7 offset:704
  ds_read_b128 v[36:39], v7 offset:768
  ds_read_b128 v[40:43], v7 offset:832
  ds_read_b128 v[44:47], v7 offset:896
  ds_read_b128 v[48:51], v7 offset:960
  ds_read_b128 v[52:55], v7 offset:1024
  ds_read_b128 v[56:59], v7 offset:1088
  ds_read_b128 v[60:63], v7 offset:1152
  ds_read_b128 v[64:67], v7 offset:1216
  s_waitcnt lgkmcnt(0)
  v_pk_add_f32 v[68:69], v[68:69], v[8:9]
  v_pk_add_f32 v[70:71], v[70:71], v[10:11]
  v_pk_add_f32 v[72:73], v[72:73], v[12:13]
  v_pk_add_f32 v[74:75], v[74:75], v[14:15]
  v_pk_add_f32 v[76:77], v[76:77], v[16:17]
  v_pk_add_f32 v[78:79], v[78:79], v[18:19]
  v_pk_add_f32 v[80:81], v[80:81], v[20:21]
  v_pk_add_f32 v[82:83], v[82:83], v[22:23]
  v_pk_add_f32 v[84:85], v[84:85], v[24:25]
  v_pk_add_f32 v[86:87], v[86:87], v[26:27]
  v_pk_add_f32 v[68:69], v[68:69], v[28:29]
  v_pk_add_f32 v[70:71], v[70:71], v[30:31]
  v_pk_add_f32 v[72:73], v[72:73], v[32:33]
  v_pk_add_f32 v[74:75], v[74:75], v[34:35]
  v_pk_add_f32 v[76:77], v[76:77], v[36:37]
  v_pk_add_f32 v[78:79], v[78:79], v[38:39]
  v_pk_add_f32 v[80:81], v[80:81], v[40:41]
  v_pk_add_f32 v[82:83], v[82:83], v[42:43]
  v_pk_add_f32 v[84:85], v[84:85], v[44:45]
  v_pk_add_f32 v[86:87], v[86:87], v[46:47]
  v_pk_add_f32 v[68:69], v[68:69], v[48:49]
  v_pk_add_f32 v[70:71], v[70:71], v[50:51]
  v_pk_add_f32 v[72:73], v[72:73], v[52:53]
  v_pk_add_f32 v[74:75], v[74:75], v[54:55]
  v_pk_add_f32 v[76:77], v[76:77], v[56:57]
  v_pk_add_f32 v[78:79], v[78:79], v[58:59]
  v_pk_add_f32 v[80:81], v[80:81], v[60:61]
  v_pk_add_f32 v[82:83], v[82:83], v[62:63]
  v_pk_add_f32 v[84:85], v[84:85], v[64:65]
  v_pk_add_f32 v[86:87], v[86:87], v[66:67]
  s_cmp_lg_u32 s8, 0
  s_cbranch_scc1 csv_21
  v_lshlrev_b32 v7, 4, v5
  s_lshl_b32 s17, s2, 9
  s_add_u32 s17, s17, 0xdb0000
  s_mov_b32 exec_lo, 0x00010001
  s_mov_b32 exec_hi, 0x00010001
  buffer_store_dwordx4 v[68:71], v7, s[4:7], s17 offen offset:0 sc1
  buffer_store_dwordx4 v[72:75], v7, s[4:7], s17 offen offset:64 sc1
  buffer_store_dwordx4 v[76:79], v7, s[4:7], s17 offen offset:128 sc1
  buffer_store_dwordx4 v[80:83], v7, s[4:7], s17 offen offset:192 sc1
  buffer_store_dwordx4 v[84:87], v7, s[4:7], s17 offen offset:256 sc1
  s_mov_b64 exec, -1
csv_21:
  s_waitcnt vmcnt(20)
  v_add_f32 v248, v248, v250
  v_add_f32 v249, v249, v251
  s_nop 1
  v_permlane16_swap_b32 v248, v249
  v_add_f32 v248, v248, v249
  v_mov_b32 v249, v248
  s_nop 1
  v_permlane32_swap_b32 v248, v249
  v_add_f32 v248, v248, v249
  v_mov_b32 v249, v248
  s_nop 1
  v_permlane16_swap_b32 v248, v249
  v_mul_f32 v248, 0x3acccccd, v248
  v_mul_f32 v250, 0x3acccccd, v249
  v_mul_f32 v249, -1.0, v248
  v_fma_f32 v250, -v248, v248, v250
  v_max_f32 v250, 0, v250
  v_add_f32 v250, 0x3727c5ac, v250
  v_rsq_f32 v250, v250
  s_nop 0
  v_mul_f32 v248, 0x3fb8aa3b, v250
  v_add_f32 v252, v252, v254
  v_add_f32 v253, v253, v255
  s_nop 1
  v_permlane16_swap_b32 v252, v253
  v_add_f32 v252, v252, v253
  v_mov_b32 v253, v252
  s_nop 1
  v_permlane32_swap_b32 v252, v253
  v_add_f32 v252, v252, v253
  v_mov_b32 v253, v252
  s_nop 1
  v_permlane16_swap_b32 v252, v253
  v_mul_f32 v252, 0x3acccccd, v252
  v_mul_f32 v254, 0x3acccccd, v253
  v_mul_f32 v253, -1.0, v252
  v_fma_f32 v254, -v252, v252, v254
  v_max_f32 v254, 0, v254
  v_add_f32 v254, 0x3727c5ac, v254
  v_rsq_f32 v254, v254
  s_nop 0
  v_mul_f32 v252, 0x3fb8aa3b, v254
  v_pk_mul_f32 v[8:9], v[68:69], v[248:249] op_sel:[0,1] op_sel_hi:[1,1]
  v_pk_mul_f32 v[10:11], v[70:71], v[248:249] op_sel:[0,1] op_sel_hi:[1,1]
  v_pk_mul_f32 v[12:13], v[72:73], v[248:249] op_sel:[0,1] op_sel_hi:[1,1]
  v_pk_mul_f32 v[14:15], v[74:75], v[248:249] op_sel:[0,1] op_sel_hi:[1,1]
  v_pk_mul_f32 v[16:17], v[76:77], v[248:249] op_sel:[0,1] op_sel_hi:[1,1]
  v_pk_mul_f32 v[18:19], v[78:79], v[248:249] op_sel:[0,1] op_sel_hi:[1,1]
  v_pk_mul_f32 v[20:21], v[80:81], v[248:249] op_sel:[0,1] op_sel_hi:[1,1]
  v_pk_mul_f32 v[22:23], v[82:83], v[248:249] op_sel:[0,1] op_sel_hi:[1,1]
  v_pk_mul_f32 v[24:25], v[84:85], v[248:249] op_sel:[0,1] op_sel_hi:[1,1]
  v_pk_mul_f32 v[26:27], v[86:87], v[248:249] op_sel:[0,1] op_sel_hi:[1,1]
  v_pk_mul_f32 v[28:29], v[68:69], v[252:253] op_sel:[0,1] op_sel_hi:[1,1]
  v_pk_mul_f32 v[30:31], v[70:71], v[252:253] op_sel:[0,1] op_sel_hi:[1,1]
  v_pk_mul_f32 v[32:33], v[72:73], v[252:253] op_sel:[0,1] op_sel_hi:[1,1]
  v_pk_mul_f32 v[34:35], v[74:75], v[252:253] op_sel:[0,1] op_sel_hi:[1,1]
  v_pk_mul_f32 v[36:37], v[76:77], v[252:253] op_sel:[0,1] op_sel_hi:[1,1]
  v_pk_mul_f32 v[38:39], v[78:79], v[252:253] op_sel:[0,1] op_sel_hi:[1,1]
  v_pk_mul_f32 v[40:41], v[80:81], v[252:253] op_sel:[0,1] op_sel_hi:[1,1]
  v_pk_mul_f32 v[42:43], v[82:83], v[252:253] op_sel:[0,1] op_sel_hi:[1,1]
  v_pk_mul_f32 v[44:45], v[84:85], v[252:253] op_sel:[0,1] op_sel_hi:[1,1]
  v_pk_mul_f32 v[46:47], v[86:87], v[252:253] op_sel:[0,1] op_sel_hi:[1,1]
  ds_read_b128 v[48:51], v1 offset:0
  ds_read_b128 v[52:55], v1 offset:1024
  ds_read_b128 v[56:59], v1 offset:2048
  ds_read_b128 v[60:63], v1 offset:3072
  ds_read_b128 v[64:67], v1 offset:4096
  s_waitcnt vmcnt(18) lgkmcnt(4)
  v_mfma_f32_16x16x32_bf16 v[8:11], v[48:51], v[88:91], v[8:11]
  ds_read_b128 v[68:71], v1 offset:5120
  v_mfma_f32_16x16x32_bf16 v[28:31], v[48:51], v[92:95], v[28:31]
  ds_read_b128 v[72:75], v1 offset:6144
  s_waitcnt lgkmcnt(5)
  v_mfma_f32_16x16x32_bf16 v[12:15], v[52:55], v[88:91], v[12:15]
  ds_read_b128 v[76:79], v1 offset:7168
  buffer_load_dwordx4 v[168:171], v1, s[4:7], s21 offen offset:2048 sc1
  v_mfma_f32_16x16x32_bf16 v[32:35], v[52:55], v[92:95], v[32:35]
  ds_read_b128 v[80:83], v1 offset:8192
  s_waitcnt lgkmcnt(6)
  v_mfma_f32_16x16x32_bf16 v[16:19], v[56:59], v[88:91], v[16:19]
  ds_read_b128 v[84:87], v1 offset:9216
  v_mfma_f32_16x16x32_bf16 v[36:39], v[56:59], v[92:95], v[36:39]
  s_waitcnt lgkmcnt(6)
  v_mfma_f32_16x16x32_bf16 v[20:23], v[60:63], v[88:91], v[20:23]
  v_mfma_f32_16x16x32_bf16 v[40:43], v[60:63], v[92:95], v[40:43]
  buffer_load_dwordx4 v[172:175], v1, s[4:7], s22 offen offset:2048 sc1
  s_waitcnt lgkmcnt(5)
  v_mfma_f32_16x16x32_bf16 v[24:27], v[64:67], v[88:91], v[24:27]
  v_mfma_f32_16x16x32_bf16 v[44:47], v[64:67], v[92:95], v[44:47]
  s_waitcnt vmcnt(18) lgkmcnt(4)
  v_mfma_f32_16x16x32_bf16 v[8:11], v[68:71], v[96:99], v[8:11]
  ds_read_b128 v[48:51], v1 offset:10240
  v_mfma_f32_16x16x32_bf16 v[28:31], v[68:71], v[100:103], v[28:31]
  ds_read_b128 v[52:55], v1 offset:11264
  s_waitcnt lgkmcnt(5)
  v_mfma_f32_16x16x32_bf16 v[12:15], v[72:75], v[96:99], v[12:15]
  ds_read_b128 v[56:59], v1 offset:12288
  buffer_load_dwordx4 v[176:179], v1, s[4:7], s21 offen offset:3072 sc1
  v_mfma_f32_16x16x32_bf16 v[32:35], v[72:75], v[100:103], v[32:35]
  ds_read_b128 v[60:63], v1 offset:13312
  s_waitcnt lgkmcnt(6)
  v_mfma_f32_16x16x32_bf16 v[16:19], v[76:79], v[96:99], v[16:19]
  ds_read_b128 v[64:67], v1 offset:14336
  v_mfma_f32_16x16x32_bf16 v[36:39], v[76:79], v[100:103], v[36:39]
  s_waitcnt lgkmcnt(6)
  v_mfma_f32_16x16x32_bf16 v[20:23], v[80:83], v[96:99], v[20:23]
  v_mfma_f32_16x16x32_bf16 v[40:43], v[80:83], v[100:103], v[40:43]
  buffer_load_dwordx4 v[180:183], v1, s[4:7], s22 offen offset:3072 sc1
  s_waitcnt lgkmcnt(5)
  v_mfma_f32_16x16x32_bf16 v[24:27], v[84:87], v[96:99], v[24:27]
  v_mfma_f32_16x16x32_bf16 v[44:47], v[84:87], v[100:103], v[44:47]
  s_waitcnt vmcnt(18) lgkmcnt(4)
  v_mfma_f32_16x16x32_bf16 v[8:11], v[48:51], v[104:107], v[8:11]
  ds_read_b128 v[68:71], v1 offset:15360
  v_mfma_f32_16x16x32_bf16 v[28:31], v[48:51], v[108:111], v[28:31]
  ds_read_b128 v[72:75], v1 offset:16384
  s_waitcnt lgkmcnt(5)
  v_mfma_f32_16x16x32_bf16 v[12:15], v[52:55], v[104:107], v[12:15]
  ds_read_b128 v[76:79], v1 offset:17408
  s_add_u32 s21, s21, 4096
  buffer_load_dwordx4 v[184:187], v1, s[4:7], s21 offen offset:0 sc1
  v_mfma_f32_16x16x32_bf16 v[32:35], v[52:55], v[108:111], v[32:35]
  ds_read_b128 v[80:83], v1 offset:18432
  s_waitcnt lgkmcnt(6)
  v_mfma_f32_16x16x32_bf16 v[16:19], v[56:59], v[104:107], v[16:19]
  ds_read_b128 v[84:87], v1 offset:19456
  v_mfma_f32_16x16x32_bf16 v[36:39], v[56:59], v[108:111], v[36:39]
  s_waitcnt lgkmcnt(6)
  v_mfma_f32_16x16x32_bf16 v[20:23], v[60:63], v[104:107], v[20:23]
  v_mfma_f32_16x16x32_bf16 v[40:43], v[60:63], v[108:111], v[40:43]
  s_add_u32 s22, s22, 4096
  buffer_load_dwordx4 v[188:191], v1, s[4:7], s22 offen offset:0 sc1
  s_waitcnt lgkmcnt(5)
  v_mfma_f32_16x16x32_bf16 v[24:27], v[64:67], v[104:107], v[24:27]
  v_mfma_f32_16x16x32_bf16 v[44:47], v[64:67], v[108:111], v[44:47]
  s_waitcnt vmcnt(18) lgkmcnt(4)
  v_mfma_f32_16x16x32_bf16 v[8:11], v[68:71], v[112:115], v[8:11]
  ds_read_b128 v[48:51], v1 offset:20480
  v_mfma_f32_16x16x32_bf16 v[28:31], v[68:71], v[116:119], v[28:31]
  ds_read_b128 v[52:55], v1 offset:21504
  s_waitcnt lgkmcnt(5)
  v_mfma_f32_16x16x32_bf16 v[12:15], v[72:75], v[112:115], v[12:15]
  ds_read_b128 v[56:59], v1 offset:22528
  buffer_load_dwordx4 v[192:195], v1, s[4:7], s21 offen offset:1024 sc1
  v_mfma_f32_16x16x32_bf16 v[32:35], v[72:75], v[116:119], v[32:35]
  ds_read_b128 v[60:63], v1 offset:23552
  s_waitcnt lgkmcnt(6)
  v_mfma_f32_16x16x32_bf16 v[16:19], v[76:79], v[112:115], v[16:19]
  ds_read_b128 v[64:67], v1 offset:24576
  v_mfma_f32_16x16x32_bf16 v[36:39], v[76:79], v[116:119], v[36:39]
  s_waitcnt lgkmcnt(6)
  v_mfma_f32_16x16x32_bf16 v[20:23], v[80:83], v[112:115], v[20:23]
  v_mfma_f32_16x16x32_bf16 v[40:43], v[80:83], v[116:119], v[40:43]
  buffer_load_dwordx4 v[196:199], v1, s[4:7], s22 offen offset:1024 sc1
  s_waitcnt lgkmcnt(5)
  v_mfma_f32_16x16x32_bf16 v[24:27], v[84:87], v[112:115], v[24:27]
  v_mfma_f32_16x16x32_bf16 v[44:47], v[84:87], v[116:119], v[44:47]
  s_waitcnt vmcnt(18) lgkmcnt(4)
  v_mfma_f32_16x16x32_bf16 v[8:11], v[48:51], v[120:123], v[8:11]
  ds_read_b128 v[68:71], v1 offset:25600
  v_mfma_f32_16x16x32_bf16 v[28:31], v[48:51], v[124:127], v[28:31]
  ds_read_b128 v[72:75], v1 offset:26624
  s_waitcnt lgkmcnt(5)
  v_mfma_f32_16x16x32_bf16 v[12:15], v[52:55], v[120:123], v[12:15]
  ds_read_b128 v[76:79], v1 offset:27648
  buffer_load_dwordx4 v[200:203], v1, s[4:7], s21 offen offset:2048 sc1
  v_mfma_f32_16x16x32_bf16 v[32:35], v[52:55], v[124:127], v[32:35]
  ds_read_b128 v[80:83], v1 offset:28672
  s_waitcnt lgkmcnt(6)
  v_mfma_f32_16x16x32_bf16 v[16:19], v[56:59], v[120:123], v[16:19]
  ds_read_b128 v[84:87], v1 offset:29696
  v_mfma_f32_16x16x32_bf16 v[36:39], v[56:59], v[124:127], v[36:39]
  s_waitcnt lgkmcnt(6)
  v_mfma_f32_16x16x32_bf16 v[20:23], v[60:63], v[120:123], v[20:23]
  v_mfma_f32_16x16x32_bf16 v[40:43], v[60:63], v[124:127], v[40:43]
  buffer_load_dwordx4 v[204:207], v1, s[4:7], s22 offen offset:2048 sc1
  s_waitcnt lgkmcnt(5)
  v_mfma_f32_16x16x32_bf16 v[24:27], v[64:67], v[120:123], v[24:27]
  v_mfma_f32_16x16x32_bf16 v[44:47], v[64:67], v[124:127], v[44:47]
  s_waitcnt vmcnt(18) lgkmcnt(4)
  v_mfma_f32_16x16x32_bf16 v[8:11], v[68:71], v[128:131], v[8:11]
  ds_read_b128 v[48:51], v1 offset:30720
  v_mfma_f32_16x16x32_bf16 v[28:31], v[68:71], v[132:135], v[28:31]
  ds_read_b128 v[52:55], v1 offset:31744
  s_waitcnt lgkmcnt(5)
  v_mfma_f32_16x16x32_bf16 v[12:15], v[72:75], v[128:131], v[12:15]
  ds_read_b128 v[56:59], v1 offset:32768
  buffer_load_dwordx4 v[208:211], v1, s[4:7], s21 offen offset:3072 sc1
  v_mfma_f32_16x16x32_bf16 v[32:35], v[72:75], v[132:135], v[32:35]
  ds_read_b128 v[60:63], v1 offset:33792
  s_waitcnt lgkmcnt(6)
  v_mfma_f32_16x16x32_bf16 v[16:19], v[76:79], v[128:131], v[16:19]
  ds_read_b128 v[64:67], v1 offset:34816
  v_mfma_f32_16x16x32_bf16 v[36:39], v[76:79], v[132:135], v[36:39]
  s_waitcnt lgkmcnt(6)
  v_mfma_f32_16x16x32_bf16 v[20:23], v[80:83], v[128:131], v[20:23]
  v_mfma_f32_16x16x32_bf16 v[40:43], v[80:83], v[132:135], v[40:43]
  buffer_load_dwordx4 v[212:215], v1, s[4:7], s22 offen offset:3072 sc1
  s_waitcnt lgkmcnt(5)
  v_mfma_f32_16x16x32_bf16 v[24:27], v[84:87], v[128:131], v[24:27]
  v_mfma_f32_16x16x32_bf16 v[44:47], v[84:87], v[132:135], v[44:47]
  s_waitcnt vmcnt(18) lgkmcnt(4)
  v_mfma_f32_16x16x32_bf16 v[8:11], v[48:51], v[136:139], v[8:11]
  ds_read_b128 v[68:71], v1 offset:35840
  v_mfma_f32_16x16x32_bf16 v[28:31], v[48:51], v[140:143], v[28:31]
  ds_read_b128 v[72:75], v1 offset:36864
  s_waitcnt lgkmcnt(5)
  v_mfma_f32_16x16x32_bf16 v[12:15], v[52:55], v[136:139], v[12:15]
  ds_read_b128 v[76:79], v1 offset:37888
  s_add_u32 s21, s21, 4096
  v_lshlrev_b32 v7, 3, v0
  buffer_load_dwordx2 v[216:217], v7, s[4:7], s21 offen offset:0 sc1
  buffer_load_dwordx2 v[218:219], v7, s[4:7], s21 offen offset:512 sc1
  v_mfma_f32_16x16x32_bf16 v[32:35], v[52:55], v[140:143], v[32:35]
  ds_read_b128 v[80:83], v1 offset:38912
  s_waitcnt lgkmcnt(6)
  v_mfma_f32_16x16x32_bf16 v[16:19], v[56:59], v[136:139], v[16:19]
  ds_read_b128 v[84:87], v1 offset:39936
  v_mfma_f32_16x16x32_bf16 v[36:39], v[56:59], v[140:143], v[36:39]
  s_waitcnt lgkmcnt(6)
  v_mfma_f32_16x16x32_bf16 v[20:23], v[60:63], v[136:139], v[20:23]
  v_mfma_f32_16x16x32_bf16 v[40:43], v[60:63], v[140:143], v[40:43]
  s_add_u32 s22, s22, 4096
  v_lshlrev_b32 v7, 3, v0
  buffer_load_dwordx2 v[220:221], v7, s[4:7], s22 offen offset:0 sc1
  buffer_load_dwordx2 v[222:223], v7, s[4:7], s22 offen offset:512 sc1
  s_waitcnt lgkmcnt(5)
  v_mfma_f32_16x16x32_bf16 v[24:27], v[64:67], v[136:139], v[24:27]
  v_mfma_f32_16x16x32_bf16 v[44:47], v[64:67], v[140:143], v[44:47]
  s_waitcnt vmcnt(20) lgkmcnt(4)
  v_mfma_f32_16x16x32_bf16 v[8:11], v[68:71], v[144:147], v[8:11]
  ds_read_b128 v[48:51], v1 offset:40960
  v_mfma_f32_16x16x32_bf16 v[28:31], v[68:71], v[148:151], v[28:31]
  ds_read_b128 v[52:55], v1 offset:41984
  s_waitcnt lgkmcnt(5)
  v_mfma_f32_16x16x32_bf16 v[12:15], v[72:75], v[144:147], v[12:15]
  ds_read_b128 v[56:59], v1 offset:43008
  v_lshlrev_b32 v7, 3, v0
  buffer_load_dwordx2 v[224:225], v7, s[4:7], s21 offen offset:1024 sc1
  buffer_load_dwordx2 v[226:227], v7, s[4:7], s21 offen offset:1536 sc1
  v_mfma_f32_16x16x32_bf16 v[32:35], v[72:75], v[148:151], v[32:35]
  ds_read_b128 v[60:63], v1 offset:44032
  s_waitcnt lgkmcnt(6)
  v_mfma_f32_16x16x32_bf16 v[16:19], v[76:79], v[144:147], v[16:19]
  ds_read_b128 v[64:67], v1 offset:45056
  v_mfma_f32_16x16x32_bf16 v[36:39], v[76:79], v[148:151], v[36:39]
  s_waitcnt lgkmcnt(6)
  v_mfma_f32_16x16x32_bf16 v[20:23], v[80:83], v[144:147], v[20:23]
  v_mfma_f32_16x16x32_bf16 v[40:43], v[80:83], v[148:151], v[40:43]
  v_lshlrev_b32 v7, 3, v0
  buffer_load_dwordx2 v[228:229], v7, s[4:7], s22 offen offset:1024 sc1
  buffer_load_dwordx2 v[230:231], v7, s[4:7], s22 offen offset:1536 sc1
  s_waitcnt lgkmcnt(5)
  v_mfma_f32_16x16x32_bf16 v[24:27], v[84:87], v[144:147], v[24:27]
  v_mfma_f32_16x16x32_bf16 v[44:47], v[84:87], v[148:151], v[44:47]
  s_waitcnt vmcnt(22) lgkmcnt(4)
  v_mfma_f32_16x16x32_bf16 v[8:11], v[48:51], v[152:155], v[8:11]
  ds_read_b128 v[68:71], v1 offset:46080
  v_mfma_f32_16x16x32_bf16 v[28:31], v[48:51], v[156:159], v[28:31]
  ds_read_b128 v[72:75], v1 offset:47104
  s_waitcnt lgkmcnt(5)
  v_mfma_f32_16x16x32_bf16 v[12:15], v[52:55], v[152:155], v[12:15]
  ds_read_b128 v[76:79], v1 offset:48128
  v_lshlrev_b32 v7, 3, v0
  buffer_load_dwordx2 v[232:233], v7, s[4:7], s21 offen offset:2048 sc1
  buffer_load_dwordx2 v[234:235], v7, s[4:7], s21 offen offset:2560 sc1
  v_mfma_f32_16x16x32_bf16 v[32:35], v[52:55], v[156:159], v[32:35]
  ds_read_b128 v[80:83], v1 offset:49152
  s_waitcnt lgkmcnt(6)
  v_mfma_f32_16x16x32_bf16 v[16:19], v[56:59], v[152:155], v[16:19]
  ds_read_b128 v[84:87], v1 offset:50176
  v_mfma_f32_16x16x32_bf16 v[36:39], v[56:59], v[156:159], v[36:39]
  s_waitcnt lgkmcnt(6)
  v_mfma_f32_16x16x32_bf16 v[20:23], v[60:63], v[152:155], v[20:23]
  v_mfma_f32_16x16x32_bf16 v[40:43], v[60:63], v[156:159], v[40:43]
  v_lshlrev_b32 v7, 3, v0
  buffer_load_dwordx2 v[236:237], v7, s[4:7], s22 offen offset:2048 sc1
  buffer_load_dwordx2 v[238:239], v7, s[4:7], s22 offen offset:2560 sc1
  s_waitcnt lgkmcnt(5)
  v_mfma_f32_16x16x32_bf16 v[24:27], v[64:67], v[152:155], v[24:27]
  v_mfma_f32_16x16x32_bf16 v[44:47], v[64:67], v[156:159], v[44:47]
  s_waitcnt vmcnt(24) lgkmcnt(4)
  v_mfma_f32_16x16x32_bf16 v[8:11], v[68:71], v[160:163], v[8:11]
  ds_read_b128 v[48:51], v1 offset:51200
  v_mfma_f32_16x16x32_bf16 v[28:31], v[68:71], v[164:167], v[28:31]
  ds_read_b128 v[52:55], v1 offset:52224
  s_waitcnt lgkmcnt(5)
  v_mfma_f32_16x16x32_bf16 v[12:15], v[72:75], v[160:163], v[12:15]
  ds_read_b128 v[56:59], v1 offset:53248
  v_lshlrev_b32 v7, 3, v0
  buffer_load_dwordx2 v[240:241], v7, s[4:7], s21 offen offset:3072 sc1
  buffer_load_dwordx2 v[242:243], v7, s[4:7], s21 offen offset:3584 sc1
  v_mfma_f32_16x16x32_bf16 v[32:35], v[72:75], v[164:167], v[32:35]
  ds_read_b128 v[60:63], v1 offset:54272
  s_waitcnt lgkmcnt(6)
  v_mfma_f32_16x16x32_bf16 v[16:19], v[76:79], v[160:163], v[16:19]
  ds_read_b128 v[64:67], v1 offset:55296
  v_mfma_f32_16x16x32_bf16 v[36:39], v[76:79], v[164:167], v[36:39]
  s_waitcnt lgkmcnt(6)
  v_mfma_f32_16x16x32_bf16 v[20:23], v[80:83], v[160:163], v[20:23]
  v_mfma_f32_16x16x32_bf16 v[40:43], v[80:83], v[164:167], v[40:43]
  v_lshlrev_b32 v7, 3, v0
  buffer_load_dwordx2 v[244:245], v7, s[4:7], s22 offen offset:3072 sc1
  buffer_load_dwordx2 v[246:247], v7, s[4:7], s22 offen offset:3584 sc1
  s_waitcnt lgkmcnt(5)
  v_mfma_f32_16x16x32_bf16 v[24:27], v[84:87], v[160:163], v[24:27]
  v_mfma_f32_16x16x32_bf16 v[44:47], v[84:87], v[164:167], v[44:47]
  s_waitcnt vmcnt(26) lgkmcnt(4)
  v_mfma_f32_16x16x32_bf16 v[8:11], v[48:51], v[168:171], v[8:11]
  ds_read_b128 v[68:71], v1 offset:56320
  v_mfma_f32_16x16x32_bf16 v[28:31], v[48:51], v[172:175], v[28:31]
  ds_read_b128 v[72:75], v1 offset:57344
  s_waitcnt lgkmcnt(5)
  v_mfma_f32_16x16x32_bf16 v[12:15], v[52:55], v[168:171], v[12:15]
  ds_read_b128 v[76:79], v1 offset:58368
  s_mul_i32 s33, s10, 163840
  s_add_u32 s33, s33, s61
  s_add_u32 s33, s33, 0xe19000
  s_add_u32 s17, s33, 0
  buffer_load_dwordx4 a[100:103], v1, s[4:7], s17 offen sc1
  v_mfma_f32_16x16x32_bf16 v[32:35], v[52:55], v[172:175], v[32:35]
  ds_read_b128 v[80:83], v1 offset:59392
  s_waitcnt lgkmcnt(6)
  v_mfma_f32_16x16x32_bf16 v[16:19], v[56:59], v[168:171], v[16:19]
  ds_read_b128 v[84:87], v1 offset:60416
  v_mfma_f32_16x16x32_bf16 v[36:39], v[56:59], v[172:175], v[36:39]
  s_waitcnt lgkmcnt(6)
  v_mfma_f32_16x16x32_bf16 v[20:23], v[60:63], v[168:171], v[20:23]
  v_mfma_f32_16x16x32_bf16 v[40:43], v[60:63], v[172:175], v[40:43]
  s_add_u32 s17, s33, 4096
  buffer_load_dwordx4 a[104:107], v1, s[4:7], s17 offen sc1
  s_waitcnt lgkmcnt(5)
  v_mfma_f32_16x16x32_bf16 v[24:27], v[64:67], v[168:171], v[24:27]
  v_mfma_f32_16x16x32_bf16 v[44:47], v[64:67], v[172:175], v[44:47]
  s_waitcnt vmcnt(26) lgkmcnt(4)
  v_mfma_f32_16x16x32_bf16 v[8:11], v[68:71], v[176:179], v[8:11]
  ds_read_b128 v[48:51], v1 offset:61440
  v_mfma_f32_16x16x32_bf16 v[28:31], v[68:71], v[180:183], v[28:31]
  ds_read_b128 v[52:55], v1 offset:62464
  s_waitcnt lgkmcnt(5)
  v_mfma_f32_16x16x32_bf16 v[12:15], v[72:75], v[176:179], v[12:15]
  ds_read_b128 v[56:59], v1 offset:63488
  s_add_u32 s17, s33, 8192
  buffer_load_dwordx4 a[108:111], v1, s[4:7], s17 offen sc1
  v_mfma_f32_16x16x32_bf16 v[32:35], v[72:75], v[180:183], v[32:35]
  ds_read_b128 v[60:63], v1 offset:64512
  s_waitcnt lgkmcnt(6)
  v_mfma_f32_16x16x32_bf16 v[16:19], v[76:79], v[176:179], v[16:19]
  ds_read_b128 v[64:67], v2 offset:0
  v_mfma_f32_16x16x32_bf16 v[36:39], v[76:79], v[180:183], v[36:39]
  s_waitcnt lgkmcnt(6)
  v_mfma_f32_16x16x32_bf16 v[20:23], v[80:83], v[176:179], v[20:23]
  v_mfma_f32_16x16x32_bf16 v[40:43], v[80:83], v[180:183], v[40:43]
  s_add_u32 s17, s33, 12288
  buffer_load_dwordx4 a[112:115], v1, s[4:7], s17 offen sc1
  s_waitcnt lgkmcnt(5)
  v_mfma_f32_16x16x32_bf16 v[24:27], v[84:87], v[176:179], v[24:27]
  v_mfma_f32_16x16x32_bf16 v[44:47], v[84:87], v[180:183], v[44:47]
  s_waitcnt vmcnt(26) lgkmcnt(4)
  v_mfma_f32_16x16x32_bf16 v[8:11], v[48:51], v[184:187], v[8:11]
  ds_read_b128 v[68:71], v2 offset:1024
  v_mfma_f32_16x16x32_bf16 v[28:31], v[48:51], v[188:191], v[28:31]
  ds_read_b128 v[72:75], v2 offset:2048
  s_waitcnt lgkmcnt(5)
  v_mfma_f32_16x16x32_bf16 v[12:15], v[52:55], v[184:187], v[12:15]
  ds_read_b128 v[76:79], v2 offset:3072
  s_add_u32 s17, s33, 16384
  buffer_load_dwordx4 a[116:119], v1, s[4:7], s17 offen sc1
  v_mfma_f32_16x16x32_bf16 v[32:35], v[52:55], v[188:191], v[32:35]
  ds_read_b128 v[80:83], v2 offset:4096
  s_waitcnt lgkmcnt(6)
  v_mfma_f32_16x16x32_bf16 v[16:19], v[56:59], v[184:187], v[16:19]
  ds_read_b128 v[84:87], v2 offset:5120
  v_mfma_f32_16x16x32_bf16 v[36:39], v[56:59], v[188:191], v[36:39]
  s_waitcnt lgkmcnt(6)
  v_mfma_f32_16x16x32_bf16 v[20:23], v[60:63], v[184:187], v[20:23]
  v_mfma_f32_16x16x32_bf16 v[40:43], v[60:63], v[188:191], v[40:43]
  s_add_u32 s17, s33, 20480
  buffer_load_dwordx4 a[120:123], v1, s[4:7], s17 offen sc1
  s_waitcnt lgkmcnt(5)
  v_mfma_f32_16x16x32_bf16 v[24:27], v[64:67], v[184:187], v[24:27]
  v_mfma_f32_16x16x32_bf16 v[44:47], v[64:67], v[188:191], v[44:47]
  s_waitcnt vmcnt(26) lgkmcnt(4)
  v_mfma_f32_16x16x32_bf16 v[8:11], v[68:71], v[192:195], v[8:11]
  ds_read_b128 v[48:51], v2 offset:6144
  v_mfma_f32_16x16x32_bf16 v[28:31], v[68:71], v[196:199], v[28:31]
  ds_read_b128 v[52:55], v2 offset:7168
  s_waitcnt lgkmcnt(5)
  v_mfma_f32_16x16x32_bf16 v[12:15], v[72:75], v[192:195], v[12:15]
  ds_read_b128 v[56:59], v2 offset:8192
  s_add_u32 s17, s33, 24576
  buffer_load_dwordx4 a[124:127], v1, s[4:7], s17 offen sc1
  v_mfma_f32_16x16x32_bf16 v[32:35], v[72:75], v[196:199], v[32:35]
  ds_read_b128 v[60:63], v2 offset:9216
  s_waitcnt lgkmcnt(6)
  v_mfma_f32_16x16x32_bf16 v[16:19], v[76:79], v[192:195], v[16:19]
  ds_read_b128 v[64:67], v2 offset:10240
  v_mfma_f32_16x16x32_bf16 v[36:39], v[76:79], v[196:199], v[36:39]
  s_waitcnt lgkmcnt(6)
  v_mfma_f32_16x16x32_bf16 v[20:23], v[80:83], v[192:195], v[20:23]
  v_mfma_f32_16x16x32_bf16 v[40:43], v[80:83], v[196:199], v[40:43]
  s_add_u32 s17, s33, 28672
  buffer_load_dwordx4 a[128:131], v1, s[4:7], s17 offen sc1
  s_waitcnt lgkmcnt(5)
  v_mfma_f32_16x16x32_bf16 v[24:27], v[84:87], v[192:195], v[24:27]
  v_mfma_f32_16x16x32_bf16 v[44:47], v[84:87], v[196:199], v[44:47]
  s_waitcnt vmcnt(26) lgkmcnt(4)
  v_mfma_f32_16x16x32_bf16 v[8:11], v[48:51], v[200:203], v[8:11]
  ds_read_b128 v[68:71], v2 offset:11264
  v_mfma_f32_16x16x32_bf16 v[28:31], v[48:51], v[204:207], v[28:31]
  ds_read_b128 v[72:75], v2 offset:12288
  s_waitcnt lgkmcnt(5)
  v_mfma_f32_16x16x32_bf16 v[12:15], v[52:55], v[200:203], v[12:15]
  ds_read_b128 v[76:79], v2 offset:13312
  s_add_u32 s17, s33, 32768
  buffer_load_dwordx4 a[132:135], v1, s[4:7], s17 offen sc1
  v_mfma_f32_16x16x32_bf16 v[32:35], v[52:55], v[204:207], v[32:35]
  ds_read_b128 v[80:83], v2 offset:14336
  s_waitcnt lgkmcnt(6)
  v_mfma_f32_16x16x32_bf16 v[16:19], v[56:59], v[200:203], v[16:19]
  ds_read_b128 v[84:87], v2 offset:15360
  v_mfma_f32_16x16x32_bf16 v[36:39], v[56:59], v[204:207], v[36:39]
  s_waitcnt lgkmcnt(6)
  v_mfma_f32_16x16x32_bf16 v[20:23], v[60:63], v[200:203], v[20:23]
  v_mfma_f32_16x16x32_bf16 v[40:43], v[60:63], v[204:207], v[40:43]
  s_add_u32 s17, s33, 36864
  buffer_load_dwordx4 a[136:139], v1, s[4:7], s17 offen sc1
  s_waitcnt lgkmcnt(5)
  v_mfma_f32_16x16x32_bf16 v[24:27], v[64:67], v[200:203], v[24:27]
  v_mfma_f32_16x16x32_bf16 v[44:47], v[64:67], v[204:207], v[44:47]
  s_waitcnt vmcnt(26) lgkmcnt(4)
  v_mfma_f32_16x16x32_bf16 v[8:11], v[68:71], v[208:211], v[8:11]
  ds_read_b128 v[48:51], v2 offset:16384
  v_mfma_f32_16x16x32_bf16 v[28:31], v[68:71], v[212:215], v[28:31]
  ds_read_b128 v[52:55], v2 offset:17408
  s_waitcnt lgkmcnt(5)
  v_mfma_f32_16x16x32_bf16 v[12:15], v[72:75], v[208:211], v[12:15]
  ds_read_b128 v[56:59], v2 offset:18432
  s_add_u32 s17, s33, 40960
  buffer_load_dwordx4 a[140:143], v1, s[4:7], s17 offen sc1
  v_mfma_f32_16x16x32_bf16 v[32:35], v[72:75], v[212:215], v[32:35]
  ds_read_b128 v[60:63], v2 offset:19456
  s_waitcnt lgkmcnt(6)
  v_mfma_f32_16x16x32_bf16 v[16:19], v[76:79], v[208:211], v[16:19]
  ds_read_b128 v[64:67], v2 offset:20480
  v_mfma_f32_16x16x32_bf16 v[36:39], v[76:79], v[212:215], v[36:39]
  s_waitcnt lgkmcnt(6)
  v_mfma_f32_16x16x32_bf16 v[20:23], v[80:83], v[208:211], v[20:23]
  v_mfma_f32_16x16x32_bf16 v[40:43], v[80:83], v[212:215], v[40:43]
  s_add_u32 s17, s33, 45056
  buffer_load_dwordx4 a[144:147], v1, s[4:7], s17 offen sc1
  s_waitcnt lgkmcnt(5)
  v_mfma_f32_16x16x32_bf16 v[24:27], v[84:87], v[208:211], v[24:27]
  v_mfma_f32_16x16x32_bf16 v[44:47], v[84:87], v[212:215], v[44:47]
  s_waitcnt vmcnt(24) lgkmcnt(4)
  v_mfma_f32_16x16x32_bf16 v[8:11], v[48:51], v[216:219], v[8:11]
  ds_read_b128 v[68:71], v2 offset:21504
  v_mfma_f32_16x16x32_bf16 v[28:31], v[48:51], v[220:223], v[28:31]
  ds_read_b128 v[72:75], v2 offset:22528
  s_waitcnt lgkmcnt(5)
  v_mfma_f32_16x16x32_bf16 v[12:15], v[52:55], v[216:219], v[12:15]
  ds_read_b128 v[76:79], v2 offset:23552
  s_add_u32 s17, s33, 49152
  buffer_load_dwordx4 a[148:151], v1, s[4:7], s17 offen sc1
  v_mfma_f32_16x16x32_bf16 v[32:35], v[52:55], v[220:223], v[32:35]
  ds_read_b128 v[80:83], v2 offset:24576
  s_waitcnt lgkmcnt(6)
  v_mfma_f32_16x16x32_bf16 v[16:19], v[56:59], v[216:219], v[16:19]
  ds_read_b128 v[84:87], v2 offset:25600
  v_mfma_f32_16x16x32_bf16 v[36:39], v[56:59], v[220:223], v[36:39]
  s_waitcnt lgkmcnt(6)
  v_mfma_f32_16x16x32_bf16 v[20:23], v[60:63], v[216:219], v[20:23]
  v_mfma_f32_16x16x32_bf16 v[40:43], v[60:63], v[220:223], v[40:43]
  s_add_u32 s17, s33, 53248
  buffer_load_dwordx4 a[152:155], v1, s[4:7], s17 offen sc1
  s_waitcnt lgkmcnt(5)
  v_mfma_f32_16x16x32_bf16 v[24:27], v[64:67], v[216:219], v[24:27]
  v_mfma_f32_16x16x32_bf16 v[44:47], v[64:67], v[220:223], v[44:47]
  s_waitcnt vmcnt(22) lgkmcnt(4)
  v_mfma_f32_16x16x32_bf16 v[8:11], v[68:71], v[224:227], v[8:11]
  ds_read_b128 v[48:51], v2 offset:26624
  v_mfma_f32_16x16x32_bf16 v[28:31], v[68:71], v[228:231], v[28:31]
  ds_read_b128 v[52:55], v2 offset:27648
  s_waitcnt lgkmcnt(5)
  v_mfma_f32_16x16x32_bf16 v[12:15], v[72:75], v[224:227], v[12:15]
  ds_read_b128 v[56:59], v2 offset:28672
  s_add_u32 s17, s33, 57344
  buffer_load_dwordx4 a[156:159], v1, s[4:7], s17 offen sc1
  v_mfma_f32_16x16x32_bf16 v[32:35], v[72:75], v[228:231], v[32:35]
  ds_read_b128 v[60:63], v2 offset:29696
  s_waitcnt lgkmcnt(6)
  v_mfma_f32_16x16x32_bf16 v[16:19], v[76:79], v[224:227], v[16:19]
  ds_read_b128 v[64:67], v2 offset:30720
  v_mfma_f32_16x16x32_bf16 v[36:39], v[76:79], v[228:231], v[36:39]
  s_waitcnt lgkmcnt(6)
  v_mfma_f32_16x16x32_bf16 v[20:23], v[80:83], v[224:227], v[20:23]
  v_mfma_f32_16x16x32_bf16 v[40:43], v[80:83], v[228:231], v[40:43]
  s_waitcnt lgkmcnt(5)
  v_mfma_f32_16x16x32_bf16 v[24:27], v[84:87], v[224:227], v[24:27]
  v_mfma_f32_16x16x32_bf16 v[44:47], v[84:87], v[228:231], v[44:47]
  s_waitcnt vmcnt(19) lgkmcnt(4)
  v_mfma_f32_16x16x32_bf16 v[8:11], v[48:51], v[232:235], v[8:11]
  ds_read_b128 v[68:71], v2 offset:31744
  v_mfma_f32_16x16x32_bf16 v[28:31], v[48:51], v[236:239], v[28:31]
  ds_read_b128 v[72:75], v2 offset:32768
  s_waitcnt lgkmcnt(5)
  v_mfma_f32_16x16x32_bf16 v[12:15], v[52:55], v[232:235], v[12:15]
  ds_read_b128 v[76:79], v2 offset:33792
  v_mfma_f32_16x16x32_bf16 v[32:35], v[52:55], v[236:239], v[32:35]
  ds_read_b128 v[80:83], v2 offset:34816
  s_waitcnt lgkmcnt(6)
  v_mfma_f32_16x16x32_bf16 v[16:19], v[56:59], v[232:235], v[16:19]
  ds_read_b128 v[84:87], v2 offset:35840
  v_mfma_f32_16x16x32_bf16 v[36:39], v[56:59], v[236:239], v[36:39]
  s_waitcnt lgkmcnt(6)
  v_mfma_f32_16x16x32_bf16 v[20:23], v[60:63], v[232:235], v[20:23]
  v_mfma_f32_16x16x32_bf16 v[40:43], v[60:63], v[236:239], v[40:43]
  s_waitcnt lgkmcnt(5)
  v_mfma_f32_16x16x32_bf16 v[24:27], v[64:67], v[232:235], v[24:27]
  v_mfma_f32_16x16x32_bf16 v[44:47], v[64:67], v[236:239], v[44:47]
  s_waitcnt vmcnt(15) lgkmcnt(4)
  v_mfma_f32_16x16x32_bf16 v[8:11], v[68:71], v[240:243], v[8:11]
  v_mfma_f32_16x16x32_bf16 v[28:31], v[68:71], v[244:247], v[28:31]
  s_waitcnt lgkmcnt(3)
  v_mfma_f32_16x16x32_bf16 v[12:15], v[72:75], v[240:243], v[12:15]
  v_mfma_f32_16x16x32_bf16 v[32:35], v[72:75], v[244:247], v[32:35]
  s_waitcnt lgkmcnt(2)
  v_mfma_f32_16x16x32_bf16 v[16:19], v[76:79], v[240:243], v[16:19]
  v_mfma_f32_16x16x32_bf16 v[36:39], v[76:79], v[244:247], v[36:39]
  s_waitcnt lgkmcnt(1)
  v_mfma_f32_16x16x32_bf16 v[20:23], v[80:83], v[240:243], v[20:23]
  v_mfma_f32_16x16x32_bf16 v[40:43], v[80:83], v[244:247], v[40:43]
  s_waitcnt lgkmcnt(0)
  v_mfma_f32_16x16x32_bf16 v[24:27], v[84:87], v[240:243], v[24:27]
  v_mfma_f32_16x16x32_bf16 v[44:47], v[84:87], v[244:247], v[44:47]
  s_barrier
  v_lshrrev_b32 v68, 1, v5
  v_and_b32 v69, 1, v5
  s_lshl_b32 s17, s8, 5
  v_lshl_add_u32 v68, v68, 7, v4
  v_add_u32 v68, s17, v68
  v_mul_u32_u24 v68, 160, v68
  v_mul_u32_u24 v80, 48, v69
  v_add_u32 v80, v80, v68
  v_mul_u32_u24 v81, 24, v69
  v_add_u32 v81, v81, v68
  v_add_u32 v81, 96, v81
  v_mov_b32 v79, 0x3f80
  v_add_u32 v7, s61, v1
  v_add_u32 v86, 0x10000, v7
  v_add_u32 v87, 0x20000, v7
  v_max3_f32 v68, v8, v9, v10
  v_max3_f32 v69, -v8, -v9, -v10
  v_max3_f32 v68, v68, v11, v12
  v_max3_f32 v69, v69, -v11, -v12
  v_max3_f32 v68, v68, v13, v14
  v_max3_f32 v69, v69, -v13, -v14
  v_max3_f32 v68, v68, v15, v16
  v_max3_f32 v69, v69, -v15, -v16
  v_max_f32 v68, v68, v17
  v_max_f32 v69, v69, -v17
  s_waitcnt vmcnt(14)
  ds_write_b128 v86, a[100:103] offset:36864
  v_mfma_f32_16x16x32_bf16 a[200:203], a[100:103], a[228:231], 0
  v_permlane16_swap_b32 v68, v69
  v_max_f32 v68, v68, v69
  v_mov_b32 v69, v68
  s_nop 1
  v_permlane16_swap_b32 v68, v69
  v_mul_f32 v70, v68, v248
  v_mul_f32 v72, v69, v248
  v_pk_fma_f32 v[48:49], v[8:9], v[248:249], v[70:71] op_sel_hi:[1,0,0] neg_lo:[0,0,1] neg_hi:[0,0,1]
  v_pk_fma_f32 v[58:59], v[8:9], v[248:249], v[72:73] op_sel_hi:[1,0,0] neg_lo:[1,0,1] neg_hi:[1,0,1]
  v_pk_fma_f32 v[50:51], v[10:11], v[248:249], v[70:71] op_sel_hi:[1,0,0] neg_lo:[0,0,1] neg_hi:[0,0,1]
  v_pk_fma_f32 v[60:61], v[10:11], v[248:249], v[72:73] op_sel_hi:[1,0,0] neg_lo:[1,0,1] neg_hi:[1,0,1]
  v_pk_fma_f32 v[52:53], v[12:13], v[248:249], v[70:71] op_sel_hi:[1,0,0] neg_lo:[0,0,1] neg_hi:[0,0,1]
  v_pk_fma_f32 v[62:63], v[12:13], v[248:249], v[72:73] op_sel_hi:[1,0,0] neg_lo:[1,0,1] neg_hi:[1,0,1]
  s_waitcnt vmcnt(13)
  ds_write_b128 v86, a[104:107] offset:40960
  v_mfma_f32_16x16x32_bf16 a[204:207], a[104:107], a[228:231], 0
  v_pk_fma_f32 v[54:55], v[14:15], v[248:249], v[70:71] op_sel_hi:[1,0,0] neg_lo:[0,0,1] neg_hi:[0,0,1]
  v_pk_fma_f32 v[64:65], v[14:15], v[248:249], v[72:73] op_sel_hi:[1,0,0] neg_lo:[1,0,1] neg_hi:[1,0,1]
  v_pk_fma_f32 v[56:57], v[16:17], v[248:249], v[70:71] op_sel_hi:[1,0,0] neg_lo:[0,0,1] neg_hi:[0,0,1]
  v_pk_fma_f32 v[66:67], v[16:17], v[248:249], v[72:73] op_sel_hi:[1,0,0] neg_lo:[1,0,1] neg_hi:[1,0,1]
  v_exp_f32 v48, v48
  v_exp_f32 v58, v58
  s_waitcnt vmcnt(12)
  ds_write_b128 v86, a[108:111] offset:45056
  v_mfma_f32_16x16x32_bf16 a[208:211], a[108:111], a[228:231], 0
  v_exp_f32 v49, v49
  v_exp_f32 v59, v59
  v_exp_f32 v50, v50
  v_exp_f32 v60, v60
  s_waitcnt vmcnt(11)
  ds_write_b128 v86, a[112:115] offset:49152
  v_mfma_f32_16x16x32_bf16 a[200:203], a[112:115], a[228:231], a[200:203]
  v_exp_f32 v51, v51
  v_exp_f32 v61, v61
  v_exp_f32 v52, v52
  v_exp_f32 v62, v62
  s_waitcnt vmcnt(10)
  ds_write_b128 v86, a[116:119] offset:53248
  v_mfma_f32_16x16x32_bf16 a[204:207], a[116:119], a[228:231], a[204:207]
  v_exp_f32 v53, v53
  v_exp_f32 v63, v63
  v_exp_f32 v54, v54
  v_exp_f32 v64, v64
  s_waitcnt vmcnt(9)
  ds_write_b128 v86, a[120:123] offset:57344
  v_mfma_f32_16x16x32_bf16 a[208:211], a[120:123], a[228:231], a[208:211]
  v_exp_f32 v55, v55
  v_exp_f32 v65, v65
  v_exp_f32 v56, v56
  v_exp_f32 v66, v66
  s_waitcnt vmcnt(8)
  ds_write_b128 v86, a[124:127] offset:61440
  v_mfma_f32_16x16x32_bf16 a[200:203], a[124:127], a[228:231], a[200:203]
  v_exp_f32 v57, v57
  v_exp_f32 v67, v67
  v_pk_add_f32 v[70:71], v[48:49], v[50:51]
  v_pk_add_f32 v[72:73], v[58:59], v[60:61]
  v_pk_add_f32 v[70:71], v[70:71], v[52:53]
  v_pk_add_f32 v[72:73], v[72:73], v[62:63]
  v_pk_add_f32 v[70:71], v[70:71], v[54:55]
  v_pk_add_f32 v[72:73], v[72:73], v[64:65]
  v_pk_add_f32 v[70:71], v[70:71], v[56:57]
  v_pk_add_f32 v[72:73], v[72:73], v[66:67]
  s_waitcnt vmcnt(7)
  ds_write_b128 v87, a[128:131] offset:0
  v_mfma_f32_16x16x32_bf16 a[204:207], a[128:131], a[228:231], a[204:207]
  v_add_f32 v70, v70, v71
  v_add_f32 v72, v72, v73
  s_nop 1
  v_permlane16_swap_b32 v70, v72
  v_add_f32 v70, v70, v72
  v_mov_b32 v72, v70
  s_nop 1
  v_permlane16_swap_b32 v70, v72
  v_rcp_f32 v70, v70
  v_rcp_f32 v72, v72
  v_pk_mul_f32 v[48:49], v[48:49], v[70:71] op_sel_hi:[1,0]
  v_pk_mul_f32 v[58:59], v[58:59], v[72:73] op_sel_hi:[1,0]
  v_pk_mul_f32 v[50:51], v[50:51], v[70:71] op_sel_hi:[1,0]
  v_pk_mul_f32 v[60:61], v[60:61], v[72:73] op_sel_hi:[1,0]
  s_waitcnt vmcnt(6)
  ds_write_b128 v87, a[132:135] offset:4096
  v_mfma_f32_16x16x32_bf16 a[208:211], a[132:135], a[228:231], a[208:211]
  v_pk_mul_f32 v[52:53], v[52:53], v[70:71] op_sel_hi:[1,0]
  v_pk_mul_f32 v[62:63], v[62:63], v[72:73] op_sel_hi:[1,0]
  v_pk_mul_f32 v[54:55], v[54:55], v[70:71] op_sel_hi:[1,0]
  v_pk_mul_f32 v[64:65], v[64:65], v[72:73] op_sel_hi:[1,0]
  s_waitcnt vmcnt(5)
  ds_write_b128 v87, a[136:139] offset:8192
  v_mfma_f32_16x16x32_bf16 a[200:203], a[136:139], a[228:231], a[200:203]
  v_pk_mul_f32 v[56:57], v[56:57], v[70:71] op_sel_hi:[1,0]
  v_pk_mul_f32 v[66:67], v[66:67], v[72:73] op_sel_hi:[1,0]
  v_cvt_pk_bf16_f32 v48, v48, v49
  v_cvt_pk_bf16_f32 v49, v50, v51
  v_cvt_pk_bf16_f32 v50, v52, v53
  v_cvt_pk_bf16_f32 v51, v54, v55
  v_cvt_pk_bf16_f32 v52, v56, v57
  s_waitcnt vmcnt(4)
  ds_write_b128 v87, a[140:143] offset:12288
  v_mfma_f32_16x16x32_bf16 a[204:207], a[140:143], a[228:231], a[204:207]
  v_cvt_pk_bf16_f32 v53, v58, v59
  v_cvt_pk_bf16_f32 v54, v60, v61
  v_cvt_pk_bf16_f32 v55, v62, v63
  v_cvt_pk_bf16_f32 v56, v64, v65
  v_cvt_pk_bf16_f32 v57, v66, v67
  v_mov_b32 v58, 0
  v_mov_b32 v59, 0
  v_pk_mul_f32 v[18:19], v[18:19], v[250:251] op_sel_hi:[1,0]
  v_pk_mul_f32 v[20:21], v[20:21], v[250:251] op_sel_hi:[1,0]
  v_pk_mul_f32 v[22:23], v[22:23], v[250:251] op_sel_hi:[1,0]
  v_pk_mul_f32 v[24:25], v[24:25], v[250:251] op_sel_hi:[1,0]
  v_pk_mul_f32 v[26:27], v[26:27], v[250:251] op_sel_hi:[1,0]
  v_cvt_pk_bf16_f32 v74, v18, v19
  v_cvt_pk_bf16_f32 v75, v20, v21
  v_cvt_pk_bf16_f32 v76, v22, v23
  v_cvt_pk_bf16_f32 v77, v24, v25
  v_cvt_pk_bf16_f32 v78, v26, v27
  ds_write_b128 v80, v[48:51] offset:0
  ds_write_b128 v80, v[52:55] offset:16
  ds_write_b128 v80, v[56:59] offset:32
  ds_write_b64 v81, v[74:75] offset:0
  ds_write_b64 v81, v[76:77] offset:8
  ds_write_b64 v81, v[78:79] offset:16
  v_max3_f32 v68, v28, v29, v30
  v_max3_f32 v69, -v28, -v29, -v30
  v_max3_f32 v68, v68, v31, v32
  v_max3_f32 v69, v69, -v31, -v32
  v_max3_f32 v68, v68, v33, v34
  v_max3_f32 v69, v69, -v33, -v34
  v_max3_f32 v68, v68, v35, v36
  v_max3_f32 v69, v69, -v35, -v36
  v_max_f32 v68, v68, v37
  v_max_f32 v69, v69, -v37
  s_waitcnt vmcnt(3)
  ds_write_b128 v87, a[144:147] offset:16384
  v_mfma_f32_16x16x32_bf16 a[208:211], a[144:147], a[228:231], a[208:211]
  v_permlane16_swap_b32 v68, v69
  v_max_f32 v68, v68, v69
  v_mov_b32 v69, v68
  s_nop 1
  v_permlane16_swap_b32 v68, v69
  v_mul_f32 v70, v68, v252
  v_mul_f32 v72, v69, v252
  v_pk_fma_f32 v[48:49], v[28:29], v[252:253], v[70:71] op_sel_hi:[1,0,0] neg_lo:[0,0,1] neg_hi:[0,0,1]
  v_pk_fma_f32 v[58:59], v[28:29], v[252:253], v[72:73] op_sel_hi:[1,0,0] neg_lo:[1,0,1] neg_hi:[1,0,1]
  v_pk_fma_f32 v[50:51], v[30:31], v[252:253], v[70:71] op_sel_hi:[1,0,0] neg_lo:[0,0,1] neg_hi:[0,0,1]
  v_pk_fma_f32 v[60:61], v[30:31], v[252:253], v[72:73] op_sel_hi:[1,0,0] neg_lo:[1,0,1] neg_hi:[1,0,1]
  v_pk_fma_f32 v[52:53], v[32:33], v[252:253], v[70:71] op_sel_hi:[1,0,0] neg_lo:[0,0,1] neg_hi:[0,0,1]
  v_pk_fma_f32 v[62:63], v[32:33], v[252:253], v[72:73] op_sel_hi:[1,0,0] neg_lo:[1,0,1] neg_hi:[1,0,1]
  s_waitcnt vmcnt(2)
  ds_write_b128 v87, a[148:151] offset:20480
  v_mfma_f32_16x16x32_bf16 a[200:203], a[148:151], a[228:231], a[200:203]
  v_pk_fma_f32 v[54:55], v[34:35], v[252:253], v[70:71] op_sel_hi:[1,0,0] neg_lo:[0,0,1] neg_hi:[0,0,1]
  v_pk_fma_f32 v[64:65], v[34:35], v[252:253], v[72:73] op_sel_hi:[1,0,0] neg_lo:[1,0,1] neg_hi:[1,0,1]
  v_pk_fma_f32 v[56:57], v[36:37], v[252:253], v[70:71] op_sel_hi:[1,0,0] neg_lo:[0,0,1] neg_hi:[0,0,1]
  v_pk_fma_f32 v[66:67], v[36:37], v[252:253], v[72:73] op_sel_hi:[1,0,0] neg_lo:[1,0,1] neg_hi:[1,0,1]
  v_exp_f32 v48, v48
  v_exp_f32 v58, v58
  s_waitcnt vmcnt(1)
  ds_write_b128 v87, a[152:155] offset:24576
  v_mfma_f32_16x16x32_bf16 a[204:207], a[152:155], a[228:231], a[204:207]
  v_exp_f32 v49, v49
  v_exp_f32 v59, v59
  v_exp_f32 v50, v50
  v_exp_f32 v60, v60
  s_waitcnt vmcnt(0)
  ds_write_b128 v87, a[156:159] offset:28672
  v_mfma_f32_16x16x32_bf16 a[208:211], a[156:159], a[228:231], a[208:211]
  v_exp_f32 v51, v51
  v_exp_f32 v61, v61
  v_exp_f32 v52, v52
  v_exp_f32 v62, v62
  v_exp_f32 v53, v53
  v_exp_f32 v63, v63
  v_exp_f32 v54, v54
  v_exp_f32 v64, v64
  v_exp_f32 v55, v55
  v_exp_f32 v65, v65
  v_exp_f32 v56, v56
  v_exp_f32 v66, v66
  v_exp_f32 v57, v57
  v_exp_f32 v67, v67
  v_pk_add_f32 v[70:71], v[48:49], v[50:51]
  v_pk_add_f32 v[72:73], v[58:59], v[60:61]
  v_pk_add_f32 v[70:71], v[70:71], v[52:53]
  v_pk_add_f32 v[72:73], v[72:73], v[62:63]
  v_pk_add_f32 v[70:71], v[70:71], v[54:55]
  v_pk_add_f32 v[72:73], v[72:73], v[64:65]
  v_pk_add_f32 v[70:71], v[70:71], v[56:57]
  v_pk_add_f32 v[72:73], v[72:73], v[66:67]
  v_add_f32 v70, v70, v71
  v_add_f32 v72, v72, v73
  s_nop 1
  v_permlane16_swap_b32 v70, v72
  v_add_f32 v70, v70, v72
  v_mov_b32 v72, v70
  s_nop 1
  v_permlane16_swap_b32 v70, v72
  v_rcp_f32 v70, v70
  v_rcp_f32 v72, v72
  v_pk_mul_f32 v[48:49], v[48:49], v[70:71] op_sel_hi:[1,0]
  v_pk_mul_f32 v[58:59], v[58:59], v[72:73] op_sel_hi:[1,0]
  v_pk_mul_f32 v[50:51], v[50:51], v[70:71] op_sel_hi:[1,0]
  v_pk_mul_f32 v[60:61], v[60:61], v[72:73] op_sel_hi:[1,0]
  v_pk_mul_f32 v[52:53], v[52:53], v[70:71] op_sel_hi:[1,0]
  v_pk_mul_f32 v[62:63], v[62:63], v[72:73] op_sel_hi:[1,0]
  v_pk_mul_f32 v[54:55], v[54:55], v[70:71] op_sel_hi:[1,0]
  v_pk_mul_f32 v[64:65], v[64:65], v[72:73] op_sel_hi:[1,0]
  v_pk_mul_f32 v[56:57], v[56:57], v[70:71] op_sel_hi:[1,0]
  v_pk_mul_f32 v[66:67], v[66:67], v[72:73] op_sel_hi:[1,0]
  v_cvt_pk_bf16_f32 v48, v48, v49
  v_cvt_pk_bf16_f32 v49, v50, v51
  v_cvt_pk_bf16_f32 v50, v52, v53
  v_cvt_pk_bf16_f32 v51, v54, v55
  v_cvt_pk_bf16_f32 v52, v56, v57
  v_cvt_pk_bf16_f32 v53, v58, v59
  v_cvt_pk_bf16_f32 v54, v60, v61
  v_cvt_pk_bf16_f32 v55, v62, v63
  v_cvt_pk_bf16_f32 v56, v64, v65
  v_cvt_pk_bf16_f32 v57, v66, v67
  v_mov_b32 v58, 0
  v_mov_b32 v59, 0
  v_pk_mul_f32 v[38:39], v[38:39], v[254:255] op_sel_hi:[1,0]
  v_pk_mul_f32 v[40:41], v[40:41], v[254:255] op_sel_hi:[1,0]
  v_pk_mul_f32 v[42:43], v[42:43], v[254:255] op_sel_hi:[1,0]
  v_pk_mul_f32 v[44:45], v[44:45], v[254:255] op_sel_hi:[1,0]
  v_pk_mul_f32 v[46:47], v[46:47], v[254:255] op_sel_hi:[1,0]
  v_cvt_pk_bf16_f32 v74, v38, v39
  v_cvt_pk_bf16_f32 v75, v40, v41
  v_cvt_pk_bf16_f32 v76, v42, v43
  v_cvt_pk_bf16_f32 v77, v44, v45
  v_cvt_pk_bf16_f32 v78, v46, v47
  ds_write_b128 v80, v[48:51] offset:2560
  ds_write_b128 v80, v[52:55] offset:2576
  ds_write_b128 v80, v[56:59] offset:2592
  ds_write_b64 v81, v[74:75] offset:2560
  ds_write_b64 v81, v[76:77] offset:2568
  ds_write_b64 v81, v[78:79] offset:2576
  v_lshlrev_b32 v7, 4, v5
  s_mov_b32 exec_lo, 0x00010001
  s_mov_b32 exec_hi, 0x00010001
  s_add_u32 s17, s8, 0
  s_mul_i32 s18, s17, 21846
  s_lshr_b32 s18, s18, 16
  s_mul_i32 s18, s18, 3
  s_sub_u32 s17, s17, s18
  s_lshl_b32 s17, s17, 6
  s_mul_i32 s18, s8, 192
  s_add_u32 s17, s17, s18
  s_add_u32 s17, s17, 49152
  v_add_u32 v87, s17, v7
  ds_write_b128 v87, a[200:203]
  s_add_u32 s17, s8, 4
  s_mul_i32 s18, s17, 21846
  s_lshr_b32 s18, s18, 16
  s_mul_i32 s18, s18, 3
  s_sub_u32 s17, s17, s18
  s_lshl_b32 s17, s17, 6
  s_mul_i32 s18, s8, 192
  s_add_u32 s17, s17, s18
  s_add_u32 s17, s17, 49152
  v_add_u32 v87, s17, v7
  ds_write_b128 v87, a[204:207]
  s_add_u32 s17, s8, 8
  s_mul_i32 s18, s17, 21846
  s_lshr_b32 s18, s18, 16
  s_mul_i32 s18, s18, 3
  s_sub_u32 s17, s17, s18
  s_lshl_b32 s17, s17, 6
  s_mul_i32 s18, s8, 192
  s_add_u32 s17, s17, s18
  s_add_u32 s17, s17, 49152
  v_add_u32 v87, s17, v7
  ds_write_b128 v87, a[208:211]
  s_mov_b64 exec, -1
  v_lshrrev_b32 v68, 2, v4
  v_lshl_add_u32 v68, v5, 2, v68
  s_lshr_b32 s17, s8, 1
  s_lshl_b32 s17, s17, 7
  v_add_u32 v68, s17, v68
  v_mul_u32_u24 v85, 160, v68
  v_and_b32 v69, 3, v4
  v_lshl_add_u32 v85, v69, 3, v85
  s_and_b32 s19, s8, 1
  s_lshl_b32 s17, s19, 5
  s_add_u32 s17, s17, 96
  v_add_u32 v84, s17, v85
  v_mov_b32 v69, 0x40000000
  v_lshlrev_b32 v86, 2, v0
  s_cmp_eq_u32 s19, 1
  s_cselect_b32 s18, 2, 4
  v_cmp_gt_u32 vcc, s18, v5
  s_nop 1
  v_cndmask_b32 v86, v69, v86, vcc
  s_sub_u32 s18, 2, s19
  v_cmp_ne_u32 vcc, s18, v5
  s_nop 1
  v_cndmask_b32 v87, v69, v86, vcc
  s_lshl_b32 s17, s10, 1
  s_lshr_b32 s3, s8, 1
  s_add_u32 s17, s17, s3
  s_mul_i32 s17, s17, 6144
  s_mul_i32 s3, s19, 3072
  s_add_u32 s17, s17, s3
  s_add_u32 s23, s17, s56
  s_and_b32 s17, s2, 3
  s_lshl_b32 s17, s17, 10
  s_add_u32 s17, s17, 0xd90000
  buffer_load_dwordx4 a[220:223], v1, s[4:7], s17 offen sc1
  s_waitcnt lgkmcnt(0)
  s_barrier
  ds_read_b64_tr_b16 v[20:21], v84 offset:0
  ds_read_b64_tr_b16 v[22:23], v84 offset:2560
  ds_read_b64_tr_b16 v[36:37], v85 offset:0
  ds_read_b64_tr_b16 v[38:39], v85 offset:2560
  ds_read_b64_tr_b16 v[40:41], v85 offset:32
  ds_read_b64_tr_b16 v[42:43], v85 offset:2592
  ds_read_b64_tr_b16 v[44:45], v85 offset:64
  ds_read_b64_tr_b16 v[46:47], v85 offset:2624
  ds_read_b64_tr_b16 v[24:25], v84 offset:5120
  ds_read_b64_tr_b16 v[26:27], v84 offset:7680
  ds_read_b64_tr_b16 v[48:49], v85 offset:5120
  ds_read_b64_tr_b16 v[50:51], v85 offset:7680
  ds_read_b64_tr_b16 v[52:53], v85 offset:5152
  ds_read_b64_tr_b16 v[54:55], v85 offset:7712
  ds_read_b64_tr_b16 v[56:57], v85 offset:5184
  ds_read_b64_tr_b16 v[58:59], v85 offset:7744
  ds_read_b64_tr_b16 v[28:29], v84 offset:10240
  ds_read_b64_tr_b16 v[30:31], v84 offset:12800
  ds_read_b64_tr_b16 v[60:61], v85 offset:10240
  ds_read_b64_tr_b16 v[62:63], v85 offset:12800
  ds_read_b64_tr_b16 v[64:65], v85 offset:10272
  ds_read_b64_tr_b16 v[66:67], v85 offset:12832
  ds_read_b64_tr_b16 v[68:69], v85 offset:10304
  ds_read_b64_tr_b16 v[70:71], v85 offset:12864
  ds_read_b64_tr_b16 v[32:33], v84 offset:15360
  ds_read_b64_tr_b16 v[34:35], v84 offset:17920
  ds_read_b64_tr_b16 v[72:73], v85 offset:15360
  ds_read_b64_tr_b16 v[74:75], v85 offset:17920
  ds_read_b64_tr_b16 v[76:77], v85 offset:15392
  ds_read_b64_tr_b16 v[78:79], v85 offset:17952
  ds_read_b64_tr_b16 v[80:81], v85 offset:15424
  ds_read_b64_tr_b16 v[82:83], v85 offset:17984
  s_waitcnt lgkmcnt(15)
  v_mfma_f32_16x16x32_bf16 v[8:11], v[20:23], v[36:39], 0
  v_mfma_f32_16x16x32_bf16 v[12:15], v[20:23], v[40:43], 0
  v_mfma_f32_16x16x32_bf16 v[16:19], v[20:23], v[44:47], 0
  s_waitcnt lgkmcnt(15)
  v_mfma_f32_16x16x32_bf16 v[8:11], v[24:27], v[48:51], v[8:11]
  v_mfma_f32_16x16x32_bf16 v[12:15], v[24:27], v[52:55], v[12:15]
  v_mfma_f32_16x16x32_bf16 v[16:19], v[24:27], v[56:59], v[16:19]
  s_waitcnt lgkmcnt(8)
  v_mfma_f32_16x16x32_bf16 v[8:11], v[28:31], v[60:63], v[8:11]
  v_mfma_f32_16x16x32_bf16 v[12:15], v[28:31], v[64:67], v[12:15]
  v_mfma_f32_16x16x32_bf16 v[16:19], v[28:31], v[68:71], v[16:19]
  s_waitcnt lgkmcnt(0)
  v_mfma_f32_16x16x32_bf16 v[8:11], v[32:35], v[72:75], v[8:11]
  v_mfma_f32_16x16x32_bf16 v[12:15], v[32:35], v[76:79], v[12:15]
  v_mfma_f32_16x16x32_bf16 v[16:19], v[32:35], v[80:83], v[16:19]
  s_nop 5
  buffer_atomic_add_f32 v8, v86, s[4:7], s23 offen offset:0
  buffer_atomic_add_f32 v9, v86, s[4:7], s23 offen offset:256
  buffer_atomic_add_f32 v10, v86, s[4:7], s23 offen offset:512
  buffer_atomic_add_f32 v11, v87, s[4:7], s23 offen offset:768
  buffer_atomic_add_f32 v12, v86, s[4:7], s23 offen offset:1024
  buffer_atomic_add_f32 v13, v86, s[4:7], s23 offen offset:1280
  buffer_atomic_add_f32 v14, v86, s[4:7], s23 offen offset:1536
  buffer_atomic_add_f32 v15, v87, s[4:7], s23 offen offset:1792
  buffer_atomic_add_f32 v16, v86, s[4:7], s23 offen offset:2048
  buffer_atomic_add_f32 v17, v86, s[4:7], s23 offen offset:2304
  buffer_atomic_add_f32 v18, v86, s[4:7], s23 offen offset:2560
  buffer_atomic_add_f32 v19, v87, s[4:7], s23 offen offset:2816
  v_lshlrev_b32 v7, 4, v5
  v_add_u32 v7, 49152, v7
  ds_read_b128 v[8:11], v7 offset:0
  ds_read_b128 v[12:15], v7 offset:64
  ds_read_b128 v[16:19], v7 offset:128
  ds_read_b128 v[20:23], v7 offset:192
  ds_read_b128 v[24:27], v7 offset:256
  ds_read_b128 v[28:31], v7 offset:320
  ds_read_b128 v[32:35], v7 offset:384
  ds_read_b128 v[36:39], v7 offset:448
  ds_read_b128 v[40:43], v7 offset:512
  ds_read_b128 v[44:47], v7 offset:576
  ds_read_b128 v[48:51], v7 offset:640
  ds_read_b128 v[52:55], v7 offset:704
  s_waitcnt lgkmcnt(0)
  v_pk_add_f32 v[8:9], v[8:9], v[20:21]
  v_pk_add_f32 v[10:11], v[10:11], v[22:23]
  v_pk_add_f32 v[12:13], v[12:13], v[24:25]
  v_pk_add_f32 v[14:15], v[14:15], v[26:27]
  v_pk_add_f32 v[16:17], v[16:17], v[28:29]
  v_pk_add_f32 v[18:19], v[18:19], v[30:31]
  v_pk_add_f32 v[8:9], v[8:9], v[32:33]
  v_pk_add_f32 v[10:11], v[10:11], v[34:35]
  v_pk_add_f32 v[12:13], v[12:13], v[36:37]
  v_pk_add_f32 v[14:15], v[14:15], v[38:39]
  v_pk_add_f32 v[16:17], v[16:17], v[40:41]
  v_pk_add_f32 v[18:19], v[18:19], v[42:43]
  v_pk_add_f32 v[8:9], v[8:9], v[44:45]
  v_pk_add_f32 v[10:11], v[10:11], v[46:47]
  v_pk_add_f32 v[12:13], v[12:13], v[48:49]
  v_pk_add_f32 v[14:15], v[14:15], v[50:51]
  v_pk_add_f32 v[16:17], v[16:17], v[52:53]
  v_pk_add_f32 v[18:19], v[18:19], v[54:55]
  s_cmp_lg_u32 s8, 0
  s_cbranch_scc1 csv_22
  v_lshlrev_b32 v7, 4, v5
  s_lshl_b32 s17, s2, 9
  s_add_u32 s17, s17, 0xdb0140
  s_mov_b32 exec_lo, 0x00010001
  s_mov_b32 exec_hi, 0x00010001
  buffer_store_dwordx4 v[8:11], v7, s[4:7], s17 offen offset:0 sc1
  buffer_store_dwordx4 v[12:15], v7, s[4:7], s17 offen offset:64 sc1
  buffer_store_dwordx4 v[16:19], v7, s[4:7], s17 offen offset:128 sc1
  s_mov_b64 exec, -1
csv_22:
  ds_read_b128 v[44:47], v2 offset:36864
  ds_read_b128 v[48:51], v2 offset:37888
  ds_read_b128 v[52:55], v2 offset:38912
  ds_read_b128 v[56:59], v2 offset:39936
  ds_read_b128 v[60:63], v2 offset:40960
  ds_read_b128 v[64:67], v2 offset:41984
  s_waitcnt lgkmcnt(5)
  v_mfma_f32_16x16x32_bf16 v[20:23], v[44:47], v[88:91], 0
  ds_read_b128 v[68:71], v2 offset:43008
  v_mfma_f32_16x16x32_bf16 v[32:35], v[44:47], v[92:95], 0
  ds_read_b128 v[72:75], v2 offset:44032
  s_waitcnt lgkmcnt(6)
  v_mfma_f32_16x16x32_bf16 v[24:27], v[48:51], v[88:91], 0
  ds_read_b128 v[76:79], v2 offset:45056
  v_mfma_f32_16x16x32_bf16 v[36:39], v[48:51], v[92:95], 0
  s_waitcnt lgkmcnt(6)
  v_mfma_f32_16x16x32_bf16 v[28:31], v[52:55], v[88:91], 0
  v_mfma_f32_16x16x32_bf16 v[40:43], v[52:55], v[92:95], 0
  s_waitcnt lgkmcnt(5)
  v_mfma_f32_16x16x32_bf16 v[20:23], v[56:59], v[96:99], v[20:23]
  ds_read_b128 v[44:47], v2 offset:46080
  v_mfma_f32_16x16x32_bf16 v[32:35], v[56:59], v[100:103], v[32:35]
  ds_read_b128 v[48:51], v2 offset:47104
  s_waitcnt lgkmcnt(6)
  v_mfma_f32_16x16x32_bf16 v[24:27], v[60:63], v[96:99], v[24:27]
  ds_read_b128 v[52:55], v2 offset:48128
  v_mfma_f32_16x16x32_bf16 v[36:39], v[60:63], v[100:103], v[36:39]
  s_waitcnt lgkmcnt(6)
  v_mfma_f32_16x16x32_bf16 v[28:31], v[64:67], v[96:99], v[28:31]
  v_mfma_f32_16x16x32_bf16 v[40:43], v[64:67], v[100:103], v[40:43]
  s_waitcnt lgkmcnt(5)
  v_mfma_f32_16x16x32_bf16 v[20:23], v[68:71], v[104:107], v[20:23]
  ds_read_b128 v[56:59], v2 offset:49152
  v_mfma_f32_16x16x32_bf16 v[32:35], v[68:71], v[108:111], v[32:35]
  ds_read_b128 v[60:63], v2 offset:50176
  s_waitcnt lgkmcnt(6)
  v_mfma_f32_16x16x32_bf16 v[24:27], v[72:75], v[104:107], v[24:27]
  ds_read_b128 v[64:67], v2 offset:51200
  v_mfma_f32_16x16x32_bf16 v[36:39], v[72:75], v[108:111], v[36:39]
  s_waitcnt lgkmcnt(6)
  v_mfma_f32_16x16x32_bf16 v[28:31], v[76:79], v[104:107], v[28:31]
  v_mfma_f32_16x16x32_bf16 v[40:43], v[76:79], v[108:111], v[40:43]
  s_waitcnt lgkmcnt(5)
  v_mfma_f32_16x16x32_bf16 v[20:23], v[44:47], v[112:115], v[20:23]
  ds_read_b128 v[68:71], v2 offset:52224
  v_mfma_f32_16x16x32_bf16 v[32:35], v[44:47], v[116:119], v[32:35]
  ds_read_b128 v[72:75], v2 offset:53248
  s_waitcnt lgkmcnt(6)
  v_mfma_f32_16x16x32_bf16 v[24:27], v[48:51], v[112:115], v[24:27]
  ds_read_b128 v[76:79], v2 offset:54272
  v_mfma_f32_16x16x32_bf16 v[36:39], v[48:51], v[116:119], v[36:39]
  s_waitcnt lgkmcnt(6)
  v_mfma_f32_16x16x32_bf16 v[28:31], v[52:55], v[112:115], v[28:31]
  v_mfma_f32_16x16x32_bf16 v[40:43], v[52:55], v[116:119], v[40:43]
  s_waitcnt lgkmcnt(5)
  v_mfma_f32_16x16x32_bf16 v[20:23], v[56:59], v[120:123], v[20:23]
  ds_read_b128 v[44:47], v2 offset:55296
  v_mfma_f32_16x16x32_bf16 v[32:35], v[56:59], v[124:127], v[32:35]
  ds_read_b128 v[48:51], v2 offset:56320
  s_waitcnt lgkmcnt(6)
  v_mfma_f32_16x16x32_bf16 v[24:27], v[60:63], v[120:123], v[24:27]
  ds_read_b128 v[52:55], v2 offset:57344
  v_mfma_f32_16x16x32_bf16 v[36:39], v[60:63], v[124:127], v[36:39]
  s_waitcnt lgkmcnt(6)
  v_mfma_f32_16x16x32_bf16 v[28:31], v[64:67], v[120:123], v[28:31]
  v_mfma_f32_16x16x32_bf16 v[40:43], v[64:67], v[124:127], v[40:43]
  s_waitcnt lgkmcnt(5)
  v_mfma_f32_16x16x32_bf16 v[20:23], v[68:71], v[128:131], v[20:23]
  ds_read_b128 v[56:59], v2 offset:58368
  v_mfma_f32_16x16x32_bf16 v[32:35], v[68:71], v[132:135], v[32:35]
  ds_read_b128 v[60:63], v2 offset:59392
  s_waitcnt lgkmcnt(6)
  v_mfma_f32_16x16x32_bf16 v[24:27], v[72:75], v[128:131], v[24:27]
  ds_read_b128 v[64:67], v2 offset:60416
  v_mfma_f32_16x16x32_bf16 v[36:39], v[72:75], v[132:135], v[36:39]
  s_waitcnt lgkmcnt(6)
  v_mfma_f32_16x16x32_bf16 v[28:31], v[76:79], v[128:131], v[28:31]
  v_mfma_f32_16x16x32_bf16 v[40:43], v[76:79], v[132:135], v[40:43]
  s_waitcnt lgkmcnt(5)
  v_mfma_f32_16x16x32_bf16 v[20:23], v[44:47], v[136:139], v[20:23]
  ds_read_b128 v[68:71], v2 offset:61440
  v_mfma_f32_16x16x32_bf16 v[32:35], v[44:47], v[140:143], v[32:35]
  ds_read_b128 v[72:75], v2 offset:62464
  s_waitcnt lgkmcnt(6)
  v_mfma_f32_16x16x32_bf16 v[24:27], v[48:51], v[136:139], v[24:27]
  ds_read_b128 v[76:79], v2 offset:63488
  v_mfma_f32_16x16x32_bf16 v[36:39], v[48:51], v[140:143], v[36:39]
  s_waitcnt lgkmcnt(6)
  v_mfma_f32_16x16x32_bf16 v[28:31], v[52:55], v[136:139], v[28:31]
  v_mfma_f32_16x16x32_bf16 v[40:43], v[52:55], v[140:143], v[40:43]
  s_waitcnt lgkmcnt(5)
  v_mfma_f32_16x16x32_bf16 v[20:23], v[56:59], v[144:147], v[20:23]
  ds_read_b128 v[44:47], v2 offset:64512
  v_mfma_f32_16x16x32_bf16 v[32:35], v[56:59], v[148:151], v[32:35]
  ds_read_b128 v[48:51], v3 offset:0
  s_waitcnt lgkmcnt(6)
  v_mfma_f32_16x16x32_bf16 v[24:27], v[60:63], v[144:147], v[24:27]
  ds_read_b128 v[52:55], v3 offset:1024
  v_mfma_f32_16x16x32_bf16 v[36:39], v[60:63], v[148:151], v[36:39]
  s_waitcnt lgkmcnt(6)
  v_mfma_f32_16x16x32_bf16 v[28:31], v[64:67], v[144:147], v[28:31]
  v_mfma_f32_16x16x32_bf16 v[40:43], v[64:67], v[148:151], v[40:43]
  s_waitcnt vmcnt(0)
  s_cmp_lg_u32 s8, 0
  s_cbranch_scc1 fskip_25
  v_accvgpr_read_b32 v84, a220
  v_accvgpr_read_b32 v85, a221
  v_accvgpr_read_b32 v86, a222
  v_accvgpr_read_b32 v87, a223
  v_xor_b32 v84, s68, v84
  v_xor_b32 v85, s68, v85
  v_xor_b32 v86, s68, v86
  v_xor_b32 v87, s68, v87
  v_or3_b32 v84, v84, v85, v86
  v_or_b32 v84, v84, v87
  v_cmp_ne_u32 vcc, 0, v84
  s_nop 3
  s_cmp_eq_u64 vcc, 0
  s_cbranch_scc1 fdone_24
  s_mov_b32 s18, 0
  s_and_b32 s17, s2, 3
  s_lshl_b32 s17, s17, 10
  s_add_u32 s17, s17, 0xd90000
fpoll_23:
  buffer_load_dwordx4 v[84:87], v1, s[4:7], s17 offen sc1
  s_waitcnt vmcnt(0)
  v_xor_b32 v84, s68, v84
  v_xor_b32 v85, s68, v85
  v_xor_b32 v86, s68, v86
  v_xor_b32 v87, s68, v87
  v_or3_b32 v84, v84, v85, v86
  v_or_b32 v84, v84, v87
  v_cmp_ne_u32 vcc, 0, v84
  s_nop 3
  s_cmp_eq_u64 vcc, 0
  s_cbranch_scc1 fdone_24
  s_add_u32 s18, s18, 1
  s_cmp_lt_u32 s18, 0x20000
  s_cbranch_scc1 fpoll_23
  s_mov_b32 s58, 1
fdone_24:
fskip_25:
  s_barrier
  s_cmp_lg_u32 s8, 0
  s_cbranch_scc1 sig_26
  s_lshl_b32 s17, s10, 7
  s_add_u32 s17, s17, s57
  s_add_u32 s17, s17, 0
  s_mov_b64 exec, 1
  v_mov_b32 v7, 1
  buffer_atomic_add v7, off, s[4:7], s17
  s_mov_b64 exec, -1
sig_26:
  s_waitcnt lgkmcnt(5)
  v_mfma_f32_16x16x32_bf16 v[20:23], v[68:71], v[152:155], v[20:23]
  ds_read_b128 v[56:59], v3 offset:2048
  v_mfma_f32_16x16x32_bf16 v[32:35], v[68:71], v[156:159], v[32:35]
  ds_read_b128 v[60:63], v3 offset:3072
  s_waitcnt lgkmcnt(6)
  v_mfma_f32_16x16x32_bf16 v[24:27], v[72:75], v[152:155], v[24:27]
  ds_read_b128 v[64:67], v3 offset:4096
  s_lshr_b32 s17, s2, 3
  s_and_b32 s17, s17, 31
  s_lshl_b32 s17, s17, 2
  s_add_u32 s17, s17, s8
  s_mul_i32 s17, s17, 6400
  s_add_u32 s17, s17, 0x1100000
  v_lshlrev_b32 v7, 7, v4
  buffer_load_dword v255, v7, s[4:7], s17 offen sc1
  v_mfma_f32_16x16x32_bf16 v[36:39], v[72:75], v[156:159], v[36:39]
  s_waitcnt lgkmcnt(6)
  v_mfma_f32_16x16x32_bf16 v[28:31], v[76:79], v[152:155], v[28:31]
  v_mfma_f32_16x16x32_bf16 v[40:43], v[76:79], v[156:159], v[40:43]
  s_waitcnt lgkmcnt(5)
  v_mfma_f32_16x16x32_bf16 v[20:23], v[44:47], v[160:163], v[20:23]
  ds_read_b128 v[68:71], v3 offset:5120
  v_mfma_f32_16x16x32_bf16 v[32:35], v[44:47], v[164:167], v[32:35]
  ds_read_b128 v[72:75], v3 offset:6144
  s_waitcnt lgkmcnt(6)
  v_mfma_f32_16x16x32_bf16 v[24:27], v[48:51], v[160:163], v[24:27]
  ds_read_b128 v[76:79], v3 offset:7168
  s_lshr_b32 s17, s2, 3
  s_and_b32 s17, s17, 31
  s_lshl_b32 s17, s17, 2
  s_add_u32 s17, s17, s8
  s_mul_i32 s17, s17, 6400
  s_add_u32 s17, s17, 0x1100800
  v_lshlrev_b32 v7, 7, v4
  buffer_load_dword v255, v7, s[4:7], s17 offen sc1
  v_mfma_f32_16x16x32_bf16 v[36:39], v[48:51], v[164:167], v[36:39]
  s_waitcnt lgkmcnt(6)
  v_mfma_f32_16x16x32_bf16 v[28:31], v[52:55], v[160:163], v[28:31]
  v_mfma_f32_16x16x32_bf16 v[40:43], v[52:55], v[164:167], v[40:43]
  s_waitcnt lgkmcnt(5)
  v_mfma_f32_16x16x32_bf16 v[20:23], v[56:59], v[168:171], v[20:23]
  ds_read_b128 v[44:47], v3 offset:8192
  v_mfma_f32_16x16x32_bf16 v[32:35], v[56:59], v[172:175], v[32:35]
  ds_read_b128 v[48:51], v3 offset:9216
  s_waitcnt lgkmcnt(6)
  v_mfma_f32_16x16x32_bf16 v[24:27], v[60:63], v[168:171], v[24:27]
  ds_read_b128 v[52:55], v3 offset:10240
  s_lshr_b32 s17, s2, 3
  s_and_b32 s17, s17, 31
  s_lshl_b32 s17, s17, 2
  s_add_u32 s17, s17, s8
  s_mul_i32 s17, s17, 6400
  s_add_u32 s17, s17, 0x1101000
  v_lshlrev_b32 v7, 7, v4
  buffer_load_dword v255, v7, s[4:7], s17 offen sc1
  v_mfma_f32_16x16x32_bf16 v[36:39], v[60:63], v[172:175], v[36:39]
  s_waitcnt lgkmcnt(6)
  v_mfma_f32_16x16x32_bf16 v[28:31], v[64:67], v[168:171], v[28:31]
  v_mfma_f32_16x16x32_bf16 v[40:43], v[64:67], v[172:175], v[40:43]
  s_waitcnt lgkmcnt(5)
  v_mfma_f32_16x16x32_bf16 v[20:23], v[68:71], v[176:179], v[20:23]
  ds_read_b128 v[56:59], v3 offset:11264
  v_mfma_f32_16x16x32_bf16 v[32:35], v[68:71], v[180:183], v[32:35]
  ds_read_b128 v[60:63], v3 offset:12288
  s_waitcnt lgkmcnt(6)
  v_mfma_f32_16x16x32_bf16 v[24:27], v[72:75], v[176:179], v[24:27]
  ds_read_b128 v[64:67], v3 offset:13312
  s_lshr_b32 s17, s2, 3
  s_and_b32 s17, s17, 31
  s_lshl_b32 s17, s17, 2
  s_add_u32 s17, s17, s8
  s_mul_i32 s17, s17, 6400
  s_add_u32 s17, s17, 0x1101800
  v_lshlrev_b32 v7, 7, v4
  buffer_load_dword v255, v7, s[4:7], s17 offen sc1
  v_mfma_f32_16x16x32_bf16 v[36:39], v[72:75], v[180:183], v[36:39]
  s_waitcnt lgkmcnt(6)
  v_mfma_f32_16x16x32_bf16 v[28:31], v[76:79], v[176:179], v[28:31]
  v_mfma_f32_16x16x32_bf16 v[40:43], v[76:79], v[180:183], v[40:43]
  s_waitcnt lgkmcnt(5)
  v_mfma_f32_16x16x32_bf16 v[20:23], v[44:47], v[184:187], v[20:23]
  ds_read_b128 v[68:71], v3 offset:14336
  v_mfma_f32_16x16x32_bf16 v[32:35], v[44:47], v[188:191], v[32:35]
  ds_read_b128 v[72:75], v3 offset:15360
  s_waitcnt lgkmcnt(6)
  v_mfma_f32_16x16x32_bf16 v[24:27], v[48:51], v[184:187], v[24:27]
  ds_read_b128 v[76:79], v3 offset:16384
  s_add_u32 s17, s62, 0
  buffer_load_dwordx4 a[0:3], v1, s[4:7], s17 offen offset:0 sc1
  v_mfma_f32_16x16x32_bf16 v[36:39], v[48:51], v[188:191], v[36:39]
  s_waitcnt lgkmcnt(6)
  v_mfma_f32_16x16x32_bf16 v[28:31], v[52:55], v[184:187], v[28:31]
  v_mfma_f32_16x16x32_bf16 v[40:43], v[52:55], v[188:191], v[40:43]
  s_waitcnt lgkmcnt(5)
  v_mfma_f32_16x16x32_bf16 v[20:23], v[56:59], v[192:195], v[20:23]
  ds_read_b128 v[44:47], v3 offset:17408
  v_mfma_f32_16x16x32_bf16 v[32:35], v[56:59], v[196:199], v[32:35]
  ds_read_b128 v[48:51], v3 offset:18432
  s_waitcnt lgkmcnt(6)
  v_mfma_f32_16x16x32_bf16 v[24:27], v[60:63], v[192:195], v[24:27]
  ds_read_b128 v[52:55], v3 offset:19456
  s_add_u32 s17, s62, 0
  buffer_load_dwordx4 a[4:7], v1, s[4:7], s17 offen offset:1024 sc1
  v_mfma_f32_16x16x32_bf16 v[36:39], v[60:63], v[196:199], v[36:39]
  s_waitcnt lgkmcnt(6)
  v_mfma_f32_16x16x32_bf16 v[28:31], v[64:67], v[192:195], v[28:31]
  v_mfma_f32_16x16x32_bf16 v[40:43], v[64:67], v[196:199], v[40:43]
  s_waitcnt lgkmcnt(5)
  v_mfma_f32_16x16x32_bf16 v[20:23], v[68:71], v[200:203], v[20:23]
  ds_read_b128 v[56:59], v3 offset:20480
  v_mfma_f32_16x16x32_bf16 v[32:35], v[68:71], v[204:207], v[32:35]
  ds_read_b128 v[60:63], v3 offset:21504
  s_waitcnt lgkmcnt(6)
  v_mfma_f32_16x16x32_bf16 v[24:27], v[72:75], v[200:203], v[24:27]
  ds_read_b128 v[64:67], v3 offset:22528
  s_add_u32 s17, s62, 0
  buffer_load_dwordx4 a[8:11], v1, s[4:7], s17 offen offset:2048 sc1
  v_mfma_f32_16x16x32_bf16 v[36:39], v[72:75], v[204:207], v[36:39]
  s_waitcnt lgkmcnt(6)
  v_mfma_f32_16x16x32_bf16 v[28:31], v[76:79], v[200:203], v[28:31]
  v_mfma_f32_16x16x32_bf16 v[40:43], v[76:79], v[204:207], v[40:43]
  s_waitcnt lgkmcnt(5)
  v_mfma_f32_16x16x32_bf16 v[20:23], v[44:47], v[208:211], v[20:23]
  ds_read_b128 v[68:71], v3 offset:23552
  v_mfma_f32_16x16x32_bf16 v[32:35], v[44:47], v[212:215], v[32:35]
  ds_read_b128 v[72:75], v3 offset:24576
  s_waitcnt lgkmcnt(6)
  v_mfma_f32_16x16x32_bf16 v[24:27], v[48:51], v[208:211], v[24:27]
  ds_read_b128 v[76:79], v3 offset:25600
  s_add_u32 s17, s62, 0
  buffer_load_dwordx4 a[12:15], v1, s[4:7], s17 offen offset:3072 sc1
  v_mfma_f32_16x16x32_bf16 v[36:39], v[48:51], v[212:215], v[36:39]
  s_waitcnt lgkmcnt(6)
  v_mfma_f32_16x16x32_bf16 v[28:31], v[52:55], v[208:211], v[28:31]
  v_mfma_f32_16x16x32_bf16 v[40:43], v[52:55], v[212:215], v[40:43]
  s_waitcnt lgkmcnt(5)
  v_mfma_f32_16x16x32_bf16 v[20:23], v[56:59], v[216:219], v[20:23]
  ds_read_b128 v[44:47], v3 offset:26624
  v_mfma_f32_16x16x32_bf16 v[32:35], v[56:59], v[220:223], v[32:35]
  ds_read_b128 v[48:51], v3 offset:27648
  s_waitcnt lgkmcnt(6)
  v_mfma_f32_16x16x32_bf16 v[24:27], v[60:63], v[216:219], v[24:27]
  ds_read_b128 v[52:55], v3 offset:28672
  s_add_u32 s17, s62, 4096
  buffer_load_dwordx4 a[16:19], v1, s[4:7], s17 offen offset:0 sc1
  v_mfma_f32_16x16x32_bf16 v[36:39], v[60:63], v[220:223], v[36:39]
  s_waitcnt lgkmcnt(6)
  v_mfma_f32_16x16x32_bf16 v[28:31], v[64:67], v[216:219], v[28:31]
  v_mfma_f32_16x16x32_bf16 v[40:43], v[64:67], v[220:223], v[40:43]
  s_waitcnt lgkmcnt(5)
  v_mfma_f32_16x16x32_bf16 v[20:23], v[68:71], v[224:227], v[20:23]
  ds_read_b128 v[56:59], v3 offset:29696
  v_mfma_f32_16x16x32_bf16 v[32:35], v[68:71], v[228:231], v[32:35]
  ds_read_b128 v[60:63], v3 offset:30720
  s_waitcnt lgkmcnt(6)
  v_mfma_f32_16x16x32_bf16 v[24:27], v[72:75], v[224:227], v[24:27]
  ds_read_b128 v[64:67], v3 offset:31744
  s_add_u32 s17, s62, 20480
  buffer_load_dwordx4 a[20:23], v1, s[4:7], s17 offen offset:0 sc1
  v_mfma_f32_16x16x32_bf16 v[36:39], v[72:75], v[228:231], v[36:39]
  s_waitcnt lgkmcnt(6)
  v_mfma_f32_16x16x32_bf16 v[28:31], v[76:79], v[224:227], v[28:31]
  v_mfma_f32_16x16x32_bf16 v[40:43], v[76:79], v[228:231], v[40:43]
  s_waitcnt lgkmcnt(5)
  v_mfma_f32_16x16x32_bf16 v[20:23], v[44:47], v[232:235], v[20:23]
  v_mfma_f32_16x16x32_bf16 v[32:35], v[44:47], v[236:239], v[32:35]
  s_waitcnt lgkmcnt(4)
  v_mfma_f32_16x16x32_bf16 v[24:27], v[48:51], v[232:235], v[24:27]
  s_add_u32 s17, s62, 20480
  buffer_load_dwordx4 a[24:27], v1, s[4:7], s17 offen offset:1024 sc1
  v_mfma_f32_16x16x32_bf16 v[36:39], v[48:51], v[236:239], v[36:39]
  s_waitcnt lgkmcnt(3)
  v_mfma_f32_16x16x32_bf16 v[28:31], v[52:55], v[232:235], v[28:31]
  v_mfma_f32_16x16x32_bf16 v[40:43], v[52:55], v[236:239], v[40:43]
  s_waitcnt lgkmcnt(2)
  v_mfma_f32_16x16x32_bf16 v[20:23], v[56:59], v[240:243], v[20:23]
  v_mfma_f32_16x16x32_bf16 v[32:35], v[56:59], v[244:247], v[32:35]
  s_waitcnt lgkmcnt(1)
  v_mfma_f32_16x16x32_bf16 v[24:27], v[60:63], v[240:243], v[24:27]
  s_add_u32 s17, s62, 20480
  buffer_load_dwordx4 a[28:31], v1, s[4:7], s17 offen offset:2048 sc1
  v_mfma_f32_16x16x32_bf16 v[36:39], v[60:63], v[244:247], v[36:39]
  s_waitcnt lgkmcnt(0)
  v_mfma_f32_16x16x32_bf16 v[28:31], v[64:67], v[240:243], v[28:31]
  v_mfma_f32_16x16x32_bf16 v[40:43], v[64:67], v[244:247], v[40:43]
  s_barrier
  v_mov_b32 v146, 0
  v_mov_b32 v147, 0
  v_mov_b32 v158, 0
  v_mov_b32 v159, 0
  v_pk_fma_f32 v[20:21], v[8:9], v[248:249], v[20:21] op_sel:[0,1,0] op_sel_hi:[1,1,1]
  v_pk_fma_f32 v[22:23], v[10:11], v[248:249], v[22:23] op_sel:[0,1,0] op_sel_hi:[1,1,1]
  v_pk_fma_f32 v[24:25], v[12:13], v[248:249], v[24:25] op_sel:[0,1,0] op_sel_hi:[1,1,1]
  v_pk_fma_f32 v[26:27], v[14:15], v[248:249], v[26:27] op_sel:[0,1,0] op_sel_hi:[1,1,1]
  v_pk_fma_f32 v[28:29], v[16:17], v[248:249], v[28:29] op_sel:[0,1,0] op_sel_hi:[1,1,1]
  v_max3_f32 v108, v20, v21, v22
  v_max3_f32 v109, -v20, -v21, -v22
  v_max3_f32 v108, v108, v23, v24
  v_max3_f32 v109, v109, -v23, -v24
  v_max3_f32 v108, v108, v25, v26
  v_max3_f32 v109, v109, -v25, -v26
  v_max3_f32 v108, v108, v27, v28
  v_max3_f32 v109, v109, -v27, -v28
  v_max_f32 v108, v108, v29
  v_max_f32 v109, v109, -v29
  s_nop 1
  v_permlane16_swap_b32 v108, v109
  v_max_f32 v108, v108, v109
  v_mov_b32 v109, v108
  s_nop 1
  v_permlane16_swap_b32 v108, v109
  v_mul_f32 v110, v108, v248
  v_mul_f32 v112, v109, v248
  v_pk_fma_f32 v[88:89], v[20:21], v[248:249], v[110:111] op_sel_hi:[1,0,0] neg_lo:[0,0,1] neg_hi:[0,0,1]
  v_pk_fma_f32 v[98:99], v[20:21], v[248:249], v[112:113] op_sel_hi:[1,0,0] neg_lo:[1,0,1] neg_hi:[1,0,1]
  s_add_u32 s17, s62, 20480
  buffer_load_dwordx4 a[32:35], v1, s[4:7], s17 offen offset:3072 sc1
  v_pk_fma_f32 v[90:91], v[22:23], v[248:249], v[110:111] op_sel_hi:[1,0,0] neg_lo:[0,0,1] neg_hi:[0,0,1]
  v_pk_fma_f32 v[100:101], v[22:23], v[248:249], v[112:113] op_sel_hi:[1,0,0] neg_lo:[1,0,1] neg_hi:[1,0,1]
  v_pk_fma_f32 v[92:93], v[24:25], v[248:249], v[110:111] op_sel_hi:[1,0,0] neg_lo:[0,0,1] neg_hi:[0,0,1]
  v_pk_fma_f32 v[102:103], v[24:25], v[248:249], v[112:113] op_sel_hi:[1,0,0] neg_lo:[1,0,1] neg_hi:[1,0,1]
  v_pk_fma_f32 v[94:95], v[26:27], v[248:249], v[110:111] op_sel_hi:[1,0,0] neg_lo:[0,0,1] neg_hi:[0,0,1]
  v_pk_fma_f32 v[104:105], v[26:27], v[248:249], v[112:113] op_sel_hi:[1,0,0] neg_lo:[1,0,1] neg_hi:[1,0,1]
  v_pk_fma_f32 v[96:97], v[28:29], v[248:249], v[110:111] op_sel_hi:[1,0,0] neg_lo:[0,0,1] neg_hi:[0,0,1]
  v_pk_fma_f32 v[106:107], v[28:29], v[248:249], v[112:113] op_sel_hi:[1,0,0] neg_lo:[1,0,1] neg_hi:[1,0,1]
  s_add_u32 s17, s62, 24576
  buffer_load_dwordx4 a[36:39], v1, s[4:7], s17 offen offset:0 sc1
  v_exp_f32 v88, v88
  v_exp_f32 v98, v98
  v_exp_f32 v89, v89
  v_exp_f32 v99, v99
  s_add_u32 s17, s62, 40960
  buffer_load_dwordx4 a[40:43], v1, s[4:7], s17 offen offset:0 sc1
  v_exp_f32 v90, v90
  v_exp_f32 v100, v100
  v_exp_f32 v91, v91
  v_exp_f32 v101, v101
  s_add_u32 s17, s62, 40960
  buffer_load_dwordx4 a[44:47], v1, s[4:7], s17 offen offset:1024 sc1
  v_exp_f32 v92, v92
  v_exp_f32 v102, v102
  v_exp_f32 v93, v93
  v_exp_f32 v103, v103
  s_add_u32 s17, s62, 40960
  buffer_load_dwordx4 a[48:51], v1, s[4:7], s17 offen offset:2048 sc1
  v_exp_f32 v94, v94
  v_exp_f32 v104, v104
  v_exp_f32 v95, v95
  v_exp_f32 v105, v105
  s_add_u32 s17, s62, 40960
  buffer_load_dwordx4 a[52:55], v1, s[4:7], s17 offen offset:3072 sc1
  v_exp_f32 v96, v96
  v_exp_f32 v106, v106
  v_exp_f32 v97, v97
  v_exp_f32 v107, v107
  s_add_u32 s17, s62, 45056
  buffer_load_dwordx4 a[56:59], v1, s[4:7], s17 offen offset:0 sc1
  v_pk_add_f32 v[110:111], v[88:89], v[90:91]
  v_pk_add_f32 v[112:113], v[98:99], v[100:101]
  v_pk_add_f32 v[110:111], v[110:111], v[92:93]
  v_pk_add_f32 v[112:113], v[112:113], v[102:103]
  v_pk_add_f32 v[110:111], v[110:111], v[94:95]
  v_pk_add_f32 v[112:113], v[112:113], v[104:105]
  v_pk_add_f32 v[110:111], v[110:111], v[96:97]
  v_pk_add_f32 v[112:113], v[112:113], v[106:107]
  s_add_u32 s17, s62, 61440
  buffer_load_dwordx4 a[60:63], v1, s[4:7], s17 offen offset:0 sc1
  v_add_f32 v110, v110, v111
  v_add_f32 v112, v112, v113
  s_nop 1
  v_permlane16_swap_b32 v110, v112
  v_add_f32 v110, v110, v112
  v_mov_b32 v112, v110
  s_nop 1
  v_permlane16_swap_b32 v110, v112
  v_rcp_f32 v110, v110
  v_rcp_f32 v112, v112
  v_pk_mul_f32 v[88:89], v[88:89], v[110:111] op_sel_hi:[1,0]
  v_pk_mul_f32 v[98:99], v[98:99], v[112:113] op_sel_hi:[1,0]
  v_pk_mul_f32 v[90:91], v[90:91], v[110:111] op_sel_hi:[1,0]
  v_pk_mul_f32 v[100:101], v[100:101], v[112:113] op_sel_hi:[1,0]
  v_pk_mul_f32 v[92:93], v[92:93], v[110:111] op_sel_hi:[1,0]
  v_pk_mul_f32 v[102:103], v[102:103], v[112:113] op_sel_hi:[1,0]
  s_add_u32 s17, s62, 61440
  buffer_load_dwordx4 a[64:67], v1, s[4:7], s17 offen offset:1024 sc1
  v_pk_mul_f32 v[94:95], v[94:95], v[110:111] op_sel_hi:[1,0]
  v_pk_mul_f32 v[104:105], v[104:105], v[112:113] op_sel_hi:[1,0]
  v_pk_mul_f32 v[96:97], v[96:97], v[110:111] op_sel_hi:[1,0]
  v_pk_mul_f32 v[106:107], v[106:107], v[112:113] op_sel_hi:[1,0]
  v_cvt_pk_bf16_f32 v136, v88, v89
  v_cvt_pk_bf16_f32 v137, v90, v91
  v_cvt_pk_bf16_f32 v138, v92, v93
  v_cvt_pk_bf16_f32 v139, v94, v95
  v_cvt_pk_bf16_f32 v140, v96, v97
  s_add_u32 s17, s62, 61440
  buffer_load_dwordx4 a[68:71], v1, s[4:7], s17 offen offset:2048 sc1
  v_cvt_pk_bf16_f32 v141, v98, v99
  v_cvt_pk_bf16_f32 v142, v100, v101
  v_cvt_pk_bf16_f32 v143, v102, v103
  v_cvt_pk_bf16_f32 v144, v104, v105
  v_cvt_pk_bf16_f32 v145, v106, v107
  v_pk_fma_f32 v[32:33], v[8:9], v[252:253], v[32:33] op_sel:[0,1,0] op_sel_hi:[1,1,1]
  v_pk_fma_f32 v[34:35], v[10:11], v[252:253], v[34:35] op_sel:[0,1,0] op_sel_hi:[1,1,1]
  v_pk_fma_f32 v[36:37], v[12:13], v[252:253], v[36:37] op_sel:[0,1,0] op_sel_hi:[1,1,1]
  v_pk_fma_f32 v[38:39], v[14:15], v[252:253], v[38:39] op_sel:[0,1,0] op_sel_hi:[1,1,1]
  v_pk_fma_f32 v[40:41], v[16:17], v[252:253], v[40:41] op_sel:[0,1,0] op_sel_hi:[1,1,1]
  v_max3_f32 v108, v32, v33, v34
  v_max3_f32 v109, -v32, -v33, -v34
  v_max3_f32 v108, v108, v35, v36
  v_max3_f32 v109, v109, -v35, -v36
  v_max3_f32 v108, v108, v37, v38
  v_max3_f32 v109, v109, -v37, -v38
  v_max3_f32 v108, v108, v39, v40
  v_max3_f32 v109, v109, -v39, -v40
  v_max_f32 v108, v108, v41
  v_max_f32 v109, v109, -v41
  s_nop 1
  v_permlane16_swap_b32 v108, v109
  v_max_f32 v108, v108, v109
  v_mov_b32 v109, v108
  s_nop 1
  v_permlane16_swap_b32 v108, v109
  v_mul_f32 v110, v108, v252
  v_mul_f32 v112, v109, v252
  v_pk_fma_f32 v[88:89], v[32:33], v[252:253], v[110:111] op_sel_hi:[1,0,0] neg_lo:[0,0,1] neg_hi:[0,0,1]
  v_pk_fma_f32 v[98:99], v[32:33], v[252:253], v[112:113] op_sel_hi:[1,0,0] neg_lo:[1,0,1] neg_hi:[1,0,1]
  v_pk_fma_f32 v[90:91], v[34:35], v[252:253], v[110:111] op_sel_hi:[1,0,0] neg_lo:[0,0,1] neg_hi:[0,0,1]
  v_pk_fma_f32 v[100:101], v[34:35], v[252:253], v[112:113] op_sel_hi:[1,0,0] neg_lo:[1,0,1] neg_hi:[1,0,1]
  v_pk_fma_f32 v[92:93], v[36:37], v[252:253], v[110:111] op_sel_hi:[1,0,0] neg_lo:[0,0,1] neg_hi:[0,0,1]
  v_pk_fma_f32 v[102:103], v[36:37], v[252:253], v[112:113] op_sel_hi:[1,0,0] neg_lo:[1,0,1] neg_hi:[1,0,1]
  v_pk_fma_f32 v[94:95], v[38:39], v[252:253], v[110:111] op_sel_hi:[1,0,0] neg_lo:[0,0,1] neg_hi:[0,0,1]
  v_pk_fma_f32 v[104:105], v[38:39], v[252:253], v[112:113] op_sel_hi:[1,0,0] neg_lo:[1,0,1] neg_hi:[1,0,1]
  v_pk_fma_f32 v[96:97], v[40:41], v[252:253], v[110:111] op_sel_hi:[1,0,0] neg_lo:[0,0,1] neg_hi:[0,0,1]
  v_pk_fma_f32 v[106:107], v[40:41], v[252:253], v[112:113] op_sel_hi:[1,0,0] neg_lo:[1,0,1] neg_hi:[1,0,1]
  v_exp_f32 v88, v88
  v_exp_f32 v98, v98
  v_exp_f32 v89, v89
  v_exp_f32 v99, v99
  v_exp_f32 v90, v90
  v_exp_f32 v100, v100
  v_exp_f32 v91, v91
  v_exp_f32 v101, v101
  v_exp_f32 v92, v92
  v_exp_f32 v102, v102
  v_exp_f32 v93, v93
  v_exp_f32 v103, v103
  v_exp_f32 v94, v94
  v_exp_f32 v104, v104
  v_exp_f32 v95, v95
  v_exp_f32 v105, v105
  v_exp_f32 v96, v96
  v_exp_f32 v106, v106
  v_exp_f32 v97, v97
  v_exp_f32 v107, v107
  v_pk_add_f32 v[110:111], v[88:89], v[90:91]
  v_pk_add_f32 v[112:113], v[98:99], v[100:101]
  v_pk_add_f32 v[110:111], v[110:111], v[92:93]
  v_pk_add_f32 v[112:113], v[112:113], v[102:103]
  v_pk_add_f32 v[110:111], v[110:111], v[94:95]
  v_pk_add_f32 v[112:113], v[112:113], v[104:105]
  v_pk_add_f32 v[110:111], v[110:111], v[96:97]
  v_pk_add_f32 v[112:113], v[112:113], v[106:107]
  v_add_f32 v110, v110, v111
  v_add_f32 v112, v112, v113
  s_nop 1
  v_permlane16_swap_b32 v110, v112
  v_add_f32 v110, v110, v112
  v_mov_b32 v112, v110
  s_nop 1
  v_permlane16_swap_b32 v110, v112
  v_rcp_f32 v110, v110
  v_rcp_f32 v112, v112
  v_pk_mul_f32 v[88:89], v[88:89], v[110:111] op_sel_hi:[1,0]
  v_pk_mul_f32 v[98:99], v[98:99], v[112:113] op_sel_hi:[1,0]
  v_pk_mul_f32 v[90:91], v[90:91], v[110:111] op_sel_hi:[1,0]
  v_pk_mul_f32 v[100:101], v[100:101], v[112:113] op_sel_hi:[1,0]
  v_pk_mul_f32 v[92:93], v[92:93], v[110:111] op_sel_hi:[1,0]
  v_pk_mul_f32 v[102:103], v[102:103], v[112:113] op_sel_hi:[1,0]
  v_pk_mul_f32 v[94:95], v[94:95], v[110:111] op_sel_hi:[1,0]
  v_pk_mul_f32 v[104:105], v[104:105], v[112:113] op_sel_hi:[1,0]
  v_pk_mul_f32 v[96:97], v[96:97], v[110:111] op_sel_hi:[1,0]
  v_pk_mul_f32 v[106:107], v[106:107], v[112:113] op_sel_hi:[1,0]
  v_cvt_pk_bf16_f32 v148, v88, v89
  v_cvt_pk_bf16_f32 v149, v90, v91
  v_cvt_pk_bf16_f32 v150, v92, v93
  v_cvt_pk_bf16_f32 v151, v94, v95
  v_cvt_pk_bf16_f32 v152, v96, v97
  v_cvt_pk_bf16_f32 v153, v98, v99
  v_cvt_pk_bf16_f32 v154, v100, v101
  v_cvt_pk_bf16_f32 v155, v102, v103
  v_cvt_pk_bf16_f32 v156, v104, v105
  v_cvt_pk_bf16_f32 v157, v106, v107
  s_lshl_b32 s94, s10, 7
  s_add_u32 s94, s94, s57
  s_add_u32 s94, s94, 0
  s_mov_b64 exec, 1
  buffer_load_dword v165, off, s[4:7], s94 sc1
  s_mov_b64 exec, -1
  v_lshrrev_b32 v108, 2, v4
  v_and_b32 v109, 3, v4
  v_lshrrev_b32 v110, 1, v108
  v_mul_u32_u24 v112, 6144, v110
  v_lshl_add_u32 v112, v109, 8, v112
  v_lshrrev_b32 v111, 1, v5
  v_mov_b32 v109, 0x40000000
  v_cmp_eq_u32 vcc, v110, v111
  s_nop 1
  v_cndmask_b32 v112, v109, v112, vcc
  v_and_b32 v110, 1, v108
  v_and_b32 v111, 1, v5
  s_mul_i32 s20, s10, 12288
  s_add_u32 s20, s20, s56
  s_add_u32 s3, s8, 0
  s_min_u32 s3, s3, 8
  s_mul_i32 s35, s3, 43
  s_lshr_b32 s35, s35, 7
  s_mul_i32 s27, s35, 3
  s_sub_u32 s27, s3, s27
  s_lshl_b32 s24, s3, 10
  s_add_u32 s24, s24, 153600
  s_lshl_b32 s28, s35, 6
  s_add_u32 s35, s35, 3
  s_lshr_b32 s29, s35, 2
  s_mul_i32 s29, s29, 3072
  s_and_b32 s35, s35, 3
  s_lshl_b32 s35, s35, 6
  s_add_u32 s29, s29, s35
  s_sub_u32 s29, s29, s28
  v_mul_u32_u24 v160, s29, v110
  v_add3_u32 v160, v160, s28, v112
  s_lshr_b32 s28, s27, 1
  s_lshl_b32 s28, s28, 10
  s_and_b32 s35, s27, 1
  s_lshl_b32 s35, s35, 5
  s_add_u32 s28, s28, s35
  s_add_u32 s27, s27, 3
  s_lshr_b32 s29, s27, 1
  s_lshl_b32 s29, s29, 10
  s_and_b32 s35, s27, 1
  s_lshl_b32 s35, s35, 5
  s_add_u32 s29, s29, s35
  s_sub_u32 s29, s29, s28
  v_mul_u32_u24 v113, s29, v111
  v_add3_u32 v113, v113, s28, v160
  v_mov_b32 v160, v113
  s_add_u32 s3, s8, 4
  s_min_u32 s3, s3, 8
  s_mul_i32 s35, s3, 43
  s_lshr_b32 s35, s35, 7
  s_mul_i32 s27, s35, 3
  s_sub_u32 s27, s3, s27
  s_lshl_b32 s25, s3, 10
  s_add_u32 s25, s25, 153600
  s_lshl_b32 s28, s35, 6
  s_add_u32 s35, s35, 3
  s_lshr_b32 s29, s35, 2
  s_mul_i32 s29, s29, 3072
  s_and_b32 s35, s35, 3
  s_lshl_b32 s35, s35, 6
  s_add_u32 s29, s29, s35
  s_sub_u32 s29, s29, s28
  v_mul_u32_u24 v161, s29, v110
  v_add3_u32 v161, v161, s28, v112
  s_lshr_b32 s28, s27, 1
  s_lshl_b32 s28, s28, 10
  s_and_b32 s35, s27, 1
  s_lshl_b32 s35, s35, 5
  s_add_u32 s28, s28, s35
  s_add_u32 s27, s27, 3
  s_lshr_b32 s29, s27, 1
  s_lshl_b32 s29, s29, 10
  s_and_b32 s35, s27, 1
  s_lshl_b32 s35, s35, 5
  s_add_u32 s29, s29, s35
  s_sub_u32 s29, s29, s28
  v_mul_u32_u24 v113, s29, v111
  v_add3_u32 v113, v113, s28, v161
  v_mov_b32 v161, v113
  s_add_u32 s3, s8, 8
  s_min_u32 s3, s3, 8
  s_mul_i32 s35, s3, 43
  s_lshr_b32 s35, s35, 7
  s_mul_i32 s27, s35, 3
  s_sub_u32 s27, s3, s27
  s_lshl_b32 s26, s3, 10
  s_add_u32 s26, s26, 153600
  s_lshl_b32 s28, s35, 6
  s_add_u32 s35, s35, 3
  s_lshr_b32 s29, s35, 2
  s_mul_i32 s29, s29, 3072
  s_and_b32 s35, s35, 3
  s_lshl_b32 s35, s35, 6
  s_add_u32 s29, s29, s35
  s_sub_u32 s29, s29, s28
  v_mul_u32_u24 v162, s29, v110
  v_add3_u32 v162, v162, s28, v112
  s_lshr_b32 s28, s27, 1
  s_lshl_b32 s28, s28, 10
  s_and_b32 s35, s27, 1
  s_lshl_b32 s35, s35, 5
  s_add_u32 s28, s28, s35
  s_add_u32 s27, s27, 3
  s_lshr_b32 s29, s27, 1
  s_lshl_b32 s29, s29, 10
  s_and_b32 s35, s27, 1
  s_lshl_b32 s35, s35, 5
  s_add_u32 s29, s29, s35
  s_sub_u32 s29, s29, s28
  v_mul_u32_u24 v113, s29, v111
  v_add3_u32 v113, v113, s28, v162
  v_mov_b32 v162, v113
  s_mov_b32 s93, s20
  s_mul_i32 s20, s59, 20480
  s_add_u32 s20, s20, s54
  s_lshl_b32 s3, s10, 10
  s_add_u32 s21, s20, s3
  s_lshl_b32 s3, s10, 8
  s_add_u32 s22, s20, s3
  s_add_u32 s22, s22, 16384
  s_waitcnt vmcnt(0)
  v_readfirstlane_b32 s19, v165
  s_nop 3
  s_cmp_ge_u32 s19, 16
  s_cbranch_scc1 pdone_28
  s_cmp_lg_u32 s58, 0
  s_cbranch_scc1 pdone_28
  s_mov_b32 s18, 0
  s_mov_b64 exec, 1
poll_27:
  buffer_load_dword v165, off, s[4:7], s94 sc1
  s_waitcnt vmcnt(0)
  v_readfirstlane_b32 s19, v165
  s_nop 3
  s_cmp_ge_u32 s19, 16
  s_cbranch_scc1 pdone_28
  s_add_u32 s18, s18, 1
  s_cmp_lt_u32 s18, 0x20000
  s_cbranch_scc1 poll_27
  s_mov_b32 s58, 1
pdone_28:
  s_mov_b64 exec, -1
  buffer_load_dwordx4 v[168:171], v160, s[4:7], s93 offen sc1
  buffer_load_dwordx4 v[172:175], v160, s[4:7], s93 offen offset:16 sc1
  buffer_load_dwordx4 v[176:179], v161, s[4:7], s93 offen sc1
  buffer_load_dwordx4 v[180:183], v161, s[4:7], s93 offen offset:16 sc1
  buffer_load_dwordx4 v[184:187], v162, s[4:7], s93 offen sc1
  buffer_load_dwordx4 v[188:191], v162, s[4:7], s93 offen offset:16 sc1
  s_mul_i32 s34, s10, 143360
  s_add_u32 s34, s34, s61
  s_add_u32 s34, s34, 0x1200000
  s_add_u32 m0, s61, 102400
  s_add_u32 s17, s34, 0
  buffer_load_dwordx4 v1, s[4:7], s17 offen sc1 lds
  s_add_u32 m0, s61, 106496
  s_add_u32 s17, s34, 4096
  buffer_load_dwordx4 v1, s[4:7], s17 offen sc1 lds
  s_add_u32 m0, s61, 110592
  s_add_u32 s17, s34, 8192
  buffer_load_dwordx4 v1, s[4:7], s17 offen sc1 lds
  s_add_u32 m0, s61, 114688
  s_add_u32 s17, s34, 12288
  buffer_load_dwordx4 v1, s[4:7], s17 offen sc1 lds
  s_add_u32 m0, s61, 118784
  s_add_u32 s17, s34, 16384
  buffer_load_dwordx4 v1, s[4:7], s17 offen sc1 lds
  s_add_u32 m0, s61, 122880
  s_add_u32 s17, s34, 20480
  buffer_load_dwordx4 v1, s[4:7], s17 offen sc1 lds
  s_add_u32 m0, s61, 126976
  s_add_u32 s17, s34, 24576
  buffer_load_dwordx4 v1, s[4:7], s17 offen sc1 lds
  s_add_u32 m0, s61, 131072
  s_add_u32 s17, s34, 28672
  buffer_load_dwordx4 v1, s[4:7], s17 offen sc1 lds
  s_add_u32 m0, s61, 135168
  s_add_u32 s17, s34, 32768
  buffer_load_dwordx4 v1, s[4:7], s17 offen sc1 lds
  s_add_u32 m0, s61, 139264
  s_add_u32 s17, s34, 36864
  buffer_load_dwordx4 v1, s[4:7], s17 offen sc1 lds
  s_add_u32 m0, s61, 143360
  s_add_u32 s17, s34, 40960
  buffer_load_dwordx4 v1, s[4:7], s17 offen sc1 lds
  s_add_u32 m0, s61, 147456
  s_add_u32 s17, s34, 45056
  buffer_load_dwordx4 v1, s[4:7], s17 offen sc1 lds
  s_mov_b32 m0, 151552
  s_sub_u32 s17, s34, s61
  s_add_u32 s17, s17, 49152
  buffer_load_dwordx4 v1, s[4:7], s17 offen sc1 lds
  s_add_u32 s17, s62, 61440
  buffer_load_dwordx4 a[72:75], v1, s[4:7], s17 offen offset:3072 sc1
  s_add_u32 s17, s62, 65536
  buffer_load_dwordx4 a[76:79], v1, s[4:7], s17 offen offset:0 sc1
  s_add_u32 s17, s62, 81920
  buffer_load_dwordx4 a[80:83], v1, s[4:7], s17 offen offset:0 sc1
  s_add_u32 s17, s62, 81920
  buffer_load_dwordx4 a[84:87], v1, s[4:7], s17 offen offset:1024 sc1
  s_add_u32 s17, s62, 81920
  buffer_load_dwordx4 a[88:91], v1, s[4:7], s17 offen offset:2048 sc1
  s_add_u32 s17, s62, 81920
  buffer_load_dwordx4 a[92:95], v1, s[4:7], s17 offen offset:3072 sc1
  s_add_u32 s17, s62, 86016
  buffer_load_dwordx4 a[96:99], v1, s[4:7], s17 offen offset:0 sc1
  s_add_u32 s17, s62, 102400
  buffer_load_dwordx4 a[100:103], v1, s[4:7], s17 offen offset:0 sc1
  v_add_u32 v7, s24, v1
  s_waitcnt vmcnt(25)
  v_cvt_pk_bf16_f32 v168, v168, v169
  v_cvt_pk_bf16_f32 v169, v170, v171
  v_cvt_pk_bf16_f32 v170, v172, v173
  v_cvt_pk_bf16_f32 v171, v174, v175
  ds_write_b128 v7, v[168:171]
  v_add_u32 v7, s25, v1
  s_waitcnt vmcnt(23)
  v_cvt_pk_bf16_f32 v176, v176, v177
  v_cvt_pk_bf16_f32 v177, v178, v179
  v_cvt_pk_bf16_f32 v178, v180, v181
  v_cvt_pk_bf16_f32 v179, v182, v183
  ds_write_b128 v7, v[176:179]
  v_add_u32 v7, s26, v1
  s_waitcnt vmcnt(21)
  v_cvt_pk_bf16_f32 v184, v184, v185
  v_cvt_pk_bf16_f32 v185, v186, v187
  v_cvt_pk_bf16_f32 v186, v188, v189
  v_cvt_pk_bf16_f32 v187, v190, v191
  ds_write_b128 v7, v[184:187]
  s_waitcnt lgkmcnt(0)
  s_barrier
  ds_read_b128 v[192:195], v3 offset:22528
  ds_read_b128 v[204:207], v3 offset:25600
  ds_read_b128 v[216:219], v3 offset:28672
  ds_read_b128 v[196:199], v3 offset:23552
  ds_read_b128 v[208:211], v3 offset:26624
  ds_read_b128 v[220:223], v3 offset:29696
  ds_read_b128 v[200:203], v3 offset:24576
  ds_read_b128 v[212:215], v3 offset:27648
  ds_read_b128 v[224:227], v3 offset:30720
  s_waitcnt lgkmcnt(6)
  v_mfma_f32_16x16x32_bf16 v[8:11], v[192:195], v[136:139], 0
  v_mfma_f32_16x16x32_bf16 v[12:15], v[204:207], v[136:139], 0
  v_mfma_f32_16x16x32_bf16 v[16:19], v[216:219], v[136:139], 0
  v_mfma_f32_16x16x32_bf16 v[20:23], v[192:195], v[148:151], 0
  v_mfma_f32_16x16x32_bf16 v[24:27], v[204:207], v[148:151], 0
  v_mfma_f32_16x16x32_bf16 v[28:31], v[216:219], v[148:151], 0
  s_waitcnt lgkmcnt(3)
  v_mfma_f32_16x16x32_bf16 v[8:11], v[196:199], v[140:143], v[8:11]
  v_mfma_f32_16x16x32_bf16 v[12:15], v[208:211], v[140:143], v[12:15]
  v_mfma_f32_16x16x32_bf16 v[16:19], v[220:223], v[140:143], v[16:19]
  v_mfma_f32_16x16x32_bf16 v[20:23], v[196:199], v[152:155], v[20:23]
  v_mfma_f32_16x16x32_bf16 v[24:27], v[208:211], v[152:155], v[24:27]
  v_mfma_f32_16x16x32_bf16 v[28:31], v[220:223], v[152:155], v[28:31]
  s_waitcnt lgkmcnt(0)
  v_mfma_f32_16x16x32_bf16 v[8:11], v[200:203], v[144:147], v[8:11]
  v_mfma_f32_16x16x32_bf16 v[12:15], v[212:215], v[144:147], v[12:15]
  v_mfma_f32_16x16x32_bf16 v[16:19], v[224:227], v[144:147], v[16:19]
  v_mfma_f32_16x16x32_bf16 v[20:23], v[200:203], v[156:159], v[20:23]
  v_mfma_f32_16x16x32_bf16 v[24:27], v[212:215], v[156:159], v[24:27]
  v_mfma_f32_16x16x32_bf16 v[28:31], v[224:227], v[156:159], v[28:31]
  s_nop 4
  v_add_f32 v108, 0x358637bd, v18
  v_rcp_f32 v108, v108
  s_nop 0
  v_pk_mul_f32 v[8:9], v[8:9], v[108:109] op_sel_hi:[1,0]
  v_pk_mul_f32 v[10:11], v[10:11], v[108:109] op_sel_hi:[1,0]
  v_pk_mul_f32 v[12:13], v[12:13], v[108:109] op_sel_hi:[1,0]
  v_pk_mul_f32 v[14:15], v[14:15], v[108:109] op_sel_hi:[1,0]
  v_pk_mul_f32 v[16:17], v[16:17], v[108:109] op_sel_hi:[1,0]
  v_cvt_pk_bf16_f32 v32, v8, v9
  v_cvt_pk_bf16_f32 v33, v10, v11
  v_cvt_pk_bf16_f32 v34, v12, v13
  v_cvt_pk_bf16_f32 v35, v14, v15
  v_cvt_pk_bf16_f32 v36, v16, v17
  buffer_store_dwordx4 v[32:35], v1, s[4:7], s21 offen sc1
  v_lshlrev_b32 v7, 2, v0
  buffer_store_dword v36, v7, s[4:7], s22 offen sc1
  v_add_f32 v108, 0x358637bd, v30
  v_rcp_f32 v108, v108
  s_nop 0
  v_pk_mul_f32 v[20:21], v[20:21], v[108:109] op_sel_hi:[1,0]
  v_pk_mul_f32 v[22:23], v[22:23], v[108:109] op_sel_hi:[1,0]
  v_pk_mul_f32 v[24:25], v[24:25], v[108:109] op_sel_hi:[1,0]
  v_pk_mul_f32 v[26:27], v[26:27], v[108:109] op_sel_hi:[1,0]
  v_pk_mul_f32 v[28:29], v[28:29], v[108:109] op_sel_hi:[1,0]
  v_cvt_pk_bf16_f32 v38, v20, v21
  v_cvt_pk_bf16_f32 v39, v22, v23
  v_cvt_pk_bf16_f32 v40, v24, v25
  v_cvt_pk_bf16_f32 v41, v26, v27
  v_cvt_pk_bf16_f32 v42, v28, v29
  s_add_u32 s21, s21, 20480
  s_add_u32 s22, s22, 20480
  buffer_store_dwordx4 v[38:41], v1, s[4:7], s21 offen sc1
  v_lshlrev_b32 v7, 2, v0
  buffer_store_dword v42, v7, s[4:7], s22 offen sc1
  s_mul_i32 s33, s13, 102400
  s_add_u32 s33, s33, s61
  s_add_u32 s33, s33, 0x1100000
  s_add_u32 m0, s61, 0
  s_add_u32 s17, s33, 0
  buffer_load_dwordx4 v1, s[4:7], s17 offen sc1 lds
  s_add_u32 m0, s61, 4096
  s_add_u32 s17, s33, 4096
  buffer_load_dwordx4 v1, s[4:7], s17 offen sc1 lds
  s_add_u32 m0, s61, 8192
  s_add_u32 s17, s33, 8192
  buffer_load_dwordx4 v1, s[4:7], s17 offen sc1 lds
  s_add_u32 m0, s61, 12288
  s_add_u32 s17, s33, 12288
  buffer_load_dwordx4 v1, s[4:7], s17 offen sc1 lds
  s_add_u32 m0, s61, 16384
  s_add_u32 s17, s33, 16384
  buffer_load_dwordx4 v1, s[4:7], s17 offen sc1 lds
  s_add_u32 m0, s61, 20480
  s_add_u32 s17, s33, 20480
  buffer_load_dwordx4 v1, s[4:7], s17 offen sc1 lds
  s_add_u32 m0, s61, 24576
  s_add_u32 s17, s33, 24576
  buffer_load_dwordx4 v1, s[4:7], s17 offen sc1 lds
  s_add_u32 m0, s61, 28672
  s_add_u32 s17, s33, 28672
  buffer_load_dwordx4 v1, s[4:7], s17 offen sc1 lds
  s_add_u32 m0, s61, 32768
  s_add_u32 s17, s33, 32768
  buffer_load_dwordx4 v1, s[4:7], s17 offen sc1 lds
  s_add_u32 m0, s61, 36864
  s_add_u32 s17, s33, 36864
  buffer_load_dwordx4 v1, s[4:7], s17 offen sc1 lds
  s_add_u32 m0, s61, 40960
  s_add_u32 s17, s33, 40960
  buffer_load_dwordx4 v1, s[4:7], s17 offen sc1 lds
  s_add_u32 m0, s61, 45056
  s_add_u32 s17, s33, 45056
  buffer_load_dwordx4 v1, s[4:7], s17 offen sc1 lds
  s_mul_i32 s25, s60, 20480
  s_lshl_b32 s3, s13, 11
  s_add_u32 s28, s25, s3
  s_lshl_b32 s3, s13, 9
  s_add_u32 s29, s25, s3
  s_add_u32 s29, s29, 16384
  s_waitcnt vmcnt(12)
  s_barrier
  s_cmp_lg_u32 s8, 0
  s_cbranch_scc1 sig_29
  s_lshl_b32 s17, s9, 7
  s_add_u32 s17, s17, s57
  s_add_u32 s17, s17, 2048
  s_mov_b64 exec, 1
  v_mov_b32 v7, 1
  buffer_atomic_add v7, off, s[4:7], s17
  s_mov_b64 exec, -1
sig_29:
  s_add_u32 m0, s61, 49152
  s_add_u32 s17, s33, 49152
  buffer_load_dwordx4 v1, s[4:7], s17 offen sc1 lds
  s_add_u32 m0, s61, 53248
  s_add_u32 s17, s33, 53248
  buffer_load_dwordx4 v1, s[4:7], s17 offen sc1 lds
  s_add_u32 m0, s61, 57344
  s_add_u32 s17, s33, 57344
  buffer_load_dwordx4 v1, s[4:7], s17 offen sc1 lds
  s_add_u32 m0, s61, 61440
  s_add_u32 s17, s33, 61440
  buffer_load_dwordx4 v1, s[4:7], s17 offen sc1 lds
  s_add_u32 m0, s61, 65536
  s_add_u32 s17, s33, 65536
  buffer_load_dwordx4 v1, s[4:7], s17 offen sc1 lds
  s_add_u32 m0, s61, 69632
  s_add_u32 s17, s33, 69632
  buffer_load_dwordx4 v1, s[4:7], s17 offen sc1 lds
  s_add_u32 m0, s61, 73728
  s_add_u32 s17, s33, 73728
  buffer_load_dwordx4 v1, s[4:7], s17 offen sc1 lds
  s_add_u32 m0, s61, 77824
  s_add_u32 s17, s33, 77824
  buffer_load_dwordx4 v1, s[4:7], s17 offen sc1 lds
  s_add_u32 m0, s61, 81920
  s_add_u32 s17, s33, 81920
  buffer_load_dwordx4 v1, s[4:7], s17 offen sc1 lds
  s_add_u32 m0, s61, 86016
  s_add_u32 s17, s33, 86016
  buffer_load_dwordx4 v1, s[4:7], s17 offen sc1 lds
  s_add_u32 m0, s61, 90112
  s_add_u32 s17, s33, 90112
  buffer_load_dwordx4 v1, s[4:7], s17 offen sc1 lds
  s_add_u32 m0, s61, 94208
  s_add_u32 s17, s33, 94208
  buffer_load_dwordx4 v1, s[4:7], s17 offen sc1 lds
  s_add_u32 m0, s61, 98304
  s_add_u32 s17, s33, 98304
  buffer_load_dwordx4 v1, s[4:7], s17 offen sc1 lds
  s_add_u32 s17, s62, 102400
  buffer_load_dwordx4 a[104:107], v1, s[4:7], s17 offen offset:1024 sc1
  s_add_u32 s17, s62, 102400
  buffer_load_dwordx4 a[108:111], v1, s[4:7], s17 offen offset:2048 sc1
  s_add_u32 s17, s62, 102400
  buffer_load_dwordx4 a[112:115], v1, s[4:7], s17 offen offset:3072 sc1
  s_add_u32 s17, s62, 106496
  buffer_load_dwordx4 a[116:119], v1, s[4:7], s17 offen offset:0 sc1
  s_add_u32 s17, s62, 122880
  buffer_load_dwordx4 a[120:123], v1, s[4:7], s17 offen offset:0 sc1
  s_add_u32 s17, s62, 122880
  buffer_load_dwordx4 a[124:127], v1, s[4:7], s17 offen offset:1024 sc1
  s_add_u32 s17, s62, 122880
  buffer_load_dwordx4 a[128:131], v1, s[4:7], s17 offen offset:2048 sc1
  s_add_u32 s17, s62, 122880
  buffer_load_dwordx4 a[132:135], v1, s[4:7], s17 offen offset:3072 sc1
  s_add_u32 s17, s62, 126976
  buffer_load_dwordx4 a[136:139], v1, s[4:7], s17 offen offset:0 sc1
  s_add_u32 s17, s62, 143360
  buffer_load_dwordx4 a[140:143], v1, s[4:7], s17 offen offset:0 sc1
  s_add_u32 s17, s62, 143360
  buffer_load_dwordx4 a[144:147], v1, s[4:7], s17 offen offset:1024 sc1
  s_add_u32 s17, s62, 143360
  buffer_load_dwordx4 a[148:151], v1, s[4:7], s17 offen offset:2048 sc1
  s_add_u32 s17, s62, 143360
  buffer_load_dwordx4 a[152:155], v1, s[4:7], s17 offen offset:3072 sc1
  s_add_u32 s17, s62, 147456
  buffer_load_dwordx4 a[156:159], v1, s[4:7], s17 offen offset:0 sc1
  s_add_u32 s17, s62, 163840
  buffer_load_dwordx4 a[160:163], v1, s[4:7], s17 offen offset:0 sc1
  s_add_u32 s17, s62, 163840
  buffer_load_dwordx4 a[164:167], v1, s[4:7], s17 offen offset:1024 sc1
  s_mul_i32 s20, s60, 20480
  s_add_u32 s20, s20, s54
  s_add_u32 s17, s28, s48
  buffer_load_dwordx4 v[8:11], v1, s[4:7], s17 offen offset:0 sc1
  buffer_load_dwordx4 v[12:15], v1, s[4:7], s17 offen offset:1024 sc1
  s_add_u32 s17, s29, s48
  v_lshlrev_b32 v7, 3, v0
  buffer_load_dwordx2 v[16:17], v7, s[4:7], s17 offen sc1
  s_cmp_lg_u32 s8, 0
  s_cbranch_scc1 wbar_30
  s_cmp_lg_u32 s58, 0
  s_cbranch_scc1 wbar_30
  s_lshl_b32 s17, s9, 7
  s_add_u32 s17, s17, s57
  s_add_u32 s17, s17, 2048
  s_mov_b32 s18, 0
  s_mov_b64 exec, 1
poll_31:
  buffer_load_dword v7, off, s[4:7], s17 sc1
  s_waitcnt vmcnt(0)
  v_readfirstlane_b32 s19, v7
  s_nop 3
  s_cmp_ge_u32 s19, 16
  s_cbranch_scc1 pdone_32
  s_add_u32 s18, s18, 1
  s_cmp_lt_u32 s18, 0x20000
  s_cbranch_scc1 poll_31
  s_mov_b32 s58, 1
pdone_32:
  s_mov_b64 exec, -1
wbar_30:
  s_waitcnt vmcnt(0)
  s_barrier
  buffer_load_dwordx4 v[40:43], v1, s[4:7], s20 offen offset:0 sc1
  buffer_load_dwordx4 v[44:47], v1, s[4:7], s20 offen offset:1024 sc1
  buffer_load_dwordx4 v[48:51], v1, s[4:7], s20 offen offset:2048 sc1
  buffer_load_dwordx4 v[52:55], v1, s[4:7], s20 offen offset:3072 sc1
  s_add_u32 s20, s20, 4096
  buffer_load_dwordx4 v[56:59], v1, s[4:7], s20 offen offset:0 sc1
  buffer_load_dwordx4 v[60:63], v1, s[4:7], s20 offen offset:1024 sc1
  buffer_load_dwordx4 v[64:67], v1, s[4:7], s20 offen offset:2048 sc1
  buffer_load_dwordx4 v[68:71], v1, s[4:7], s20 offen offset:3072 sc1
  s_add_u32 s20, s20, 4096
  buffer_load_dwordx4 v[72:75], v1, s[4:7], s20 offen offset:0 sc1
  buffer_load_dwordx4 v[76:79], v1, s[4:7], s20 offen offset:1024 sc1
  buffer_load_dwordx4 v[80:83], v1, s[4:7], s20 offen offset:2048 sc1
  buffer_load_dwordx4 v[84:87], v1, s[4:7], s20 offen offset:3072 sc1
  s_add_u32 s20, s20, 4096
  buffer_load_dwordx4 v[88:91], v1, s[4:7], s20 offen offset:0 sc1
  buffer_load_dwordx4 v[92:95], v1, s[4:7], s20 offen offset:1024 sc1
  buffer_load_dwordx4 v[96:99], v1, s[4:7], s20 offen offset:2048 sc1
  buffer_load_dwordx4 v[100:103], v1, s[4:7], s20 offen offset:3072 sc1
  ds_read_b128 v[136:139], v1 offset:0
  ds_read_b128 v[140:143], v1 offset:1024
  ds_read_b128 v[144:147], v1 offset:2048
  ds_read_b128 v[148:151], v1 offset:3072
  ds_read_b128 v[152:155], v1 offset:4096
  ds_read_b128 v[156:159], v1 offset:5120
  ds_read_b128 v[160:163], v1 offset:6144
  ds_read_b128 v[164:167], v1 offset:7168
  ds_read_b128 v[168:171], v1 offset:8192
  ds_read_b128 v[172:175], v1 offset:9216
  s_waitcnt vmcnt(15) lgkmcnt(9)
  v_mfma_f32_16x16x32_bf16 v[20:23], v[136:139], v[40:43], 0
  ds_read_b128 v[176:179], v1 offset:10240
  s_waitcnt lgkmcnt(9)
  v_mfma_f32_16x16x32_bf16 v[24:27], v[140:143], v[40:43], 0
  ds_read_b128 v[180:183], v1 offset:11264
  s_add_u32 s20, s20, 4096
  v_lshlrev_b32 v7, 2, v0
  buffer_load_dword v104, v7, s[4:7], s20 offen offset:0 sc1
  buffer_load_dword v105, v7, s[4:7], s20 offen offset:256 sc1
  buffer_load_dword v106, v7, s[4:7], s20 offen offset:512 sc1
  buffer_load_dword v107, v7, s[4:7], s20 offen offset:768 sc1
  s_waitcnt lgkmcnt(9)
  v_mfma_f32_16x16x32_bf16 v[28:31], v[144:147], v[40:43], 0
  ds_read_b128 v[184:187], v1 offset:12288
  s_waitcnt lgkmcnt(9)
  v_mfma_f32_16x16x32_bf16 v[32:35], v[148:151], v[40:43], 0
  ds_read_b128 v[188:191], v1 offset:13312
  s_waitcnt lgkmcnt(9)
  v_mfma_f32_16x16x32_bf16 v[36:39], v[152:155], v[40:43], 0
  ds_read_b128 v[192:195], v1 offset:14336
  s_waitcnt vmcnt(18) lgkmcnt(9)
  v_mfma_f32_16x16x32_bf16 v[20:23], v[156:159], v[44:47], v[20:23]
  ds_read_b128 v[136:139], v1 offset:15360
  s_waitcnt lgkmcnt(9)
  v_mfma_f32_16x16x32_bf16 v[24:27], v[160:163], v[44:47], v[24:27]
  ds_read_b128 v[140:143], v1 offset:16384
  v_lshlrev_b32 v7, 2, v0
  buffer_load_dword v108, v7, s[4:7], s20 offen offset:1024 sc1
  buffer_load_dword v109, v7, s[4:7], s20 offen offset:1280 sc1
  buffer_load_dword v110, v7, s[4:7], s20 offen offset:1536 sc1
  buffer_load_dword v111, v7, s[4:7], s20 offen offset:1792 sc1
  s_waitcnt lgkmcnt(9)
  v_mfma_f32_16x16x32_bf16 v[28:31], v[164:167], v[44:47], v[28:31]
  ds_read_b128 v[144:147], v1 offset:17408
  s_waitcnt lgkmcnt(9)
  v_mfma_f32_16x16x32_bf16 v[32:35], v[168:171], v[44:47], v[32:35]
  ds_read_b128 v[148:151], v1 offset:18432
  s_waitcnt lgkmcnt(9)
  v_mfma_f32_16x16x32_bf16 v[36:39], v[172:175], v[44:47], v[36:39]
  ds_read_b128 v[152:155], v1 offset:19456
  s_waitcnt vmcnt(21) lgkmcnt(9)
  v_mfma_f32_16x16x32_bf16 v[20:23], v[176:179], v[48:51], v[20:23]
  ds_read_b128 v[156:159], v1 offset:20480
  s_waitcnt lgkmcnt(9)
  v_mfma_f32_16x16x32_bf16 v[24:27], v[180:183], v[48:51], v[24:27]
  ds_read_b128 v[160:163], v1 offset:21504
  v_lshlrev_b32 v7, 2, v0
  buffer_load_dword v112, v7, s[4:7], s20 offen offset:2048 sc1
  buffer_load_dword v113, v7, s[4:7], s20 offen offset:2304 sc1
  buffer_load_dword v114, v7, s[4:7], s20 offen offset:2560 sc1
  buffer_load_dword v115, v7, s[4:7], s20 offen offset:2816 sc1
  s_waitcnt lgkmcnt(9)
  v_mfma_f32_16x16x32_bf16 v[28:31], v[184:187], v[48:51], v[28:31]
  ds_read_b128 v[164:167], v1 offset:22528
  s_waitcnt lgkmcnt(9)
  v_mfma_f32_16x16x32_bf16 v[32:35], v[188:191], v[48:51], v[32:35]
  ds_read_b128 v[168:171], v1 offset:23552
  s_waitcnt lgkmcnt(9)
  v_mfma_f32_16x16x32_bf16 v[36:39], v[192:195], v[48:51], v[36:39]
  ds_read_b128 v[172:175], v1 offset:24576
  s_waitcnt vmcnt(24) lgkmcnt(9)
  v_mfma_f32_16x16x32_bf16 v[20:23], v[136:139], v[52:55], v[20:23]
  ds_read_b128 v[176:179], v1 offset:25600
  s_waitcnt lgkmcnt(9)
  v_mfma_f32_16x16x32_bf16 v[24:27], v[140:143], v[52:55], v[24:27]
  ds_read_b128 v[180:183], v1 offset:26624
  v_lshlrev_b32 v7, 2, v0
  buffer_load_dword v116, v7, s[4:7], s20 offen offset:3072 sc1
  buffer_load_dword v117, v7, s[4:7], s20 offen offset:3328 sc1
  buffer_load_dword v118, v7, s[4:7], s20 offen offset:3584 sc1
  buffer_load_dword v119, v7, s[4:7], s20 offen offset:3840 sc1
  s_waitcnt lgkmcnt(9)
  v_mfma_f32_16x16x32_bf16 v[28:31], v[144:147], v[52:55], v[28:31]
  ds_read_b128 v[184:187], v1 offset:27648
  s_waitcnt lgkmcnt(9)
  v_mfma_f32_16x16x32_bf16 v[32:35], v[148:151], v[52:55], v[32:35]
  ds_read_b128 v[188:191], v1 offset:28672
  s_waitcnt lgkmcnt(9)
  v_mfma_f32_16x16x32_bf16 v[36:39], v[152:155], v[52:55], v[36:39]
  ds_read_b128 v[192:195], v1 offset:29696
  s_waitcnt vmcnt(27) lgkmcnt(9)
  v_mfma_f32_16x16x32_bf16 v[20:23], v[156:159], v[56:59], v[20:23]
  ds_read_b128 v[136:139], v1 offset:30720
  s_waitcnt lgkmcnt(9)
  v_mfma_f32_16x16x32_bf16 v[24:27], v[160:163], v[56:59], v[24:27]
  ds_read_b128 v[140:143], v1 offset:31744
  s_add_u32 s17, s62, 163840
  buffer_load_dwordx4 a[168:171], v1, s[4:7], s17 offen offset:2048 sc1
  s_waitcnt lgkmcnt(9)
  v_mfma_f32_16x16x32_bf16 v[28:31], v[164:167], v[56:59], v[28:31]
  ds_read_b128 v[144:147], v1 offset:32768
  s_waitcnt lgkmcnt(9)
  v_mfma_f32_16x16x32_bf16 v[32:35], v[168:171], v[56:59], v[32:35]
  ds_read_b128 v[148:151], v1 offset:33792
  s_waitcnt lgkmcnt(9)
  v_mfma_f32_16x16x32_bf16 v[36:39], v[172:175], v[56:59], v[36:39]
  ds_read_b128 v[152:155], v1 offset:34816
  s_waitcnt vmcnt(27) lgkmcnt(9)
  v_mfma_f32_16x16x32_bf16 v[20:23], v[176:179], v[60:63], v[20:23]
  ds_read_b128 v[156:159], v1 offset:35840
  s_waitcnt lgkmcnt(9)
  v_mfma_f32_16x16x32_bf16 v[24:27], v[180:183], v[60:63], v[24:27]
  ds_read_b128 v[160:163], v1 offset:36864
  s_add_u32 s17, s62, 163840
  buffer_load_dwordx4 a[172:175], v1, s[4:7], s17 offen offset:3072 sc1
  s_waitcnt lgkmcnt(9)
  v_mfma_f32_16x16x32_bf16 v[28:31], v[184:187], v[60:63], v[28:31]
  ds_read_b128 v[164:167], v1 offset:37888
  s_waitcnt lgkmcnt(9)
  v_mfma_f32_16x16x32_bf16 v[32:35], v[188:191], v[60:63], v[32:35]
  ds_read_b128 v[168:171], v1 offset:38912
  s_waitcnt lgkmcnt(9)
  v_mfma_f32_16x16x32_bf16 v[36:39], v[192:195], v[60:63], v[36:39]
  ds_read_b128 v[172:175], v1 offset:39936
  s_waitcnt vmcnt(27) lgkmcnt(9)
  v_mfma_f32_16x16x32_bf16 v[20:23], v[136:139], v[64:67], v[20:23]
  ds_read_b128 v[176:179], v1 offset:40960
  s_waitcnt lgkmcnt(9)
  v_mfma_f32_16x16x32_bf16 v[24:27], v[140:143], v[64:67], v[24:27]
  ds_read_b128 v[180:183], v1 offset:41984
  s_add_u32 s17, s62, 167936
  buffer_load_dwordx4 a[176:179], v1, s[4:7], s17 offen offset:0 sc1
  s_waitcnt lgkmcnt(9)
  v_mfma_f32_16x16x32_bf16 v[28:31], v[144:147], v[64:67], v[28:31]
  ds_read_b128 v[184:187], v1 offset:43008
  s_waitcnt lgkmcnt(9)
  v_mfma_f32_16x16x32_bf16 v[32:35], v[148:151], v[64:67], v[32:35]
  ds_read_b128 v[188:191], v1 offset:44032
  s_waitcnt lgkmcnt(9)
  v_mfma_f32_16x16x32_bf16 v[36:39], v[152:155], v[64:67], v[36:39]
  ds_read_b128 v[192:195], v1 offset:45056
  s_waitcnt vmcnt(27) lgkmcnt(9)
  v_mfma_f32_16x16x32_bf16 v[20:23], v[156:159], v[68:71], v[20:23]
  ds_read_b128 v[136:139], v1 offset:46080
  s_waitcnt lgkmcnt(9)
  v_mfma_f32_16x16x32_bf16 v[24:27], v[160:163], v[68:71], v[24:27]
  ds_read_b128 v[140:143], v1 offset:47104
  s_add_u32 s17, s62, 184320
  buffer_load_dwordx4 a[180:183], v1, s[4:7], s17 offen offset:0 sc1
  s_waitcnt lgkmcnt(9)
  v_mfma_f32_16x16x32_bf16 v[28:31], v[164:167], v[68:71], v[28:31]
  ds_read_b128 v[144:147], v1 offset:48128
  s_waitcnt lgkmcnt(9)
  v_mfma_f32_16x16x32_bf16 v[32:35], v[168:171], v[68:71], v[32:35]
  ds_read_b128 v[148:151], v1 offset:49152
  s_waitcnt lgkmcnt(9)
  v_mfma_f32_16x16x32_bf16 v[36:39], v[172:175], v[68:71], v[36:39]
  ds_read_b128 v[152:155], v1 offset:50176
  s_waitcnt vmcnt(27) lgkmcnt(9)
  v_mfma_f32_16x16x32_bf16 v[20:23], v[176:179], v[72:75], v[20:23]
  ds_read_b128 v[156:159], v1 offset:51200
  s_waitcnt lgkmcnt(9)
  v_mfma_f32_16x16x32_bf16 v[24:27], v[180:183], v[72:75], v[24:27]
  ds_read_b128 v[160:163], v1 offset:52224
  s_add_u32 s17, s62, 184320
  buffer_load_dwordx4 a[184:187], v1, s[4:7], s17 offen offset:1024 sc1
  s_waitcnt lgkmcnt(9)
  v_mfma_f32_16x16x32_bf16 v[28:31], v[184:187], v[72:75], v[28:31]
  ds_read_b128 v[164:167], v1 offset:53248
  s_waitcnt lgkmcnt(9)
  v_mfma_f32_16x16x32_bf16 v[32:35], v[188:191], v[72:75], v[32:35]
  ds_read_b128 v[168:171], v1 offset:54272
  s_waitcnt lgkmcnt(9)
  v_mfma_f32_16x16x32_bf16 v[36:39], v[192:195], v[72:75], v[36:39]
  ds_read_b128 v[172:175], v1 offset:55296
  s_waitcnt vmcnt(27) lgkmcnt(9)
  v_mfma_f32_16x16x32_bf16 v[20:23], v[136:139], v[76:79], v[20:23]
  ds_read_b128 v[176:179], v1 offset:56320
  s_waitcnt lgkmcnt(9)
  v_mfma_f32_16x16x32_bf16 v[24:27], v[140:143], v[76:79], v[24:27]
  ds_read_b128 v[180:183], v1 offset:57344
  s_add_u32 s17, s62, 184320
  buffer_load_dwordx4 a[188:191], v1, s[4:7], s17 offen offset:2048 sc1
  s_waitcnt lgkmcnt(9)
  v_mfma_f32_16x16x32_bf16 v[28:31], v[144:147], v[76:79], v[28:31]
  ds_read_b128 v[184:187], v1 offset:58368
  s_waitcnt lgkmcnt(9)
  v_mfma_f32_16x16x32_bf16 v[32:35], v[148:151], v[76:79], v[32:35]
  ds_read_b128 v[188:191], v1 offset:59392
  s_waitcnt lgkmcnt(9)
  v_mfma_f32_16x16x32_bf16 v[36:39], v[152:155], v[76:79], v[36:39]
  ds_read_b128 v[192:195], v1 offset:60416
  s_add_u32 s17, s62, 184320
  buffer_load_dwordx4 a[192:195], v1, s[4:7], s17 offen offset:3072 sc1
  s_add_u32 s17, s62, 188416
  buffer_load_dwordx4 a[196:199], v1, s[4:7], s17 offen offset:0 sc1
  s_add_u32 s17, s62, 204800
  buffer_load_dwordx4 a[200:203], v1, s[4:7], s17 offen offset:0 sc1
  s_add_u32 s17, s62, 204800
  buffer_load_dwordx4 a[204:207], v1, s[4:7], s17 offen offset:1024 sc1
  s_waitcnt lgkmcnt(9)
  s_barrier
  s_waitcnt vmcnt(31) lgkmcnt(9)
  v_mfma_f32_16x16x32_bf16 v[20:23], v[156:159], v[80:83], v[20:23]
  ds_read_b128 v[136:139], v1 offset:61440
  s_waitcnt lgkmcnt(9)
  v_mfma_f32_16x16x32_bf16 v[24:27], v[160:163], v[80:83], v[24:27]
  ds_read_b128 v[140:143], v1 offset:62464
  s_waitcnt lgkmcnt(9)
  v_mfma_f32_16x16x32_bf16 v[28:31], v[164:167], v[80:83], v[28:31]
  ds_read_b128 v[144:147], v1 offset:63488
  s_waitcnt lgkmcnt(9)
  v_mfma_f32_16x16x32_bf16 v[32:35], v[168:171], v[80:83], v[32:35]
  ds_read_b128 v[148:151], v1 offset:64512
  s_add_u32 m0, s61, 0
  s_add_u32 s17, s34, 50176
  buffer_load_dwordx4 v1, s[4:7], s17 offen sc1 lds
  s_waitcnt lgkmcnt(9)
  v_mfma_f32_16x16x32_bf16 v[36:39], v[172:175], v[80:83], v[36:39]
  ds_read_b128 v[152:155], v2 offset:0
  s_waitcnt vmcnt(31) lgkmcnt(9)
  v_mfma_f32_16x16x32_bf16 v[20:23], v[176:179], v[84:87], v[20:23]
  ds_read_b128 v[156:159], v2 offset:1024
  s_waitcnt lgkmcnt(9)
  v_mfma_f32_16x16x32_bf16 v[24:27], v[180:183], v[84:87], v[24:27]
  ds_read_b128 v[160:163], v2 offset:2048
  s_waitcnt lgkmcnt(9)
  v_mfma_f32_16x16x32_bf16 v[28:31], v[184:187], v[84:87], v[28:31]
  ds_read_b128 v[164:167], v2 offset:3072
  s_waitcnt lgkmcnt(9)
  v_mfma_f32_16x16x32_bf16 v[32:35], v[188:191], v[84:87], v[32:35]
  ds_read_b128 v[168:171], v2 offset:4096
  s_add_u32 m0, s61, 4096
  s_add_u32 s17, s34, 54272
  buffer_load_dwordx4 v1, s[4:7], s17 offen sc1 lds
  s_waitcnt lgkmcnt(9)
  v_mfma_f32_16x16x32_bf16 v[36:39], v[192:195], v[84:87], v[36:39]
  ds_read_b128 v[172:175], v2 offset:5120
  s_waitcnt vmcnt(31) lgkmcnt(9)
  v_mfma_f32_16x16x32_bf16 v[20:23], v[136:139], v[88:91], v[20:23]
  ds_read_b128 v[176:179], v2 offset:6144
  s_waitcnt lgkmcnt(9)
  v_mfma_f32_16x16x32_bf16 v[24:27], v[140:143], v[88:91], v[24:27]
  ds_read_b128 v[180:183], v2 offset:7168
  s_waitcnt lgkmcnt(9)
  v_mfma_f32_16x16x32_bf16 v[28:31], v[144:147], v[88:91], v[28:31]
  ds_read_b128 v[184:187], v2 offset:8192
  s_waitcnt lgkmcnt(9)
  v_mfma_f32_16x16x32_bf16 v[32:35], v[148:151], v[88:91], v[32:35]
  ds_read_b128 v[188:191], v2 offset:9216
  s_add_u32 m0, s61, 8192
  s_add_u32 s17, s34, 58368
  buffer_load_dwordx4 v1, s[4:7], s17 offen sc1 lds
  s_waitcnt lgkmcnt(9)
  v_mfma_f32_16x16x32_bf16 v[36:39], v[152:155], v[88:91], v[36:39]
  ds_read_b128 v[192:195], v2 offset:10240
  s_waitcnt vmcnt(31) lgkmcnt(9)
  v_mfma_f32_16x16x32_bf16 v[20:23], v[156:159], v[92:95], v[20:23]
  ds_read_b128 v[136:139], v2 offset:11264
  s_waitcnt lgkmcnt(9)
  v_mfma_f32_16x16x32_bf16 v[24:27], v[160:163], v[92:95], v[24:27]
  ds_read_b128 v[140:143], v2 offset:12288
  s_waitcnt lgkmcnt(9)
  v_mfma_f32_16x16x32_bf16 v[28:31], v[164:167], v[92:95], v[28:31]
  ds_read_b128 v[144:147], v2 offset:13312
  s_waitcnt lgkmcnt(9)
  v_mfma_f32_16x16x32_bf16 v[32:35], v[168:171], v[92:95], v[32:35]
  ds_read_b128 v[148:151], v2 offset:14336
  s_add_u32 m0, s61, 12288
  s_add_u32 s17, s34, 62464
  buffer_load_dwordx4 v1, s[4:7], s17 offen sc1 lds
  s_waitcnt lgkmcnt(9)
  v_mfma_f32_16x16x32_bf16 v[36:39], v[172:175], v[92:95], v[36:39]
  ds_read_b128 v[152:155], v2 offset:15360
  s_waitcnt vmcnt(31) lgkmcnt(9)
  v_mfma_f32_16x16x32_bf16 v[20:23], v[176:179], v[96:99], v[20:23]
  ds_read_b128 v[156:159], v2 offset:16384
  s_waitcnt lgkmcnt(9)
  v_mfma_f32_16x16x32_bf16 v[24:27], v[180:183], v[96:99], v[24:27]
  ds_read_b128 v[160:163], v2 offset:17408
  s_waitcnt lgkmcnt(9)
  v_mfma_f32_16x16x32_bf16 v[28:31], v[184:187], v[96:99], v[28:31]
  ds_read_b128 v[164:167], v2 offset:18432
  s_waitcnt lgkmcnt(9)
  v_mfma_f32_16x16x32_bf16 v[32:35], v[188:191], v[96:99], v[32:35]
  ds_read_b128 v[168:171], v2 offset:19456
  s_add_u32 m0, s61, 16384
  s_add_u32 s17, s34, 66560
  buffer_load_dwordx4 v1, s[4:7], s17 offen sc1 lds
  s_waitcnt lgkmcnt(9)
  v_mfma_f32_16x16x32_bf16 v[36:39], v[192:195], v[96:99], v[36:39]
  ds_read_b128 v[172:175], v2 offset:20480
  s_waitcnt vmcnt(31) lgkmcnt(9)
  v_mfma_f32_16x16x32_bf16 v[20:23], v[136:139], v[100:103], v[20:23]
  ds_read_b128 v[176:179], v2 offset:21504
  s_waitcnt lgkmcnt(9)
  v_mfma_f32_16x16x32_bf16 v[24:27], v[140:143], v[100:103], v[24:27]
  ds_read_b128 v[180:183], v2 offset:22528
  s_waitcnt lgkmcnt(9)
  v_mfma_f32_16x16x32_bf16 v[28:31], v[144:147], v[100:103], v[28:31]
  ds_read_b128 v[184:187], v2 offset:23552
  s_waitcnt lgkmcnt(9)
  v_mfma_f32_16x16x32_bf16 v[32:35], v[148:151], v[100:103], v[32:35]
  ds_read_b128 v[188:191], v2 offset:24576
  s_add_u32 m0, s61, 20480
  s_add_u32 s17, s34, 70656
  buffer_load_dwordx4 v1, s[4:7], s17 offen sc1 lds
  s_waitcnt lgkmcnt(9)
  v_mfma_f32_16x16x32_bf16 v[36:39], v[152:155], v[100:103], v[36:39]
  ds_read_b128 v[192:195], v2 offset:25600
  s_waitcnt vmcnt(28) lgkmcnt(9)
  v_mfma_f32_16x16x32_bf16 v[20:23], v[156:159], v[104:107], v[20:23]
  ds_read_b128 v[136:139], v2 offset:26624
  s_waitcnt lgkmcnt(9)
  v_mfma_f32_16x16x32_bf16 v[24:27], v[160:163], v[104:107], v[24:27]
  ds_read_b128 v[140:143], v2 offset:27648
  s_waitcnt lgkmcnt(9)
  v_mfma_f32_16x16x32_bf16 v[28:31], v[164:167], v[104:107], v[28:31]
  ds_read_b128 v[144:147], v2 offset:28672
  s_waitcnt lgkmcnt(9)
  v_mfma_f32_16x16x32_bf16 v[32:35], v[168:171], v[104:107], v[32:35]
  ds_read_b128 v[148:151], v2 offset:29696
  s_add_u32 m0, s61, 24576
  s_add_u32 s17, s34, 74752
  buffer_load_dwordx4 v1, s[4:7], s17 offen sc1 lds
  s_waitcnt lgkmcnt(9)
  v_mfma_f32_16x16x32_bf16 v[36:39], v[172:175], v[104:107], v[36:39]
  ds_read_b128 v[152:155], v2 offset:30720
  s_waitcnt vmcnt(25) lgkmcnt(9)
  v_mfma_f32_16x16x32_bf16 v[20:23], v[176:179], v[108:111], v[20:23]
  ds_read_b128 v[156:159], v2 offset:31744
  s_waitcnt lgkmcnt(9)
  v_mfma_f32_16x16x32_bf16 v[24:27], v[180:183], v[108:111], v[24:27]
  ds_read_b128 v[160:163], v2 offset:32768
  s_waitcnt lgkmcnt(9)
  v_mfma_f32_16x16x32_bf16 v[28:31], v[184:187], v[108:111], v[28:31]
  ds_read_b128 v[164:167], v2 offset:33792
  s_waitcnt lgkmcnt(9)
  v_mfma_f32_16x16x32_bf16 v[32:35], v[188:191], v[108:111], v[32:35]
  ds_read_b128 v[168:171], v2 offset:34816
  s_add_u32 m0, s61, 28672
  s_add_u32 s17, s34, 78848
  buffer_load_dwordx4 v1, s[4:7], s17 offen sc1 lds
  s_waitcnt lgkmcnt(9)
  v_mfma_f32_16x16x32_bf16 v[36:39], v[192:195], v[108:111], v[36:39]
  ds_read_b128 v[172:175], v2 offset:35840
  s_waitcnt vmcnt(22) lgkmcnt(9)
  v_mfma_f32_16x16x32_bf16 v[20:23], v[136:139], v[112:115], v[20:23]
  s_waitcnt lgkmcnt(8)
  v_mfma_f32_16x16x32_bf16 v[24:27], v[140:143], v[112:115], v[24:27]
  s_waitcnt lgkmcnt(7)
  v_mfma_f32_16x16x32_bf16 v[28:31], v[144:147], v[112:115], v[28:31]
  s_waitcnt lgkmcnt(6)
  v_mfma_f32_16x16x32_bf16 v[32:35], v[148:151], v[112:115], v[32:35]
  s_add_u32 m0, s61, 32768
  s_add_u32 s17, s34, 82944
  buffer_load_dwordx4 v1, s[4:7], s17 offen sc1 lds
  s_waitcnt lgkmcnt(5)
  v_mfma_f32_16x16x32_bf16 v[36:39], v[152:155], v[112:115], v[36:39]
  s_waitcnt vmcnt(19) lgkmcnt(4)
  v_mfma_f32_16x16x32_bf16 v[20:23], v[156:159], v[116:119], v[20:23]
  s_waitcnt lgkmcnt(3)
  v_mfma_f32_16x16x32_bf16 v[24:27], v[160:163], v[116:119], v[24:27]
  s_waitcnt lgkmcnt(2)
  v_mfma_f32_16x16x32_bf16 v[28:31], v[164:167], v[116:119], v[28:31]
  s_waitcnt lgkmcnt(1)
  v_mfma_f32_16x16x32_bf16 v[32:35], v[168:171], v[116:119], v[32:35]
  s_add_u32 m0, s61, 36864
  s_add_u32 s17, s34, 87040
  buffer_load_dwordx4 v1, s[4:7], s17 offen sc1 lds
  s_waitcnt lgkmcnt(0)
  v_mfma_f32_16x16x32_bf16 v[36:39], v[172:175], v[116:119], v[36:39]
  v_lshlrev_b32 v132, 16, v8
  v_and_b32 v133, 0xffff0000, v8
  v_pk_add_f32 v[20:21], v[20:21], v[132:133]
  v_lshlrev_b32 v132, 16, v9
  v_and_b32 v133, 0xffff0000, v9
  v_pk_add_f32 v[22:23], v[22:23], v[132:133]
  v_lshlrev_b32 v132, 16, v10
  v_and_b32 v133, 0xffff0000, v10
  v_pk_add_f32 v[24:25], v[24:25], v[132:133]
  v_lshlrev_b32 v132, 16, v11
  v_and_b32 v133, 0xffff0000, v11
  v_pk_add_f32 v[26:27], v[26:27], v[132:133]
  v_lshlrev_b32 v132, 16, v12
  v_and_b32 v133, 0xffff0000, v12
  v_pk_add_f32 v[28:29], v[28:29], v[132:133]
  v_lshlrev_b32 v132, 16, v13
  v_and_b32 v133, 0xffff0000, v13
  v_pk_add_f32 v[30:31], v[30:31], v[132:133]
  v_lshlrev_b32 v132, 16, v14
  v_and_b32 v133, 0xffff0000, v14
  v_pk_add_f32 v[32:33], v[32:33], v[132:133]
  v_lshlrev_b32 v132, 16, v15
  v_and_b32 v133, 0xffff0000, v15
  v_pk_add_f32 v[34:35], v[34:35], v[132:133]
  v_lshlrev_b32 v132, 16, v16
  v_and_b32 v133, 0xffff0000, v16
  v_pk_add_f32 v[36:37], v[36:37], v[132:133]
  v_lshlrev_b32 v132, 16, v17
  v_and_b32 v133, 0xffff0000, v17
  v_pk_add_f32 v[38:39], v[38:39], v[132:133]
  v_cvt_pk_bf16_f32 v120, v20, v21
  v_cvt_pk_bf16_f32 v121, v22, v23
  v_cvt_pk_bf16_f32 v122, v24, v25
  v_cvt_pk_bf16_f32 v123, v26, v27
  v_cvt_pk_bf16_f32 v124, v28, v29
  v_cvt_pk_bf16_f32 v125, v30, v31
  v_cvt_pk_bf16_f32 v126, v32, v33
  v_cvt_pk_bf16_f32 v127, v34, v35
  v_cvt_pk_bf16_f32 v128, v36, v37
  v_cvt_pk_bf16_f32 v129, v38, v39
  s_add_u32 s17, s28, s49
  buffer_store_dwordx4 v[120:123], v1, s[4:7], s17 offen offset:0 sc1
  buffer_store_dwordx4 v[124:127], v1, s[4:7], s17 offen offset:1024 sc1
  s_add_u32 s17, s29, s49
  v_lshlrev_b32 v7, 3, v0
  buffer_store_dwordx2 v[128:129], v7, s[4:7], s17 offen sc1
  v_pk_add_f32 v[132:133], v[20:21], v[22:23]
  v_pk_mul_f32 v[130:131], v[20:21], v[20:21]
  v_pk_fma_f32 v[130:131], v[22:23], v[22:23], v[130:131]
  v_pk_add_f32 v[132:133], v[132:133], v[24:25]
  v_pk_fma_f32 v[130:131], v[24:25], v[24:25], v[130:131]
  v_pk_add_f32 v[132:133], v[132:133], v[26:27]
  v_pk_fma_f32 v[130:131], v[26:27], v[26:27], v[130:131]
  v_pk_add_f32 v[132:133], v[132:133], v[28:29]
  v_pk_fma_f32 v[130:131], v[28:29], v[28:29], v[130:131]
  v_pk_add_f32 v[132:133], v[132:133], v[30:31]
  v_pk_fma_f32 v[130:131], v[30:31], v[30:31], v[130:131]
  v_pk_add_f32 v[132:133], v[132:133], v[32:33]
  v_pk_fma_f32 v[130:131], v[32:33], v[32:33], v[130:131]
  v_pk_add_f32 v[132:133], v[132:133], v[34:35]
  v_pk_fma_f32 v[130:131], v[34:35], v[34:35], v[130:131]
  v_pk_add_f32 v[132:133], v[132:133], v[36:37]
  v_pk_fma_f32 v[130:131], v[36:37], v[36:37], v[130:131]
  v_pk_add_f32 v[132:133], v[132:133], v[38:39]
  v_pk_fma_f32 v[130:131], v[38:39], v[38:39], v[130:131]
  v_add_f32 v131, v130, v131
  v_add_f32 v130, v132, v133
  s_nop 1
  v_permlane16_swap_b32 v130, v131
  v_add_f32 v130, v130, v131
  v_mov_b32 v131, v130
  s_nop 1
  v_permlane32_swap_b32 v130, v131
  v_add_f32 v130, v130, v131
  v_mov_b32 v131, v130
  s_nop 1
  v_permlane16_swap_b32 v130, v131
  s_lshl_b32 s17, s60, 10
  s_lshl_b32 s18, s13, 7
  s_add_u32 s17, s17, s18
  s_add_u32 s17, s17, s52
  s_mov_b64 exec, 0xffff
  buffer_store_dwordx2 v[130:131], v7, s[4:7], s17 offen sc1
  s_mov_b64 exec, -1
  s_waitcnt vmcnt(0)
  s_barrier
  s_cmp_lg_u32 s8, 0
  s_cbranch_scc1 sig_33
  s_lshl_b32 s17, s9, 7
  s_add_u32 s17, s17, s57
  s_add_u32 s17, s17, 4096
  s_mov_b64 exec, 1
  v_mov_b32 v7, 1
  buffer_atomic_add v7, off, s[4:7], s17
  s_mov_b64 exec, -1
sig_33:
  s_add_u32 m0, s61, 40960
  s_add_u32 s17, s34, 91136
  buffer_load_dwordx4 v1, s[4:7], s17 offen sc1 lds
  s_add_u32 m0, s61, 45056
  s_add_u32 s17, s34, 95232
  buffer_load_dwordx4 v1, s[4:7], s17 offen sc1 lds
  s_add_u32 m0, s61, 49152
  s_add_u32 s17, s34, 99328
  buffer_load_dwordx4 v1, s[4:7], s17 offen sc1 lds
  s_add_u32 m0, s61, 53248
  s_add_u32 s17, s34, 103424
  buffer_load_dwordx4 v1, s[4:7], s17 offen sc1 lds
  s_add_u32 m0, s61, 57344
  s_add_u32 s17, s34, 107520
  buffer_load_dwordx4 v1, s[4:7], s17 offen sc1 lds
  s_add_u32 m0, s61, 61440
  s_add_u32 s17, s34, 111616
  buffer_load_dwordx4 v1, s[4:7], s17 offen sc1 lds
  s_add_u32 m0, s61, 65536
  s_add_u32 s17, s34, 115712
  buffer_load_dwordx4 v1, s[4:7], s17 offen sc1 lds
  s_add_u32 m0, s61, 69632
  s_add_u32 s17, s34, 119808
  buffer_load_dwordx4 v1, s[4:7], s17 offen sc1 lds
  s_add_u32 m0, s61, 73728
  s_add_u32 s17, s34, 123904
  buffer_load_dwordx4 v1, s[4:7], s17 offen sc1 lds
  s_add_u32 m0, s61, 77824
  s_add_u32 s17, s34, 128000
  buffer_load_dwordx4 v1, s[4:7], s17 offen sc1 lds
  s_add_u32 m0, s61, 81920
  s_add_u32 s17, s34, 132096
  buffer_load_dwordx4 v1, s[4:7], s17 offen sc1 lds
  s_add_u32 m0, s61, 86016
  s_add_u32 s17, s34, 136192
  buffer_load_dwordx4 v1, s[4:7], s17 offen sc1 lds
  s_add_u32 m0, s61, 90112
  s_add_u32 s17, s34, 140288
  buffer_load_dwordx4 v1, s[4:7], s17 offen sc1 lds
  s_and_b32 s17, s10, 7
  s_mul_i32 s26, s17, 7
  s_cmp_eq_u32 s17, 7
  s_cselect_b32 s26, 48, s26
  s_lshr_b32 s3, s10, 3
  s_mul_i32 s3, s3, 54
  s_add_u32 s26, s26, s3
  v_lshlrev_b32 v7, 3, v5
  s_lshl_b32 s17, s26, 5
  buffer_load_dwordx2 v[72:73], v7, s[36:39], s17 offen offset:0
  buffer_load_dwordx2 v[74:75], v7, s[36:39], s17 offen offset:32
  buffer_load_dwordx2 v[76:77], v7, s[36:39], s17 offen offset:64
  buffer_load_dwordx2 v[78:79], v7, s[36:39], s17 offen offset:96
  buffer_load_dwordx2 v[80:81], v7, s[36:39], s17 offen offset:128
  buffer_load_dwordx2 v[82:83], v7, s[36:39], s17 offen offset:160
  buffer_load_dwordx2 v[84:85], v7, s[36:39], s17 offen offset:192
  s_mul_i32 s21, s59, 20480
  s_add_u32 s21, s21, s49
  s_add_u32 s22, s21, 20480
  s_cmp_lg_u32 s8, 0
  s_cbranch_scc1 wbar_34
  s_cmp_lg_u32 s58, 0
  s_cbranch_scc1 wbar_34
  s_lshl_b32 s17, s9, 7
  s_add_u32 s17, s17, s57
  s_add_u32 s17, s17, 4096
  s_mov_b32 s18, 0
  s_mov_b64 exec, 1
poll_35:
  buffer_load_dword v7, off, s[4:7], s17 sc1
  s_waitcnt vmcnt(0)
  v_readfirstlane_b32 s19, v7
  s_nop 3
  s_cmp_ge_u32 s19, 16
  s_cbranch_scc1 pdone_36
  s_add_u32 s18, s18, 1
  s_cmp_lt_u32 s18, 0x20000
  s_cbranch_scc1 poll_35
  s_mov_b32 s58, 1
pdone_36:
  s_mov_b64 exec, -1
wbar_34:
  s_barrier
  buffer_load_dwordx4 v[144:147], v1, s[4:7], s21 offen offset:0 sc1
  buffer_load_dwordx4 v[148:151], v1, s[4:7], s22 offen offset:0 sc1
  buffer_load_dwordx4 v[152:155], v1, s[4:7], s21 offen offset:1024 sc1
  buffer_load_dwordx4 v[156:159], v1, s[4:7], s22 offen offset:1024 sc1
  v_lshlrev_b32 v7, 3, v4
  v_lshl_add_u32 v7, v5, 8, v7
  s_lshl_b32 s17, s59, 10
  s_add_u32 s17, s17, s52
  buffer_load_dwordx2 v[64:65], v7, s[4:7], s17 offen offset:0 sc1
  buffer_load_dwordx2 v[66:67], v7, s[4:7], s17 offen offset:128 sc1
  buffer_load_dwordx2 v[68:69], v7, s[4:7], s17 offen offset:1024 sc1
  buffer_load_dwordx2 v[70:71], v7, s[4:7], s17 offen offset:1152 sc1
  buffer_load_dwordx4 v[160:163], v1, s[4:7], s21 offen offset:2048 sc1
  buffer_load_dwordx4 v[164:167], v1, s[4:7], s22 offen offset:2048 sc1
  buffer_load_dwordx4 v[168:171], v1, s[4:7], s21 offen offset:3072 sc1
  buffer_load_dwordx4 v[172:175], v1, s[4:7], s22 offen offset:3072 sc1
  s_add_u32 s21, s21, 4096
  buffer_load_dwordx4 v[176:179], v1, s[4:7], s21 offen offset:0 sc1
  s_add_u32 s22, s22, 4096
  buffer_load_dwordx4 v[180:183], v1, s[4:7], s22 offen offset:0 sc1
  buffer_load_dwordx4 v[184:187], v1, s[4:7], s21 offen offset:1024 sc1
  buffer_load_dwordx4 v[188:191], v1, s[4:7], s22 offen offset:1024 sc1
  buffer_load_dwordx4 v[192:195], v1, s[4:7], s21 offen offset:2048 sc1
  buffer_load_dwordx4 v[196:199], v1, s[4:7], s22 offen offset:2048 sc1
  buffer_load_dwordx4 v[200:203], v1, s[4:7], s21 offen offset:3072 sc1
  buffer_load_dwordx4 v[204:207], v1, s[4:7], s22 offen offset:3072 sc1
  ds_read_b128 v[88:91], v2 offset:36864
  ds_read_b128 v[92:95], v2 offset:37888
  ds_read_b128 v[96:99], v2 offset:38912
  ds_read_b128 v[100:103], v2 offset:39936
  ds_read_b128 v[104:107], v2 offset:40960
  ds_read_b128 v[108:111], v2 offset:41984
  ds_read_b128 v[112:115], v2 offset:43008
  s_waitcnt vmcnt(18) lgkmcnt(6)
  v_mfma_f32_16x16x32_bf16 v[8:11], v[88:91], v[144:147], 0
  ds_read_b128 v[116:119], v2 offset:44032
  v_mfma_f32_16x16x32_bf16 v[36:39], v[88:91], v[148:151], 0
  ds_read_b128 v[120:123], v2 offset:45056
  s_waitcnt lgkmcnt(7)
  v_mfma_f32_16x16x32_bf16 v[12:15], v[92:95], v[144:147], 0
  ds_read_b128 v[124:127], v2 offset:46080
  v_mfma_f32_16x16x32_bf16 v[40:43], v[92:95], v[148:151], 0
  ds_read_b128 v[128:131], v2 offset:47104
  s_add_u32 s21, s21, 4096
  buffer_load_dwordx4 v[208:211], v1, s[4:7], s21 offen offset:0 sc1
  s_waitcnt lgkmcnt(8)
  v_mfma_f32_16x16x32_bf16 v[16:19], v[96:99], v[144:147], 0
  ds_read_b128 v[132:135], v2 offset:48128
  v_mfma_f32_16x16x32_bf16 v[44:47], v[96:99], v[148:151], 0
  ds_read_b128 v[136:139], v2 offset:49152
  s_waitcnt lgkmcnt(9)
  v_mfma_f32_16x16x32_bf16 v[20:23], v[100:103], v[144:147], 0
  ds_read_b128 v[140:143], v2 offset:50176
  v_mfma_f32_16x16x32_bf16 v[48:51], v[100:103], v[148:151], 0
  s_waitcnt lgkmcnt(9)
  v_mfma_f32_16x16x32_bf16 v[24:27], v[104:107], v[144:147], 0
  v_mfma_f32_16x16x32_bf16 v[52:55], v[104:107], v[148:151], 0
  s_waitcnt lgkmcnt(8)
  v_mfma_f32_16x16x32_bf16 v[28:31], v[108:111], v[144:147], 0
  s_add_u32 s22, s22, 4096
  buffer_load_dwordx4 v[212:215], v1, s[4:7], s22 offen offset:0 sc1
  v_mfma_f32_16x16x32_bf16 v[56:59], v[108:111], v[148:151], 0
  s_waitcnt lgkmcnt(7)
  v_mfma_f32_16x16x32_bf16 v[32:35], v[112:115], v[144:147], 0
  v_mfma_f32_16x16x32_bf16 v[60:63], v[112:115], v[148:151], 0
  s_waitcnt vmcnt(18) lgkmcnt(6)
  v_mfma_f32_16x16x32_bf16 v[8:11], v[116:119], v[152:155], v[8:11]
  ds_read_b128 v[88:91], v2 offset:51200
  v_mfma_f32_16x16x32_bf16 v[36:39], v[116:119], v[156:159], v[36:39]
  ds_read_b128 v[92:95], v2 offset:52224
  s_waitcnt lgkmcnt(7)
  v_mfma_f32_16x16x32_bf16 v[12:15], v[120:123], v[152:155], v[12:15]
  ds_read_b128 v[96:99], v2 offset:53248
  v_mfma_f32_16x16x32_bf16 v[40:43], v[120:123], v[156:159], v[40:43]
  ds_read_b128 v[100:103], v2 offset:54272
  buffer_load_dwordx4 v[216:219], v1, s[4:7], s21 offen offset:1024 sc1
  s_waitcnt lgkmcnt(8)
  v_mfma_f32_16x16x32_bf16 v[16:19], v[124:127], v[152:155], v[16:19]
  ds_read_b128 v[104:107], v2 offset:55296
  v_mfma_f32_16x16x32_bf16 v[44:47], v[124:127], v[156:159], v[44:47]
  ds_read_b128 v[108:111], v2 offset:56320
  s_waitcnt lgkmcnt(9)
  v_mfma_f32_16x16x32_bf16 v[20:23], v[128:131], v[152:155], v[20:23]
  ds_read_b128 v[112:115], v2 offset:57344
  v_mfma_f32_16x16x32_bf16 v[48:51], v[128:131], v[156:159], v[48:51]
  s_waitcnt lgkmcnt(9)
  v_mfma_f32_16x16x32_bf16 v[24:27], v[132:135], v[152:155], v[24:27]
  v_mfma_f32_16x16x32_bf16 v[52:55], v[132:135], v[156:159], v[52:55]
  s_waitcnt lgkmcnt(8)
  v_mfma_f32_16x16x32_bf16 v[28:31], v[136:139], v[152:155], v[28:31]
  buffer_load_dwordx4 v[220:223], v1, s[4:7], s22 offen offset:1024 sc1
  v_mfma_f32_16x16x32_bf16 v[56:59], v[136:139], v[156:159], v[56:59]
  s_waitcnt lgkmcnt(7)
  v_mfma_f32_16x16x32_bf16 v[32:35], v[140:143], v[152:155], v[32:35]
  v_mfma_f32_16x16x32_bf16 v[60:63], v[140:143], v[156:159], v[60:63]
  s_waitcnt vmcnt(14) lgkmcnt(6)
  v_mfma_f32_16x16x32_bf16 v[8:11], v[88:91], v[160:163], v[8:11]
  ds_read_b128 v[116:119], v2 offset:58368
  v_mfma_f32_16x16x32_bf16 v[36:39], v[88:91], v[164:167], v[36:39]
  ds_read_b128 v[120:123], v2 offset:59392
  s_waitcnt lgkmcnt(7)
  v_mfma_f32_16x16x32_bf16 v[12:15], v[92:95], v[160:163], v[12:15]
  ds_read_b128 v[124:127], v2 offset:60416
  v_mfma_f32_16x16x32_bf16 v[40:43], v[92:95], v[164:167], v[40:43]
  ds_read_b128 v[128:131], v2 offset:61440
  buffer_load_dwordx4 v[224:227], v1, s[4:7], s21 offen offset:2048 sc1
  s_waitcnt lgkmcnt(8)
  v_mfma_f32_16x16x32_bf16 v[16:19], v[96:99], v[160:163], v[16:19]
  ds_read_b128 v[132:135], v2 offset:62464
  v_mfma_f32_16x16x32_bf16 v[44:47], v[96:99], v[164:167], v[44:47]
  ds_read_b128 v[136:139], v2 offset:63488
  s_waitcnt lgkmcnt(9)
  v_mfma_f32_16x16x32_bf16 v[20:23], v[100:103], v[160:163], v[20:23]
  ds_read_b128 v[140:143], v2 offset:64512
  v_mfma_f32_16x16x32_bf16 v[48:51], v[100:103], v[164:167], v[48:51]
  s_waitcnt lgkmcnt(9)
  v_mfma_f32_16x16x32_bf16 v[24:27], v[104:107], v[160:163], v[24:27]
  v_mfma_f32_16x16x32_bf16 v[52:55], v[104:107], v[164:167], v[52:55]
  s_waitcnt lgkmcnt(8)
  v_mfma_f32_16x16x32_bf16 v[28:31], v[108:111], v[160:163], v[28:31]
  buffer_load_dwordx4 v[228:231], v1, s[4:7], s22 offen offset:2048 sc1
  v_mfma_f32_16x16x32_bf16 v[56:59], v[108:111], v[164:167], v[56:59]
  s_waitcnt lgkmcnt(7)
  v_mfma_f32_16x16x32_bf16 v[32:35], v[112:115], v[160:163], v[32:35]
  v_mfma_f32_16x16x32_bf16 v[60:63], v[112:115], v[164:167], v[60:63]
  s_waitcnt vmcnt(14) lgkmcnt(6)
  v_mfma_f32_16x16x32_bf16 v[8:11], v[116:119], v[168:171], v[8:11]
  ds_read_b128 v[88:91], v3 offset:0
  v_mfma_f32_16x16x32_bf16 v[36:39], v[116:119], v[172:175], v[36:39]
  ds_read_b128 v[92:95], v3 offset:1024
  s_waitcnt lgkmcnt(7)
  v_mfma_f32_16x16x32_bf16 v[12:15], v[120:123], v[168:171], v[12:15]
  ds_read_b128 v[96:99], v3 offset:2048
  v_mfma_f32_16x16x32_bf16 v[40:43], v[120:123], v[172:175], v[40:43]
  ds_read_b128 v[100:103], v3 offset:3072
  buffer_load_dwordx4 v[232:235], v1, s[4:7], s21 offen offset:3072 sc1
  s_waitcnt lgkmcnt(8)
  v_mfma_f32_16x16x32_bf16 v[16:19], v[124:127], v[168:171], v[16:19]
  ds_read_b128 v[104:107], v3 offset:4096
  v_mfma_f32_16x16x32_bf16 v[44:47], v[124:127], v[172:175], v[44:47]
  ds_read_b128 v[108:111], v3 offset:5120
  s_waitcnt lgkmcnt(9)
  v_mfma_f32_16x16x32_bf16 v[20:23], v[128:131], v[168:171], v[20:23]
  ds_read_b128 v[112:115], v3 offset:6144
  v_mfma_f32_16x16x32_bf16 v[48:51], v[128:131], v[172:175], v[48:51]
  s_waitcnt lgkmcnt(9)
  v_mfma_f32_16x16x32_bf16 v[24:27], v[132:135], v[168:171], v[24:27]
  v_mfma_f32_16x16x32_bf16 v[52:55], v[132:135], v[172:175], v[52:55]
  s_waitcnt lgkmcnt(8)
  v_mfma_f32_16x16x32_bf16 v[28:31], v[136:139], v[168:171], v[28:31]
  buffer_load_dwordx4 v[236:239], v1, s[4:7], s22 offen offset:3072 sc1
  v_mfma_f32_16x16x32_bf16 v[56:59], v[136:139], v[172:175], v[56:59]
  s_waitcnt lgkmcnt(7)
  v_mfma_f32_16x16x32_bf16 v[32:35], v[140:143], v[168:171], v[32:35]
  v_mfma_f32_16x16x32_bf16 v[60:63], v[140:143], v[172:175], v[60:63]
  s_waitcnt vmcnt(14) lgkmcnt(6)
  v_mfma_f32_16x16x32_bf16 v[8:11], v[88:91], v[176:179], v[8:11]
  ds_read_b128 v[116:119], v3 offset:7168
  v_mfma_f32_16x16x32_bf16 v[36:39], v[88:91], v[180:183], v[36:39]
  ds_read_b128 v[120:123], v3 offset:8192
  s_waitcnt lgkmcnt(7)
  v_mfma_f32_16x16x32_bf16 v[12:15], v[92:95], v[176:179], v[12:15]
  ds_read_b128 v[124:127], v3 offset:9216
  v_mfma_f32_16x16x32_bf16 v[40:43], v[92:95], v[180:183], v[40:43]
  ds_read_b128 v[128:131], v3 offset:10240
  s_add_u32 s21, s21, 4096
  buffer_load_dwordx4 v[144:147], v1, s[4:7], s21 offen offset:0 sc1
  s_waitcnt lgkmcnt(8)
  v_mfma_f32_16x16x32_bf16 v[16:19], v[96:99], v[176:179], v[16:19]
  ds_read_b128 v[132:135], v3 offset:11264
  v_mfma_f32_16x16x32_bf16 v[44:47], v[96:99], v[180:183], v[44:47]
  ds_read_b128 v[136:139], v3 offset:12288
  s_waitcnt lgkmcnt(9)
  v_mfma_f32_16x16x32_bf16 v[20:23], v[100:103], v[176:179], v[20:23]
  ds_read_b128 v[140:143], v3 offset:13312
  v_mfma_f32_16x16x32_bf16 v[48:51], v[100:103], v[180:183], v[48:51]
  s_waitcnt lgkmcnt(9)
  v_mfma_f32_16x16x32_bf16 v[24:27], v[104:107], v[176:179], v[24:27]
  v_mfma_f32_16x16x32_bf16 v[52:55], v[104:107], v[180:183], v[52:55]
  s_waitcnt lgkmcnt(8)
  v_mfma_f32_16x16x32_bf16 v[28:31], v[108:111], v[176:179], v[28:31]
  s_add_u32 s22, s22, 4096
  buffer_load_dwordx4 v[148:151], v1, s[4:7], s22 offen offset:0 sc1
  v_mfma_f32_16x16x32_bf16 v[56:59], v[108:111], v[180:183], v[56:59]
  s_waitcnt lgkmcnt(7)
  v_mfma_f32_16x16x32_bf16 v[32:35], v[112:115], v[176:179], v[32:35]
  v_mfma_f32_16x16x32_bf16 v[60:63], v[112:115], v[180:183], v[60:63]
  s_waitcnt vmcnt(14) lgkmcnt(6)
  v_mfma_f32_16x16x32_bf16 v[8:11], v[116:119], v[184:187], v[8:11]
  ds_read_b128 v[88:91], v3 offset:14336
  v_mfma_f32_16x16x32_bf16 v[36:39], v[116:119], v[188:191], v[36:39]
  ds_read_b128 v[92:95], v3 offset:15360
  s_waitcnt lgkmcnt(7)
  v_mfma_f32_16x16x32_bf16 v[12:15], v[120:123], v[184:187], v[12:15]
  ds_read_b128 v[96:99], v3 offset:16384
  v_mfma_f32_16x16x32_bf16 v[40:43], v[120:123], v[188:191], v[40:43]
  ds_read_b128 v[100:103], v3 offset:17408
  buffer_load_dwordx4 v[152:155], v1, s[4:7], s21 offen offset:1024 sc1
  s_waitcnt lgkmcnt(8)
  v_mfma_f32_16x16x32_bf16 v[16:19], v[124:127], v[184:187], v[16:19]
  ds_read_b128 v[104:107], v3 offset:18432
  v_mfma_f32_16x16x32_bf16 v[44:47], v[124:127], v[188:191], v[44:47]
  ds_read_b128 v[108:111], v3 offset:19456
  s_waitcnt lgkmcnt(9)
  v_mfma_f32_16x16x32_bf16 v[20:23], v[128:131], v[184:187], v[20:23]
  ds_read_b128 v[112:115], v3 offset:20480
  v_mfma_f32_16x16x32_bf16 v[48:51], v[128:131], v[188:191], v[48:51]
  s_waitcnt lgkmcnt(9)
  v_mfma_f32_16x16x32_bf16 v[24:27], v[132:135], v[184:187], v[24:27]
  v_mfma_f32_16x16x32_bf16 v[52:55], v[132:135], v[188:191], v[52:55]
  s_waitcnt lgkmcnt(8)
  v_mfma_f32_16x16x32_bf16 v[28:31], v[136:139], v[184:187], v[28:31]
  buffer_load_dwordx4 v[156:159], v1, s[4:7], s22 offen offset:1024 sc1
  v_mfma_f32_16x16x32_bf16 v[56:59], v[136:139], v[188:191], v[56:59]
  s_waitcnt lgkmcnt(7)
  v_mfma_f32_16x16x32_bf16 v[32:35], v[140:143], v[184:187], v[32:35]
  v_mfma_f32_16x16x32_bf16 v[60:63], v[140:143], v[188:191], v[60:63]
  s_waitcnt vmcnt(32)
  s_barrier
  s_waitcnt vmcnt(14) lgkmcnt(6)
  v_mfma_f32_16x16x32_bf16 v[8:11], v[88:91], v[192:195], v[8:11]
  ds_read_b128 v[116:119], v1 offset:0
  v_mfma_f32_16x16x32_bf16 v[36:39], v[88:91], v[196:199], v[36:39]
  ds_read_b128 v[120:123], v1 offset:1024
  s_waitcnt lgkmcnt(7)
  v_mfma_f32_16x16x32_bf16 v[12:15], v[92:95], v[192:195], v[12:15]
  ds_read_b128 v[124:127], v1 offset:2048
  v_mfma_f32_16x16x32_bf16 v[40:43], v[92:95], v[196:199], v[40:43]
  ds_read_b128 v[128:131], v1 offset:3072
  buffer_load_dwordx4 v[160:163], v1, s[4:7], s21 offen offset:2048 sc1
  s_waitcnt lgkmcnt(8)
  v_mfma_f32_16x16x32_bf16 v[16:19], v[96:99], v[192:195], v[16:19]
  ds_read_b128 v[132:135], v1 offset:4096
  v_mfma_f32_16x16x32_bf16 v[44:47], v[96:99], v[196:199], v[44:47]
  ds_read_b128 v[136:139], v1 offset:5120
  s_waitcnt lgkmcnt(9)
  v_mfma_f32_16x16x32_bf16 v[20:23], v[100:103], v[192:195], v[20:23]
  ds_read_b128 v[140:143], v1 offset:6144
  v_mfma_f32_16x16x32_bf16 v[48:51], v[100:103], v[196:199], v[48:51]
  s_waitcnt lgkmcnt(9)
  v_mfma_f32_16x16x32_bf16 v[24:27], v[104:107], v[192:195], v[24:27]
  v_mfma_f32_16x16x32_bf16 v[52:55], v[104:107], v[196:199], v[52:55]
  s_waitcnt lgkmcnt(8)
  v_mfma_f32_16x16x32_bf16 v[28:31], v[108:111], v[192:195], v[28:31]
  buffer_load_dwordx4 v[164:167], v1, s[4:7], s22 offen offset:2048 sc1
  v_mfma_f32_16x16x32_bf16 v[56:59], v[108:111], v[196:199], v[56:59]
  s_waitcnt lgkmcnt(7)
  v_mfma_f32_16x16x32_bf16 v[32:35], v[112:115], v[192:195], v[32:35]
  v_mfma_f32_16x16x32_bf16 v[60:63], v[112:115], v[196:199], v[60:63]
  s_waitcnt vmcnt(14) lgkmcnt(6)
  v_mfma_f32_16x16x32_bf16 v[8:11], v[116:119], v[200:203], v[8:11]
  ds_read_b128 v[88:91], v1 offset:7168
  v_mfma_f32_16x16x32_bf16 v[36:39], v[116:119], v[204:207], v[36:39]
  ds_read_b128 v[92:95], v1 offset:8192
  s_waitcnt lgkmcnt(7)
  v_mfma_f32_16x16x32_bf16 v[12:15], v[120:123], v[200:203], v[12:15]
  ds_read_b128 v[96:99], v1 offset:9216
  v_mfma_f32_16x16x32_bf16 v[40:43], v[120:123], v[204:207], v[40:43]
  ds_read_b128 v[100:103], v1 offset:10240
  buffer_load_dwordx4 v[168:171], v1, s[4:7], s21 offen offset:3072 sc1
  s_waitcnt lgkmcnt(8)
  v_mfma_f32_16x16x32_bf16 v[16:19], v[124:127], v[200:203], v[16:19]
  ds_read_b128 v[104:107], v1 offset:11264
  v_mfma_f32_16x16x32_bf16 v[44:47], v[124:127], v[204:207], v[44:47]
  ds_read_b128 v[108:111], v1 offset:12288
  s_waitcnt lgkmcnt(9)
  v_mfma_f32_16x16x32_bf16 v[20:23], v[128:131], v[200:203], v[20:23]
  ds_read_b128 v[112:115], v1 offset:13312
  v_mfma_f32_16x16x32_bf16 v[48:51], v[128:131], v[204:207], v[48:51]
  s_waitcnt lgkmcnt(9)
  v_mfma_f32_16x16x32_bf16 v[24:27], v[132:135], v[200:203], v[24:27]
  v_mfma_f32_16x16x32_bf16 v[52:55], v[132:135], v[204:207], v[52:55]
  s_waitcnt lgkmcnt(8)
  v_mfma_f32_16x16x32_bf16 v[28:31], v[136:139], v[200:203], v[28:31]
  buffer_load_dwordx4 v[172:175], v1, s[4:7], s22 offen offset:3072 sc1
  v_mfma_f32_16x16x32_bf16 v[56:59], v[136:139], v[204:207], v[56:59]
  s_waitcnt lgkmcnt(7)
  v_mfma_f32_16x16x32_bf16 v[32:35], v[140:143], v[200:203], v[32:35]
  v_mfma_f32_16x16x32_bf16 v[60:63], v[140:143], v[204:207], v[60:63]
  s_waitcnt vmcnt(14) lgkmcnt(6)
  v_mfma_f32_16x16x32_bf16 v[8:11], v[88:91], v[208:211], v[8:11]
  ds_read_b128 v[116:119], v1 offset:14336
  v_mfma_f32_16x16x32_bf16 v[36:39], v[88:91], v[212:215], v[36:39]
  ds_read_b128 v[120:123], v1 offset:15360
  s_waitcnt lgkmcnt(7)
  v_mfma_f32_16x16x32_bf16 v[12:15], v[92:95], v[208:211], v[12:15]
  ds_read_b128 v[124:127], v1 offset:16384
  v_mfma_f32_16x16x32_bf16 v[40:43], v[92:95], v[212:215], v[40:43]
  ds_read_b128 v[128:131], v1 offset:17408
  s_add_u32 s21, s21, 4096
  v_lshlrev_b32 v7, 3, v0
  buffer_load_dwordx2 v[176:177], v7, s[4:7], s21 offen offset:0 sc1
  buffer_load_dwordx2 v[178:179], v7, s[4:7], s21 offen offset:512 sc1
  s_waitcnt lgkmcnt(8)
  v_mfma_f32_16x16x32_bf16 v[16:19], v[96:99], v[208:211], v[16:19]
  ds_read_b128 v[132:135], v1 offset:18432
  v_mfma_f32_16x16x32_bf16 v[44:47], v[96:99], v[212:215], v[44:47]
  ds_read_b128 v[136:139], v1 offset:19456
  s_waitcnt lgkmcnt(9)
  v_mfma_f32_16x16x32_bf16 v[20:23], v[100:103], v[208:211], v[20:23]
  ds_read_b128 v[140:143], v1 offset:20480
  v_mfma_f32_16x16x32_bf16 v[48:51], v[100:103], v[212:215], v[48:51]
  s_waitcnt lgkmcnt(9)
  v_mfma_f32_16x16x32_bf16 v[24:27], v[104:107], v[208:211], v[24:27]
  v_mfma_f32_16x16x32_bf16 v[52:55], v[104:107], v[212:215], v[52:55]
  s_waitcnt lgkmcnt(8)
  v_mfma_f32_16x16x32_bf16 v[28:31], v[108:111], v[208:211], v[28:31]
  s_add_u32 s22, s22, 4096
  v_lshlrev_b32 v7, 3, v0
  buffer_load_dwordx2 v[180:181], v7, s[4:7], s22 offen offset:0 sc1
  buffer_load_dwordx2 v[182:183], v7, s[4:7], s22 offen offset:512 sc1
  v_mfma_f32_16x16x32_bf16 v[56:59], v[108:111], v[212:215], v[56:59]
  s_waitcnt lgkmcnt(7)
  v_mfma_f32_16x16x32_bf16 v[32:35], v[112:115], v[208:211], v[32:35]
  v_mfma_f32_16x16x32_bf16 v[60:63], v[112:115], v[212:215], v[60:63]
  s_waitcnt vmcnt(16) lgkmcnt(6)
  v_mfma_f32_16x16x32_bf16 v[8:11], v[116:119], v[216:219], v[8:11]
  ds_read_b128 v[88:91], v1 offset:21504
  v_mfma_f32_16x16x32_bf16 v[36:39], v[116:119], v[220:223], v[36:39]
  ds_read_b128 v[92:95], v1 offset:22528
  s_waitcnt lgkmcnt(7)
  v_mfma_f32_16x16x32_bf16 v[12:15], v[120:123], v[216:219], v[12:15]
  ds_read_b128 v[96:99], v1 offset:23552
  v_mfma_f32_16x16x32_bf16 v[40:43], v[120:123], v[220:223], v[40:43]
  ds_read_b128 v[100:103], v1 offset:24576
  v_lshlrev_b32 v7, 3, v0
  buffer_load_dwordx2 v[184:185], v7, s[4:7], s21 offen offset:1024 sc1
  buffer_load_dwordx2 v[186:187], v7, s[4:7], s21 offen offset:1536 sc1
  s_waitcnt lgkmcnt(8)
  v_mfma_f32_16x16x32_bf16 v[16:19], v[124:127], v[216:219], v[16:19]
  ds_read_b128 v[104:107], v1 offset:25600
  v_mfma_f32_16x16x32_bf16 v[44:47], v[124:127], v[220:223], v[44:47]
  ds_read_b128 v[108:111], v1 offset:26624
  s_waitcnt lgkmcnt(9)
  v_mfma_f32_16x16x32_bf16 v[20:23], v[128:131], v[216:219], v[20:23]
  ds_read_b128 v[112:115], v1 offset:27648
  v_mfma_f32_16x16x32_bf16 v[48:51], v[128:131], v[220:223], v[48:51]
  s_waitcnt lgkmcnt(9)
  v_mfma_f32_16x16x32_bf16 v[24:27], v[132:135], v[216:219], v[24:27]
  v_mfma_f32_16x16x32_bf16 v[52:55], v[132:135], v[220:223], v[52:55]
  s_waitcnt lgkmcnt(8)
  v_mfma_f32_16x16x32_bf16 v[28:31], v[136:139], v[216:219], v[28:31]
  v_lshlrev_b32 v7, 3, v0
  buffer_load_dwordx2 v[188:189], v7, s[4:7], s22 offen offset:1024 sc1
  buffer_load_dwordx2 v[190:191], v7, s[4:7], s22 offen offset:1536 sc1
  v_mfma_f32_16x16x32_bf16 v[56:59], v[136:139], v[220:223], v[56:59]
  s_waitcnt lgkmcnt(7)
  v_mfma_f32_16x16x32_bf16 v[32:35], v[140:143], v[216:219], v[32:35]
  v_mfma_f32_16x16x32_bf16 v[60:63], v[140:143], v[220:223], v[60:63]
  s_waitcnt vmcnt(18) lgkmcnt(6)
  v_mfma_f32_16x16x32_bf16 v[8:11], v[88:91], v[224:227], v[8:11]
  ds_read_b128 v[116:119], v1 offset:28672
  v_mfma_f32_16x16x32_bf16 v[36:39], v[88:91], v[228:231], v[36:39]
  ds_read_b128 v[120:123], v1 offset:29696
  s_waitcnt lgkmcnt(7)
  v_mfma_f32_16x16x32_bf16 v[12:15], v[92:95], v[224:227], v[12:15]
  ds_read_b128 v[124:127], v1 offset:30720
  v_mfma_f32_16x16x32_bf16 v[40:43], v[92:95], v[228:231], v[40:43]
  ds_read_b128 v[128:131], v1 offset:31744
  v_lshlrev_b32 v7, 3, v0
  buffer_load_dwordx2 v[192:193], v7, s[4:7], s21 offen offset:2048 sc1
  buffer_load_dwordx2 v[194:195], v7, s[4:7], s21 offen offset:2560 sc1
  s_waitcnt lgkmcnt(8)
  v_mfma_f32_16x16x32_bf16 v[16:19], v[96:99], v[224:227], v[16:19]
  ds_read_b128 v[132:135], v1 offset:32768
  v_mfma_f32_16x16x32_bf16 v[44:47], v[96:99], v[228:231], v[44:47]
  ds_read_b128 v[136:139], v1 offset:33792
  s_waitcnt lgkmcnt(9)
  v_mfma_f32_16x16x32_bf16 v[20:23], v[100:103], v[224:227], v[20:23]
  ds_read_b128 v[140:143], v1 offset:34816
  v_mfma_f32_16x16x32_bf16 v[48:51], v[100:103], v[228:231], v[48:51]
  s_waitcnt lgkmcnt(9)
  v_mfma_f32_16x16x32_bf16 v[24:27], v[104:107], v[224:227], v[24:27]
  v_mfma_f32_16x16x32_bf16 v[52:55], v[104:107], v[228:231], v[52:55]
  s_waitcnt lgkmcnt(8)
  v_mfma_f32_16x16x32_bf16 v[28:31], v[108:111], v[224:227], v[28:31]
  v_lshlrev_b32 v7, 3, v0
  buffer_load_dwordx2 v[196:197], v7, s[4:7], s22 offen offset:2048 sc1
  buffer_load_dwordx2 v[198:199], v7, s[4:7], s22 offen offset:2560 sc1
  v_mfma_f32_16x16x32_bf16 v[56:59], v[108:111], v[228:231], v[56:59]
  s_waitcnt lgkmcnt(7)
  v_mfma_f32_16x16x32_bf16 v[32:35], v[112:115], v[224:227], v[32:35]
  v_mfma_f32_16x16x32_bf16 v[60:63], v[112:115], v[228:231], v[60:63]
  s_waitcnt vmcnt(20) lgkmcnt(6)
  v_mfma_f32_16x16x32_bf16 v[8:11], v[116:119], v[232:235], v[8:11]
  ds_read_b128 v[88:91], v1 offset:35840
  v_mfma_f32_16x16x32_bf16 v[36:39], v[116:119], v[236:239], v[36:39]
  ds_read_b128 v[92:95], v1 offset:36864
  s_waitcnt lgkmcnt(7)
  v_mfma_f32_16x16x32_bf16 v[12:15], v[120:123], v[232:235], v[12:15]
  ds_read_b128 v[96:99], v1 offset:37888
  v_mfma_f32_16x16x32_bf16 v[40:43], v[120:123], v[236:239], v[40:43]
  ds_read_b128 v[100:103], v1 offset:38912
  v_lshlrev_b32 v7, 3, v0
  buffer_load_dwordx2 v[200:201], v7, s[4:7], s21 offen offset:3072 sc1
  buffer_load_dwordx2 v[202:203], v7, s[4:7], s21 offen offset:3584 sc1
  s_waitcnt lgkmcnt(8)
  v_mfma_f32_16x16x32_bf16 v[16:19], v[124:127], v[232:235], v[16:19]
  ds_read_b128 v[104:107], v1 offset:39936
  v_mfma_f32_16x16x32_bf16 v[44:47], v[124:127], v[236:239], v[44:47]
  ds_read_b128 v[108:111], v1 offset:40960
  s_waitcnt lgkmcnt(9)
  v_mfma_f32_16x16x32_bf16 v[20:23], v[128:131], v[232:235], v[20:23]
  ds_read_b128 v[112:115], v1 offset:41984
  v_mfma_f32_16x16x32_bf16 v[48:51], v[128:131], v[236:239], v[48:51]
  s_waitcnt lgkmcnt(9)
  v_mfma_f32_16x16x32_bf16 v[24:27], v[132:135], v[232:235], v[24:27]
  v_mfma_f32_16x16x32_bf16 v[52:55], v[132:135], v[236:239], v[52:55]
  s_waitcnt lgkmcnt(8)
  v_mfma_f32_16x16x32_bf16 v[28:31], v[136:139], v[232:235], v[28:31]
  v_lshlrev_b32 v7, 3, v0
  buffer_load_dwordx2 v[204:205], v7, s[4:7], s22 offen offset:3072 sc1
  buffer_load_dwordx2 v[206:207], v7, s[4:7], s22 offen offset:3584 sc1
  v_mfma_f32_16x16x32_bf16 v[56:59], v[136:139], v[236:239], v[56:59]
  s_waitcnt lgkmcnt(7)
  v_mfma_f32_16x16x32_bf16 v[32:35], v[140:143], v[232:235], v[32:35]
  v_mfma_f32_16x16x32_bf16 v[60:63], v[140:143], v[236:239], v[60:63]
  s_waitcnt vmcnt(22) lgkmcnt(6)
  v_mfma_f32_16x16x32_bf16 v[8:11], v[88:91], v[144:147], v[8:11]
  ds_read_b128 v[116:119], v1 offset:43008
  v_mfma_f32_16x16x32_bf16 v[36:39], v[88:91], v[148:151], v[36:39]
  ds_read_b128 v[120:123], v1 offset:44032
  s_waitcnt lgkmcnt(7)
  v_mfma_f32_16x16x32_bf16 v[12:15], v[92:95], v[144:147], v[12:15]
  ds_read_b128 v[124:127], v1 offset:45056
  v_mfma_f32_16x16x32_bf16 v[40:43], v[92:95], v[148:151], v[40:43]
  ds_read_b128 v[128:131], v1 offset:46080
  s_add_u32 s17, s62, 204800
  buffer_load_dwordx4 a[208:211], v1, s[4:7], s17 offen offset:2048 sc1
  s_waitcnt lgkmcnt(8)
  v_mfma_f32_16x16x32_bf16 v[16:19], v[96:99], v[144:147], v[16:19]
  ds_read_b128 v[132:135], v1 offset:47104
  v_mfma_f32_16x16x32_bf16 v[44:47], v[96:99], v[148:151], v[44:47]
  ds_read_b128 v[136:139], v1 offset:48128
  s_waitcnt lgkmcnt(9)
  v_mfma_f32_16x16x32_bf16 v[20:23], v[100:103], v[144:147], v[20:23]
  ds_read_b128 v[140:143], v1 offset:49152
  v_mfma_f32_16x16x32_bf16 v[48:51], v[100:103], v[148:151], v[48:51]
  s_waitcnt lgkmcnt(9)
  v_mfma_f32_16x16x32_bf16 v[24:27], v[104:107], v[144:147], v[24:27]
  v_mfma_f32_16x16x32_bf16 v[52:55], v[104:107], v[148:151], v[52:55]
  s_waitcnt lgkmcnt(8)
  v_mfma_f32_16x16x32_bf16 v[28:31], v[108:111], v[144:147], v[28:31]
  s_add_u32 s17, s62, 204800
  buffer_load_dwordx4 a[212:215], v1, s[4:7], s17 offen offset:3072 sc1
  v_mfma_f32_16x16x32_bf16 v[56:59], v[108:111], v[148:151], v[56:59]
  s_waitcnt lgkmcnt(7)
  v_mfma_f32_16x16x32_bf16 v[32:35], v[112:115], v[144:147], v[32:35]
  v_mfma_f32_16x16x32_bf16 v[60:63], v[112:115], v[148:151], v[60:63]
  s_waitcnt vmcnt(22) lgkmcnt(6)
  v_mfma_f32_16x16x32_bf16 v[8:11], v[116:119], v[152:155], v[8:11]
  ds_read_b128 v[88:91], v1 offset:50176
  v_mfma_f32_16x16x32_bf16 v[36:39], v[116:119], v[156:159], v[36:39]
  ds_read_b128 v[92:95], v1 offset:51200
  s_waitcnt lgkmcnt(7)
  v_mfma_f32_16x16x32_bf16 v[12:15], v[120:123], v[152:155], v[12:15]
  ds_read_b128 v[96:99], v1 offset:52224
  v_mfma_f32_16x16x32_bf16 v[40:43], v[120:123], v[156:159], v[40:43]
  ds_read_b128 v[100:103], v1 offset:53248
  s_add_u32 s17, s62, 208896
  buffer_load_dwordx4 a[216:219], v1, s[4:7], s17 offen offset:0 sc1
  s_waitcnt lgkmcnt(8)
  v_mfma_f32_16x16x32_bf16 v[16:19], v[124:127], v[152:155], v[16:19]
  ds_read_b128 v[104:107], v1 offset:54272
  v_mfma_f32_16x16x32_bf16 v[44:47], v[124:127], v[156:159], v[44:47]
  ds_read_b128 v[108:111], v1 offset:55296
  s_waitcnt lgkmcnt(9)
  v_mfma_f32_16x16x32_bf16 v[20:23], v[128:131], v[152:155], v[20:23]
  ds_read_b128 v[112:115], v1 offset:56320
  v_mfma_f32_16x16x32_bf16 v[48:51], v[128:131], v[156:159], v[48:51]
  s_waitcnt lgkmcnt(9)
  v_mfma_f32_16x16x32_bf16 v[24:27], v[132:135], v[152:155], v[24:27]
  v_mfma_f32_16x16x32_bf16 v[52:55], v[132:135], v[156:159], v[52:55]
  s_waitcnt lgkmcnt(8)
  v_mfma_f32_16x16x32_bf16 v[28:31], v[136:139], v[152:155], v[28:31]
  s_add_u32 s17, s62, 225280
  buffer_load_dwordx4 a[220:223], v1, s[4:7], s17 offen offset:0 sc1
  v_mfma_f32_16x16x32_bf16 v[56:59], v[136:139], v[156:159], v[56:59]
  s_waitcnt lgkmcnt(7)
  v_mfma_f32_16x16x32_bf16 v[32:35], v[140:143], v[152:155], v[32:35]
  v_mfma_f32_16x16x32_bf16 v[60:63], v[140:143], v[156:159], v[60:63]
  s_waitcnt vmcnt(22) lgkmcnt(6)
  v_mfma_f32_16x16x32_bf16 v[8:11], v[88:91], v[160:163], v[8:11]
  ds_read_b128 v[116:119], v1 offset:57344
  v_mfma_f32_16x16x32_bf16 v[36:39], v[88:91], v[164:167], v[36:39]
  ds_read_b128 v[120:123], v1 offset:58368
  s_waitcnt lgkmcnt(7)
  v_mfma_f32_16x16x32_bf16 v[12:15], v[92:95], v[160:163], v[12:15]
  ds_read_b128 v[124:127], v1 offset:59392
  v_mfma_f32_16x16x32_bf16 v[40:43], v[92:95], v[164:167], v[40:43]
  ds_read_b128 v[128:131], v1 offset:60416
  s_add_u32 s17, s62, 225280
  buffer_load_dwordx4 a[224:227], v1, s[4:7], s17 offen offset:1024 sc1
  s_waitcnt lgkmcnt(8)
  v_mfma_f32_16x16x32_bf16 v[16:19], v[96:99], v[160:163], v[16:19]
  ds_read_b128 v[132:135], v1 offset:61440
  v_mfma_f32_16x16x32_bf16 v[44:47], v[96:99], v[164:167], v[44:47]
  ds_read_b128 v[136:139], v1 offset:62464
  s_waitcnt lgkmcnt(9)
  v_mfma_f32_16x16x32_bf16 v[20:23], v[100:103], v[160:163], v[20:23]
  ds_read_b128 v[140:143], v1 offset:63488
  v_mfma_f32_16x16x32_bf16 v[48:51], v[100:103], v[164:167], v[48:51]
  s_waitcnt lgkmcnt(9)
  v_mfma_f32_16x16x32_bf16 v[24:27], v[104:107], v[160:163], v[24:27]
  v_mfma_f32_16x16x32_bf16 v[52:55], v[104:107], v[164:167], v[52:55]
  s_waitcnt lgkmcnt(8)
  v_mfma_f32_16x16x32_bf16 v[28:31], v[108:111], v[160:163], v[28:31]
  s_add_u32 s17, s62, 225280
  buffer_load_dwordx4 a[228:231], v1, s[4:7], s17 offen offset:2048 sc1
  v_mfma_f32_16x16x32_bf16 v[56:59], v[108:111], v[164:167], v[56:59]
  s_waitcnt lgkmcnt(7)
  v_mfma_f32_16x16x32_bf16 v[32:35], v[112:115], v[160:163], v[32:35]
  v_mfma_f32_16x16x32_bf16 v[60:63], v[112:115], v[164:167], v[60:63]
  s_waitcnt vmcnt(22) lgkmcnt(6)
  v_mfma_f32_16x16x32_bf16 v[8:11], v[116:119], v[168:171], v[8:11]
  ds_read_b128 v[88:91], v1 offset:64512
  v_mfma_f32_16x16x32_bf16 v[36:39], v[116:119], v[172:175], v[36:39]
  ds_read_b128 v[92:95], v2 offset:0
  s_waitcnt lgkmcnt(7)
  v_mfma_f32_16x16x32_bf16 v[12:15], v[120:123], v[168:171], v[12:15]
  ds_read_b128 v[96:99], v2 offset:1024
  v_mfma_f32_16x16x32_bf16 v[40:43], v[120:123], v[172:175], v[40:43]
  ds_read_b128 v[100:103], v2 offset:2048
  s_add_u32 s17, s62, 225280
  buffer_load_dwordx4 a[232:235], v1, s[4:7], s17 offen offset:3072 sc1
  s_waitcnt lgkmcnt(8)
  v_mfma_f32_16x16x32_bf16 v[16:19], v[124:127], v[168:171], v[16:19]
  ds_read_b128 v[104:107], v2 offset:3072
  v_mfma_f32_16x16x32_bf16 v[44:47], v[124:127], v[172:175], v[44:47]
  ds_read_b128 v[108:111], v2 offset:4096
  s_waitcnt lgkmcnt(9)
  v_mfma_f32_16x16x32_bf16 v[20:23], v[128:131], v[168:171], v[20:23]
  ds_read_b128 v[112:115], v2 offset:5120
  v_mfma_f32_16x16x32_bf16 v[48:51], v[128:131], v[172:175], v[48:51]
  s_waitcnt lgkmcnt(9)
  v_mfma_f32_16x16x32_bf16 v[24:27], v[132:135], v[168:171], v[24:27]
  v_mfma_f32_16x16x32_bf16 v[52:55], v[132:135], v[172:175], v[52:55]
  s_waitcnt lgkmcnt(8)
  v_mfma_f32_16x16x32_bf16 v[28:31], v[136:139], v[168:171], v[28:31]
  s_add_u32 s17, s62, 229376
  buffer_load_dwordx4 a[236:239], v1, s[4:7], s17 offen offset:0 sc1
  v_mfma_f32_16x16x32_bf16 v[56:59], v[136:139], v[172:175], v[56:59]
  s_waitcnt lgkmcnt(7)
  v_mfma_f32_16x16x32_bf16 v[32:35], v[140:143], v[168:171], v[32:35]
  v_mfma_f32_16x16x32_bf16 v[60:63], v[140:143], v[172:175], v[60:63]
  s_waitcnt vmcnt(20) lgkmcnt(6)
  v_mfma_f32_16x16x32_bf16 v[8:11], v[88:91], v[176:179], v[8:11]
  ds_read_b128 v[116:119], v2 offset:6144
  v_mfma_f32_16x16x32_bf16 v[36:39], v[88:91], v[180:183], v[36:39]
  ds_read_b128 v[120:123], v2 offset:7168
  s_waitcnt lgkmcnt(7)
  v_mfma_f32_16x16x32_bf16 v[12:15], v[92:95], v[176:179], v[12:15]
  ds_read_b128 v[124:127], v2 offset:8192
  v_mfma_f32_16x16x32_bf16 v[40:43], v[92:95], v[180:183], v[40:43]
  ds_read_b128 v[128:131], v2 offset:9216
  s_add_u32 s17, s62, 245760
  buffer_load_dwordx4 a[240:243], v1, s[4:7], s17 offen offset:0 sc1
  s_waitcnt lgkmcnt(8)
  v_mfma_f32_16x16x32_bf16 v[16:19], v[96:99], v[176:179], v[16:19]
  ds_read_b128 v[132:135], v2 offset:10240
  v_mfma_f32_16x16x32_bf16 v[44:47], v[96:99], v[180:183], v[44:47]
  ds_read_b128 v[136:139], v2 offset:11264
  s_waitcnt lgkmcnt(9)
  v_mfma_f32_16x16x32_bf16 v[20:23], v[100:103], v[176:179], v[20:23]
  ds_read_b128 v[140:143], v2 offset:12288
  v_mfma_f32_16x16x32_bf16 v[48:51], v[100:103], v[180:183], v[48:51]
  s_waitcnt lgkmcnt(9)
  v_mfma_f32_16x16x32_bf16 v[24:27], v[104:107], v[176:179], v[24:27]
  v_mfma_f32_16x16x32_bf16 v[52:55], v[104:107], v[180:183], v[52:55]
  s_waitcnt lgkmcnt(8)
  v_mfma_f32_16x16x32_bf16 v[28:31], v[108:111], v[176:179], v[28:31]
  s_add_u32 s17, s62, 245760
  buffer_load_dwordx4 a[244:247], v1, s[4:7], s17 offen offset:1024 sc1
  v_mfma_f32_16x16x32_bf16 v[56:59], v[108:111], v[180:183], v[56:59]
  s_waitcnt lgkmcnt(7)
  v_mfma_f32_16x16x32_bf16 v[32:35], v[112:115], v[176:179], v[32:35]
  v_mfma_f32_16x16x32_bf16 v[60:63], v[112:115], v[180:183], v[60:63]
  s_waitcnt vmcnt(18) lgkmcnt(6)
  v_mfma_f32_16x16x32_bf16 v[8:11], v[116:119], v[184:187], v[8:11]
  ds_read_b128 v[88:91], v2 offset:13312
  v_mfma_f32_16x16x32_bf16 v[36:39], v[116:119], v[188:191], v[36:39]
  ds_read_b128 v[92:95], v2 offset:14336
  s_waitcnt lgkmcnt(7)
  v_mfma_f32_16x16x32_bf16 v[12:15], v[120:123], v[184:187], v[12:15]
  ds_read_b128 v[96:99], v2 offset:15360
  v_mfma_f32_16x16x32_bf16 v[40:43], v[120:123], v[188:191], v[40:43]
  ds_read_b128 v[100:103], v2 offset:16384
  s_add_u32 s17, s62, 245760
  buffer_load_dwordx4 a[248:251], v1, s[4:7], s17 offen offset:2048 sc1
  s_waitcnt lgkmcnt(8)
  v_mfma_f32_16x16x32_bf16 v[16:19], v[124:127], v[184:187], v[16:19]
  ds_read_b128 v[104:107], v2 offset:17408
  v_mfma_f32_16x16x32_bf16 v[44:47], v[124:127], v[188:191], v[44:47]
  ds_read_b128 v[108:111], v2 offset:18432
  s_waitcnt lgkmcnt(9)
  v_mfma_f32_16x16x32_bf16 v[20:23], v[128:131], v[184:187], v[20:23]
  ds_read_b128 v[112:115], v2 offset:19456
  v_mfma_f32_16x16x32_bf16 v[48:51], v[128:131], v[188:191], v[48:51]
  s_waitcnt lgkmcnt(9)
  v_mfma_f32_16x16x32_bf16 v[24:27], v[132:135], v[184:187], v[24:27]
  v_mfma_f32_16x16x32_bf16 v[52:55], v[132:135], v[188:191], v[52:55]
  s_waitcnt lgkmcnt(8)
  v_mfma_f32_16x16x32_bf16 v[28:31], v[136:139], v[184:187], v[28:31]
  s_add_u32 s17, s62, 245760
  buffer_load_dwordx4 a[252:255], v1, s[4:7], s17 offen offset:3072 sc1
  v_mfma_f32_16x16x32_bf16 v[56:59], v[136:139], v[188:191], v[56:59]
  s_waitcnt lgkmcnt(7)
  v_mfma_f32_16x16x32_bf16 v[32:35], v[140:143], v[184:187], v[32:35]
  v_mfma_f32_16x16x32_bf16 v[60:63], v[140:143], v[188:191], v[60:63]
  s_waitcnt vmcnt(16) lgkmcnt(6)
  v_mfma_f32_16x16x32_bf16 v[8:11], v[88:91], v[192:195], v[8:11]
  ds_read_b128 v[116:119], v2 offset:20480
  v_mfma_f32_16x16x32_bf16 v[36:39], v[88:91], v[196:199], v[36:39]
  ds_read_b128 v[120:123], v2 offset:21504
  s_waitcnt lgkmcnt(7)
  v_mfma_f32_16x16x32_bf16 v[12:15], v[92:95], v[192:195], v[12:15]
  ds_read_b128 v[124:127], v2 offset:22528
  v_mfma_f32_16x16x32_bf16 v[40:43], v[92:95], v[196:199], v[40:43]
  ds_read_b128 v[128:131], v2 offset:23552
  s_waitcnt lgkmcnt(8)
  v_mfma_f32_16x16x32_bf16 v[16:19], v[96:99], v[192:195], v[16:19]
  ds_read_b128 v[132:135], v2 offset:24576
  v_mfma_f32_16x16x32_bf16 v[44:47], v[96:99], v[196:199], v[44:47]
  ds_read_b128 v[136:139], v2 offset:25600
  s_waitcnt lgkmcnt(9)
  v_mfma_f32_16x16x32_bf16 v[20:23], v[100:103], v[192:195], v[20:23]
  ds_read_b128 v[140:143], v2 offset:26624
  v_mfma_f32_16x16x32_bf16 v[48:51], v[100:103], v[196:199], v[48:51]
  s_waitcnt lgkmcnt(9)
  v_mfma_f32_16x16x32_bf16 v[24:27], v[104:107], v[192:195], v[24:27]
  v_mfma_f32_16x16x32_bf16 v[52:55], v[104:107], v[196:199], v[52:55]
  s_waitcnt lgkmcnt(8)
  v_mfma_f32_16x16x32_bf16 v[28:31], v[108:111], v[192:195], v[28:31]
  v_mfma_f32_16x16x32_bf16 v[56:59], v[108:111], v[196:199], v[56:59]
  s_waitcnt lgkmcnt(7)
  v_mfma_f32_16x16x32_bf16 v[32:35], v[112:115], v[192:195], v[32:35]
  v_mfma_f32_16x16x32_bf16 v[60:63], v[112:115], v[196:199], v[60:63]
  s_waitcnt vmcnt(12) lgkmcnt(6)
  v_mfma_f32_16x16x32_bf16 v[8:11], v[116:119], v[200:203], v[8:11]
  v_mfma_f32_16x16x32_bf16 v[36:39], v[116:119], v[204:207], v[36:39]
  s_waitcnt lgkmcnt(5)
  v_mfma_f32_16x16x32_bf16 v[12:15], v[120:123], v[200:203], v[12:15]
  v_mfma_f32_16x16x32_bf16 v[40:43], v[120:123], v[204:207], v[40:43]
  s_waitcnt lgkmcnt(4)
  v_mfma_f32_16x16x32_bf16 v[16:19], v[124:127], v[200:203], v[16:19]
  v_mfma_f32_16x16x32_bf16 v[44:47], v[124:127], v[204:207], v[44:47]
  s_waitcnt lgkmcnt(3)
  v_mfma_f32_16x16x32_bf16 v[20:23], v[128:131], v[200:203], v[20:23]
  v_mfma_f32_16x16x32_bf16 v[48:51], v[128:131], v[204:207], v[48:51]
  s_waitcnt lgkmcnt(2)
  v_mfma_f32_16x16x32_bf16 v[24:27], v[132:135], v[200:203], v[24:27]
  v_mfma_f32_16x16x32_bf16 v[52:55], v[132:135], v[204:207], v[52:55]
  s_waitcnt lgkmcnt(1)
  v_mfma_f32_16x16x32_bf16 v[28:31], v[136:139], v[200:203], v[28:31]
  v_mfma_f32_16x16x32_bf16 v[56:59], v[136:139], v[204:207], v[56:59]
  s_waitcnt lgkmcnt(0)
  v_mfma_f32_16x16x32_bf16 v[32:35], v[140:143], v[200:203], v[32:35]
  v_mfma_f32_16x16x32_bf16 v[60:63], v[140:143], v[204:207], v[60:63]
  v_lshlrev_b32 v88, 16, v72
  v_and_b32 v89, 0xffff0000, v72
  v_lshlrev_b32 v90, 16, v73
  v_and_b32 v91, 0xffff0000, v73
  v_lshlrev_b32 v92, 16, v74
  v_and_b32 v93, 0xffff0000, v74
  v_lshlrev_b32 v94, 16, v75
  v_and_b32 v95, 0xffff0000, v75
  v_lshlrev_b32 v96, 16, v76
  v_and_b32 v97, 0xffff0000, v76
  v_lshlrev_b32 v98, 16, v77
  v_and_b32 v99, 0xffff0000, v77
  v_lshlrev_b32 v100, 16, v78
  v_and_b32 v101, 0xffff0000, v78
  v_lshlrev_b32 v102, 16, v79
  v_and_b32 v103, 0xffff0000, v79
  v_lshlrev_b32 v104, 16, v80
  v_and_b32 v105, 0xffff0000, v80
  v_lshlrev_b32 v106, 16, v81
  v_and_b32 v107, 0xffff0000, v81
  v_lshlrev_b32 v108, 16, v82
  v_and_b32 v109, 0xffff0000, v82
  v_lshlrev_b32 v110, 16, v83
  v_and_b32 v111, 0xffff0000, v83
  v_lshlrev_b32 v112, 16, v84
  v_and_b32 v113, 0xffff0000, v84
  v_lshlrev_b32 v114, 16, v85
  v_and_b32 v115, 0xffff0000, v85
  v_mov_b32 v164, 0xc0135761
  v_mov_b32 v166, 0xbdd2d3e8
  v_add_f32 v64, v64, v66
  v_add_f32 v65, v65, v67
  s_nop 1
  v_permlane16_swap_b32 v64, v65
  v_add_f32 v64, v64, v65
  v_mov_b32 v65, v64
  s_nop 1
  v_permlane32_swap_b32 v64, v65
  v_add_f32 v64, v64, v65
  v_mov_b32 v65, v64
  s_nop 1
  v_permlane16_swap_b32 v64, v65
  v_mul_f32 v64, 0x3acccccd, v64
  v_mul_f32 v116, 0x3acccccd, v65
  v_fma_f32 v116, -v64, v64, v116
  v_max_f32 v116, 0, v116
  v_add_f32 v120, 0x3727c5ac, v116
  v_rcp_f32 v121, v120
  v_rsq_f32 v120, v120
  v_mul_f32 v116, v116, v121
  v_add_f32 v116, 0x3727c5ac, v116
  v_rsq_f32 v116, v116
  s_nop 0
  v_mul_f32 v116, v116, v120
  v_add_f32 v68, v68, v70
  v_add_f32 v69, v69, v71
  s_nop 1
  v_permlane16_swap_b32 v68, v69
  v_add_f32 v68, v68, v69
  v_mov_b32 v69, v68
  s_nop 1
  v_permlane32_swap_b32 v68, v69
  v_add_f32 v68, v68, v69
  v_mov_b32 v69, v68
  s_nop 1
  v_permlane16_swap_b32 v68, v69
  v_mul_f32 v68, 0x3acccccd, v68
  v_mul_f32 v118, 0x3acccccd, v69
  v_fma_f32 v118, -v68, v68, v118
  v_max_f32 v118, 0, v118
  v_add_f32 v120, 0x3727c5ac, v118
  v_rcp_f32 v121, v120
  v_rsq_f32 v120, v120
  v_mul_f32 v118, v118, v121
  v_add_f32 v118, 0x3727c5ac, v118
  v_rsq_f32 v118, v118
  s_nop 0
  v_mul_f32 v118, v118, v120
  s_and_b32 s17, s10, 7
  s_cmp_ge_u32 s17, 6
  s_cselect_b32 s18, 0x40000000, 0
  v_lshlrev_b32 v168, 3, v0
  v_add_u32 v168, s18, v168
  s_lshl_b32 s17, s17, 9
  s_lshr_b32 s18, s10, 3
  s_mul_i32 s18, s18, 3072
  s_add_u32 s17, s17, s18
  s_mul_i32 s18, s10, 3072
  s_sub_u32 s22, s17, s18
  s_add_u32 s22, s22, 49152
  s_add_u32 s21, s59, 0
  s_mul_i32 s21, s21, 55296
  s_add_u32 s21, s21, s55
  s_mul_i32 s17, s10, 3072
  s_add_u32 s21, s21, s17
  v_pk_fma_f32 v[8:9], v[8:9], v[116:117], v[88:89] op_sel_hi:[1,0,1]
  v_pk_fma_f32 v[10:11], v[10:11], v[116:117], v[90:91] op_sel_hi:[1,0,1]
  v_pk_mul_f32 v[128:129], v[8:9], v[8:9]
  v_pk_mul_f32 v[130:131], v[10:11], v[10:11]
  v_pk_fma_f32 v[128:129], v[128:129], v[166:167], v[164:165] op_sel_hi:[1,0,0]
  v_pk_fma_f32 v[130:131], v[130:131], v[166:167], v[164:165] op_sel_hi:[1,0,0]
  v_pk_mul_f32 v[128:129], v[128:129], v[8:9]
  v_pk_mul_f32 v[130:131], v[130:131], v[10:11]
  v_exp_f32 v128, v128
  v_exp_f32 v129, v129
  v_exp_f32 v130, v130
  v_exp_f32 v131, v131
  v_pk_add_f32 v[128:129], v[128:129], 1.0 op_sel_hi:[1,0]
  v_pk_add_f32 v[130:131], v[130:131], 1.0 op_sel_hi:[1,0]
  v_rcp_f32 v128, v128
  v_rcp_f32 v129, v129
  v_rcp_f32 v130, v130
  v_rcp_f32 v131, v131
  v_pk_mul_f32 v[128:129], v[128:129], v[8:9]
  v_pk_mul_f32 v[130:131], v[130:131], v[10:11]
  v_cvt_pk_bf16_f32 v136, v128, v129
  v_cvt_pk_bf16_f32 v137, v130, v131
  v_pk_fma_f32 v[12:13], v[12:13], v[116:117], v[92:93] op_sel_hi:[1,0,1]
  v_pk_fma_f32 v[14:15], v[14:15], v[116:117], v[94:95] op_sel_hi:[1,0,1]
  v_pk_mul_f32 v[128:129], v[12:13], v[12:13]
  v_pk_mul_f32 v[130:131], v[14:15], v[14:15]
  v_pk_fma_f32 v[128:129], v[128:129], v[166:167], v[164:165] op_sel_hi:[1,0,0]
  v_pk_fma_f32 v[130:131], v[130:131], v[166:167], v[164:165] op_sel_hi:[1,0,0]
  v_pk_mul_f32 v[128:129], v[128:129], v[12:13]
  v_pk_mul_f32 v[130:131], v[130:131], v[14:15]
  v_exp_f32 v128, v128
  v_exp_f32 v129, v129
  v_exp_f32 v130, v130
  v_exp_f32 v131, v131
  v_pk_add_f32 v[128:129], v[128:129], 1.0 op_sel_hi:[1,0]
  v_pk_add_f32 v[130:131], v[130:131], 1.0 op_sel_hi:[1,0]
  v_rcp_f32 v128, v128
  v_rcp_f32 v129, v129
  v_rcp_f32 v130, v130
  v_rcp_f32 v131, v131
  v_pk_mul_f32 v[128:129], v[128:129], v[12:13]
  v_pk_mul_f32 v[130:131], v[130:131], v[14:15]
  v_cvt_pk_bf16_f32 v138, v128, v129
  v_cvt_pk_bf16_f32 v139, v130, v131
  buffer_store_dwordx4 v[136:139], v1, s[4:7], s21 offen offset:0 sc1
  v_pk_fma_f32 v[16:17], v[16:17], v[116:117], v[96:97] op_sel_hi:[1,0,1]
  v_pk_fma_f32 v[18:19], v[18:19], v[116:117], v[98:99] op_sel_hi:[1,0,1]
  v_pk_mul_f32 v[128:129], v[16:17], v[16:17]
  v_pk_mul_f32 v[130:131], v[18:19], v[18:19]
  v_pk_fma_f32 v[128:129], v[128:129], v[166:167], v[164:165] op_sel_hi:[1,0,0]
  v_pk_fma_f32 v[130:131], v[130:131], v[166:167], v[164:165] op_sel_hi:[1,0,0]
  v_pk_mul_f32 v[128:129], v[128:129], v[16:17]
  v_pk_mul_f32 v[130:131], v[130:131], v[18:19]
  v_exp_f32 v128, v128
  v_exp_f32 v129, v129
  v_exp_f32 v130, v130
  v_exp_f32 v131, v131
  v_pk_add_f32 v[128:129], v[128:129], 1.0 op_sel_hi:[1,0]
  v_pk_add_f32 v[130:131], v[130:131], 1.0 op_sel_hi:[1,0]
  v_rcp_f32 v128, v128
  v_rcp_f32 v129, v129
  v_rcp_f32 v130, v130
  v_rcp_f32 v131, v131
  v_pk_mul_f32 v[128:129], v[128:129], v[16:17]
  v_pk_mul_f32 v[130:131], v[130:131], v[18:19]
  v_cvt_pk_bf16_f32 v140, v128, v129
  v_cvt_pk_bf16_f32 v141, v130, v131
  v_pk_fma_f32 v[20:21], v[20:21], v[116:117], v[100:101] op_sel_hi:[1,0,1]
  v_pk_fma_f32 v[22:23], v[22:23], v[116:117], v[102:103] op_sel_hi:[1,0,1]
  v_pk_mul_f32 v[128:129], v[20:21], v[20:21]
  v_pk_mul_f32 v[130:131], v[22:23], v[22:23]
  v_pk_fma_f32 v[128:129], v[128:129], v[166:167], v[164:165] op_sel_hi:[1,0,0]
  v_pk_fma_f32 v[130:131], v[130:131], v[166:167], v[164:165] op_sel_hi:[1,0,0]
  v_pk_mul_f32 v[128:129], v[128:129], v[20:21]
  v_pk_mul_f32 v[130:131], v[130:131], v[22:23]
  v_exp_f32 v128, v128
  v_exp_f32 v129, v129
  v_exp_f32 v130, v130
  v_exp_f32 v131, v131
  v_pk_add_f32 v[128:129], v[128:129], 1.0 op_sel_hi:[1,0]
  v_pk_add_f32 v[130:131], v[130:131], 1.0 op_sel_hi:[1,0]
  v_rcp_f32 v128, v128
  v_rcp_f32 v129, v129
  v_rcp_f32 v130, v130
  v_rcp_f32 v131, v131
  v_pk_mul_f32 v[128:129], v[128:129], v[20:21]
  v_pk_mul_f32 v[130:131], v[130:131], v[22:23]
  v_cvt_pk_bf16_f32 v142, v128, v129
  v_cvt_pk_bf16_f32 v143, v130, v131
  buffer_store_dwordx4 v[140:143], v1, s[4:7], s21 offen offset:1024 sc1
  v_pk_fma_f32 v[24:25], v[24:25], v[116:117], v[104:105] op_sel_hi:[1,0,1]
  v_pk_fma_f32 v[26:27], v[26:27], v[116:117], v[106:107] op_sel_hi:[1,0,1]
  v_pk_mul_f32 v[128:129], v[24:25], v[24:25]
  v_pk_mul_f32 v[130:131], v[26:27], v[26:27]
  v_pk_fma_f32 v[128:129], v[128:129], v[166:167], v[164:165] op_sel_hi:[1,0,0]
  v_pk_fma_f32 v[130:131], v[130:131], v[166:167], v[164:165] op_sel_hi:[1,0,0]
  v_pk_mul_f32 v[128:129], v[128:129], v[24:25]
  v_pk_mul_f32 v[130:131], v[130:131], v[26:27]
  v_exp_f32 v128, v128
  v_exp_f32 v129, v129
  v_exp_f32 v130, v130
  v_exp_f32 v131, v131
  v_pk_add_f32 v[128:129], v[128:129], 1.0 op_sel_hi:[1,0]
  v_pk_add_f32 v[130:131], v[130:131], 1.0 op_sel_hi:[1,0]
  v_rcp_f32 v128, v128
  v_rcp_f32 v129, v129
  v_rcp_f32 v130, v130
  v_rcp_f32 v131, v131
  v_pk_mul_f32 v[128:129], v[128:129], v[24:25]
  v_pk_mul_f32 v[130:131], v[130:131], v[26:27]
  v_cvt_pk_bf16_f32 v144, v128, v129
  v_cvt_pk_bf16_f32 v145, v130, v131
  v_pk_fma_f32 v[28:29], v[28:29], v[116:117], v[108:109] op_sel_hi:[1,0,1]
  v_pk_fma_f32 v[30:31], v[30:31], v[116:117], v[110:111] op_sel_hi:[1,0,1]
  v_pk_mul_f32 v[128:129], v[28:29], v[28:29]
  v_pk_mul_f32 v[130:131], v[30:31], v[30:31]
  v_pk_fma_f32 v[128:129], v[128:129], v[166:167], v[164:165] op_sel_hi:[1,0,0]
  v_pk_fma_f32 v[130:131], v[130:131], v[166:167], v[164:165] op_sel_hi:[1,0,0]
  v_pk_mul_f32 v[128:129], v[128:129], v[28:29]
  v_pk_mul_f32 v[130:131], v[130:131], v[30:31]
  v_exp_f32 v128, v128
  v_exp_f32 v129, v129
  v_exp_f32 v130, v130
  v_exp_f32 v131, v131
  v_pk_add_f32 v[128:129], v[128:129], 1.0 op_sel_hi:[1,0]
  v_pk_add_f32 v[130:131], v[130:131], 1.0 op_sel_hi:[1,0]
  v_rcp_f32 v128, v128
  v_rcp_f32 v129, v129
  v_rcp_f32 v130, v130
  v_rcp_f32 v131, v131
  v_pk_mul_f32 v[128:129], v[128:129], v[28:29]
  v_pk_mul_f32 v[130:131], v[130:131], v[30:31]
  v_cvt_pk_bf16_f32 v146, v128, v129
  v_cvt_pk_bf16_f32 v147, v130, v131
  buffer_store_dwordx4 v[144:147], v1, s[4:7], s21 offen offset:2048 sc1
  v_pk_fma_f32 v[32:33], v[32:33], v[116:117], v[112:113] op_sel_hi:[1,0,1]
  v_pk_fma_f32 v[34:35], v[34:35], v[116:117], v[114:115] op_sel_hi:[1,0,1]
  v_pk_mul_f32 v[128:129], v[32:33], v[32:33]
  v_pk_mul_f32 v[130:131], v[34:35], v[34:35]
  v_pk_fma_f32 v[128:129], v[128:129], v[166:167], v[164:165] op_sel_hi:[1,0,0]
  v_pk_fma_f32 v[130:131], v[130:131], v[166:167], v[164:165] op_sel_hi:[1,0,0]
  v_pk_mul_f32 v[128:129], v[128:129], v[32:33]
  v_pk_mul_f32 v[130:131], v[130:131], v[34:35]
  v_exp_f32 v128, v128
  v_exp_f32 v129, v129
  v_exp_f32 v130, v130
  v_exp_f32 v131, v131
  v_pk_add_f32 v[128:129], v[128:129], 1.0 op_sel_hi:[1,0]
  v_pk_add_f32 v[130:131], v[130:131], 1.0 op_sel_hi:[1,0]
  v_rcp_f32 v128, v128
  v_rcp_f32 v129, v129
  v_rcp_f32 v130, v130
  v_rcp_f32 v131, v131
  v_pk_mul_f32 v[128:129], v[128:129], v[32:33]
  v_pk_mul_f32 v[130:131], v[130:131], v[34:35]
  v_cvt_pk_bf16_f32 v148, v128, v129
  v_cvt_pk_bf16_f32 v149, v130, v131
  s_add_u32 s17, s21, s22
  buffer_store_dwordx2 v[148:149], v168, s[4:7], s17 offen sc1
  s_add_u32 s21, s59, 1
  s_mul_i32 s21, s21, 55296
  s_add_u32 s21, s21, s55
  s_mul_i32 s17, s10, 3072
  s_add_u32 s21, s21, s17
  v_pk_fma_f32 v[36:37], v[36:37], v[118:119], v[88:89] op_sel_hi:[1,0,1]
  v_pk_fma_f32 v[38:39], v[38:39], v[118:119], v[90:91] op_sel_hi:[1,0,1]
  v_pk_mul_f32 v[128:129], v[36:37], v[36:37]
  v_pk_mul_f32 v[130:131], v[38:39], v[38:39]
  v_pk_fma_f32 v[128:129], v[128:129], v[166:167], v[164:165] op_sel_hi:[1,0,0]
  v_pk_fma_f32 v[130:131], v[130:131], v[166:167], v[164:165] op_sel_hi:[1,0,0]
  v_pk_mul_f32 v[128:129], v[128:129], v[36:37]
  v_pk_mul_f32 v[130:131], v[130:131], v[38:39]
  v_exp_f32 v128, v128
  v_exp_f32 v129, v129
  v_exp_f32 v130, v130
  v_exp_f32 v131, v131
  v_pk_add_f32 v[128:129], v[128:129], 1.0 op_sel_hi:[1,0]
  v_pk_add_f32 v[130:131], v[130:131], 1.0 op_sel_hi:[1,0]
  v_rcp_f32 v128, v128
  v_rcp_f32 v129, v129
  v_rcp_f32 v130, v130
  v_rcp_f32 v131, v131
  v_pk_mul_f32 v[128:129], v[128:129], v[36:37]
  v_pk_mul_f32 v[130:131], v[130:131], v[38:39]
  v_cvt_pk_bf16_f32 v150, v128, v129
  v_cvt_pk_bf16_f32 v151, v130, v131
  v_pk_fma_f32 v[40:41], v[40:41], v[118:119], v[92:93] op_sel_hi:[1,0,1]
  v_pk_fma_f32 v[42:43], v[42:43], v[118:119], v[94:95] op_sel_hi:[1,0,1]
  v_pk_mul_f32 v[128:129], v[40:41], v[40:41]
  v_pk_mul_f32 v[130:131], v[42:43], v[42:43]
  v_pk_fma_f32 v[128:129], v[128:129], v[166:167], v[164:165] op_sel_hi:[1,0,0]
  v_pk_fma_f32 v[130:131], v[130:131], v[166:167], v[164:165] op_sel_hi:[1,0,0]
  v_pk_mul_f32 v[128:129], v[128:129], v[40:41]
  v_pk_mul_f32 v[130:131], v[130:131], v[42:43]
  v_exp_f32 v128, v128
  v_exp_f32 v129, v129
  v_exp_f32 v130, v130
  v_exp_f32 v131, v131
  v_pk_add_f32 v[128:129], v[128:129], 1.0 op_sel_hi:[1,0]
  v_pk_add_f32 v[130:131], v[130:131], 1.0 op_sel_hi:[1,0]
  v_rcp_f32 v128, v128
  v_rcp_f32 v129, v129
  v_rcp_f32 v130, v130
  v_rcp_f32 v131, v131
  v_pk_mul_f32 v[128:129], v[128:129], v[40:41]
  v_pk_mul_f32 v[130:131], v[130:131], v[42:43]
  v_cvt_pk_bf16_f32 v152, v128, v129
  v_cvt_pk_bf16_f32 v153, v130, v131
  buffer_store_dwordx4 v[150:153], v1, s[4:7], s21 offen offset:0 sc1
  v_pk_fma_f32 v[44:45], v[44:45], v[118:119], v[96:97] op_sel_hi:[1,0,1]
  v_pk_fma_f32 v[46:47], v[46:47], v[118:119], v[98:99] op_sel_hi:[1,0,1]
  v_pk_mul_f32 v[128:129], v[44:45], v[44:45]
  v_pk_mul_f32 v[130:131], v[46:47], v[46:47]
  v_pk_fma_f32 v[128:129], v[128:129], v[166:167], v[164:165] op_sel_hi:[1,0,0]
  v_pk_fma_f32 v[130:131], v[130:131], v[166:167], v[164:165] op_sel_hi:[1,0,0]
  v_pk_mul_f32 v[128:129], v[128:129], v[44:45]
  v_pk_mul_f32 v[130:131], v[130:131], v[46:47]
  v_exp_f32 v128, v128
  v_exp_f32 v129, v129
  v_exp_f32 v130, v130
  v_exp_f32 v131, v131
  v_pk_add_f32 v[128:129], v[128:129], 1.0 op_sel_hi:[1,0]
  v_pk_add_f32 v[130:131], v[130:131], 1.0 op_sel_hi:[1,0]
  v_rcp_f32 v128, v128
  v_rcp_f32 v129, v129
  v_rcp_f32 v130, v130
  v_rcp_f32 v131, v131
  v_pk_mul_f32 v[128:129], v[128:129], v[44:45]
  v_pk_mul_f32 v[130:131], v[130:131], v[46:47]
  v_cvt_pk_bf16_f32 v154, v128, v129
  v_cvt_pk_bf16_f32 v155, v130, v131
  v_pk_fma_f32 v[48:49], v[48:49], v[118:119], v[100:101] op_sel_hi:[1,0,1]
  v_pk_fma_f32 v[50:51], v[50:51], v[118:119], v[102:103] op_sel_hi:[1,0,1]
  v_pk_mul_f32 v[128:129], v[48:49], v[48:49]
  v_pk_mul_f32 v[130:131], v[50:51], v[50:51]
  v_pk_fma_f32 v[128:129], v[128:129], v[166:167], v[164:165] op_sel_hi:[1,0,0]
  v_pk_fma_f32 v[130:131], v[130:131], v[166:167], v[164:165] op_sel_hi:[1,0,0]
  v_pk_mul_f32 v[128:129], v[128:129], v[48:49]
  v_pk_mul_f32 v[130:131], v[130:131], v[50:51]
  v_exp_f32 v128, v128
  v_exp_f32 v129, v129
  v_exp_f32 v130, v130
  v_exp_f32 v131, v131
  v_pk_add_f32 v[128:129], v[128:129], 1.0 op_sel_hi:[1,0]
  v_pk_add_f32 v[130:131], v[130:131], 1.0 op_sel_hi:[1,0]
  v_rcp_f32 v128, v128
  v_rcp_f32 v129, v129
  v_rcp_f32 v130, v130
  v_rcp_f32 v131, v131
  v_pk_mul_f32 v[128:129], v[128:129], v[48:49]
  v_pk_mul_f32 v[130:131], v[130:131], v[50:51]
  v_cvt_pk_bf16_f32 v156, v128, v129
  v_cvt_pk_bf16_f32 v157, v130, v131
  buffer_store_dwordx4 v[154:157], v1, s[4:7], s21 offen offset:1024 sc1
  v_pk_fma_f32 v[52:53], v[52:53], v[118:119], v[104:105] op_sel_hi:[1,0,1]
  v_pk_fma_f32 v[54:55], v[54:55], v[118:119], v[106:107] op_sel_hi:[1,0,1]
  v_pk_mul_f32 v[128:129], v[52:53], v[52:53]
  v_pk_mul_f32 v[130:131], v[54:55], v[54:55]
  v_pk_fma_f32 v[128:129], v[128:129], v[166:167], v[164:165] op_sel_hi:[1,0,0]
  v_pk_fma_f32 v[130:131], v[130:131], v[166:167], v[164:165] op_sel_hi:[1,0,0]
  v_pk_mul_f32 v[128:129], v[128:129], v[52:53]
  v_pk_mul_f32 v[130:131], v[130:131], v[54:55]
  v_exp_f32 v128, v128
  v_exp_f32 v129, v129
  v_exp_f32 v130, v130
  v_exp_f32 v131, v131
  v_pk_add_f32 v[128:129], v[128:129], 1.0 op_sel_hi:[1,0]
  v_pk_add_f32 v[130:131], v[130:131], 1.0 op_sel_hi:[1,0]
  v_rcp_f32 v128, v128
  v_rcp_f32 v129, v129
  v_rcp_f32 v130, v130
  v_rcp_f32 v131, v131
  v_pk_mul_f32 v[128:129], v[128:129], v[52:53]
  v_pk_mul_f32 v[130:131], v[130:131], v[54:55]
  v_cvt_pk_bf16_f32 v158, v128, v129
  v_cvt_pk_bf16_f32 v159, v130, v131
  v_pk_fma_f32 v[56:57], v[56:57], v[118:119], v[108:109] op_sel_hi:[1,0,1]
  v_pk_fma_f32 v[58:59], v[58:59], v[118:119], v[110:111] op_sel_hi:[1,0,1]
  v_pk_mul_f32 v[128:129], v[56:57], v[56:57]
  v_pk_mul_f32 v[130:131], v[58:59], v[58:59]
  v_pk_fma_f32 v[128:129], v[128:129], v[166:167], v[164:165] op_sel_hi:[1,0,0]
  v_pk_fma_f32 v[130:131], v[130:131], v[166:167], v[164:165] op_sel_hi:[1,0,0]
  v_pk_mul_f32 v[128:129], v[128:129], v[56:57]
  v_pk_mul_f32 v[130:131], v[130:131], v[58:59]
  v_exp_f32 v128, v128
  v_exp_f32 v129, v129
  v_exp_f32 v130, v130
  v_exp_f32 v131, v131
  v_pk_add_f32 v[128:129], v[128:129], 1.0 op_sel_hi:[1,0]
  v_pk_add_f32 v[130:131], v[130:131], 1.0 op_sel_hi:[1,0]
  v_rcp_f32 v128, v128
  v_rcp_f32 v129, v129
  v_rcp_f32 v130, v130
  v_rcp_f32 v131, v131
  v_pk_mul_f32 v[128:129], v[128:129], v[56:57]
  v_pk_mul_f32 v[130:131], v[130:131], v[58:59]
  v_cvt_pk_bf16_f32 v160, v128, v129
  v_cvt_pk_bf16_f32 v161, v130, v131
  buffer_store_dwordx4 v[158:161], v1, s[4:7], s21 offen offset:2048 sc1
  v_pk_fma_f32 v[60:61], v[60:61], v[118:119], v[112:113] op_sel_hi:[1,0,1]
  v_pk_fma_f32 v[62:63], v[62:63], v[118:119], v[114:115] op_sel_hi:[1,0,1]
  v_pk_mul_f32 v[128:129], v[60:61], v[60:61]
  v_pk_mul_f32 v[130:131], v[62:63], v[62:63]
  v_pk_fma_f32 v[128:129], v[128:129], v[166:167], v[164:165] op_sel_hi:[1,0,0]
  v_pk_fma_f32 v[130:131], v[130:131], v[166:167], v[164:165] op_sel_hi:[1,0,0]
  v_pk_mul_f32 v[128:129], v[128:129], v[60:61]
  v_pk_mul_f32 v[130:131], v[130:131], v[62:63]
  v_exp_f32 v128, v128
  v_exp_f32 v129, v129
  v_exp_f32 v130, v130
  v_exp_f32 v131, v131
  v_pk_add_f32 v[128:129], v[128:129], 1.0 op_sel_hi:[1,0]
  v_pk_add_f32 v[130:131], v[130:131], 1.0 op_sel_hi:[1,0]
  v_rcp_f32 v128, v128
  v_rcp_f32 v129, v129
  v_rcp_f32 v130, v130
  v_rcp_f32 v131, v131
  v_pk_mul_f32 v[128:129], v[128:129], v[60:61]
  v_pk_mul_f32 v[130:131], v[130:131], v[62:63]
  v_cvt_pk_bf16_f32 v162, v128, v129
  v_cvt_pk_bf16_f32 v163, v130, v131
  s_add_u32 s17, s21, s22
  buffer_store_dwordx2 v[162:163], v168, s[4:7], s17 offen sc1
  s_mul_i32 s25, s60, 20480
  s_lshl_b32 s3, s13, 11
  s_add_u32 s28, s25, s3
  s_lshl_b32 s3, s13, 9
  s_add_u32 s29, s25, s3
  s_add_u32 s29, s29, 16384
  s_waitcnt vmcnt(0)
  s_barrier
  s_cmp_lg_u32 s8, 0
  s_cbranch_scc1 sig_37
  s_lshl_b32 s17, s9, 7
  s_add_u32 s17, s17, s57
  s_add_u32 s17, s17, 6144
  s_mov_b64 exec, 1
  v_mov_b32 v7, 1
  buffer_atomic_add v7, off, s[4:7], s17
  s_mov_b64 exec, -1
sig_37:
  s_mul_i32 s33, s10, 163840
  s_add_u32 s33, s33, s61
  s_add_u32 s33, s33, 0xe00000
  s_add_u32 m0, s61, 0
  s_add_u32 s17, s33, 0
  buffer_load_dwordx4 v1, s[4:7], s17 offen sc1 lds
  s_add_u32 m0, s61, 4096
  s_add_u32 s17, s33, 4096
  buffer_load_dwordx4 v1, s[4:7], s17 offen sc1 lds
  s_add_u32 m0, s61, 8192
  s_add_u32 s17, s33, 8192
  buffer_load_dwordx4 v1, s[4:7], s17 offen sc1 lds
  s_add_u32 m0, s61, 12288
  s_add_u32 s17, s33, 12288
  buffer_load_dwordx4 v1, s[4:7], s17 offen sc1 lds
  s_add_u32 m0, s61, 16384
  s_add_u32 s17, s33, 16384
  buffer_load_dwordx4 v1, s[4:7], s17 offen sc1 lds
  s_add_u32 m0, s61, 20480
  s_add_u32 s17, s33, 20480
  buffer_load_dwordx4 v1, s[4:7], s17 offen sc1 lds
  s_add_u32 m0, s61, 24576
  s_add_u32 s17, s33, 24576
  buffer_load_dwordx4 v1, s[4:7], s17 offen sc1 lds
  s_add_u32 m0, s61, 28672
  s_add_u32 s17, s33, 28672
  buffer_load_dwordx4 v1, s[4:7], s17 offen sc1 lds
  s_add_u32 s17, s8, 0
  s_and_b32 s17, s17, 3
  s_lshl_b32 s18, s12, 2
  s_add_u32 s17, s17, s18
  s_mul_i32 s17, s17, 55296
  s_add_u32 s17, s17, s55
  s_add_u32 s20, s17, s61
  s_add_u32 s17, s8, 1
  s_and_b32 s17, s17, 3
  s_lshl_b32 s18, s12, 2
  s_add_u32 s17, s17, s18
  s_mul_i32 s17, s17, 55296
  s_add_u32 s17, s17, s55
  s_add_u32 s21, s17, s61
  s_add_u32 s17, s8, 2
  s_and_b32 s17, s17, 3
  s_lshl_b32 s18, s12, 2
  s_add_u32 s17, s17, s18
  s_mul_i32 s17, s17, 55296
  s_add_u32 s17, s17, s55
  s_add_u32 s22, s17, s61
  s_add_u32 s17, s8, 3
  s_and_b32 s17, s17, 3
  s_lshl_b32 s18, s12, 2
  s_add_u32 s17, s17, s18
  s_mul_i32 s17, s17, 55296
  s_add_u32 s17, s17, s55
  s_add_u32 s23, s17, s61
  s_cmp_lt_u32 s8, 2
  s_cselect_b32 s24, 0, 4096
  s_add_u32 s17, s62, 249856
  buffer_load_dwordx4 v[220:223], v1, s[4:7], s17 offen offset:0 sc1
  s_add_u32 s17, s62, 266240
  buffer_load_dwordx4 v[224:227], v1, s[4:7], s17 offen offset:0 sc1
  s_add_u32 s17, s62, 266240
  buffer_load_dwordx4 v[228:231], v1, s[4:7], s17 offen offset:1024 sc1
  s_add_u32 s17, s62, 266240
  buffer_load_dwordx4 v[232:235], v1, s[4:7], s17 offen offset:2048 sc1
  s_add_u32 s17, s62, 266240
  buffer_load_dwordx4 v[236:239], v1, s[4:7], s17 offen offset:3072 sc1
  s_add_u32 s17, s62, 270336
  buffer_load_dwordx4 v[240:243], v1, s[4:7], s17 offen offset:0 sc1
  s_add_u32 s17, s28, s49
  buffer_load_dwordx4 v[184:187], v1, s[4:7], s17 offen offset:0 sc1
  buffer_load_dwordx4 v[188:191], v1, s[4:7], s17 offen offset:1024 sc1
  s_add_u32 s17, s29, s49
  v_lshlrev_b32 v7, 3, v0
  buffer_load_dwordx2 v[192:193], v7, s[4:7], s17 offen sc1
  v_lshlrev_b32 v7, 3, v5
  s_mul_i32 s17, s13, 160
  buffer_load_dwordx2 v[194:195], v7, s[40:43], s17 offen offset:0
  buffer_load_dwordx2 v[196:197], v7, s[40:43], s17 offen offset:32
  buffer_load_dwordx2 v[198:199], v7, s[40:43], s17 offen offset:64
  buffer_load_dwordx2 v[200:201], v7, s[40:43], s17 offen offset:96
  buffer_load_dwordx2 v[202:203], v7, s[40:43], s17 offen offset:128
  s_cmp_lg_u32 s8, 0
  s_cbranch_scc1 wbar_38
  s_cmp_lg_u32 s58, 0
  s_cbranch_scc1 wbar_38
  s_lshl_b32 s17, s9, 7
  s_add_u32 s17, s17, s57
  s_add_u32 s17, s17, 6144
  s_mov_b32 s18, 0
  s_mov_b64 exec, 1
poll_39:
  buffer_load_dword v7, off, s[4:7], s17 sc1
  s_waitcnt vmcnt(0)
  v_readfirstlane_b32 s19, v7
  s_nop 3
  s_cmp_ge_u32 s19, 16
  s_cbranch_scc1 pdone_40
  s_add_u32 s18, s18, 1
  s_cmp_lt_u32 s18, 0x20000
  s_cbranch_scc1 poll_39
  s_mov_b32 s58, 1
pdone_40:
  s_mov_b64 exec, -1
wbar_38:
  s_waitcnt vmcnt(0)
  s_barrier
  s_add_u32 s17, s20, 0
  buffer_load_dwordx4 v[88:91], v1, s[4:7], s17 offen sc1
  s_add_u32 s17, s21, 0
  buffer_load_dwordx4 v[92:95], v1, s[4:7], s17 offen sc1
  s_add_u32 s17, s22, 0
  buffer_load_dwordx4 v[96:99], v1, s[4:7], s17 offen sc1
  s_add_u32 s17, s23, 0
  buffer_load_dwordx4 v[100:103], v1, s[4:7], s17 offen sc1
  s_add_u32 s17, s20, 4096
  buffer_load_dwordx4 v[104:107], v1, s[4:7], s17 offen sc1
  s_add_u32 s17, s21, 4096
  buffer_load_dwordx4 v[108:111], v1, s[4:7], s17 offen sc1
  s_add_u32 s17, s22, 4096
  buffer_load_dwordx4 v[112:115], v1, s[4:7], s17 offen sc1
  s_add_u32 s17, s23, 4096
  buffer_load_dwordx4 v[116:119], v1, s[4:7], s17 offen sc1
  s_add_u32 s17, s20, 8192
  buffer_load_dwordx4 v[120:123], v1, s[4:7], s17 offen sc1
  s_add_u32 s17, s21, 8192
  buffer_load_dwordx4 v[124:127], v1, s[4:7], s17 offen sc1
  s_add_u32 s17, s22, 8192
  buffer_load_dwordx4 v[128:131], v1, s[4:7], s17 offen sc1
  s_add_u32 s17, s23, 8192
  buffer_load_dwordx4 v[132:135], v1, s[4:7], s17 offen sc1
  s_add_u32 s17, s20, 12288
  buffer_load_dwordx4 v[136:139], v1, s[4:7], s17 offen sc1
  s_add_u32 s17, s21, 12288
  buffer_load_dwordx4 v[140:143], v1, s[4:7], s17 offen sc1
  s_add_u32 s17, s22, 12288
  buffer_load_dwordx4 v[144:147], v1, s[4:7], s17 offen sc1
  s_add_u32 s17, s23, 12288
  buffer_load_dwordx4 v[148:151], v1, s[4:7], s17 offen sc1
  s_waitcnt vmcnt(12)
  v_mfma_f32_16x16x32_bf16 v[8:11], a[0:3], v[88:91], 0
  v_mfma_f32_16x16x32_bf16 v[28:31], a[0:3], v[92:95], 0
  s_add_u32 s17, s20, 16384
  buffer_load_dwordx4 v[152:155], v1, s[4:7], s17 offen sc1
  v_mfma_f32_16x16x32_bf16 v[48:51], a[0:3], v[96:99], 0
  v_mfma_f32_16x16x32_bf16 v[68:71], a[0:3], v[100:103], 0
  v_mfma_f32_16x16x32_bf16 v[12:15], a[4:7], v[88:91], 0
  v_mfma_f32_16x16x32_bf16 v[32:35], a[4:7], v[92:95], 0
  v_mfma_f32_16x16x32_bf16 v[52:55], a[4:7], v[96:99], 0
  s_add_u32 s17, s21, 16384
  buffer_load_dwordx4 v[156:159], v1, s[4:7], s17 offen sc1
  v_mfma_f32_16x16x32_bf16 v[72:75], a[4:7], v[100:103], 0
  v_mfma_f32_16x16x32_bf16 v[16:19], a[8:11], v[88:91], 0
  v_mfma_f32_16x16x32_bf16 v[36:39], a[8:11], v[92:95], 0
  v_mfma_f32_16x16x32_bf16 v[56:59], a[8:11], v[96:99], 0
  v_mfma_f32_16x16x32_bf16 v[76:79], a[8:11], v[100:103], 0
  s_add_u32 s17, s22, 16384
  buffer_load_dwordx4 v[160:163], v1, s[4:7], s17 offen sc1
  v_mfma_f32_16x16x32_bf16 v[20:23], a[12:15], v[88:91], 0
  v_mfma_f32_16x16x32_bf16 v[40:43], a[12:15], v[92:95], 0
  v_mfma_f32_16x16x32_bf16 v[60:63], a[12:15], v[96:99], 0
  v_mfma_f32_16x16x32_bf16 v[80:83], a[12:15], v[100:103], 0
  v_mfma_f32_16x16x32_bf16 v[24:27], a[16:19], v[88:91], 0
  s_add_u32 s17, s23, 16384
  buffer_load_dwordx4 v[164:167], v1, s[4:7], s17 offen sc1
  v_mfma_f32_16x16x32_bf16 v[44:47], a[16:19], v[92:95], 0
  v_mfma_f32_16x16x32_bf16 v[64:67], a[16:19], v[96:99], 0
  v_mfma_f32_16x16x32_bf16 v[84:87], a[16:19], v[100:103], 0
  s_waitcnt vmcnt(12)
  v_mfma_f32_16x16x32_bf16 v[8:11], a[20:23], v[104:107], v[8:11]
  v_mfma_f32_16x16x32_bf16 v[28:31], a[20:23], v[108:111], v[28:31]
  s_add_u32 s17, s20, 20480
  buffer_load_dwordx4 v[168:171], v1, s[4:7], s17 offen sc1
  v_mfma_f32_16x16x32_bf16 v[48:51], a[20:23], v[112:115], v[48:51]
  v_mfma_f32_16x16x32_bf16 v[68:71], a[20:23], v[116:119], v[68:71]
  v_mfma_f32_16x16x32_bf16 v[12:15], a[24:27], v[104:107], v[12:15]
  v_mfma_f32_16x16x32_bf16 v[32:35], a[24:27], v[108:111], v[32:35]
  v_mfma_f32_16x16x32_bf16 v[52:55], a[24:27], v[112:115], v[52:55]
  s_add_u32 s17, s21, 20480
  buffer_load_dwordx4 v[172:175], v1, s[4:7], s17 offen sc1
  v_mfma_f32_16x16x32_bf16 v[72:75], a[24:27], v[116:119], v[72:75]
  v_mfma_f32_16x16x32_bf16 v[16:19], a[28:31], v[104:107], v[16:19]
  v_mfma_f32_16x16x32_bf16 v[36:39], a[28:31], v[108:111], v[36:39]
  v_mfma_f32_16x16x32_bf16 v[56:59], a[28:31], v[112:115], v[56:59]
  v_mfma_f32_16x16x32_bf16 v[76:79], a[28:31], v[116:119], v[76:79]
  s_add_u32 s17, s22, 20480
  buffer_load_dwordx4 v[176:179], v1, s[4:7], s17 offen sc1
  v_mfma_f32_16x16x32_bf16 v[20:23], a[32:35], v[104:107], v[20:23]
  v_mfma_f32_16x16x32_bf16 v[40:43], a[32:35], v[108:111], v[40:43]
  v_mfma_f32_16x16x32_bf16 v[60:63], a[32:35], v[112:115], v[60:63]
  v_mfma_f32_16x16x32_bf16 v[80:83], a[32:35], v[116:119], v[80:83]
  v_mfma_f32_16x16x32_bf16 v[24:27], a[36:39], v[104:107], v[24:27]
  s_add_u32 s17, s23, 20480
  buffer_load_dwordx4 v[180:183], v1, s[4:7], s17 offen sc1
  v_mfma_f32_16x16x32_bf16 v[44:47], a[36:39], v[108:111], v[44:47]
  v_mfma_f32_16x16x32_bf16 v[64:67], a[36:39], v[112:115], v[64:67]
  v_mfma_f32_16x16x32_bf16 v[84:87], a[36:39], v[116:119], v[84:87]
  s_waitcnt vmcnt(12)
  v_mfma_f32_16x16x32_bf16 v[8:11], a[40:43], v[120:123], v[8:11]
  v_mfma_f32_16x16x32_bf16 v[28:31], a[40:43], v[124:127], v[28:31]
  s_add_u32 s17, s20, 24576
  buffer_load_dwordx4 v[88:91], v1, s[4:7], s17 offen sc1
  v_mfma_f32_16x16x32_bf16 v[48:51], a[40:43], v[128:131], v[48:51]
  v_mfma_f32_16x16x32_bf16 v[68:71], a[40:43], v[132:135], v[68:71]
  v_mfma_f32_16x16x32_bf16 v[12:15], a[44:47], v[120:123], v[12:15]
  v_mfma_f32_16x16x32_bf16 v[32:35], a[44:47], v[124:127], v[32:35]
  v_mfma_f32_16x16x32_bf16 v[52:55], a[44:47], v[128:131], v[52:55]
  s_add_u32 s17, s21, 24576
  buffer_load_dwordx4 v[92:95], v1, s[4:7], s17 offen sc1
  v_mfma_f32_16x16x32_bf16 v[72:75], a[44:47], v[132:135], v[72:75]
  v_mfma_f32_16x16x32_bf16 v[16:19], a[48:51], v[120:123], v[16:19]
  v_mfma_f32_16x16x32_bf16 v[36:39], a[48:51], v[124:127], v[36:39]
  v_mfma_f32_16x16x32_bf16 v[56:59], a[48:51], v[128:131], v[56:59]
  v_mfma_f32_16x16x32_bf16 v[76:79], a[48:51], v[132:135], v[76:79]
  s_add_u32 s17, s22, 24576
  buffer_load_dwordx4 v[96:99], v1, s[4:7], s17 offen sc1
  v_mfma_f32_16x16x32_bf16 v[20:23], a[52:55], v[120:123], v[20:23]
  v_mfma_f32_16x16x32_bf16 v[40:43], a[52:55], v[124:127], v[40:43]
  v_mfma_f32_16x16x32_bf16 v[60:63], a[52:55], v[128:131], v[60:63]
  v_mfma_f32_16x16x32_bf16 v[80:83], a[52:55], v[132:135], v[80:83]
  v_mfma_f32_16x16x32_bf16 v[24:27], a[56:59], v[120:123], v[24:27]
  s_add_u32 s17, s23, 24576
  buffer_load_dwordx4 v[100:103], v1, s[4:7], s17 offen sc1
  v_mfma_f32_16x16x32_bf16 v[44:47], a[56:59], v[124:127], v[44:47]
  v_mfma_f32_16x16x32_bf16 v[64:67], a[56:59], v[128:131], v[64:67]
  v_mfma_f32_16x16x32_bf16 v[84:87], a[56:59], v[132:135], v[84:87]
  s_waitcnt vmcnt(12)
  v_mfma_f32_16x16x32_bf16 v[8:11], a[60:63], v[136:139], v[8:11]
  v_mfma_f32_16x16x32_bf16 v[28:31], a[60:63], v[140:143], v[28:31]
  s_add_u32 s17, s20, 28672
  buffer_load_dwordx4 v[104:107], v1, s[4:7], s17 offen sc1
  v_mfma_f32_16x16x32_bf16 v[48:51], a[60:63], v[144:147], v[48:51]
  v_mfma_f32_16x16x32_bf16 v[68:71], a[60:63], v[148:151], v[68:71]
  v_mfma_f32_16x16x32_bf16 v[12:15], a[64:67], v[136:139], v[12:15]
  v_mfma_f32_16x16x32_bf16 v[32:35], a[64:67], v[140:143], v[32:35]
  v_mfma_f32_16x16x32_bf16 v[52:55], a[64:67], v[144:147], v[52:55]
  s_add_u32 s17, s21, 28672
  buffer_load_dwordx4 v[108:111], v1, s[4:7], s17 offen sc1
  v_mfma_f32_16x16x32_bf16 v[72:75], a[64:67], v[148:151], v[72:75]
  v_mfma_f32_16x16x32_bf16 v[16:19], a[68:71], v[136:139], v[16:19]
  v_mfma_f32_16x16x32_bf16 v[36:39], a[68:71], v[140:143], v[36:39]
  v_mfma_f32_16x16x32_bf16 v[56:59], a[68:71], v[144:147], v[56:59]
  v_mfma_f32_16x16x32_bf16 v[76:79], a[68:71], v[148:151], v[76:79]
  s_add_u32 s17, s22, 28672
  buffer_load_dwordx4 v[112:115], v1, s[4:7], s17 offen sc1
  v_mfma_f32_16x16x32_bf16 v[20:23], a[72:75], v[136:139], v[20:23]
  v_mfma_f32_16x16x32_bf16 v[40:43], a[72:75], v[140:143], v[40:43]
  v_mfma_f32_16x16x32_bf16 v[60:63], a[72:75], v[144:147], v[60:63]
  v_mfma_f32_16x16x32_bf16 v[80:83], a[72:75], v[148:151], v[80:83]
  v_mfma_f32_16x16x32_bf16 v[24:27], a[76:79], v[136:139], v[24:27]
  s_add_u32 s17, s23, 28672
  buffer_load_dwordx4 v[116:119], v1, s[4:7], s17 offen sc1
  v_mfma_f32_16x16x32_bf16 v[44:47], a[76:79], v[140:143], v[44:47]
  v_mfma_f32_16x16x32_bf16 v[64:67], a[76:79], v[144:147], v[64:67]
  v_mfma_f32_16x16x32_bf16 v[84:87], a[76:79], v[148:151], v[84:87]
  s_waitcnt vmcnt(12)
  v_mfma_f32_16x16x32_bf16 v[8:11], a[80:83], v[152:155], v[8:11]
  v_mfma_f32_16x16x32_bf16 v[28:31], a[80:83], v[156:159], v[28:31]
  s_add_u32 s17, s20, 32768
  buffer_load_dwordx4 v[120:123], v1, s[4:7], s17 offen sc1
  v_mfma_f32_16x16x32_bf16 v[48:51], a[80:83], v[160:163], v[48:51]
  v_mfma_f32_16x16x32_bf16 v[68:71], a[80:83], v[164:167], v[68:71]
  v_mfma_f32_16x16x32_bf16 v[12:15], a[84:87], v[152:155], v[12:15]
  v_mfma_f32_16x16x32_bf16 v[32:35], a[84:87], v[156:159], v[32:35]
  v_mfma_f32_16x16x32_bf16 v[52:55], a[84:87], v[160:163], v[52:55]
  s_add_u32 s17, s21, 32768
  buffer_load_dwordx4 v[124:127], v1, s[4:7], s17 offen sc1
  v_mfma_f32_16x16x32_bf16 v[72:75], a[84:87], v[164:167], v[72:75]
  v_mfma_f32_16x16x32_bf16 v[16:19], a[88:91], v[152:155], v[16:19]
  v_mfma_f32_16x16x32_bf16 v[36:39], a[88:91], v[156:159], v[36:39]
  v_mfma_f32_16x16x32_bf16 v[56:59], a[88:91], v[160:163], v[56:59]
  v_mfma_f32_16x16x32_bf16 v[76:79], a[88:91], v[164:167], v[76:79]
  s_add_u32 s17, s22, 32768
  buffer_load_dwordx4 v[128:131], v1, s[4:7], s17 offen sc1
  v_mfma_f32_16x16x32_bf16 v[20:23], a[92:95], v[152:155], v[20:23]
  v_mfma_f32_16x16x32_bf16 v[40:43], a[92:95], v[156:159], v[40:43]
  v_mfma_f32_16x16x32_bf16 v[60:63], a[92:95], v[160:163], v[60:63]
  v_mfma_f32_16x16x32_bf16 v[80:83], a[92:95], v[164:167], v[80:83]
  v_mfma_f32_16x16x32_bf16 v[24:27], a[96:99], v[152:155], v[24:27]
  s_add_u32 s17, s23, 32768
  buffer_load_dwordx4 v[132:135], v1, s[4:7], s17 offen sc1
  v_mfma_f32_16x16x32_bf16 v[44:47], a[96:99], v[156:159], v[44:47]
  v_mfma_f32_16x16x32_bf16 v[64:67], a[96:99], v[160:163], v[64:67]
  v_mfma_f32_16x16x32_bf16 v[84:87], a[96:99], v[164:167], v[84:87]
  s_waitcnt vmcnt(12)
  v_mfma_f32_16x16x32_bf16 v[8:11], a[100:103], v[168:171], v[8:11]
  v_mfma_f32_16x16x32_bf16 v[28:31], a[100:103], v[172:175], v[28:31]
  s_add_u32 s17, s20, 36864
  buffer_load_dwordx4 v[136:139], v1, s[4:7], s17 offen sc1
  v_mfma_f32_16x16x32_bf16 v[48:51], a[100:103], v[176:179], v[48:51]
  v_mfma_f32_16x16x32_bf16 v[68:71], a[100:103], v[180:183], v[68:71]
  v_mfma_f32_16x16x32_bf16 v[12:15], a[104:107], v[168:171], v[12:15]
  v_mfma_f32_16x16x32_bf16 v[32:35], a[104:107], v[172:175], v[32:35]
  v_mfma_f32_16x16x32_bf16 v[52:55], a[104:107], v[176:179], v[52:55]
  s_add_u32 s17, s21, 36864
  buffer_load_dwordx4 v[140:143], v1, s[4:7], s17 offen sc1
  v_mfma_f32_16x16x32_bf16 v[72:75], a[104:107], v[180:183], v[72:75]
  v_mfma_f32_16x16x32_bf16 v[16:19], a[108:111], v[168:171], v[16:19]
  v_mfma_f32_16x16x32_bf16 v[36:39], a[108:111], v[172:175], v[36:39]
  v_mfma_f32_16x16x32_bf16 v[56:59], a[108:111], v[176:179], v[56:59]
  v_mfma_f32_16x16x32_bf16 v[76:79], a[108:111], v[180:183], v[76:79]
  s_add_u32 s17, s22, 36864
  buffer_load_dwordx4 v[144:147], v1, s[4:7], s17 offen sc1
  v_mfma_f32_16x16x32_bf16 v[20:23], a[112:115], v[168:171], v[20:23]
  v_mfma_f32_16x16x32_bf16 v[40:43], a[112:115], v[172:175], v[40:43]
  v_mfma_f32_16x16x32_bf16 v[60:63], a[112:115], v[176:179], v[60:63]
  v_mfma_f32_16x16x32_bf16 v[80:83], a[112:115], v[180:183], v[80:83]
  v_mfma_f32_16x16x32_bf16 v[24:27], a[116:119], v[168:171], v[24:27]
  s_add_u32 s17, s23, 36864
  buffer_load_dwordx4 v[148:151], v1, s[4:7], s17 offen sc1
  v_mfma_f32_16x16x32_bf16 v[44:47], a[116:119], v[172:175], v[44:47]
  v_mfma_f32_16x16x32_bf16 v[64:67], a[116:119], v[176:179], v[64:67]
  v_mfma_f32_16x16x32_bf16 v[84:87], a[116:119], v[180:183], v[84:87]
  s_waitcnt vmcnt(12)
  v_mfma_f32_16x16x32_bf16 v[8:11], a[120:123], v[88:91], v[8:11]
  v_mfma_f32_16x16x32_bf16 v[28:31], a[120:123], v[92:95], v[28:31]
  s_add_u32 s17, s20, 40960
  buffer_load_dwordx4 v[152:155], v1, s[4:7], s17 offen sc1
  v_mfma_f32_16x16x32_bf16 v[48:51], a[120:123], v[96:99], v[48:51]
  v_mfma_f32_16x16x32_bf16 v[68:71], a[120:123], v[100:103], v[68:71]
  v_mfma_f32_16x16x32_bf16 v[12:15], a[124:127], v[88:91], v[12:15]
  v_mfma_f32_16x16x32_bf16 v[32:35], a[124:127], v[92:95], v[32:35]
  v_mfma_f32_16x16x32_bf16 v[52:55], a[124:127], v[96:99], v[52:55]
  s_add_u32 s17, s21, 40960
  buffer_load_dwordx4 v[156:159], v1, s[4:7], s17 offen sc1
  v_mfma_f32_16x16x32_bf16 v[72:75], a[124:127], v[100:103], v[72:75]
  v_mfma_f32_16x16x32_bf16 v[16:19], a[128:131], v[88:91], v[16:19]
  v_mfma_f32_16x16x32_bf16 v[36:39], a[128:131], v[92:95], v[36:39]
  v_mfma_f32_16x16x32_bf16 v[56:59], a[128:131], v[96:99], v[56:59]
  v_mfma_f32_16x16x32_bf16 v[76:79], a[128:131], v[100:103], v[76:79]
  s_add_u32 s17, s22, 40960
  buffer_load_dwordx4 v[160:163], v1, s[4:7], s17 offen sc1
  v_mfma_f32_16x16x32_bf16 v[20:23], a[132:135], v[88:91], v[20:23]
  v_mfma_f32_16x16x32_bf16 v[40:43], a[132:135], v[92:95], v[40:43]
  v_mfma_f32_16x16x32_bf16 v[60:63], a[132:135], v[96:99], v[60:63]
  v_mfma_f32_16x16x32_bf16 v[80:83], a[132:135], v[100:103], v[80:83]
  v_mfma_f32_16x16x32_bf16 v[24:27], a[136:139], v[88:91], v[24:27]
  s_add_u32 s17, s23, 40960
  buffer_load_dwordx4 v[164:167], v1, s[4:7], s17 offen sc1
  v_mfma_f32_16x16x32_bf16 v[44:47], a[136:139], v[92:95], v[44:47]
  v_mfma_f32_16x16x32_bf16 v[64:67], a[136:139], v[96:99], v[64:67]
  v_mfma_f32_16x16x32_bf16 v[84:87], a[136:139], v[100:103], v[84:87]
  s_waitcnt vmcnt(12)
  v_mfma_f32_16x16x32_bf16 v[8:11], a[140:143], v[104:107], v[8:11]
  v_mfma_f32_16x16x32_bf16 v[28:31], a[140:143], v[108:111], v[28:31]
  s_add_u32 s17, s20, 45056
  buffer_load_dwordx4 v[168:171], v1, s[4:7], s17 offen sc1
  v_mfma_f32_16x16x32_bf16 v[48:51], a[140:143], v[112:115], v[48:51]
  v_mfma_f32_16x16x32_bf16 v[68:71], a[140:143], v[116:119], v[68:71]
  v_mfma_f32_16x16x32_bf16 v[12:15], a[144:147], v[104:107], v[12:15]
  v_mfma_f32_16x16x32_bf16 v[32:35], a[144:147], v[108:111], v[32:35]
  v_mfma_f32_16x16x32_bf16 v[52:55], a[144:147], v[112:115], v[52:55]
  s_add_u32 s17, s21, 45056
  buffer_load_dwordx4 v[172:175], v1, s[4:7], s17 offen sc1
  v_mfma_f32_16x16x32_bf16 v[72:75], a[144:147], v[116:119], v[72:75]
  v_mfma_f32_16x16x32_bf16 v[16:19], a[148:151], v[104:107], v[16:19]
  v_mfma_f32_16x16x32_bf16 v[36:39], a[148:151], v[108:111], v[36:39]
  v_mfma_f32_16x16x32_bf16 v[56:59], a[148:151], v[112:115], v[56:59]
  v_mfma_f32_16x16x32_bf16 v[76:79], a[148:151], v[116:119], v[76:79]
  s_add_u32 s17, s22, 45056
  buffer_load_dwordx4 v[176:179], v1, s[4:7], s17 offen sc1
  v_mfma_f32_16x16x32_bf16 v[20:23], a[152:155], v[104:107], v[20:23]
  v_mfma_f32_16x16x32_bf16 v[40:43], a[152:155], v[108:111], v[40:43]
  v_mfma_f32_16x16x32_bf16 v[60:63], a[152:155], v[112:115], v[60:63]
  v_mfma_f32_16x16x32_bf16 v[80:83], a[152:155], v[116:119], v[80:83]
  v_mfma_f32_16x16x32_bf16 v[24:27], a[156:159], v[104:107], v[24:27]
  s_add_u32 s17, s23, 45056
  buffer_load_dwordx4 v[180:183], v1, s[4:7], s17 offen sc1
  v_mfma_f32_16x16x32_bf16 v[44:47], a[156:159], v[108:111], v[44:47]
  v_mfma_f32_16x16x32_bf16 v[64:67], a[156:159], v[112:115], v[64:67]
  v_mfma_f32_16x16x32_bf16 v[84:87], a[156:159], v[116:119], v[84:87]
  s_waitcnt vmcnt(12)
  v_mfma_f32_16x16x32_bf16 v[8:11], a[160:163], v[120:123], v[8:11]
  v_mfma_f32_16x16x32_bf16 v[28:31], a[160:163], v[124:127], v[28:31]
  s_add_u32 s17, s20, 49152
  v_lshlrev_b32 v7, 3, v0
  buffer_load_dwordx2 v[88:89], v7, s[4:7], s17 offen sc1
  buffer_load_dwordx2 v[90:91], v7, s[4:7], s17 offen offset:512 sc1
  v_mfma_f32_16x16x32_bf16 v[48:51], a[160:163], v[128:131], v[48:51]
  v_mfma_f32_16x16x32_bf16 v[68:71], a[160:163], v[132:135], v[68:71]
  v_mfma_f32_16x16x32_bf16 v[12:15], a[164:167], v[120:123], v[12:15]
  v_mfma_f32_16x16x32_bf16 v[32:35], a[164:167], v[124:127], v[32:35]
  v_mfma_f32_16x16x32_bf16 v[52:55], a[164:167], v[128:131], v[52:55]
  s_add_u32 s17, s21, 49152
  v_lshlrev_b32 v7, 3, v0
  buffer_load_dwordx2 v[92:93], v7, s[4:7], s17 offen sc1
  buffer_load_dwordx2 v[94:95], v7, s[4:7], s17 offen offset:512 sc1
  v_mfma_f32_16x16x32_bf16 v[72:75], a[164:167], v[132:135], v[72:75]
  v_mfma_f32_16x16x32_bf16 v[16:19], a[168:171], v[120:123], v[16:19]
  v_mfma_f32_16x16x32_bf16 v[36:39], a[168:171], v[124:127], v[36:39]
  v_mfma_f32_16x16x32_bf16 v[56:59], a[168:171], v[128:131], v[56:59]
  v_mfma_f32_16x16x32_bf16 v[76:79], a[168:171], v[132:135], v[76:79]
  s_add_u32 s17, s22, 49152
  v_lshlrev_b32 v7, 3, v0
  buffer_load_dwordx2 v[96:97], v7, s[4:7], s17 offen sc1
  buffer_load_dwordx2 v[98:99], v7, s[4:7], s17 offen offset:512 sc1
  v_mfma_f32_16x16x32_bf16 v[20:23], a[172:175], v[120:123], v[20:23]
  v_mfma_f32_16x16x32_bf16 v[40:43], a[172:175], v[124:127], v[40:43]
  v_mfma_f32_16x16x32_bf16 v[60:63], a[172:175], v[128:131], v[60:63]
  v_mfma_f32_16x16x32_bf16 v[80:83], a[172:175], v[132:135], v[80:83]
  v_mfma_f32_16x16x32_bf16 v[24:27], a[176:179], v[120:123], v[24:27]
  s_add_u32 s17, s23, 49152
  v_lshlrev_b32 v7, 3, v0
  buffer_load_dwordx2 v[100:101], v7, s[4:7], s17 offen sc1
  buffer_load_dwordx2 v[102:103], v7, s[4:7], s17 offen offset:512 sc1
  v_mfma_f32_16x16x32_bf16 v[44:47], a[176:179], v[124:127], v[44:47]
  v_mfma_f32_16x16x32_bf16 v[64:67], a[176:179], v[128:131], v[64:67]
  v_mfma_f32_16x16x32_bf16 v[84:87], a[176:179], v[132:135], v[84:87]
  s_waitcnt vmcnt(16)
  v_mfma_f32_16x16x32_bf16 v[8:11], a[180:183], v[136:139], v[8:11]
  v_mfma_f32_16x16x32_bf16 v[28:31], a[180:183], v[140:143], v[28:31]
  s_add_u32 s17, s20, 53248
  s_sub_u32 s17, s17, s24
  v_lshlrev_b32 v7, 3, v0
  buffer_load_dwordx2 v[104:105], v7, s[4:7], s17 offen sc1
  buffer_load_dwordx2 v[106:107], v7, s[4:7], s17 offen offset:512 sc1
  v_mfma_f32_16x16x32_bf16 v[48:51], a[180:183], v[144:147], v[48:51]
  v_mfma_f32_16x16x32_bf16 v[68:71], a[180:183], v[148:151], v[68:71]
  v_mfma_f32_16x16x32_bf16 v[12:15], a[184:187], v[136:139], v[12:15]
  v_mfma_f32_16x16x32_bf16 v[32:35], a[184:187], v[140:143], v[32:35]
  v_mfma_f32_16x16x32_bf16 v[52:55], a[184:187], v[144:147], v[52:55]
  s_add_u32 s17, s21, 53248
  s_sub_u32 s17, s17, s24
  v_lshlrev_b32 v7, 3, v0
  buffer_load_dwordx2 v[108:109], v7, s[4:7], s17 offen sc1
  buffer_load_dwordx2 v[110:111], v7, s[4:7], s17 offen offset:512 sc1
  v_mfma_f32_16x16x32_bf16 v[72:75], a[184:187], v[148:151], v[72:75]
  v_mfma_f32_16x16x32_bf16 v[16:19], a[188:191], v[136:139], v[16:19]
  v_mfma_f32_16x16x32_bf16 v[36:39], a[188:191], v[140:143], v[36:39]
  v_mfma_f32_16x16x32_bf16 v[56:59], a[188:191], v[144:147], v[56:59]
  v_mfma_f32_16x16x32_bf16 v[76:79], a[188:191], v[148:151], v[76:79]
  s_add_u32 s17, s22, 53248
  s_sub_u32 s17, s17, s24
  v_lshlrev_b32 v7, 3, v0
  buffer_load_dwordx2 v[112:113], v7, s[4:7], s17 offen sc1
  buffer_load_dwordx2 v[114:115], v7, s[4:7], s17 offen offset:512 sc1
  v_mfma_f32_16x16x32_bf16 v[20:23], a[192:195], v[136:139], v[20:23]
  v_mfma_f32_16x16x32_bf16 v[40:43], a[192:195], v[140:143], v[40:43]
  v_mfma_f32_16x16x32_bf16 v[60:63], a[192:195], v[144:147], v[60:63]
  v_mfma_f32_16x16x32_bf16 v[80:83], a[192:195], v[148:151], v[80:83]
  v_mfma_f32_16x16x32_bf16 v[24:27], a[196:199], v[136:139], v[24:27]
  s_add_u32 s17, s23, 53248
  s_sub_u32 s17, s17, s24
  v_lshlrev_b32 v7, 3, v0
  buffer_load_dwordx2 v[116:117], v7, s[4:7], s17 offen sc1
  buffer_load_dwordx2 v[118:119], v7, s[4:7], s17 offen offset:512 sc1
  v_mfma_f32_16x16x32_bf16 v[44:47], a[196:199], v[140:143], v[44:47]
  v_mfma_f32_16x16x32_bf16 v[64:67], a[196:199], v[144:147], v[64:67]
  v_mfma_f32_16x16x32_bf16 v[84:87], a[196:199], v[148:151], v[84:87]
  s_waitcnt vmcnt(20)
  v_mfma_f32_16x16x32_bf16 v[8:11], a[200:203], v[152:155], v[8:11]
  v_mfma_f32_16x16x32_bf16 v[28:31], a[200:203], v[156:159], v[28:31]
  v_mfma_f32_16x16x32_bf16 v[48:51], a[200:203], v[160:163], v[48:51]
  v_mfma_f32_16x16x32_bf16 v[68:71], a[200:203], v[164:167], v[68:71]
  v_mfma_f32_16x16x32_bf16 v[12:15], a[204:207], v[152:155], v[12:15]
  s_mul_i32 s33, s10, 163840
  s_add_u32 s33, s33, s61
  s_add_u32 s33, s33, 0xe00000
  s_add_u32 m0, s61, 32768
  s_add_u32 s17, s33, 32768
  buffer_load_dwordx4 v1, s[4:7], s17 offen sc1 lds
  v_mfma_f32_16x16x32_bf16 v[32:35], a[204:207], v[156:159], v[32:35]
  v_mfma_f32_16x16x32_bf16 v[52:55], a[204:207], v[160:163], v[52:55]
  v_mfma_f32_16x16x32_bf16 v[72:75], a[204:207], v[164:167], v[72:75]
  v_mfma_f32_16x16x32_bf16 v[16:19], a[208:211], v[152:155], v[16:19]
  v_mfma_f32_16x16x32_bf16 v[36:39], a[208:211], v[156:159], v[36:39]
  v_mfma_f32_16x16x32_bf16 v[56:59], a[208:211], v[160:163], v[56:59]
  v_mfma_f32_16x16x32_bf16 v[76:79], a[208:211], v[164:167], v[76:79]
  v_mfma_f32_16x16x32_bf16 v[20:23], a[212:215], v[152:155], v[20:23]
  v_mfma_f32_16x16x32_bf16 v[40:43], a[212:215], v[156:159], v[40:43]
  v_mfma_f32_16x16x32_bf16 v[60:63], a[212:215], v[160:163], v[60:63]
  s_add_u32 m0, s61, 36864
  s_add_u32 s17, s33, 36864
  buffer_load_dwordx4 v1, s[4:7], s17 offen sc1 lds
  v_mfma_f32_16x16x32_bf16 v[80:83], a[212:215], v[164:167], v[80:83]
  v_mfma_f32_16x16x32_bf16 v[24:27], a[216:219], v[152:155], v[24:27]
  v_mfma_f32_16x16x32_bf16 v[44:47], a[216:219], v[156:159], v[44:47]
  v_mfma_f32_16x16x32_bf16 v[64:67], a[216:219], v[160:163], v[64:67]
  v_mfma_f32_16x16x32_bf16 v[84:87], a[216:219], v[164:167], v[84:87]
  s_waitcnt vmcnt(18)
  v_mfma_f32_16x16x32_bf16 v[8:11], a[220:223], v[168:171], v[8:11]
  v_mfma_f32_16x16x32_bf16 v[28:31], a[220:223], v[172:175], v[28:31]
  v_mfma_f32_16x16x32_bf16 v[48:51], a[220:223], v[176:179], v[48:51]
  v_mfma_f32_16x16x32_bf16 v[68:71], a[220:223], v[180:183], v[68:71]
  v_mfma_f32_16x16x32_bf16 v[12:15], a[224:227], v[168:171], v[12:15]
  s_add_u32 m0, s61, 40960
  s_add_u32 s17, s33, 40960
  buffer_load_dwordx4 v1, s[4:7], s17 offen sc1 lds
  v_mfma_f32_16x16x32_bf16 v[32:35], a[224:227], v[172:175], v[32:35]
  v_mfma_f32_16x16x32_bf16 v[52:55], a[224:227], v[176:179], v[52:55]
  v_mfma_f32_16x16x32_bf16 v[72:75], a[224:227], v[180:183], v[72:75]
  v_mfma_f32_16x16x32_bf16 v[16:19], a[228:231], v[168:171], v[16:19]
  v_mfma_f32_16x16x32_bf16 v[36:39], a[228:231], v[172:175], v[36:39]
  v_mfma_f32_16x16x32_bf16 v[56:59], a[228:231], v[176:179], v[56:59]
  v_mfma_f32_16x16x32_bf16 v[76:79], a[228:231], v[180:183], v[76:79]
  v_mfma_f32_16x16x32_bf16 v[20:23], a[232:235], v[168:171], v[20:23]
  v_mfma_f32_16x16x32_bf16 v[40:43], a[232:235], v[172:175], v[40:43]
  v_mfma_f32_16x16x32_bf16 v[60:63], a[232:235], v[176:179], v[60:63]
  s_add_u32 m0, s61, 45056
  s_add_u32 s17, s33, 45056
  buffer_load_dwordx4 v1, s[4:7], s17 offen sc1 lds
  v_mfma_f32_16x16x32_bf16 v[80:83], a[232:235], v[180:183], v[80:83]
  v_mfma_f32_16x16x32_bf16 v[24:27], a[236:239], v[168:171], v[24:27]
  v_mfma_f32_16x16x32_bf16 v[44:47], a[236:239], v[172:175], v[44:47]
  v_mfma_f32_16x16x32_bf16 v[64:67], a[236:239], v[176:179], v[64:67]
  v_mfma_f32_16x16x32_bf16 v[84:87], a[236:239], v[180:183], v[84:87]
  s_waitcnt vmcnt(12)
  v_mfma_f32_16x16x32_bf16 v[8:11], a[240:243], v[88:91], v[8:11]
  v_mfma_f32_16x16x32_bf16 v[28:31], a[240:243], v[92:95], v[28:31]
  v_mfma_f32_16x16x32_bf16 v[48:51], a[240:243], v[96:99], v[48:51]
  v_mfma_f32_16x16x32_bf16 v[68:71], a[240:243], v[100:103], v[68:71]
  v_mfma_f32_16x16x32_bf16 v[12:15], a[244:247], v[88:91], v[12:15]
  s_add_u32 m0, s61, 49152
  s_add_u32 s17, s33, 49152
  buffer_load_dwordx4 v1, s[4:7], s17 offen sc1 lds
  v_mfma_f32_16x16x32_bf16 v[32:35], a[244:247], v[92:95], v[32:35]
  v_mfma_f32_16x16x32_bf16 v[52:55], a[244:247], v[96:99], v[52:55]
  v_mfma_f32_16x16x32_bf16 v[72:75], a[244:247], v[100:103], v[72:75]
  v_mfma_f32_16x16x32_bf16 v[16:19], a[248:251], v[88:91], v[16:19]
  v_mfma_f32_16x16x32_bf16 v[36:39], a[248:251], v[92:95], v[36:39]
  v_mfma_f32_16x16x32_bf16 v[56:59], a[248:251], v[96:99], v[56:59]
  v_mfma_f32_16x16x32_bf16 v[76:79], a[248:251], v[100:103], v[76:79]
  v_mfma_f32_16x16x32_bf16 v[20:23], a[252:255], v[88:91], v[20:23]
  v_mfma_f32_16x16x32_bf16 v[40:43], a[252:255], v[92:95], v[40:43]
  v_mfma_f32_16x16x32_bf16 v[60:63], a[252:255], v[96:99], v[60:63]
  v_mfma_f32_16x16x32_bf16 v[80:83], a[252:255], v[100:103], v[80:83]
  v_mfma_f32_16x16x32_bf16 v[24:27], v[220:223], v[88:91], v[24:27]
  v_mfma_f32_16x16x32_bf16 v[44:47], v[220:223], v[92:95], v[44:47]
  v_mfma_f32_16x16x32_bf16 v[64:67], v[220:223], v[96:99], v[64:67]
  v_mfma_f32_16x16x32_bf16 v[84:87], v[220:223], v[100:103], v[84:87]
  s_waitcnt vmcnt(5)
  v_mfma_f32_16x16x32_bf16 v[8:11], v[224:227], v[104:107], v[8:11]
  v_mfma_f32_16x16x32_bf16 v[28:31], v[224:227], v[108:111], v[28:31]
  v_mfma_f32_16x16x32_bf16 v[48:51], v[224:227], v[112:115], v[48:51]
  v_mfma_f32_16x16x32_bf16 v[68:71], v[224:227], v[116:119], v[68:71]
  v_mfma_f32_16x16x32_bf16 v[12:15], v[228:231], v[104:107], v[12:15]
  v_mfma_f32_16x16x32_bf16 v[32:35], v[228:231], v[108:111], v[32:35]
  v_mfma_f32_16x16x32_bf16 v[52:55], v[228:231], v[112:115], v[52:55]
  v_mfma_f32_16x16x32_bf16 v[72:75], v[228:231], v[116:119], v[72:75]
  v_mfma_f32_16x16x32_bf16 v[16:19], v[232:235], v[104:107], v[16:19]
  v_mfma_f32_16x16x32_bf16 v[36:39], v[232:235], v[108:111], v[36:39]
  v_mfma_f32_16x16x32_bf16 v[56:59], v[232:235], v[112:115], v[56:59]
  v_mfma_f32_16x16x32_bf16 v[76:79], v[232:235], v[116:119], v[76:79]
  v_mfma_f32_16x16x32_bf16 v[20:23], v[236:239], v[104:107], v[20:23]
  v_mfma_f32_16x16x32_bf16 v[40:43], v[236:239], v[108:111], v[40:43]
  v_mfma_f32_16x16x32_bf16 v[60:63], v[236:239], v[112:115], v[60:63]
  v_mfma_f32_16x16x32_bf16 v[80:83], v[236:239], v[116:119], v[80:83]
  v_mfma_f32_16x16x32_bf16 v[24:27], v[240:243], v[104:107], v[24:27]
  v_mfma_f32_16x16x32_bf16 v[44:47], v[240:243], v[108:111], v[44:47]
  v_mfma_f32_16x16x32_bf16 v[64:67], v[240:243], v[112:115], v[64:67]
  v_mfma_f32_16x16x32_bf16 v[84:87], v[240:243], v[116:119], v[84:87]
  s_add_u32 s17, s8, 1
  s_and_b32 s17, s17, 3
  s_mul_i32 s17, s17, 15360
  s_add_u32 s17, s17, 102400
  v_add_u32 v7, s17, v1
  ds_write_b128 v7, v[28:31] offset:0
  ds_write_b128 v7, v[32:35] offset:1024
  ds_write_b128 v7, v[36:39] offset:2048
  ds_write_b128 v7, v[40:43] offset:3072
  ds_write_b128 v7, v[44:47] offset:4096
  s_add_u32 s17, s8, 2
  s_and_b32 s17, s17, 3
  s_mul_i32 s17, s17, 15360
  s_add_u32 s17, s17, 107520
  v_add_u32 v7, s17, v1
  ds_write_b128 v7, v[48:51] offset:0
  ds_write_b128 v7, v[52:55] offset:1024
  ds_write_b128 v7, v[56:59] offset:2048
  ds_write_b128 v7, v[60:63] offset:3072
  ds_write_b128 v7, v[64:67] offset:4096
  s_add_u32 s17, s8, 3
  s_and_b32 s17, s17, 3
  s_mul_i32 s17, s17, 15360
  s_add_u32 s17, s17, 112640
  v_add_u32 v7, s17, v1
  ds_write_b128 v7, v[68:71] offset:0
  ds_write_b128 v7, v[72:75] offset:1024
  ds_write_b128 v7, v[76:79] offset:2048
  ds_write_b128 v7, v[80:83] offset:3072
  ds_write_b128 v7, v[84:87] offset:4096
  s_mul_i32 s17, s8, 15360
  s_add_u32 s17, s17, 102400
  v_add_u32 v7, s17, v1
  s_waitcnt lgkmcnt(0)
  s_barrier
  ds_read_b128 v[88:91], v7 offset:0
  ds_read_b128 v[92:95], v7 offset:1024
  ds_read_b128 v[96:99], v7 offset:2048
  ds_read_b128 v[100:103], v7 offset:3072
  ds_read_b128 v[104:107], v7 offset:4096
  ds_read_b128 v[108:111], v7 offset:5120
  ds_read_b128 v[112:115], v7 offset:6144
  ds_read_b128 v[116:119], v7 offset:7168
  ds_read_b128 v[120:123], v7 offset:8192
  ds_read_b128 v[124:127], v7 offset:9216
  ds_read_b128 v[128:131], v7 offset:10240
  ds_read_b128 v[132:135], v7 offset:11264
  ds_read_b128 v[136:139], v7 offset:12288
  ds_read_b128 v[140:143], v7 offset:13312
  ds_read_b128 v[144:147], v7 offset:14336
  s_waitcnt lgkmcnt(10)
  v_pk_add_f32 v[8:9], v[8:9], v[88:89]
  v_pk_add_f32 v[10:11], v[10:11], v[90:91]
  v_pk_add_f32 v[12:13], v[12:13], v[92:93]
  v_pk_add_f32 v[14:15], v[14:15], v[94:95]
  v_pk_add_f32 v[16:17], v[16:17], v[96:97]
  v_pk_add_f32 v[18:19], v[18:19], v[98:99]
  v_pk_add_f32 v[20:21], v[20:21], v[100:101]
  v_pk_add_f32 v[22:23], v[22:23], v[102:103]
  v_pk_add_f32 v[24:25], v[24:25], v[104:105]
  v_pk_add_f32 v[26:27], v[26:27], v[106:107]
  s_waitcnt lgkmcnt(5)
  v_pk_add_f32 v[8:9], v[8:9], v[108:109]
  v_pk_add_f32 v[10:11], v[10:11], v[110:111]
  v_pk_add_f32 v[12:13], v[12:13], v[112:113]
  v_pk_add_f32 v[14:15], v[14:15], v[114:115]
  v_pk_add_f32 v[16:17], v[16:17], v[116:117]
  v_pk_add_f32 v[18:19], v[18:19], v[118:119]
  v_pk_add_f32 v[20:21], v[20:21], v[120:121]
  v_pk_add_f32 v[22:23], v[22:23], v[122:123]
  v_pk_add_f32 v[24:25], v[24:25], v[124:125]
  v_pk_add_f32 v[26:27], v[26:27], v[126:127]
  s_waitcnt lgkmcnt(0)
  v_pk_add_f32 v[8:9], v[8:9], v[128:129]
  v_pk_add_f32 v[10:11], v[10:11], v[130:131]
  v_pk_add_f32 v[12:13], v[12:13], v[132:133]
  v_pk_add_f32 v[14:15], v[14:15], v[134:135]
  v_pk_add_f32 v[16:17], v[16:17], v[136:137]
  v_pk_add_f32 v[18:19], v[18:19], v[138:139]
  v_pk_add_f32 v[20:21], v[20:21], v[140:141]
  v_pk_add_f32 v[22:23], v[22:23], v[142:143]
  v_pk_add_f32 v[24:25], v[24:25], v[144:145]
  v_pk_add_f32 v[26:27], v[26:27], v[146:147]
  v_lshlrev_b32 v216, 16, v184
  v_and_b32 v217, 0xffff0000, v184
  v_pk_add_f32 v[8:9], v[8:9], v[216:217]
  v_lshlrev_b32 v216, 16, v194
  v_and_b32 v217, 0xffff0000, v194
  v_pk_add_f32 v[8:9], v[8:9], v[216:217]
  v_lshlrev_b32 v216, 16, v185
  v_and_b32 v217, 0xffff0000, v185
  v_pk_add_f32 v[10:11], v[10:11], v[216:217]
  v_lshlrev_b32 v216, 16, v195
  v_and_b32 v217, 0xffff0000, v195
  v_pk_add_f32 v[10:11], v[10:11], v[216:217]
  v_lshlrev_b32 v216, 16, v186
  v_and_b32 v217, 0xffff0000, v186
  v_pk_add_f32 v[12:13], v[12:13], v[216:217]
  v_lshlrev_b32 v216, 16, v196
  v_and_b32 v217, 0xffff0000, v196
  v_pk_add_f32 v[12:13], v[12:13], v[216:217]
  v_lshlrev_b32 v216, 16, v187
  v_and_b32 v217, 0xffff0000, v187
  v_pk_add_f32 v[14:15], v[14:15], v[216:217]
  v_lshlrev_b32 v216, 16, v197
  v_and_b32 v217, 0xffff0000, v197
  v_pk_add_f32 v[14:15], v[14:15], v[216:217]
  v_lshlrev_b32 v216, 16, v188
  v_and_b32 v217, 0xffff0000, v188
  v_pk_add_f32 v[16:17], v[16:17], v[216:217]
  v_lshlrev_b32 v216, 16, v198
  v_and_b32 v217, 0xffff0000, v198
  v_pk_add_f32 v[16:17], v[16:17], v[216:217]
  v_lshlrev_b32 v216, 16, v189
  v_and_b32 v217, 0xffff0000, v189
  v_pk_add_f32 v[18:19], v[18:19], v[216:217]
  v_lshlrev_b32 v216, 16, v199
  v_and_b32 v217, 0xffff0000, v199
  v_pk_add_f32 v[18:19], v[18:19], v[216:217]
  v_lshlrev_b32 v216, 16, v190
  v_and_b32 v217, 0xffff0000, v190
  v_pk_add_f32 v[20:21], v[20:21], v[216:217]
  v_lshlrev_b32 v216, 16, v200
  v_and_b32 v217, 0xffff0000, v200
  v_pk_add_f32 v[20:21], v[20:21], v[216:217]
  v_lshlrev_b32 v216, 16, v191
  v_and_b32 v217, 0xffff0000, v191
  v_pk_add_f32 v[22:23], v[22:23], v[216:217]
  v_lshlrev_b32 v216, 16, v201
  v_and_b32 v217, 0xffff0000, v201
  v_pk_add_f32 v[22:23], v[22:23], v[216:217]
  v_lshlrev_b32 v216, 16, v192
  v_and_b32 v217, 0xffff0000, v192
  v_pk_add_f32 v[24:25], v[24:25], v[216:217]
  v_lshlrev_b32 v216, 16, v202
  v_and_b32 v217, 0xffff0000, v202
  v_pk_add_f32 v[24:25], v[24:25], v[216:217]
  v_lshlrev_b32 v216, 16, v193
  v_and_b32 v217, 0xffff0000, v193
  v_pk_add_f32 v[26:27], v[26:27], v[216:217]
  v_lshlrev_b32 v216, 16, v203
  v_and_b32 v217, 0xffff0000, v203
  v_pk_add_f32 v[26:27], v[26:27], v[216:217]
  v_cvt_pk_bf16_f32 v204, v8, v9
  v_cvt_pk_bf16_f32 v205, v10, v11
  v_cvt_pk_bf16_f32 v206, v12, v13
  v_cvt_pk_bf16_f32 v207, v14, v15
  v_cvt_pk_bf16_f32 v208, v16, v17
  v_cvt_pk_bf16_f32 v209, v18, v19
  v_cvt_pk_bf16_f32 v210, v20, v21
  v_cvt_pk_bf16_f32 v211, v22, v23
  v_cvt_pk_bf16_f32 v212, v24, v25
  v_cvt_pk_bf16_f32 v213, v26, v27
  s_add_u32 s17, s28, s50
  buffer_store_dwordx4 v[204:207], v1, s[4:7], s17 offen offset:0 sc1
  buffer_store_dwordx4 v[208:211], v1, s[4:7], s17 offen offset:1024 sc1
  s_add_u32 s17, s29, s50
  v_lshlrev_b32 v7, 3, v0
  buffer_store_dwordx2 v[212:213], v7, s[4:7], s17 offen sc1
  v_pk_add_f32 v[216:217], v[8:9], v[10:11]
  v_pk_mul_f32 v[214:215], v[8:9], v[8:9]
  v_pk_fma_f32 v[214:215], v[10:11], v[10:11], v[214:215]
  v_pk_add_f32 v[216:217], v[216:217], v[12:13]
  v_pk_fma_f32 v[214:215], v[12:13], v[12:13], v[214:215]
  v_pk_add_f32 v[216:217], v[216:217], v[14:15]
  v_pk_fma_f32 v[214:215], v[14:15], v[14:15], v[214:215]
  v_pk_add_f32 v[216:217], v[216:217], v[16:17]
  v_pk_fma_f32 v[214:215], v[16:17], v[16:17], v[214:215]
  v_pk_add_f32 v[216:217], v[216:217], v[18:19]
  v_pk_fma_f32 v[214:215], v[18:19], v[18:19], v[214:215]
  v_pk_add_f32 v[216:217], v[216:217], v[20:21]
  v_pk_fma_f32 v[214:215], v[20:21], v[20:21], v[214:215]
  v_pk_add_f32 v[216:217], v[216:217], v[22:23]
  v_pk_fma_f32 v[214:215], v[22:23], v[22:23], v[214:215]
  v_pk_add_f32 v[216:217], v[216:217], v[24:25]
  v_pk_fma_f32 v[214:215], v[24:25], v[24:25], v[214:215]
  v_pk_add_f32 v[216:217], v[216:217], v[26:27]
  v_pk_fma_f32 v[214:215], v[26:27], v[26:27], v[214:215]
  v_add_f32 v215, v214, v215
  v_add_f32 v214, v216, v217
  s_nop 1
  v_permlane16_swap_b32 v214, v215
  v_add_f32 v214, v214, v215
  v_mov_b32 v215, v214
  s_nop 1
  v_permlane32_swap_b32 v214, v215
  v_add_f32 v214, v214, v215
  v_mov_b32 v215, v214
  s_nop 1
  v_permlane16_swap_b32 v214, v215
  s_lshl_b32 s17, s60, 10
  s_lshl_b32 s18, s13, 7
  s_add_u32 s17, s17, s18
  s_add_u32 s17, s17, s53
  s_mov_b64 exec, 0xffff
  buffer_store_dwordx2 v[214:215], v7, s[4:7], s17 offen sc1
  s_mov_b64 exec, -1
  s_waitcnt vmcnt(0)
  s_barrier
  s_cmp_lg_u32 s8, 0
  s_cbranch_scc1 sig_41
  s_lshl_b32 s17, s9, 7
  s_add_u32 s17, s17, s57
  s_add_u32 s17, s17, 8192
  s_mov_b64 exec, 1
  v_mov_b32 v7, 1
  buffer_atomic_add v7, off, s[4:7], s17
  s_mov_b64 exec, -1
sig_41:
  s_mul_i32 s33, s10, 163840
  s_add_u32 s33, s33, s61
  s_add_u32 s33, s33, 0xe00000
  s_add_u32 m0, s61, 53248
  s_add_u32 s17, s33, 53248
  buffer_load_dwordx4 v1, s[4:7], s17 offen sc1 lds
  s_add_u32 m0, s61, 57344
  s_add_u32 s17, s33, 57344
  buffer_load_dwordx4 v1, s[4:7], s17 offen sc1 lds
  s_add_u32 m0, s61, 61440
  s_add_u32 s17, s33, 61440
  buffer_load_dwordx4 v1, s[4:7], s17 offen sc1 lds
  s_add_u32 m0, s61, 65536
  s_add_u32 s17, s33, 65536
  buffer_load_dwordx4 v1, s[4:7], s17 offen sc1 lds
  s_add_u32 m0, s61, 69632
  s_add_u32 s17, s33, 69632
  buffer_load_dwordx4 v1, s[4:7], s17 offen sc1 lds
  s_add_u32 m0, s61, 73728
  s_add_u32 s17, s33, 73728
  buffer_load_dwordx4 v1, s[4:7], s17 offen sc1 lds
  s_add_u32 m0, s61, 77824
  s_add_u32 s17, s33, 77824
  buffer_load_dwordx4 v1, s[4:7], s17 offen sc1 lds
  s_add_u32 m0, s61, 81920
  s_add_u32 s17, s33, 81920
  buffer_load_dwordx4 v1, s[4:7], s17 offen sc1 lds
  s_add_u32 m0, s61, 86016
  s_add_u32 s17, s33, 86016
  buffer_load_dwordx4 v1, s[4:7], s17 offen sc1 lds
  s_add_u32 m0, s61, 90112
  s_add_u32 s17, s33, 90112
  buffer_load_dwordx4 v1, s[4:7], s17 offen sc1 lds
  s_add_u32 m0, s61, 94208
  s_add_u32 s17, s33, 94208
  buffer_load_dwordx4 v1, s[4:7], s17 offen sc1 lds
  s_add_u32 m0, s61, 98304
  s_add_u32 s17, s33, 98304
  buffer_load_dwordx4 v1, s[4:7], s17 offen sc1 lds
  s_mov_b32 s48, 0x600000
  s_mov_b32 s49, 0x900000
  s_mov_b32 s50, 0x900000
  s_mov_b32 s51, 0xc40000
  s_mov_b32 s52, 0xc60000
  s_mov_b32 s53, 0xc60000
  s_mov_b32 s54, 0x1c00000
  s_mov_b32 s55, 0x2800000
  s_mov_b32 s56, 0x1830000
  s_mov_b32 s57, 0xd02800
  v_lshlrev_b32 v7, 4, v5
  s_lshl_b32 s17, s2, 9
  s_add_u32 s17, s17, 0xdb0000
  buffer_load_dwordx4 v[68:71], v7, s[4:7], s17 offen offset:0 sc1
  buffer_load_dwordx4 v[72:75], v7, s[4:7], s17 offen offset:64 sc1
  buffer_load_dwordx4 v[76:79], v7, s[4:7], s17 offen offset:128 sc1
  buffer_load_dwordx4 v[80:83], v7, s[4:7], s17 offen offset:192 sc1
  buffer_load_dwordx4 v[84:87], v7, s[4:7], s17 offen offset:256 sc1
  s_cmp_lg_u32 s8, 0
  s_cbranch_scc1 wbar_42
  s_cmp_lg_u32 s58, 0
  s_cbranch_scc1 wbar_42
  s_lshl_b32 s17, s9, 7
  s_add_u32 s17, s17, s57
  s_sub_u32 s17, s17, 2048
  s_mov_b32 s18, 0
  s_mov_b64 exec, 1
poll_43:
  buffer_load_dword v7, off, s[4:7], s17 sc1
  s_waitcnt vmcnt(0)
  v_readfirstlane_b32 s19, v7
  s_nop 3
  s_cmp_ge_u32 s19, 16
  s_cbranch_scc1 pdone_44
  s_add_u32 s18, s18, 1
  s_cmp_lt_u32 s18, 0x20000
  s_cbranch_scc1 poll_43
  s_mov_b32 s58, 1
pdone_44:
  s_mov_b64 exec, -1
wbar_42:
  s_waitcnt vmcnt(0)
  s_barrier
  s_mul_i32 s21, s59, 20480
  s_add_u32 s21, s21, s48
  s_add_u32 s22, s21, 20480
  buffer_load_dwordx4 v[88:91], v1, s[4:7], s21 offen offset:0 sc1
  buffer_load_dwordx4 v[92:95], v1, s[4:7], s22 offen offset:0 sc1
  buffer_load_dwordx4 v[96:99], v1, s[4:7], s21 offen offset:1024 sc1
  buffer_load_dwordx4 v[100:103], v1, s[4:7], s22 offen offset:1024 sc1
  v_lshlrev_b32 v7, 3, v4
  v_lshl_add_u32 v7, v5, 8, v7
  s_lshl_b32 s17, s59, 10
  s_add_u32 s17, s17, s51
  buffer_load_dwordx2 v[248:249], v7, s[4:7], s17 offen offset:0 sc1
  buffer_load_dwordx2 v[250:251], v7, s[4:7], s17 offen offset:128 sc1
  buffer_load_dwordx2 v[252:253], v7, s[4:7], s17 offen offset:1024 sc1
  buffer_load_dwordx2 v[254:255], v7, s[4:7], s17 offen offset:1152 sc1
  buffer_load_dwordx4 v[104:107], v1, s[4:7], s21 offen offset:2048 sc1
  buffer_load_dwordx4 v[108:111], v1, s[4:7], s22 offen offset:2048 sc1
  buffer_load_dwordx4 v[112:115], v1, s[4:7], s21 offen offset:3072 sc1
  buffer_load_dwordx4 v[116:119], v1, s[4:7], s22 offen offset:3072 sc1
  s_add_u32 s21, s21, 4096
  buffer_load_dwordx4 v[120:123], v1, s[4:7], s21 offen offset:0 sc1
  s_add_u32 s22, s22, 4096
  buffer_load_dwordx4 v[124:127], v1, s[4:7], s22 offen offset:0 sc1
  buffer_load_dwordx4 v[128:131], v1, s[4:7], s21 offen offset:1024 sc1
  buffer_load_dwordx4 v[132:135], v1, s[4:7], s22 offen offset:1024 sc1
  buffer_load_dwordx4 v[136:139], v1, s[4:7], s21 offen offset:2048 sc1
  buffer_load_dwordx4 v[140:143], v1, s[4:7], s22 offen offset:2048 sc1
  buffer_load_dwordx4 v[144:147], v1, s[4:7], s21 offen offset:3072 sc1
  buffer_load_dwordx4 v[148:151], v1, s[4:7], s22 offen offset:3072 sc1
  s_waitcnt vmcnt(12)
  v_add_f32 v248, v248, v250
  v_add_f32 v249, v249, v251
  s_nop 1
  v_permlane16_swap_b32 v248, v249
  v_add_f32 v248, v248, v249
  v_mov_b32 v249, v248
  s_nop 1
  v_permlane32_swap_b32 v248, v249
  v_add_f32 v248, v248, v249
  v_mov_b32 v249, v248
  s_nop 1
  v_permlane16_swap_b32 v248, v249
  v_mul_f32 v248, 0x3acccccd, v248
  v_mul_f32 v250, 0x3acccccd, v249
  v_mul_f32 v249, -1.0, v248
  v_fma_f32 v250, -v248, v248, v250
  v_max_f32 v250, 0, v250
  v_add_f32 v250, 0x3727c5ac, v250
  v_rsq_f32 v250, v250
  s_nop 0
  v_mul_f32 v248, 0x3fb8aa3b, v250
  v_add_f32 v252, v252, v254
  v_add_f32 v253, v253, v255
  s_nop 1
  v_permlane16_swap_b32 v252, v253
  v_add_f32 v252, v252, v253
  v_mov_b32 v253, v252
  s_nop 1
  v_permlane32_swap_b32 v252, v253
  v_add_f32 v252, v252, v253
  v_mov_b32 v253, v252
  s_nop 1
  v_permlane16_swap_b32 v252, v253
  v_mul_f32 v252, 0x3acccccd, v252
  v_mul_f32 v254, 0x3acccccd, v253
  v_mul_f32 v253, -1.0, v252
  v_fma_f32 v254, -v252, v252, v254
  v_max_f32 v254, 0, v254
  v_add_f32 v254, 0x3727c5ac, v254
  v_rsq_f32 v254, v254
  s_nop 0
  v_mul_f32 v252, 0x3fb8aa3b, v254
  v_pk_mul_f32 v[8:9], v[68:69], v[248:249] op_sel:[0,1] op_sel_hi:[1,1]
  v_pk_mul_f32 v[10:11], v[70:71], v[248:249] op_sel:[0,1] op_sel_hi:[1,1]
  v_pk_mul_f32 v[12:13], v[72:73], v[248:249] op_sel:[0,1] op_sel_hi:[1,1]
  v_pk_mul_f32 v[14:15], v[74:75], v[248:249] op_sel:[0,1] op_sel_hi:[1,1]
  v_pk_mul_f32 v[16:17], v[76:77], v[248:249] op_sel:[0,1] op_sel_hi:[1,1]
  v_pk_mul_f32 v[18:19], v[78:79], v[248:249] op_sel:[0,1] op_sel_hi:[1,1]
  v_pk_mul_f32 v[20:21], v[80:81], v[248:249] op_sel:[0,1] op_sel_hi:[1,1]
  v_pk_mul_f32 v[22:23], v[82:83], v[248:249] op_sel:[0,1] op_sel_hi:[1,1]
  v_pk_mul_f32 v[24:25], v[84:85], v[248:249] op_sel:[0,1] op_sel_hi:[1,1]
  v_pk_mul_f32 v[26:27], v[86:87], v[248:249] op_sel:[0,1] op_sel_hi:[1,1]
  v_pk_mul_f32 v[28:29], v[68:69], v[252:253] op_sel:[0,1] op_sel_hi:[1,1]
  v_pk_mul_f32 v[30:31], v[70:71], v[252:253] op_sel:[0,1] op_sel_hi:[1,1]
  v_pk_mul_f32 v[32:33], v[72:73], v[252:253] op_sel:[0,1] op_sel_hi:[1,1]
  v_pk_mul_f32 v[34:35], v[74:75], v[252:253] op_sel:[0,1] op_sel_hi:[1,1]
  v_pk_mul_f32 v[36:37], v[76:77], v[252:253] op_sel:[0,1] op_sel_hi:[1,1]
  v_pk_mul_f32 v[38:39], v[78:79], v[252:253] op_sel:[0,1] op_sel_hi:[1,1]
  v_pk_mul_f32 v[40:41], v[80:81], v[252:253] op_sel:[0,1] op_sel_hi:[1,1]
  v_pk_mul_f32 v[42:43], v[82:83], v[252:253] op_sel:[0,1] op_sel_hi:[1,1]
  v_pk_mul_f32 v[44:45], v[84:85], v[252:253] op_sel:[0,1] op_sel_hi:[1,1]
  v_pk_mul_f32 v[46:47], v[86:87], v[252:253] op_sel:[0,1] op_sel_hi:[1,1]
  ds_read_b128 v[48:51], v1 offset:0
  ds_read_b128 v[52:55], v1 offset:1024
  ds_read_b128 v[56:59], v1 offset:2048
  ds_read_b128 v[60:63], v1 offset:3072
  ds_read_b128 v[64:67], v1 offset:4096
  s_waitcnt vmcnt(18) lgkmcnt(4)
  v_mfma_f32_16x16x32_bf16 v[8:11], v[48:51], v[88:91], v[8:11]
  ds_read_b128 v[68:71], v1 offset:5120
  v_mfma_f32_16x16x32_bf16 v[28:31], v[48:51], v[92:95], v[28:31]
  ds_read_b128 v[72:75], v1 offset:6144
  s_waitcnt lgkmcnt(5)
  v_mfma_f32_16x16x32_bf16 v[12:15], v[52:55], v[88:91], v[12:15]
  ds_read_b128 v[76:79], v1 offset:7168
  s_add_u32 s21, s21, 4096
  buffer_load_dwordx4 v[152:155], v1, s[4:7], s21 offen offset:0 sc1
  v_mfma_f32_16x16x32_bf16 v[32:35], v[52:55], v[92:95], v[32:35]
  ds_read_b128 v[80:83], v1 offset:8192
  s_waitcnt lgkmcnt(6)
  v_mfma_f32_16x16x32_bf16 v[16:19], v[56:59], v[88:91], v[16:19]
  ds_read_b128 v[84:87], v1 offset:9216
  v_mfma_f32_16x16x32_bf16 v[36:39], v[56:59], v[92:95], v[36:39]
  s_waitcnt lgkmcnt(6)
  v_mfma_f32_16x16x32_bf16 v[20:23], v[60:63], v[88:91], v[20:23]
  v_mfma_f32_16x16x32_bf16 v[40:43], v[60:63], v[92:95], v[40:43]
  s_add_u32 s22, s22, 4096
  buffer_load_dwordx4 v[156:159], v1, s[4:7], s22 offen offset:0 sc1
  s_waitcnt lgkmcnt(5)
  v_mfma_f32_16x16x32_bf16 v[24:27], v[64:67], v[88:91], v[24:27]
  v_mfma_f32_16x16x32_bf16 v[44:47], v[64:67], v[92:95], v[44:47]
  s_waitcnt vmcnt(18) lgkmcnt(4)
  v_mfma_f32_16x16x32_bf16 v[8:11], v[68:71], v[96:99], v[8:11]
  ds_read_b128 v[48:51], v1 offset:10240
  v_mfma_f32_16x16x32_bf16 v[28:31], v[68:71], v[100:103], v[28:31]
  ds_read_b128 v[52:55], v1 offset:11264
  s_waitcnt lgkmcnt(5)
  v_mfma_f32_16x16x32_bf16 v[12:15], v[72:75], v[96:99], v[12:15]
  ds_read_b128 v[56:59], v1 offset:12288
  buffer_load_dwordx4 v[160:163], v1, s[4:7], s21 offen offset:1024 sc1
  v_mfma_f32_16x16x32_bf16 v[32:35], v[72:75], v[100:103], v[32:35]
  ds_read_b128 v[60:63], v1 offset:13312
  s_waitcnt lgkmcnt(6)
  v_mfma_f32_16x16x32_bf16 v[16:19], v[76:79], v[96:99], v[16:19]
  ds_read_b128 v[64:67], v1 offset:14336
  v_mfma_f32_16x16x32_bf16 v[36:39], v[76:79], v[100:103], v[36:39]
  s_waitcnt lgkmcnt(6)
  v_mfma_f32_16x16x32_bf16 v[20:23], v[80:83], v[96:99], v[20:23]
  v_mfma_f32_16x16x32_bf16 v[40:43], v[80:83], v[100:103], v[40:43]
  buffer_load_dwordx4 v[164:167], v1, s[4:7], s22 offen offset:1024 sc1
  s_waitcnt lgkmcnt(5)
  v_mfma_f32_16x16x32_bf16 v[24:27], v[84:87], v[96:99], v[24:27]
  v_mfma_f32_16x16x32_bf16 v[44:47], v[84:87], v[100:103], v[44:47]
  s_waitcnt vmcnt(14) lgkmcnt(4)
  v_mfma_f32_16x16x32_bf16 v[8:11], v[48:51], v[104:107], v[8:11]
  ds_read_b128 v[68:71], v1 offset:15360
  v_mfma_f32_16x16x32_bf16 v[28:31], v[48:51], v[108:111], v[28:31]
  ds_read_b128 v[72:75], v1 offset:16384
  s_waitcnt lgkmcnt(5)
  v_mfma_f32_16x16x32_bf16 v[12:15], v[52:55], v[104:107], v[12:15]
  ds_read_b128 v[76:79], v1 offset:17408
  buffer_load_dwordx4 v[168:171], v1, s[4:7], s21 offen offset:2048 sc1
  v_mfma_f32_16x16x32_bf16 v[32:35], v[52:55], v[108:111], v[32:35]
  ds_read_b128 v[80:83], v1 offset:18432
  s_waitcnt lgkmcnt(6)
  v_mfma_f32_16x16x32_bf16 v[16:19], v[56:59], v[104:107], v[16:19]
  ds_read_b128 v[84:87], v1 offset:19456
  v_mfma_f32_16x16x32_bf16 v[36:39], v[56:59], v[108:111], v[36:39]
  s_waitcnt lgkmcnt(6)
  v_mfma_f32_16x16x32_bf16 v[20:23], v[60:63], v[104:107], v[20:23]
  v_mfma_f32_16x16x32_bf16 v[40:43], v[60:63], v[108:111], v[40:43]
  buffer_load_dwordx4 v[172:175], v1, s[4:7], s22 offen offset:2048 sc1
  s_waitcnt lgkmcnt(5)
  v_mfma_f32_16x16x32_bf16 v[24:27], v[64:67], v[104:107], v[24:27]
  v_mfma_f32_16x16x32_bf16 v[44:47], v[64:67], v[108:111], v[44:47]
  s_waitcnt vmcnt(14) lgkmcnt(4)
  v_mfma_f32_16x16x32_bf16 v[8:11], v[68:71], v[112:115], v[8:11]
  ds_read_b128 v[48:51], v1 offset:20480
  v_mfma_f32_16x16x32_bf16 v[28:31], v[68:71], v[116:119], v[28:31]
  ds_read_b128 v[52:55], v1 offset:21504
  s_waitcnt lgkmcnt(5)
  v_mfma_f32_16x16x32_bf16 v[12:15], v[72:75], v[112:115], v[12:15]
  ds_read_b128 v[56:59], v1 offset:22528
  buffer_load_dwordx4 v[176:179], v1, s[4:7], s21 offen offset:3072 sc1
  v_mfma_f32_16x16x32_bf16 v[32:35], v[72:75], v[116:119], v[32:35]
  ds_read_b128 v[60:63], v1 offset:23552
  s_waitcnt lgkmcnt(6)
  v_mfma_f32_16x16x32_bf16 v[16:19], v[76:79], v[112:115], v[16:19]
  ds_read_b128 v[64:67], v1 offset:24576
  v_mfma_f32_16x16x32_bf16 v[36:39], v[76:79], v[116:119], v[36:39]
  s_waitcnt lgkmcnt(6)
  v_mfma_f32_16x16x32_bf16 v[20:23], v[80:83], v[112:115], v[20:23]
  v_mfma_f32_16x16x32_bf16 v[40:43], v[80:83], v[116:119], v[40:43]
  buffer_load_dwordx4 v[180:183], v1, s[4:7], s22 offen offset:3072 sc1
  s_waitcnt lgkmcnt(5)
  v_mfma_f32_16x16x32_bf16 v[24:27], v[84:87], v[112:115], v[24:27]
  v_mfma_f32_16x16x32_bf16 v[44:47], v[84:87], v[116:119], v[44:47]
  s_waitcnt vmcnt(14) lgkmcnt(4)
  v_mfma_f32_16x16x32_bf16 v[8:11], v[48:51], v[120:123], v[8:11]
  ds_read_b128 v[68:71], v1 offset:25600
  v_mfma_f32_16x16x32_bf16 v[28:31], v[48:51], v[124:127], v[28:31]
  ds_read_b128 v[72:75], v1 offset:26624
  s_waitcnt lgkmcnt(5)
  v_mfma_f32_16x16x32_bf16 v[12:15], v[52:55], v[120:123], v[12:15]
  ds_read_b128 v[76:79], v1 offset:27648
  s_add_u32 s21, s21, 4096
  buffer_load_dwordx4 v[184:187], v1, s[4:7], s21 offen offset:0 sc1
  v_mfma_f32_16x16x32_bf16 v[32:35], v[52:55], v[124:127], v[32:35]
  ds_read_b128 v[80:83], v1 offset:28672
  s_waitcnt lgkmcnt(6)
  v_mfma_f32_16x16x32_bf16 v[16:19], v[56:59], v[120:123], v[16:19]
  ds_read_b128 v[84:87], v1 offset:29696
  v_mfma_f32_16x16x32_bf16 v[36:39], v[56:59], v[124:127], v[36:39]
  s_waitcnt lgkmcnt(6)
  v_mfma_f32_16x16x32_bf16 v[20:23], v[60:63], v[120:123], v[20:23]
  v_mfma_f32_16x16x32_bf16 v[40:43], v[60:63], v[124:127], v[40:43]
  s_add_u32 s22, s22, 4096
  buffer_load_dwordx4 v[188:191], v1, s[4:7], s22 offen offset:0 sc1
  s_waitcnt lgkmcnt(5)
  v_mfma_f32_16x16x32_bf16 v[24:27], v[64:67], v[120:123], v[24:27]
  v_mfma_f32_16x16x32_bf16 v[44:47], v[64:67], v[124:127], v[44:47]
  s_waitcnt vmcnt(14) lgkmcnt(4)
  v_mfma_f32_16x16x32_bf16 v[8:11], v[68:71], v[128:131], v[8:11]
  ds_read_b128 v[48:51], v1 offset:30720
  v_mfma_f32_16x16x32_bf16 v[28:31], v[68:71], v[132:135], v[28:31]
  ds_read_b128 v[52:55], v1 offset:31744
  s_waitcnt lgkmcnt(5)
  v_mfma_f32_16x16x32_bf16 v[12:15], v[72:75], v[128:131], v[12:15]
  ds_read_b128 v[56:59], v1 offset:32768
  buffer_load_dwordx4 v[192:195], v1, s[4:7], s21 offen offset:1024 sc1
  v_mfma_f32_16x16x32_bf16 v[32:35], v[72:75], v[132:135], v[32:35]
  ds_read_b128 v[60:63], v1 offset:33792
  s_waitcnt lgkmcnt(6)
  v_mfma_f32_16x16x32_bf16 v[16:19], v[76:79], v[128:131], v[16:19]
  ds_read_b128 v[64:67], v1 offset:34816
  v_mfma_f32_16x16x32_bf16 v[36:39], v[76:79], v[132:135], v[36:39]
  s_waitcnt lgkmcnt(6)
  v_mfma_f32_16x16x32_bf16 v[20:23], v[80:83], v[128:131], v[20:23]
  v_mfma_f32_16x16x32_bf16 v[40:43], v[80:83], v[132:135], v[40:43]
  buffer_load_dwordx4 v[196:199], v1, s[4:7], s22 offen offset:1024 sc1
  s_waitcnt lgkmcnt(5)
  v_mfma_f32_16x16x32_bf16 v[24:27], v[84:87], v[128:131], v[24:27]
  v_mfma_f32_16x16x32_bf16 v[44:47], v[84:87], v[132:135], v[44:47]
  s_waitcnt vmcnt(14) lgkmcnt(4)
  v_mfma_f32_16x16x32_bf16 v[8:11], v[48:51], v[136:139], v[8:11]
  ds_read_b128 v[68:71], v1 offset:35840
  v_mfma_f32_16x16x32_bf16 v[28:31], v[48:51], v[140:143], v[28:31]
  ds_read_b128 v[72:75], v1 offset:36864
  s_waitcnt lgkmcnt(5)
  v_mfma_f32_16x16x32_bf16 v[12:15], v[52:55], v[136:139], v[12:15]
  ds_read_b128 v[76:79], v1 offset:37888
  buffer_load_dwordx4 v[200:203], v1, s[4:7], s21 offen offset:2048 sc1
  v_mfma_f32_16x16x32_bf16 v[32:35], v[52:55], v[140:143], v[32:35]
  ds_read_b128 v[80:83], v1 offset:38912
  s_waitcnt lgkmcnt(6)
  v_mfma_f32_16x16x32_bf16 v[16:19], v[56:59], v[136:139], v[16:19]
  ds_read_b128 v[84:87], v1 offset:39936
  v_mfma_f32_16x16x32_bf16 v[36:39], v[56:59], v[140:143], v[36:39]
  s_waitcnt lgkmcnt(6)
  v_mfma_f32_16x16x32_bf16 v[20:23], v[60:63], v[136:139], v[20:23]
  v_mfma_f32_16x16x32_bf16 v[40:43], v[60:63], v[140:143], v[40:43]
  buffer_load_dwordx4 v[204:207], v1, s[4:7], s22 offen offset:2048 sc1
  s_waitcnt lgkmcnt(5)
  v_mfma_f32_16x16x32_bf16 v[24:27], v[64:67], v[136:139], v[24:27]
  v_mfma_f32_16x16x32_bf16 v[44:47], v[64:67], v[140:143], v[44:47]
  s_waitcnt vmcnt(14) lgkmcnt(4)
  v_mfma_f32_16x16x32_bf16 v[8:11], v[68:71], v[144:147], v[8:11]
  ds_read_b128 v[48:51], v1 offset:40960
  v_mfma_f32_16x16x32_bf16 v[28:31], v[68:71], v[148:151], v[28:31]
  ds_read_b128 v[52:55], v1 offset:41984
  s_waitcnt lgkmcnt(5)
  v_mfma_f32_16x16x32_bf16 v[12:15], v[72:75], v[144:147], v[12:15]
  ds_read_b128 v[56:59], v1 offset:43008
  buffer_load_dwordx4 v[208:211], v1, s[4:7], s21 offen offset:3072 sc1
  v_mfma_f32_16x16x32_bf16 v[32:35], v[72:75], v[148:151], v[32:35]
  ds_read_b128 v[60:63], v1 offset:44032
  s_waitcnt lgkmcnt(6)
  v_mfma_f32_16x16x32_bf16 v[16:19], v[76:79], v[144:147], v[16:19]
  ds_read_b128 v[64:67], v1 offset:45056
  v_mfma_f32_16x16x32_bf16 v[36:39], v[76:79], v[148:151], v[36:39]
  s_waitcnt lgkmcnt(6)
  v_mfma_f32_16x16x32_bf16 v[20:23], v[80:83], v[144:147], v[20:23]
  v_mfma_f32_16x16x32_bf16 v[40:43], v[80:83], v[148:151], v[40:43]
  buffer_load_dwordx4 v[212:215], v1, s[4:7], s22 offen offset:3072 sc1
  s_waitcnt lgkmcnt(5)
  v_mfma_f32_16x16x32_bf16 v[24:27], v[84:87], v[144:147], v[24:27]
  v_mfma_f32_16x16x32_bf16 v[44:47], v[84:87], v[148:151], v[44:47]
  s_waitcnt vmcnt(14) lgkmcnt(4)
  v_mfma_f32_16x16x32_bf16 v[8:11], v[48:51], v[152:155], v[8:11]
  ds_read_b128 v[68:71], v1 offset:46080
  v_mfma_f32_16x16x32_bf16 v[28:31], v[48:51], v[156:159], v[28:31]
  ds_read_b128 v[72:75], v1 offset:47104
  s_waitcnt lgkmcnt(5)
  v_mfma_f32_16x16x32_bf16 v[12:15], v[52:55], v[152:155], v[12:15]
  ds_read_b128 v[76:79], v1 offset:48128
  s_add_u32 s21, s21, 4096
  v_lshlrev_b32 v7, 3, v0
  buffer_load_dwordx2 v[216:217], v7, s[4:7], s21 offen offset:0 sc1
  buffer_load_dwordx2 v[218:219], v7, s[4:7], s21 offen offset:512 sc1
  v_mfma_f32_16x16x32_bf16 v[32:35], v[52:55], v[156:159], v[32:35]
  ds_read_b128 v[80:83], v1 offset:49152
  s_waitcnt lgkmcnt(6)
  v_mfma_f32_16x16x32_bf16 v[16:19], v[56:59], v[152:155], v[16:19]
  ds_read_b128 v[84:87], v1 offset:50176
  v_mfma_f32_16x16x32_bf16 v[36:39], v[56:59], v[156:159], v[36:39]
  s_waitcnt lgkmcnt(6)
  v_mfma_f32_16x16x32_bf16 v[20:23], v[60:63], v[152:155], v[20:23]
  v_mfma_f32_16x16x32_bf16 v[40:43], v[60:63], v[156:159], v[40:43]
  s_add_u32 s22, s22, 4096
  v_lshlrev_b32 v7, 3, v0
  buffer_load_dwordx2 v[220:221], v7, s[4:7], s22 offen offset:0 sc1
  buffer_load_dwordx2 v[222:223], v7, s[4:7], s22 offen offset:512 sc1
  s_waitcnt lgkmcnt(5)
  v_mfma_f32_16x16x32_bf16 v[24:27], v[64:67], v[152:155], v[24:27]
  v_mfma_f32_16x16x32_bf16 v[44:47], v[64:67], v[156:159], v[44:47]
  s_waitcnt vmcnt(16) lgkmcnt(4)
  v_mfma_f32_16x16x32_bf16 v[8:11], v[68:71], v[160:163], v[8:11]
  ds_read_b128 v[48:51], v1 offset:51200
  v_mfma_f32_16x16x32_bf16 v[28:31], v[68:71], v[164:167], v[28:31]
  ds_read_b128 v[52:55], v1 offset:52224
  s_waitcnt lgkmcnt(5)
  v_mfma_f32_16x16x32_bf16 v[12:15], v[72:75], v[160:163], v[12:15]
  ds_read_b128 v[56:59], v1 offset:53248
  v_lshlrev_b32 v7, 3, v0
  buffer_load_dwordx2 v[224:225], v7, s[4:7], s21 offen offset:1024 sc1
  buffer_load_dwordx2 v[226:227], v7, s[4:7], s21 offen offset:1536 sc1
  v_mfma_f32_16x16x32_bf16 v[32:35], v[72:75], v[164:167], v[32:35]
  ds_read_b128 v[60:63], v1 offset:54272
  s_waitcnt lgkmcnt(6)
  v_mfma_f32_16x16x32_bf16 v[16:19], v[76:79], v[160:163], v[16:19]
  ds_read_b128 v[64:67], v1 offset:55296
  v_mfma_f32_16x16x32_bf16 v[36:39], v[76:79], v[164:167], v[36:39]
  s_waitcnt lgkmcnt(6)
  v_mfma_f32_16x16x32_bf16 v[20:23], v[80:83], v[160:163], v[20:23]
  v_mfma_f32_16x16x32_bf16 v[40:43], v[80:83], v[164:167], v[40:43]
  v_lshlrev_b32 v7, 3, v0
  buffer_load_dwordx2 v[228:229], v7, s[4:7], s22 offen offset:1024 sc1
  buffer_load_dwordx2 v[230:231], v7, s[4:7], s22 offen offset:1536 sc1
  s_waitcnt lgkmcnt(5)
  v_mfma_f32_16x16x32_bf16 v[24:27], v[84:87], v[160:163], v[24:27]
  v_mfma_f32_16x16x32_bf16 v[44:47], v[84:87], v[164:167], v[44:47]
  s_waitcnt vmcnt(18) lgkmcnt(4)
  v_mfma_f32_16x16x32_bf16 v[8:11], v[48:51], v[168:171], v[8:11]
  ds_read_b128 v[68:71], v1 offset:56320
  v_mfma_f32_16x16x32_bf16 v[28:31], v[48:51], v[172:175], v[28:31]
  ds_read_b128 v[72:75], v1 offset:57344
  s_waitcnt lgkmcnt(5)
  v_mfma_f32_16x16x32_bf16 v[12:15], v[52:55], v[168:171], v[12:15]
  ds_read_b128 v[76:79], v1 offset:58368
  v_lshlrev_b32 v7, 3, v0
  buffer_load_dwordx2 v[232:233], v7, s[4:7], s21 offen offset:2048 sc1
  buffer_load_dwordx2 v[234:235], v7, s[4:7], s21 offen offset:2560 sc1
  v_mfma_f32_16x16x32_bf16 v[32:35], v[52:55], v[172:175], v[32:35]
  ds_read_b128 v[80:83], v1 offset:59392
  s_waitcnt lgkmcnt(6)
  v_mfma_f32_16x16x32_bf16 v[16:19], v[56:59], v[168:171], v[16:19]
  ds_read_b128 v[84:87], v1 offset:60416
  v_mfma_f32_16x16x32_bf16 v[36:39], v[56:59], v[172:175], v[36:39]
  s_waitcnt lgkmcnt(6)
  v_mfma_f32_16x16x32_bf16 v[20:23], v[60:63], v[168:171], v[20:23]
  v_mfma_f32_16x16x32_bf16 v[40:43], v[60:63], v[172:175], v[40:43]
  v_lshlrev_b32 v7, 3, v0
  buffer_load_dwordx2 v[236:237], v7, s[4:7], s22 offen offset:2048 sc1
  buffer_load_dwordx2 v[238:239], v7, s[4:7], s22 offen offset:2560 sc1
  s_waitcnt lgkmcnt(5)
  v_mfma_f32_16x16x32_bf16 v[24:27], v[64:67], v[168:171], v[24:27]
  v_mfma_f32_16x16x32_bf16 v[44:47], v[64:67], v[172:175], v[44:47]
  s_waitcnt vmcnt(20) lgkmcnt(4)
  v_mfma_f32_16x16x32_bf16 v[8:11], v[68:71], v[176:179], v[8:11]
  ds_read_b128 v[48:51], v1 offset:61440
  v_mfma_f32_16x16x32_bf16 v[28:31], v[68:71], v[180:183], v[28:31]
  ds_read_b128 v[52:55], v1 offset:62464
  s_waitcnt lgkmcnt(5)
  v_mfma_f32_16x16x32_bf16 v[12:15], v[72:75], v[176:179], v[12:15]
  ds_read_b128 v[56:59], v1 offset:63488
  v_lshlrev_b32 v7, 3, v0
  buffer_load_dwordx2 v[240:241], v7, s[4:7], s21 offen offset:3072 sc1
  buffer_load_dwordx2 v[242:243], v7, s[4:7], s21 offen offset:3584 sc1
  v_mfma_f32_16x16x32_bf16 v[32:35], v[72:75], v[180:183], v[32:35]
  ds_read_b128 v[60:63], v1 offset:64512
  s_waitcnt lgkmcnt(6)
  v_mfma_f32_16x16x32_bf16 v[16:19], v[76:79], v[176:179], v[16:19]
  ds_read_b128 v[64:67], v2 offset:0
  v_mfma_f32_16x16x32_bf16 v[36:39], v[76:79], v[180:183], v[36:39]
  s_waitcnt lgkmcnt(6)
  v_mfma_f32_16x16x32_bf16 v[20:23], v[80:83], v[176:179], v[20:23]
  v_mfma_f32_16x16x32_bf16 v[40:43], v[80:83], v[180:183], v[40:43]
  v_lshlrev_b32 v7, 3, v0
  buffer_load_dwordx2 v[244:245], v7, s[4:7], s22 offen offset:3072 sc1
  buffer_load_dwordx2 v[246:247], v7, s[4:7], s22 offen offset:3584 sc1
  s_waitcnt lgkmcnt(5)
  v_mfma_f32_16x16x32_bf16 v[24:27], v[84:87], v[176:179], v[24:27]
  v_mfma_f32_16x16x32_bf16 v[44:47], v[84:87], v[180:183], v[44:47]
  s_waitcnt vmcnt(22) lgkmcnt(4)
  v_mfma_f32_16x16x32_bf16 v[8:11], v[48:51], v[184:187], v[8:11]
  ds_read_b128 v[68:71], v2 offset:1024
  v_mfma_f32_16x16x32_bf16 v[28:31], v[48:51], v[188:191], v[28:31]
  ds_read_b128 v[72:75], v2 offset:2048
  s_waitcnt lgkmcnt(5)
  v_mfma_f32_16x16x32_bf16 v[12:15], v[52:55], v[184:187], v[12:15]
  ds_read_b128 v[76:79], v2 offset:3072
  s_mul_i32 s33, s10, 163840
  s_add_u32 s33, s33, s61
  s_add_u32 s33, s33, 0xe19000
  s_add_u32 m0, s61, 102400
  s_add_u32 s17, s33, 0
  buffer_load_dwordx4 v1, s[4:7], s17 offen lds
  v_mfma_f32_16x16x32_bf16 v[32:35], v[52:55], v[188:191], v[32:35]
  ds_read_b128 v[80:83], v2 offset:4096
  s_waitcnt lgkmcnt(6)
  v_mfma_f32_16x16x32_bf16 v[16:19], v[56:59], v[184:187], v[16:19]
  ds_read_b128 v[84:87], v2 offset:5120
  v_mfma_f32_16x16x32_bf16 v[36:39], v[56:59], v[188:191], v[36:39]
  s_waitcnt lgkmcnt(6)
  v_mfma_f32_16x16x32_bf16 v[20:23], v[60:63], v[184:187], v[20:23]
  v_mfma_f32_16x16x32_bf16 v[40:43], v[60:63], v[188:191], v[40:43]
  s_add_u32 m0, s61, 106496
  s_add_u32 s17, s33, 4096
  buffer_load_dwordx4 v1, s[4:7], s17 offen lds
  s_waitcnt lgkmcnt(5)
  v_mfma_f32_16x16x32_bf16 v[24:27], v[64:67], v[184:187], v[24:27]
  v_mfma_f32_16x16x32_bf16 v[44:47], v[64:67], v[188:191], v[44:47]
  s_waitcnt vmcnt(22) lgkmcnt(4)
  v_mfma_f32_16x16x32_bf16 v[8:11], v[68:71], v[192:195], v[8:11]
  ds_read_b128 v[48:51], v2 offset:6144
  v_mfma_f32_16x16x32_bf16 v[28:31], v[68:71], v[196:199], v[28:31]
  ds_read_b128 v[52:55], v2 offset:7168
  s_waitcnt lgkmcnt(5)
  v_mfma_f32_16x16x32_bf16 v[12:15], v[72:75], v[192:195], v[12:15]
  ds_read_b128 v[56:59], v2 offset:8192
  s_add_u32 m0, s61, 110592
  s_add_u32 s17, s33, 8192
  buffer_load_dwordx4 v1, s[4:7], s17 offen lds
  v_mfma_f32_16x16x32_bf16 v[32:35], v[72:75], v[196:199], v[32:35]
  ds_read_b128 v[60:63], v2 offset:9216
  s_waitcnt lgkmcnt(6)
  v_mfma_f32_16x16x32_bf16 v[16:19], v[76:79], v[192:195], v[16:19]
  ds_read_b128 v[64:67], v2 offset:10240
  v_mfma_f32_16x16x32_bf16 v[36:39], v[76:79], v[196:199], v[36:39]
  s_waitcnt lgkmcnt(6)
  v_mfma_f32_16x16x32_bf16 v[20:23], v[80:83], v[192:195], v[20:23]
  v_mfma_f32_16x16x32_bf16 v[40:43], v[80:83], v[196:199], v[40:43]
  s_add_u32 m0, s61, 114688
  s_add_u32 s17, s33, 12288
  buffer_load_dwordx4 v1, s[4:7], s17 offen lds
  s_waitcnt lgkmcnt(5)
  v_mfma_f32_16x16x32_bf16 v[24:27], v[84:87], v[192:195], v[24:27]
  v_mfma_f32_16x16x32_bf16 v[44:47], v[84:87], v[196:199], v[44:47]
  s_waitcnt vmcnt(22) lgkmcnt(4)
  v_mfma_f32_16x16x32_bf16 v[8:11], v[48:51], v[200:203], v[8:11]
  ds_read_b128 v[68:71], v2 offset:11264
  v_mfma_f32_16x16x32_bf16 v[28:31], v[48:51], v[204:207], v[28:31]
  ds_read_b128 v[72:75], v2 offset:12288
  s_waitcnt lgkmcnt(5)
  v_mfma_f32_16x16x32_bf16 v[12:15], v[52:55], v[200:203], v[12:15]
  ds_read_b128 v[76:79], v2 offset:13312
  s_add_u32 m0, s61, 118784
  s_add_u32 s17, s33, 16384
  buffer_load_dwordx4 v1, s[4:7], s17 offen lds
  v_mfma_f32_16x16x32_bf16 v[32:35], v[52:55], v[204:207], v[32:35]
  ds_read_b128 v[80:83], v2 offset:14336
  s_waitcnt lgkmcnt(6)
  v_mfma_f32_16x16x32_bf16 v[16:19], v[56:59], v[200:203], v[16:19]
  ds_read_b128 v[84:87], v2 offset:15360
  v_mfma_f32_16x16x32_bf16 v[36:39], v[56:59], v[204:207], v[36:39]
  s_waitcnt lgkmcnt(6)
  v_mfma_f32_16x16x32_bf16 v[20:23], v[60:63], v[200:203], v[20:23]
  v_mfma_f32_16x16x32_bf16 v[40:43], v[60:63], v[204:207], v[40:43]
  s_add_u32 m0, s61, 122880
  s_add_u32 s17, s33, 20480
  buffer_load_dwordx4 v1, s[4:7], s17 offen lds
  s_waitcnt lgkmcnt(5)
  v_mfma_f32_16x16x32_bf16 v[24:27], v[64:67], v[200:203], v[24:27]
  v_mfma_f32_16x16x32_bf16 v[44:47], v[64:67], v[204:207], v[44:47]
  s_waitcnt vmcnt(22) lgkmcnt(4)
  v_mfma_f32_16x16x32_bf16 v[8:11], v[68:71], v[208:211], v[8:11]
  ds_read_b128 v[48:51], v2 offset:16384
  v_mfma_f32_16x16x32_bf16 v[28:31], v[68:71], v[212:215], v[28:31]
  ds_read_b128 v[52:55], v2 offset:17408
  s_waitcnt lgkmcnt(5)
  v_mfma_f32_16x16x32_bf16 v[12:15], v[72:75], v[208:211], v[12:15]
  ds_read_b128 v[56:59], v2 offset:18432
  s_add_u32 m0, s61, 126976
  s_add_u32 s17, s33, 24576
  buffer_load_dwordx4 v1, s[4:7], s17 offen lds
  v_mfma_f32_16x16x32_bf16 v[32:35], v[72:75], v[212:215], v[32:35]
  ds_read_b128 v[60:63], v2 offset:19456
  s_waitcnt lgkmcnt(6)
  v_mfma_f32_16x16x32_bf16 v[16:19], v[76:79], v[208:211], v[16:19]
  ds_read_b128 v[64:67], v2 offset:20480
  v_mfma_f32_16x16x32_bf16 v[36:39], v[76:79], v[212:215], v[36:39]
  s_waitcnt lgkmcnt(6)
  v_mfma_f32_16x16x32_bf16 v[20:23], v[80:83], v[208:211], v[20:23]
  v_mfma_f32_16x16x32_bf16 v[40:43], v[80:83], v[212:215], v[40:43]
  s_add_u32 m0, s61, 131072
  s_add_u32 s17, s33, 28672
  buffer_load_dwordx4 v1, s[4:7], s17 offen lds
  s_waitcnt lgkmcnt(5)
  v_mfma_f32_16x16x32_bf16 v[24:27], v[84:87], v[208:211], v[24:27]
  v_mfma_f32_16x16x32_bf16 v[44:47], v[84:87], v[212:215], v[44:47]
  s_waitcnt vmcnt(20) lgkmcnt(4)
  v_mfma_f32_16x16x32_bf16 v[8:11], v[48:51], v[216:219], v[8:11]
  ds_read_b128 v[68:71], v2 offset:21504
  v_mfma_f32_16x16x32_bf16 v[28:31], v[48:51], v[220:223], v[28:31]
  ds_read_b128 v[72:75], v2 offset:22528
  s_waitcnt lgkmcnt(5)
  v_mfma_f32_16x16x32_bf16 v[12:15], v[52:55], v[216:219], v[12:15]
  ds_read_b128 v[76:79], v2 offset:23552
  s_add_u32 m0, s61, 135168
  s_add_u32 s17, s33, 32768
  buffer_load_dwordx4 v1, s[4:7], s17 offen lds
  v_mfma_f32_16x16x32_bf16 v[32:35], v[52:55], v[220:223], v[32:35]
  ds_read_b128 v[80:83], v2 offset:24576
  s_waitcnt lgkmcnt(6)
  v_mfma_f32_16x16x32_bf16 v[16:19], v[56:59], v[216:219], v[16:19]
  ds_read_b128 v[84:87], v2 offset:25600
  v_mfma_f32_16x16x32_bf16 v[36:39], v[56:59], v[220:223], v[36:39]
  s_waitcnt lgkmcnt(6)
  v_mfma_f32_16x16x32_bf16 v[20:23], v[60:63], v[216:219], v[20:23]
  v_mfma_f32_16x16x32_bf16 v[40:43], v[60:63], v[220:223], v[40:43]
  s_add_u32 m0, s61, 139264
  s_add_u32 s17, s33, 36864
  buffer_load_dwordx4 v1, s[4:7], s17 offen lds
  s_waitcnt lgkmcnt(5)
  v_mfma_f32_16x16x32_bf16 v[24:27], v[64:67], v[216:219], v[24:27]
  v_mfma_f32_16x16x32_bf16 v[44:47], v[64:67], v[220:223], v[44:47]
  s_waitcnt vmcnt(18) lgkmcnt(4)
  v_mfma_f32_16x16x32_bf16 v[8:11], v[68:71], v[224:227], v[8:11]
  ds_read_b128 v[48:51], v2 offset:26624
  v_mfma_f32_16x16x32_bf16 v[28:31], v[68:71], v[228:231], v[28:31]
  ds_read_b128 v[52:55], v2 offset:27648
  s_waitcnt lgkmcnt(5)
  v_mfma_f32_16x16x32_bf16 v[12:15], v[72:75], v[224:227], v[12:15]
  ds_read_b128 v[56:59], v2 offset:28672
  s_add_u32 m0, s61, 143360
  s_add_u32 s17, s33, 40960
  buffer_load_dwordx4 v1, s[4:7], s17 offen lds
  v_mfma_f32_16x16x32_bf16 v[32:35], v[72:75], v[228:231], v[32:35]
  ds_read_b128 v[60:63], v2 offset:29696
  s_waitcnt lgkmcnt(6)
  v_mfma_f32_16x16x32_bf16 v[16:19], v[76:79], v[224:227], v[16:19]
  ds_read_b128 v[64:67], v2 offset:30720
  v_mfma_f32_16x16x32_bf16 v[36:39], v[76:79], v[228:231], v[36:39]
  s_waitcnt lgkmcnt(6)
  v_mfma_f32_16x16x32_bf16 v[20:23], v[80:83], v[224:227], v[20:23]
  v_mfma_f32_16x16x32_bf16 v[40:43], v[80:83], v[228:231], v[40:43]
  s_add_u32 m0, s61, 147456
  s_add_u32 s17, s33, 45056
  buffer_load_dwordx4 v1, s[4:7], s17 offen lds
  s_waitcnt lgkmcnt(5)
  v_mfma_f32_16x16x32_bf16 v[24:27], v[84:87], v[224:227], v[24:27]
  v_mfma_f32_16x16x32_bf16 v[44:47], v[84:87], v[228:231], v[44:47]
  s_waitcnt vmcnt(16) lgkmcnt(4)
  v_mfma_f32_16x16x32_bf16 v[8:11], v[48:51], v[232:235], v[8:11]
  ds_read_b128 v[68:71], v2 offset:31744
  v_mfma_f32_16x16x32_bf16 v[28:31], v[48:51], v[236:239], v[28:31]
  ds_read_b128 v[72:75], v2 offset:32768
  s_waitcnt lgkmcnt(5)
  v_mfma_f32_16x16x32_bf16 v[12:15], v[52:55], v[232:235], v[12:15]
  ds_read_b128 v[76:79], v2 offset:33792
  s_add_u32 m0, s61, 151552
  s_add_u32 s17, s33, 49152
  buffer_load_dwordx4 v1, s[4:7], s17 offen lds
  v_mfma_f32_16x16x32_bf16 v[32:35], v[52:55], v[236:239], v[32:35]
  ds_read_b128 v[80:83], v2 offset:34816
  s_waitcnt lgkmcnt(6)
  v_mfma_f32_16x16x32_bf16 v[16:19], v[56:59], v[232:235], v[16:19]
  ds_read_b128 v[84:87], v2 offset:35840
  v_mfma_f32_16x16x32_bf16 v[36:39], v[56:59], v[236:239], v[36:39]
  s_waitcnt lgkmcnt(6)
  v_mfma_f32_16x16x32_bf16 v[20:23], v[60:63], v[232:235], v[20:23]
  v_mfma_f32_16x16x32_bf16 v[40:43], v[60:63], v[236:239], v[40:43]
  s_add_u32 m0, s61, 155648
  s_add_u32 s17, s33, 53248
  buffer_load_dwordx4 v1, s[4:7], s17 offen lds
  s_waitcnt lgkmcnt(5)
  v_mfma_f32_16x16x32_bf16 v[24:27], v[64:67], v[232:235], v[24:27]
  v_mfma_f32_16x16x32_bf16 v[44:47], v[64:67], v[236:239], v[44:47]
  s_waitcnt vmcnt(14) lgkmcnt(4)
  v_mfma_f32_16x16x32_bf16 v[8:11], v[68:71], v[240:243], v[8:11]
  v_mfma_f32_16x16x32_bf16 v[28:31], v[68:71], v[244:247], v[28:31]
  s_waitcnt lgkmcnt(3)
  v_mfma_f32_16x16x32_bf16 v[12:15], v[72:75], v[240:243], v[12:15]
  s_add_u32 m0, s61, 159744
  s_add_u32 s17, s33, 57344
  buffer_load_dwordx4 v1, s[4:7], s17 offen lds
  v_mfma_f32_16x16x32_bf16 v[32:35], v[72:75], v[244:247], v[32:35]
  s_waitcnt lgkmcnt(2)
  v_mfma_f32_16x16x32_bf16 v[16:19], v[76:79], v[240:243], v[16:19]
  v_mfma_f32_16x16x32_bf16 v[36:39], v[76:79], v[244:247], v[36:39]
  s_waitcnt lgkmcnt(1)
  v_mfma_f32_16x16x32_bf16 v[20:23], v[80:83], v[240:243], v[20:23]
  v_mfma_f32_16x16x32_bf16 v[40:43], v[80:83], v[244:247], v[40:43]
  s_waitcnt lgkmcnt(0)
  v_mfma_f32_16x16x32_bf16 v[24:27], v[84:87], v[240:243], v[24:27]
  v_mfma_f32_16x16x32_bf16 v[44:47], v[84:87], v[244:247], v[44:47]
  s_barrier
  v_lshrrev_b32 v68, 1, v5
  v_and_b32 v69, 1, v5
  s_lshl_b32 s17, s8, 5
  v_lshl_add_u32 v68, v68, 7, v4
  v_add_u32 v68, s17, v68
  v_mul_u32_u24 v68, 160, v68
  v_mul_u32_u24 v80, 48, v69
  v_add_u32 v80, v80, v68
  v_mul_u32_u24 v81, 24, v69
  v_add_u32 v81, v81, v68
  v_add_u32 v81, 96, v81
  v_mov_b32 v79, 0x3f80
  v_max3_f32 v68, v8, v9, v10
  v_max3_f32 v69, -v8, -v9, -v10
  v_max3_f32 v68, v68, v11, v12
  v_max3_f32 v69, v69, -v11, -v12
  v_max3_f32 v68, v68, v13, v14
  v_max3_f32 v69, v69, -v13, -v14
  v_max3_f32 v68, v68, v15, v16
  v_max3_f32 v69, v69, -v15, -v16
  v_max_f32 v68, v68, v17
  v_max_f32 v69, v69, -v17
  s_lshr_b32 s17, s2, 3
  s_and_b32 s17, s17, 31
  s_lshl_b32 s17, s17, 2
  s_add_u32 s17, s17, s8
  s_mul_i32 s17, s17, 6400
  s_add_u32 s17, s17, 0x1100000
  v_lshlrev_b32 v7, 7, v4
  buffer_load_dword v255, v7, s[4:7], s17 offen
  v_permlane16_swap_b32 v68, v69
  v_max_f32 v68, v68, v69
  v_mov_b32 v69, v68
  s_nop 1
  v_permlane16_swap_b32 v68, v69
  v_mul_f32 v70, v68, v248
  v_mul_f32 v72, v69, v248
  v_pk_fma_f32 v[48:49], v[8:9], v[248:249], v[70:71] op_sel_hi:[1,0,0] neg_lo:[0,0,1] neg_hi:[0,0,1]
  v_pk_fma_f32 v[58:59], v[8:9], v[248:249], v[72:73] op_sel_hi:[1,0,0] neg_lo:[1,0,1] neg_hi:[1,0,1]
  v_pk_fma_f32 v[50:51], v[10:11], v[248:249], v[70:71] op_sel_hi:[1,0,0] neg_lo:[0,0,1] neg_hi:[0,0,1]
  v_pk_fma_f32 v[60:61], v[10:11], v[248:249], v[72:73] op_sel_hi:[1,0,0] neg_lo:[1,0,1] neg_hi:[1,0,1]
  v_pk_fma_f32 v[52:53], v[12:13], v[248:249], v[70:71] op_sel_hi:[1,0,0] neg_lo:[0,0,1] neg_hi:[0,0,1]
  v_pk_fma_f32 v[62:63], v[12:13], v[248:249], v[72:73] op_sel_hi:[1,0,0] neg_lo:[1,0,1] neg_hi:[1,0,1]
  v_pk_fma_f32 v[54:55], v[14:15], v[248:249], v[70:71] op_sel_hi:[1,0,0] neg_lo:[0,0,1] neg_hi:[0,0,1]
  v_pk_fma_f32 v[64:65], v[14:15], v[248:249], v[72:73] op_sel_hi:[1,0,0] neg_lo:[1,0,1] neg_hi:[1,0,1]
  v_pk_fma_f32 v[56:57], v[16:17], v[248:249], v[70:71] op_sel_hi:[1,0,0] neg_lo:[0,0,1] neg_hi:[0,0,1]
  v_pk_fma_f32 v[66:67], v[16:17], v[248:249], v[72:73] op_sel_hi:[1,0,0] neg_lo:[1,0,1] neg_hi:[1,0,1]
  v_exp_f32 v48, v48
  v_exp_f32 v58, v58
  v_exp_f32 v49, v49
  v_exp_f32 v59, v59
  v_exp_f32 v50, v50
  v_exp_f32 v60, v60
  v_exp_f32 v51, v51
  v_exp_f32 v61, v61
  v_exp_f32 v52, v52
  v_exp_f32 v62, v62
  v_exp_f32 v53, v53
  v_exp_f32 v63, v63
  v_exp_f32 v54, v54
  v_exp_f32 v64, v64
  v_exp_f32 v55, v55
  v_exp_f32 v65, v65
  v_exp_f32 v56, v56
  v_exp_f32 v66, v66
  v_exp_f32 v57, v57
  v_exp_f32 v67, v67
  s_lshr_b32 s17, s2, 3
  s_and_b32 s17, s17, 31
  s_lshl_b32 s17, s17, 2
  s_add_u32 s17, s17, s8
  s_mul_i32 s17, s17, 6400
  s_add_u32 s17, s17, 0x1100800
  v_lshlrev_b32 v7, 7, v4
  buffer_load_dword v255, v7, s[4:7], s17 offen
  v_pk_add_f32 v[70:71], v[48:49], v[50:51]
  v_pk_add_f32 v[72:73], v[58:59], v[60:61]
  v_pk_add_f32 v[70:71], v[70:71], v[52:53]
  v_pk_add_f32 v[72:73], v[72:73], v[62:63]
  v_pk_add_f32 v[70:71], v[70:71], v[54:55]
  v_pk_add_f32 v[72:73], v[72:73], v[64:65]
  v_pk_add_f32 v[70:71], v[70:71], v[56:57]
  v_pk_add_f32 v[72:73], v[72:73], v[66:67]
  v_add_f32 v70, v70, v71
  v_add_f32 v72, v72, v73
  s_nop 1
  v_permlane16_swap_b32 v70, v72
  v_add_f32 v70, v70, v72
  v_mov_b32 v72, v70
  s_nop 1
  v_permlane16_swap_b32 v70, v72
  v_rcp_f32 v70, v70
  v_rcp_f32 v72, v72
  v_pk_mul_f32 v[48:49], v[48:49], v[70:71] op_sel_hi:[1,0]
  v_pk_mul_f32 v[58:59], v[58:59], v[72:73] op_sel_hi:[1,0]
  v_pk_mul_f32 v[50:51], v[50:51], v[70:71] op_sel_hi:[1,0]
  v_pk_mul_f32 v[60:61], v[60:61], v[72:73] op_sel_hi:[1,0]
  v_pk_mul_f32 v[52:53], v[52:53], v[70:71] op_sel_hi:[1,0]
  v_pk_mul_f32 v[62:63], v[62:63], v[72:73] op_sel_hi:[1,0]
  v_pk_mul_f32 v[54:55], v[54:55], v[70:71] op_sel_hi:[1,0]
  v_pk_mul_f32 v[64:65], v[64:65], v[72:73] op_sel_hi:[1,0]
  v_pk_mul_f32 v[56:57], v[56:57], v[70:71] op_sel_hi:[1,0]
  v_pk_mul_f32 v[66:67], v[66:67], v[72:73] op_sel_hi:[1,0]
  v_cvt_pk_bf16_f32 v48, v48, v49
  v_cvt_pk_bf16_f32 v49, v50, v51
  v_cvt_pk_bf16_f32 v50, v52, v53
  v_cvt_pk_bf16_f32 v51, v54, v55
  v_cvt_pk_bf16_f32 v52, v56, v57
  v_cvt_pk_bf16_f32 v53, v58, v59
  v_cvt_pk_bf16_f32 v54, v60, v61
  v_cvt_pk_bf16_f32 v55, v62, v63
  v_cvt_pk_bf16_f32 v56, v64, v65
  v_cvt_pk_bf16_f32 v57, v66, v67
  v_mov_b32 v58, 0
  v_mov_b32 v59, 0
  v_pk_mul_f32 v[18:19], v[18:19], v[250:251] op_sel_hi:[1,0]
  v_pk_mul_f32 v[20:21], v[20:21], v[250:251] op_sel_hi:[1,0]
  v_pk_mul_f32 v[22:23], v[22:23], v[250:251] op_sel_hi:[1,0]
  v_pk_mul_f32 v[24:25], v[24:25], v[250:251] op_sel_hi:[1,0]
  v_pk_mul_f32 v[26:27], v[26:27], v[250:251] op_sel_hi:[1,0]
  v_cvt_pk_bf16_f32 v74, v18, v19
  v_cvt_pk_bf16_f32 v75, v20, v21
  v_cvt_pk_bf16_f32 v76, v22, v23
  v_cvt_pk_bf16_f32 v77, v24, v25
  v_cvt_pk_bf16_f32 v78, v26, v27
  ds_write_b128 v80, v[48:51] offset:0
  ds_write_b128 v80, v[52:55] offset:16
  ds_write_b128 v80, v[56:59] offset:32
  ds_write_b64 v81, v[74:75] offset:0
  ds_write_b64 v81, v[76:77] offset:8
  ds_write_b64 v81, v[78:79] offset:16
  v_max3_f32 v68, v28, v29, v30
  v_max3_f32 v69, -v28, -v29, -v30
  v_max3_f32 v68, v68, v31, v32
  v_max3_f32 v69, v69, -v31, -v32
  v_max3_f32 v68, v68, v33, v34
  v_max3_f32 v69, v69, -v33, -v34
  v_max3_f32 v68, v68, v35, v36
  v_max3_f32 v69, v69, -v35, -v36
  v_max_f32 v68, v68, v37
  v_max_f32 v69, v69, -v37
  s_nop 1
  v_permlane16_swap_b32 v68, v69
  v_max_f32 v68, v68, v69
  v_mov_b32 v69, v68
  s_nop 1
  v_permlane16_swap_b32 v68, v69
  v_mul_f32 v70, v68, v252
  v_mul_f32 v72, v69, v252
  v_pk_fma_f32 v[48:49], v[28:29], v[252:253], v[70:71] op_sel_hi:[1,0,0] neg_lo:[0,0,1] neg_hi:[0,0,1]
  v_pk_fma_f32 v[58:59], v[28:29], v[252:253], v[72:73] op_sel_hi:[1,0,0] neg_lo:[1,0,1] neg_hi:[1,0,1]
  v_pk_fma_f32 v[50:51], v[30:31], v[252:253], v[70:71] op_sel_hi:[1,0,0] neg_lo:[0,0,1] neg_hi:[0,0,1]
  v_pk_fma_f32 v[60:61], v[30:31], v[252:253], v[72:73] op_sel_hi:[1,0,0] neg_lo:[1,0,1] neg_hi:[1,0,1]
  v_pk_fma_f32 v[52:53], v[32:33], v[252:253], v[70:71] op_sel_hi:[1,0,0] neg_lo:[0,0,1] neg_hi:[0,0,1]
  v_pk_fma_f32 v[62:63], v[32:33], v[252:253], v[72:73] op_sel_hi:[1,0,0] neg_lo:[1,0,1] neg_hi:[1,0,1]
  v_pk_fma_f32 v[54:55], v[34:35], v[252:253], v[70:71] op_sel_hi:[1,0,0] neg_lo:[0,0,1] neg_hi:[0,0,1]
  v_pk_fma_f32 v[64:65], v[34:35], v[252:253], v[72:73] op_sel_hi:[1,0,0] neg_lo:[1,0,1] neg_hi:[1,0,1]
  v_pk_fma_f32 v[56:57], v[36:37], v[252:253], v[70:71] op_sel_hi:[1,0,0] neg_lo:[0,0,1] neg_hi:[0,0,1]
  v_pk_fma_f32 v[66:67], v[36:37], v[252:253], v[72:73] op_sel_hi:[1,0,0] neg_lo:[1,0,1] neg_hi:[1,0,1]
  v_exp_f32 v48, v48
  v_exp_f32 v58, v58
  v_exp_f32 v49, v49
  v_exp_f32 v59, v59
  s_lshr_b32 s17, s2, 3
  s_and_b32 s17, s17, 31
  s_lshl_b32 s17, s17, 2
  s_add_u32 s17, s17, s8
  s_mul_i32 s17, s17, 6400
  s_add_u32 s17, s17, 0x1101000
  v_lshlrev_b32 v7, 7, v4
  buffer_load_dword v255, v7, s[4:7], s17 offen
  v_exp_f32 v50, v50
  v_exp_f32 v60, v60
  v_exp_f32 v51, v51
  v_exp_f32 v61, v61
  v_exp_f32 v52, v52
  v_exp_f32 v62, v62
  v_exp_f32 v53, v53
  v_exp_f32 v63, v63
  v_exp_f32 v54, v54
  v_exp_f32 v64, v64
  v_exp_f32 v55, v55
  v_exp_f32 v65, v65
  v_exp_f32 v56, v56
  v_exp_f32 v66, v66
  v_exp_f32 v57, v57
  v_exp_f32 v67, v67
  v_pk_add_f32 v[70:71], v[48:49], v[50:51]
  v_pk_add_f32 v[72:73], v[58:59], v[60:61]
  v_pk_add_f32 v[70:71], v[70:71], v[52:53]
  v_pk_add_f32 v[72:73], v[72:73], v[62:63]
  v_pk_add_f32 v[70:71], v[70:71], v[54:55]
  v_pk_add_f32 v[72:73], v[72:73], v[64:65]
  v_pk_add_f32 v[70:71], v[70:71], v[56:57]
  v_pk_add_f32 v[72:73], v[72:73], v[66:67]
  v_add_f32 v70, v70, v71
  v_add_f32 v72, v72, v73
  s_nop 1
  v_permlane16_swap_b32 v70, v72
  v_add_f32 v70, v70, v72
  v_mov_b32 v72, v70
  s_nop 1
  v_permlane16_swap_b32 v70, v72
  v_rcp_f32 v70, v70
  v_rcp_f32 v72, v72
  v_pk_mul_f32 v[48:49], v[48:49], v[70:71] op_sel_hi:[1,0]
  v_pk_mul_f32 v[58:59], v[58:59], v[72:73] op_sel_hi:[1,0]
  v_pk_mul_f32 v[50:51], v[50:51], v[70:71] op_sel_hi:[1,0]
  v_pk_mul_f32 v[60:61], v[60:61], v[72:73] op_sel_hi:[1,0]
  v_pk_mul_f32 v[52:53], v[52:53], v[70:71] op_sel_hi:[1,0]
  v_pk_mul_f32 v[62:63], v[62:63], v[72:73] op_sel_hi:[1,0]
  v_pk_mul_f32 v[54:55], v[54:55], v[70:71] op_sel_hi:[1,0]
  v_pk_mul_f32 v[64:65], v[64:65], v[72:73] op_sel_hi:[1,0]
  s_lshr_b32 s17, s2, 3
  s_and_b32 s17, s17, 31
  s_lshl_b32 s17, s17, 2
  s_add_u32 s17, s17, s8
  s_mul_i32 s17, s17, 6400
  s_add_u32 s17, s17, 0x1101800
  v_lshlrev_b32 v7, 7, v4
  buffer_load_dword v255, v7, s[4:7], s17 offen
  v_pk_mul_f32 v[56:57], v[56:57], v[70:71] op_sel_hi:[1,0]
  v_pk_mul_f32 v[66:67], v[66:67], v[72:73] op_sel_hi:[1,0]
  v_cvt_pk_bf16_f32 v48, v48, v49
  v_cvt_pk_bf16_f32 v49, v50, v51
  v_cvt_pk_bf16_f32 v50, v52, v53
  v_cvt_pk_bf16_f32 v51, v54, v55
  v_cvt_pk_bf16_f32 v52, v56, v57
  v_cvt_pk_bf16_f32 v53, v58, v59
  v_cvt_pk_bf16_f32 v54, v60, v61
  v_cvt_pk_bf16_f32 v55, v62, v63
  v_cvt_pk_bf16_f32 v56, v64, v65
  v_cvt_pk_bf16_f32 v57, v66, v67
  v_mov_b32 v58, 0
  v_mov_b32 v59, 0
  v_pk_mul_f32 v[38:39], v[38:39], v[254:255] op_sel_hi:[1,0]
  v_pk_mul_f32 v[40:41], v[40:41], v[254:255] op_sel_hi:[1,0]
  v_pk_mul_f32 v[42:43], v[42:43], v[254:255] op_sel_hi:[1,0]
  v_pk_mul_f32 v[44:45], v[44:45], v[254:255] op_sel_hi:[1,0]
  v_pk_mul_f32 v[46:47], v[46:47], v[254:255] op_sel_hi:[1,0]
  v_cvt_pk_bf16_f32 v74, v38, v39
  v_cvt_pk_bf16_f32 v75, v40, v41
  v_cvt_pk_bf16_f32 v76, v42, v43
  v_cvt_pk_bf16_f32 v77, v44, v45
  v_cvt_pk_bf16_f32 v78, v46, v47
  ds_write_b128 v80, v[48:51] offset:2560
  ds_write_b128 v80, v[52:55] offset:2576
  ds_write_b128 v80, v[56:59] offset:2592
  ds_write_b64 v81, v[74:75] offset:2560
  ds_write_b64 v81, v[76:77] offset:2568
  ds_write_b64 v81, v[78:79] offset:2576
  v_lshrrev_b32 v68, 2, v4
  v_lshl_add_u32 v68, v5, 2, v68
  s_lshr_b32 s17, s8, 1
  s_lshl_b32 s17, s17, 7
  v_add_u32 v68, s17, v68
  v_mul_u32_u24 v85, 160, v68
  v_and_b32 v69, 3, v4
  v_lshl_add_u32 v85, v69, 3, v85
  s_and_b32 s19, s8, 1
  s_lshl_b32 s17, s19, 5
  s_add_u32 s17, s17, 96
  v_add_u32 v84, s17, v85
  v_mov_b32 v69, 0x40000000
  v_lshlrev_b32 v86, 2, v0
  s_cmp_eq_u32 s19, 1
  s_cselect_b32 s18, 2, 4
  v_cmp_gt_u32 vcc, s18, v5
  s_nop 1
  v_cndmask_b32 v86, v69, v86, vcc
  s_sub_u32 s18, 2, s19
  v_cmp_ne_u32 vcc, s18, v5
  s_nop 1
  v_cndmask_b32 v87, v69, v86, vcc
  s_lshl_b32 s17, s10, 1
  s_lshr_b32 s3, s8, 1
  s_add_u32 s17, s17, s3
  s_mul_i32 s17, s17, 6144
  s_mul_i32 s3, s19, 3072
  s_add_u32 s17, s17, s3
  s_add_u32 s23, s17, s56
  s_waitcnt lgkmcnt(0)
  s_barrier
  ds_read_b64_tr_b16 v[20:21], v84 offset:0
  ds_read_b64_tr_b16 v[22:23], v84 offset:2560
  ds_read_b64_tr_b16 v[36:37], v85 offset:0
  ds_read_b64_tr_b16 v[38:39], v85 offset:2560
  ds_read_b64_tr_b16 v[40:41], v85 offset:32
  ds_read_b64_tr_b16 v[42:43], v85 offset:2592
  ds_read_b64_tr_b16 v[44:45], v85 offset:64
  ds_read_b64_tr_b16 v[46:47], v85 offset:2624
  ds_read_b64_tr_b16 v[24:25], v84 offset:5120
  ds_read_b64_tr_b16 v[26:27], v84 offset:7680
  ds_read_b64_tr_b16 v[48:49], v85 offset:5120
  ds_read_b64_tr_b16 v[50:51], v85 offset:7680
  ds_read_b64_tr_b16 v[52:53], v85 offset:5152
  ds_read_b64_tr_b16 v[54:55], v85 offset:7712
  ds_read_b64_tr_b16 v[56:57], v85 offset:5184
  ds_read_b64_tr_b16 v[58:59], v85 offset:7744
  ds_read_b64_tr_b16 v[28:29], v84 offset:10240
  ds_read_b64_tr_b16 v[30:31], v84 offset:12800
  ds_read_b64_tr_b16 v[60:61], v85 offset:10240
  ds_read_b64_tr_b16 v[62:63], v85 offset:12800
  ds_read_b64_tr_b16 v[64:65], v85 offset:10272
  ds_read_b64_tr_b16 v[66:67], v85 offset:12832
  ds_read_b64_tr_b16 v[68:69], v85 offset:10304
  ds_read_b64_tr_b16 v[70:71], v85 offset:12864
  ds_read_b64_tr_b16 v[32:33], v84 offset:15360
  ds_read_b64_tr_b16 v[34:35], v84 offset:17920
  ds_read_b64_tr_b16 v[72:73], v85 offset:15360
  ds_read_b64_tr_b16 v[74:75], v85 offset:17920
  ds_read_b64_tr_b16 v[76:77], v85 offset:15392
  ds_read_b64_tr_b16 v[78:79], v85 offset:17952
  ds_read_b64_tr_b16 v[80:81], v85 offset:15424
  ds_read_b64_tr_b16 v[82:83], v85 offset:17984
  s_waitcnt lgkmcnt(15)
  v_mfma_f32_16x16x32_bf16 v[8:11], v[20:23], v[36:39], 0
  v_mfma_f32_16x16x32_bf16 v[12:15], v[20:23], v[40:43], 0
  v_mfma_f32_16x16x32_bf16 v[16:19], v[20:23], v[44:47], 0
  s_waitcnt lgkmcnt(15)
  v_mfma_f32_16x16x32_bf16 v[8:11], v[24:27], v[48:51], v[8:11]
  v_mfma_f32_16x16x32_bf16 v[12:15], v[24:27], v[52:55], v[12:15]
  v_mfma_f32_16x16x32_bf16 v[16:19], v[24:27], v[56:59], v[16:19]
  s_waitcnt lgkmcnt(8)
  v_mfma_f32_16x16x32_bf16 v[8:11], v[28:31], v[60:63], v[8:11]
  v_mfma_f32_16x16x32_bf16 v[12:15], v[28:31], v[64:67], v[12:15]
  v_mfma_f32_16x16x32_bf16 v[16:19], v[28:31], v[68:71], v[16:19]
  s_waitcnt lgkmcnt(0)
  v_mfma_f32_16x16x32_bf16 v[8:11], v[32:35], v[72:75], v[8:11]
  v_mfma_f32_16x16x32_bf16 v[12:15], v[32:35], v[76:79], v[12:15]
  v_mfma_f32_16x16x32_bf16 v[16:19], v[32:35], v[80:83], v[16:19]
  s_nop 5
  buffer_atomic_add_f32 v8, v86, s[4:7], s23 offen offset:0
  buffer_atomic_add_f32 v9, v86, s[4:7], s23 offen offset:256
  buffer_atomic_add_f32 v10, v86, s[4:7], s23 offen offset:512
  buffer_atomic_add_f32 v11, v87, s[4:7], s23 offen offset:768
  buffer_atomic_add_f32 v12, v86, s[4:7], s23 offen offset:1024
  buffer_atomic_add_f32 v13, v86, s[4:7], s23 offen offset:1280
  buffer_atomic_add_f32 v14, v86, s[4:7], s23 offen offset:1536
  buffer_atomic_add_f32 v15, v87, s[4:7], s23 offen offset:1792
  buffer_atomic_add_f32 v16, v86, s[4:7], s23 offen offset:2048
  buffer_atomic_add_f32 v17, v86, s[4:7], s23 offen offset:2304
  buffer_atomic_add_f32 v18, v86, s[4:7], s23 offen offset:2560
  buffer_atomic_add_f32 v19, v87, s[4:7], s23 offen offset:2816
  v_lshlrev_b32 v7, 4, v5
  s_lshl_b32 s17, s2, 9
  s_add_u32 s17, s17, 0xdb0140
  buffer_load_dwordx4 v[8:11], v7, s[4:7], s17 offen offset:0 sc1
  buffer_load_dwordx4 v[12:15], v7, s[4:7], s17 offen offset:64 sc1
  buffer_load_dwordx4 v[16:19], v7, s[4:7], s17 offen offset:128 sc1
  s_waitcnt vmcnt(19)
  s_barrier
  ds_read_b128 v[44:47], v2 offset:36864
  ds_read_b128 v[48:51], v2 offset:37888
  ds_read_b128 v[52:55], v2 offset:38912
  ds_read_b128 v[56:59], v2 offset:39936
  ds_read_b128 v[60:63], v2 offset:40960
  ds_read_b128 v[64:67], v2 offset:41984
  s_waitcnt lgkmcnt(5)
  v_mfma_f32_16x16x32_bf16 v[20:23], v[44:47], v[88:91], 0
  ds_read_b128 v[68:71], v2 offset:43008
  v_mfma_f32_16x16x32_bf16 v[32:35], v[44:47], v[92:95], 0
  ds_read_b128 v[72:75], v2 offset:44032
  s_waitcnt lgkmcnt(6)
  v_mfma_f32_16x16x32_bf16 v[24:27], v[48:51], v[88:91], 0
  ds_read_b128 v[76:79], v2 offset:45056
  s_lshr_b32 s17, s2, 3
  s_and_b32 s17, s17, 31
  s_lshl_b32 s17, s17, 2
  s_add_u32 s17, s17, s8
  s_mul_i32 s17, s17, 8960
  s_add_u32 s17, s17, 0x1200000
  s_lshr_b32 s18, s10, 3
  s_mul_i32 s18, s18, 1146880
  s_add_u32 s17, s17, s18
  v_lshlrev_b32 v7, 7, v4
  buffer_load_dword v255, v7, s[4:7], s17 offen
  v_mfma_f32_16x16x32_bf16 v[36:39], v[48:51], v[92:95], 0
  s_waitcnt lgkmcnt(6)
  v_mfma_f32_16x16x32_bf16 v[28:31], v[52:55], v[88:91], 0
  v_mfma_f32_16x16x32_bf16 v[40:43], v[52:55], v[92:95], 0
  s_waitcnt lgkmcnt(5)
  v_mfma_f32_16x16x32_bf16 v[20:23], v[56:59], v[96:99], v[20:23]
  ds_read_b128 v[44:47], v2 offset:46080
  v_mfma_f32_16x16x32_bf16 v[32:35], v[56:59], v[100:103], v[32:35]
  ds_read_b128 v[48:51], v2 offset:47104
  s_waitcnt lgkmcnt(6)
  v_mfma_f32_16x16x32_bf16 v[24:27], v[60:63], v[96:99], v[24:27]
  ds_read_b128 v[52:55], v2 offset:48128
  v_mfma_f32_16x16x32_bf16 v[36:39], v[60:63], v[100:103], v[36:39]
  s_waitcnt lgkmcnt(6)
  v_mfma_f32_16x16x32_bf16 v[28:31], v[64:67], v[96:99], v[28:31]
  v_mfma_f32_16x16x32_bf16 v[40:43], v[64:67], v[100:103], v[40:43]
  s_waitcnt lgkmcnt(5)
  v_mfma_f32_16x16x32_bf16 v[20:23], v[68:71], v[104:107], v[20:23]
  ds_read_b128 v[56:59], v2 offset:49152
  v_mfma_f32_16x16x32_bf16 v[32:35], v[68:71], v[108:111], v[32:35]
  ds_read_b128 v[60:63], v2 offset:50176
  s_waitcnt lgkmcnt(6)
  v_mfma_f32_16x16x32_bf16 v[24:27], v[72:75], v[104:107], v[24:27]
  ds_read_b128 v[64:67], v2 offset:51200
  v_mfma_f32_16x16x32_bf16 v[36:39], v[72:75], v[108:111], v[36:39]
  s_waitcnt lgkmcnt(6)
  v_mfma_f32_16x16x32_bf16 v[28:31], v[76:79], v[104:107], v[28:31]
  v_mfma_f32_16x16x32_bf16 v[40:43], v[76:79], v[108:111], v[40:43]
  s_waitcnt lgkmcnt(5)
  v_mfma_f32_16x16x32_bf16 v[20:23], v[44:47], v[112:115], v[20:23]
  ds_read_b128 v[68:71], v2 offset:52224
  v_mfma_f32_16x16x32_bf16 v[32:35], v[44:47], v[116:119], v[32:35]
  ds_read_b128 v[72:75], v2 offset:53248
  s_waitcnt lgkmcnt(6)
  v_mfma_f32_16x16x32_bf16 v[24:27], v[48:51], v[112:115], v[24:27]
  ds_read_b128 v[76:79], v2 offset:54272
  v_mfma_f32_16x16x32_bf16 v[36:39], v[48:51], v[116:119], v[36:39]
  s_waitcnt lgkmcnt(6)
  v_mfma_f32_16x16x32_bf16 v[28:31], v[52:55], v[112:115], v[28:31]
  v_mfma_f32_16x16x32_bf16 v[40:43], v[52:55], v[116:119], v[40:43]
  s_waitcnt lgkmcnt(5)
  v_mfma_f32_16x16x32_bf16 v[20:23], v[56:59], v[120:123], v[20:23]
  ds_read_b128 v[44:47], v2 offset:55296
  v_mfma_f32_16x16x32_bf16 v[32:35], v[56:59], v[124:127], v[32:35]
  ds_read_b128 v[48:51], v2 offset:56320
  s_waitcnt lgkmcnt(6)
  v_mfma_f32_16x16x32_bf16 v[24:27], v[60:63], v[120:123], v[24:27]
  ds_read_b128 v[52:55], v2 offset:57344
  v_mfma_f32_16x16x32_bf16 v[36:39], v[60:63], v[124:127], v[36:39]
  s_waitcnt lgkmcnt(6)
  v_mfma_f32_16x16x32_bf16 v[28:31], v[64:67], v[120:123], v[28:31]
  v_mfma_f32_16x16x32_bf16 v[40:43], v[64:67], v[124:127], v[40:43]
  s_waitcnt lgkmcnt(5)
  v_mfma_f32_16x16x32_bf16 v[20:23], v[68:71], v[128:131], v[20:23]
  ds_read_b128 v[56:59], v2 offset:58368
  v_mfma_f32_16x16x32_bf16 v[32:35], v[68:71], v[132:135], v[32:35]
  ds_read_b128 v[60:63], v2 offset:59392
  s_waitcnt lgkmcnt(6)
  v_mfma_f32_16x16x32_bf16 v[24:27], v[72:75], v[128:131], v[24:27]
  ds_read_b128 v[64:67], v2 offset:60416
  v_mfma_f32_16x16x32_bf16 v[36:39], v[72:75], v[132:135], v[36:39]
  s_waitcnt lgkmcnt(6)
  v_mfma_f32_16x16x32_bf16 v[28:31], v[76:79], v[128:131], v[28:31]
  v_mfma_f32_16x16x32_bf16 v[40:43], v[76:79], v[132:135], v[40:43]
  s_waitcnt lgkmcnt(5)
  v_mfma_f32_16x16x32_bf16 v[20:23], v[44:47], v[136:139], v[20:23]
  ds_read_b128 v[68:71], v2 offset:61440
  v_mfma_f32_16x16x32_bf16 v[32:35], v[44:47], v[140:143], v[32:35]
  ds_read_b128 v[72:75], v2 offset:62464
  s_waitcnt lgkmcnt(6)
  v_mfma_f32_16x16x32_bf16 v[24:27], v[48:51], v[136:139], v[24:27]
  ds_read_b128 v[76:79], v2 offset:63488
  s_lshr_b32 s17, s2, 3
  s_and_b32 s17, s17, 31
  s_lshl_b32 s17, s17, 2
  s_add_u32 s17, s17, s8
  s_mul_i32 s17, s17, 8960
  s_add_u32 s17, s17, 0x1200800
  s_lshr_b32 s18, s10, 3
  s_mul_i32 s18, s18, 1146880
  s_add_u32 s17, s17, s18
  v_lshlrev_b32 v7, 7, v4
  buffer_load_dword v255, v7, s[4:7], s17 offen
  v_mfma_f32_16x16x32_bf16 v[36:39], v[48:51], v[140:143], v[36:39]
  s_waitcnt lgkmcnt(6)
  v_mfma_f32_16x16x32_bf16 v[28:31], v[52:55], v[136:139], v[28:31]
  v_mfma_f32_16x16x32_bf16 v[40:43], v[52:55], v[140:143], v[40:43]
  s_waitcnt lgkmcnt(5)
  v_mfma_f32_16x16x32_bf16 v[20:23], v[56:59], v[144:147], v[20:23]
  ds_read_b128 v[44:47], v2 offset:64512
  v_mfma_f32_16x16x32_bf16 v[32:35], v[56:59], v[148:151], v[32:35]
  ds_read_b128 v[48:51], v3 offset:0
  s_waitcnt lgkmcnt(6)
  v_mfma_f32_16x16x32_bf16 v[24:27], v[60:63], v[144:147], v[24:27]
  ds_read_b128 v[52:55], v3 offset:1024
  v_mfma_f32_16x16x32_bf16 v[36:39], v[60:63], v[148:151], v[36:39]
  s_waitcnt lgkmcnt(6)
  v_mfma_f32_16x16x32_bf16 v[28:31], v[64:67], v[144:147], v[28:31]
  v_mfma_f32_16x16x32_bf16 v[40:43], v[64:67], v[148:151], v[40:43]
  s_waitcnt lgkmcnt(5)
  v_mfma_f32_16x16x32_bf16 v[20:23], v[68:71], v[152:155], v[20:23]
  ds_read_b128 v[56:59], v3 offset:2048
  v_mfma_f32_16x16x32_bf16 v[32:35], v[68:71], v[156:159], v[32:35]
  ds_read_b128 v[60:63], v3 offset:3072
  s_waitcnt lgkmcnt(6)
  v_mfma_f32_16x16x32_bf16 v[24:27], v[72:75], v[152:155], v[24:27]
  ds_read_b128 v[64:67], v3 offset:4096
  v_mfma_f32_16x16x32_bf16 v[36:39], v[72:75], v[156:159], v[36:39]
  s_waitcnt lgkmcnt(6)
  v_mfma_f32_16x16x32_bf16 v[28:31], v[76:79], v[152:155], v[28:31]
  v_mfma_f32_16x16x32_bf16 v[40:43], v[76:79], v[156:159], v[40:43]
  s_waitcnt lgkmcnt(5)
  v_mfma_f32_16x16x32_bf16 v[20:23], v[44:47], v[160:163], v[20:23]
  ds_read_b128 v[68:71], v3 offset:5120
  v_mfma_f32_16x16x32_bf16 v[32:35], v[44:47], v[164:167], v[32:35]
  ds_read_b128 v[72:75], v3 offset:6144
  s_waitcnt lgkmcnt(6)
  v_mfma_f32_16x16x32_bf16 v[24:27], v[48:51], v[160:163], v[24:27]
  ds_read_b128 v[76:79], v3 offset:7168
  v_mfma_f32_16x16x32_bf16 v[36:39], v[48:51], v[164:167], v[36:39]
  s_waitcnt lgkmcnt(6)
  v_mfma_f32_16x16x32_bf16 v[28:31], v[52:55], v[160:163], v[28:31]
  v_mfma_f32_16x16x32_bf16 v[40:43], v[52:55], v[164:167], v[40:43]
  s_waitcnt lgkmcnt(5)
  v_mfma_f32_16x16x32_bf16 v[20:23], v[56:59], v[168:171], v[20:23]
  ds_read_b128 v[44:47], v3 offset:8192
  v_mfma_f32_16x16x32_bf16 v[32:35], v[56:59], v[172:175], v[32:35]
  ds_read_b128 v[48:51], v3 offset:9216
  s_waitcnt lgkmcnt(6)
  v_mfma_f32_16x16x32_bf16 v[24:27], v[60:63], v[168:171], v[24:27]
  ds_read_b128 v[52:55], v3 offset:10240
  v_mfma_f32_16x16x32_bf16 v[36:39], v[60:63], v[172:175], v[36:39]
  s_waitcnt lgkmcnt(6)
  v_mfma_f32_16x16x32_bf16 v[28:31], v[64:67], v[168:171], v[28:31]
  v_mfma_f32_16x16x32_bf16 v[40:43], v[64:67], v[172:175], v[40:43]
  s_waitcnt lgkmcnt(5)
  v_mfma_f32_16x16x32_bf16 v[20:23], v[68:71], v[176:179], v[20:23]
  ds_read_b128 v[56:59], v3 offset:11264
  v_mfma_f32_16x16x32_bf16 v[32:35], v[68:71], v[180:183], v[32:35]
  ds_read_b128 v[60:63], v3 offset:12288
  s_waitcnt lgkmcnt(6)
  v_mfma_f32_16x16x32_bf16 v[24:27], v[72:75], v[176:179], v[24:27]
  ds_read_b128 v[64:67], v3 offset:13312
  v_mfma_f32_16x16x32_bf16 v[36:39], v[72:75], v[180:183], v[36:39]
  s_waitcnt lgkmcnt(6)
  v_mfma_f32_16x16x32_bf16 v[28:31], v[76:79], v[176:179], v[28:31]
  v_mfma_f32_16x16x32_bf16 v[40:43], v[76:79], v[180:183], v[40:43]
  s_waitcnt lgkmcnt(5)
  v_mfma_f32_16x16x32_bf16 v[20:23], v[44:47], v[184:187], v[20:23]
  ds_read_b128 v[68:71], v3 offset:14336
  v_mfma_f32_16x16x32_bf16 v[32:35], v[44:47], v[188:191], v[32:35]
  ds_read_b128 v[72:75], v3 offset:15360
  s_waitcnt lgkmcnt(6)
  v_mfma_f32_16x16x32_bf16 v[24:27], v[48:51], v[184:187], v[24:27]
  ds_read_b128 v[76:79], v3 offset:16384
  s_lshr_b32 s17, s2, 3
  s_and_b32 s17, s17, 31
  s_lshl_b32 s17, s17, 2
  s_add_u32 s17, s17, s8
  s_mul_i32 s17, s17, 8960
  s_add_u32 s17, s17, 0x1201000
  s_lshr_b32 s18, s10, 3
  s_mul_i32 s18, s18, 1146880
  s_add_u32 s17, s17, s18
  v_lshlrev_b32 v7, 7, v4
  buffer_load_dword v255, v7, s[4:7], s17 offen
  v_mfma_f32_16x16x32_bf16 v[36:39], v[48:51], v[188:191], v[36:39]
  s_waitcnt lgkmcnt(6)
  v_mfma_f32_16x16x32_bf16 v[28:31], v[52:55], v[184:187], v[28:31]
  v_mfma_f32_16x16x32_bf16 v[40:43], v[52:55], v[188:191], v[40:43]
  s_waitcnt lgkmcnt(5)
  v_mfma_f32_16x16x32_bf16 v[20:23], v[56:59], v[192:195], v[20:23]
  ds_read_b128 v[44:47], v3 offset:17408
  v_mfma_f32_16x16x32_bf16 v[32:35], v[56:59], v[196:199], v[32:35]
  ds_read_b128 v[48:51], v3 offset:18432
  s_waitcnt lgkmcnt(6)
  v_mfma_f32_16x16x32_bf16 v[24:27], v[60:63], v[192:195], v[24:27]
  ds_read_b128 v[52:55], v3 offset:19456
  v_mfma_f32_16x16x32_bf16 v[36:39], v[60:63], v[196:199], v[36:39]
  s_waitcnt lgkmcnt(6)
  v_mfma_f32_16x16x32_bf16 v[28:31], v[64:67], v[192:195], v[28:31]
  v_mfma_f32_16x16x32_bf16 v[40:43], v[64:67], v[196:199], v[40:43]
  s_waitcnt lgkmcnt(5)
  v_mfma_f32_16x16x32_bf16 v[20:23], v[68:71], v[200:203], v[20:23]
  ds_read_b128 v[56:59], v3 offset:20480
  v_mfma_f32_16x16x32_bf16 v[32:35], v[68:71], v[204:207], v[32:35]
  ds_read_b128 v[60:63], v3 offset:21504
  s_waitcnt lgkmcnt(6)
  v_mfma_f32_16x16x32_bf16 v[24:27], v[72:75], v[200:203], v[24:27]
  ds_read_b128 v[64:67], v3 offset:22528
  v_mfma_f32_16x16x32_bf16 v[36:39], v[72:75], v[204:207], v[36:39]
  s_waitcnt lgkmcnt(6)
  v_mfma_f32_16x16x32_bf16 v[28:31], v[76:79], v[200:203], v[28:31]
  v_mfma_f32_16x16x32_bf16 v[40:43], v[76:79], v[204:207], v[40:43]
  s_waitcnt lgkmcnt(5)
  v_mfma_f32_16x16x32_bf16 v[20:23], v[44:47], v[208:211], v[20:23]
  ds_read_b128 v[68:71], v3 offset:23552
  v_mfma_f32_16x16x32_bf16 v[32:35], v[44:47], v[212:215], v[32:35]
  ds_read_b128 v[72:75], v3 offset:24576
  s_waitcnt lgkmcnt(6)
  v_mfma_f32_16x16x32_bf16 v[24:27], v[48:51], v[208:211], v[24:27]
  ds_read_b128 v[76:79], v3 offset:25600
  v_mfma_f32_16x16x32_bf16 v[36:39], v[48:51], v[212:215], v[36:39]
  s_waitcnt lgkmcnt(6)
  v_mfma_f32_16x16x32_bf16 v[28:31], v[52:55], v[208:211], v[28:31]
  v_mfma_f32_16x16x32_bf16 v[40:43], v[52:55], v[212:215], v[40:43]
  s_waitcnt lgkmcnt(5)
  v_mfma_f32_16x16x32_bf16 v[20:23], v[56:59], v[216:219], v[20:23]
  ds_read_b128 v[44:47], v3 offset:26624
  v_mfma_f32_16x16x32_bf16 v[32:35], v[56:59], v[220:223], v[32:35]
  ds_read_b128 v[48:51], v3 offset:27648
  s_waitcnt lgkmcnt(6)
  v_mfma_f32_16x16x32_bf16 v[24:27], v[60:63], v[216:219], v[24:27]
  ds_read_b128 v[52:55], v3 offset:28672
  v_mfma_f32_16x16x32_bf16 v[36:39], v[60:63], v[220:223], v[36:39]
  s_waitcnt lgkmcnt(6)
  v_mfma_f32_16x16x32_bf16 v[28:31], v[64:67], v[216:219], v[28:31]
  v_mfma_f32_16x16x32_bf16 v[40:43], v[64:67], v[220:223], v[40:43]
  s_waitcnt lgkmcnt(5)
  v_mfma_f32_16x16x32_bf16 v[20:23], v[68:71], v[224:227], v[20:23]
  ds_read_b128 v[56:59], v3 offset:29696
  v_mfma_f32_16x16x32_bf16 v[32:35], v[68:71], v[228:231], v[32:35]
  ds_read_b128 v[60:63], v3 offset:30720
  s_waitcnt lgkmcnt(6)
  v_mfma_f32_16x16x32_bf16 v[24:27], v[72:75], v[224:227], v[24:27]
  ds_read_b128 v[64:67], v3 offset:31744
  v_mfma_f32_16x16x32_bf16 v[36:39], v[72:75], v[228:231], v[36:39]
  s_waitcnt lgkmcnt(6)
  v_mfma_f32_16x16x32_bf16 v[28:31], v[76:79], v[224:227], v[28:31]
  v_mfma_f32_16x16x32_bf16 v[40:43], v[76:79], v[228:231], v[40:43]
  s_waitcnt lgkmcnt(5)
  v_mfma_f32_16x16x32_bf16 v[20:23], v[44:47], v[232:235], v[20:23]
  v_mfma_f32_16x16x32_bf16 v[32:35], v[44:47], v[236:239], v[32:35]
  s_waitcnt lgkmcnt(4)
  v_mfma_f32_16x16x32_bf16 v[24:27], v[48:51], v[232:235], v[24:27]
  s_lshr_b32 s17, s2, 3
  s_and_b32 s17, s17, 31
  s_lshl_b32 s17, s17, 2
  s_add_u32 s17, s17, s8
  s_mul_i32 s17, s17, 8960
  s_add_u32 s17, s17, 0x1201800
  s_lshr_b32 s18, s10, 3
  s_mul_i32 s18, s18, 1146880
  s_add_u32 s17, s17, s18
  v_lshlrev_b32 v7, 7, v4
  buffer_load_dword v255, v7, s[4:7], s17 offen
  v_mfma_f32_16x16x32_bf16 v[36:39], v[48:51], v[236:239], v[36:39]
  s_waitcnt lgkmcnt(3)
  v_mfma_f32_16x16x32_bf16 v[28:31], v[52:55], v[232:235], v[28:31]
  v_mfma_f32_16x16x32_bf16 v[40:43], v[52:55], v[236:239], v[40:43]
  s_waitcnt lgkmcnt(2)
  v_mfma_f32_16x16x32_bf16 v[20:23], v[56:59], v[240:243], v[20:23]
  v_mfma_f32_16x16x32_bf16 v[32:35], v[56:59], v[244:247], v[32:35]
  s_waitcnt lgkmcnt(1)
  v_mfma_f32_16x16x32_bf16 v[24:27], v[60:63], v[240:243], v[24:27]
  v_mfma_f32_16x16x32_bf16 v[36:39], v[60:63], v[244:247], v[36:39]
  s_waitcnt lgkmcnt(0)
  v_mfma_f32_16x16x32_bf16 v[28:31], v[64:67], v[240:243], v[28:31]
  v_mfma_f32_16x16x32_bf16 v[40:43], v[64:67], v[244:247], v[40:43]
  s_waitcnt vmcnt(7)
  s_barrier
  s_cmp_lg_u32 s8, 0
  s_cbranch_scc1 sig_45
  s_lshl_b32 s17, s10, 7
  s_add_u32 s17, s17, s57
  s_add_u32 s17, s17, 0
  s_mov_b64 exec, 1
  v_mov_b32 v7, 1
  buffer_atomic_add v7, off, s[4:7], s17
  s_mov_b64 exec, -1
sig_45:
  s_waitcnt vmcnt(4)
  v_mov_b32 v146, 0
  v_mov_b32 v147, 0
  v_mov_b32 v158, 0
  v_mov_b32 v159, 0
  s_lshr_b32 s17, s2, 3
  s_and_b32 s17, s17, 31
  s_lshl_b32 s17, s17, 2
  s_add_u32 s17, s17, s8
  s_mul_i32 s17, s17, 8960
  s_add_u32 s17, s17, 0x1202000
  s_lshr_b32 s18, s10, 3
  s_mul_i32 s18, s18, 1146880
  s_add_u32 s17, s17, s18
  v_lshlrev_b32 v7, 7, v4
  buffer_load_dword v255, v7, s[4:7], s17 offen
  v_pk_fma_f32 v[20:21], v[8:9], v[248:249], v[20:21] op_sel:[0,1,0] op_sel_hi:[1,1,1]
  v_pk_fma_f32 v[22:23], v[10:11], v[248:249], v[22:23] op_sel:[0,1,0] op_sel_hi:[1,1,1]
  v_pk_fma_f32 v[24:25], v[12:13], v[248:249], v[24:25] op_sel:[0,1,0] op_sel_hi:[1,1,1]
  v_pk_fma_f32 v[26:27], v[14:15], v[248:249], v[26:27] op_sel:[0,1,0] op_sel_hi:[1,1,1]
  v_pk_fma_f32 v[28:29], v[16:17], v[248:249], v[28:29] op_sel:[0,1,0] op_sel_hi:[1,1,1]
  v_max3_f32 v108, v20, v21, v22
  v_max3_f32 v109, -v20, -v21, -v22
  v_max3_f32 v108, v108, v23, v24
  v_max3_f32 v109, v109, -v23, -v24
  v_max3_f32 v108, v108, v25, v26
  v_max3_f32 v109, v109, -v25, -v26
  v_max3_f32 v108, v108, v27, v28
  v_max3_f32 v109, v109, -v27, -v28
  v_max_f32 v108, v108, v29
  v_max_f32 v109, v109, -v29
  s_nop 1
  v_permlane16_swap_b32 v108, v109
  v_max_f32 v108, v108, v109
  v_mov_b32 v109, v108
  s_nop 1
  v_permlane16_swap_b32 v108, v109
  v_mul_f32 v110, v108, v248
  v_mul_f32 v112, v109, v248
  v_pk_fma_f32 v[88:89], v[20:21], v[248:249], v[110:111] op_sel_hi:[1,0,0] neg_lo:[0,0,1] neg_hi:[0,0,1]
  v_pk_fma_f32 v[98:99], v[20:21], v[248:249], v[112:113] op_sel_hi:[1,0,0] neg_lo:[1,0,1] neg_hi:[1,0,1]
  v_pk_fma_f32 v[90:91], v[22:23], v[248:249], v[110:111] op_sel_hi:[1,0,0] neg_lo:[0,0,1] neg_hi:[0,0,1]
  v_pk_fma_f32 v[100:101], v[22:23], v[248:249], v[112:113] op_sel_hi:[1,0,0] neg_lo:[1,0,1] neg_hi:[1,0,1]
  v_pk_fma_f32 v[92:93], v[24:25], v[248:249], v[110:111] op_sel_hi:[1,0,0] neg_lo:[0,0,1] neg_hi:[0,0,1]
  v_pk_fma_f32 v[102:103], v[24:25], v[248:249], v[112:113] op_sel_hi:[1,0,0] neg_lo:[1,0,1] neg_hi:[1,0,1]
  v_pk_fma_f32 v[94:95], v[26:27], v[248:249], v[110:111] op_sel_hi:[1,0,0] neg_lo:[0,0,1] neg_hi:[0,0,1]
  v_pk_fma_f32 v[104:105], v[26:27], v[248:249], v[112:113] op_sel_hi:[1,0,0] neg_lo:[1,0,1] neg_hi:[1,0,1]
  v_pk_fma_f32 v[96:97], v[28:29], v[248:249], v[110:111] op_sel_hi:[1,0,0] neg_lo:[0,0,1] neg_hi:[0,0,1]
  v_pk_fma_f32 v[106:107], v[28:29], v[248:249], v[112:113] op_sel_hi:[1,0,0] neg_lo:[1,0,1] neg_hi:[1,0,1]
  v_exp_f32 v88, v88
  v_exp_f32 v98, v98
  v_exp_f32 v89, v89
  v_exp_f32 v99, v99
  v_exp_f32 v90, v90
  v_exp_f32 v100, v100
  v_exp_f32 v91, v91
  v_exp_f32 v101, v101
  v_exp_f32 v92, v92
  v_exp_f32 v102, v102
  v_exp_f32 v93, v93
  v_exp_f32 v103, v103
  v_exp_f32 v94, v94
  v_exp_f32 v104, v104
  v_exp_f32 v95, v95
  v_exp_f32 v105, v105
  v_exp_f32 v96, v96
  v_exp_f32 v106, v106
  v_exp_f32 v97, v97
  v_exp_f32 v107, v107
  v_pk_add_f32 v[110:111], v[88:89], v[90:91]
  v_pk_add_f32 v[112:113], v[98:99], v[100:101]
  v_pk_add_f32 v[110:111], v[110:111], v[92:93]
  v_pk_add_f32 v[112:113], v[112:113], v[102:103]
  v_pk_add_f32 v[110:111], v[110:111], v[94:95]
  v_pk_add_f32 v[112:113], v[112:113], v[104:105]
  v_pk_add_f32 v[110:111], v[110:111], v[96:97]
  v_pk_add_f32 v[112:113], v[112:113], v[106:107]
  v_add_f32 v110, v110, v111
  v_add_f32 v112, v112, v113
  s_nop 1
  v_permlane16_swap_b32 v110, v112
  v_add_f32 v110, v110, v112
  v_mov_b32 v112, v110
  s_nop 1
  v_permlane16_swap_b32 v110, v112
  v_rcp_f32 v110, v110
  v_rcp_f32 v112, v112
  v_pk_mul_f32 v[88:89], v[88:89], v[110:111] op_sel_hi:[1,0]
  v_pk_mul_f32 v[98:99], v[98:99], v[112:113] op_sel_hi:[1,0]
  v_pk_mul_f32 v[90:91], v[90:91], v[110:111] op_sel_hi:[1,0]
  v_pk_mul_f32 v[100:101], v[100:101], v[112:113] op_sel_hi:[1,0]
  v_pk_mul_f32 v[92:93], v[92:93], v[110:111] op_sel_hi:[1,0]
  v_pk_mul_f32 v[102:103], v[102:103], v[112:113] op_sel_hi:[1,0]
  v_pk_mul_f32 v[94:95], v[94:95], v[110:111] op_sel_hi:[1,0]
  v_pk_mul_f32 v[104:105], v[104:105], v[112:113] op_sel_hi:[1,0]
  v_pk_mul_f32 v[96:97], v[96:97], v[110:111] op_sel_hi:[1,0]
  v_pk_mul_f32 v[106:107], v[106:107], v[112:113] op_sel_hi:[1,0]
  v_cvt_pk_bf16_f32 v136, v88, v89
  v_cvt_pk_bf16_f32 v137, v90, v91
  v_cvt_pk_bf16_f32 v138, v92, v93
  v_cvt_pk_bf16_f32 v139, v94, v95
  v_cvt_pk_bf16_f32 v140, v96, v97
  v_cvt_pk_bf16_f32 v141, v98, v99
  v_cvt_pk_bf16_f32 v142, v100, v101
  v_cvt_pk_bf16_f32 v143, v102, v103
  v_cvt_pk_bf16_f32 v144, v104, v105
  v_cvt_pk_bf16_f32 v145, v106, v107
  v_pk_fma_f32 v[32:33], v[8:9], v[252:253], v[32:33] op_sel:[0,1,0] op_sel_hi:[1,1,1]
  v_pk_fma_f32 v[34:35], v[10:11], v[252:253], v[34:35] op_sel:[0,1,0] op_sel_hi:[1,1,1]
  v_pk_fma_f32 v[36:37], v[12:13], v[252:253], v[36:37] op_sel:[0,1,0] op_sel_hi:[1,1,1]
  v_pk_fma_f32 v[38:39], v[14:15], v[252:253], v[38:39] op_sel:[0,1,0] op_sel_hi:[1,1,1]
  v_pk_fma_f32 v[40:41], v[16:17], v[252:253], v[40:41] op_sel:[0,1,0] op_sel_hi:[1,1,1]
  v_max3_f32 v108, v32, v33, v34
  v_max3_f32 v109, -v32, -v33, -v34
  v_max3_f32 v108, v108, v35, v36
  v_max3_f32 v109, v109, -v35, -v36
  v_max3_f32 v108, v108, v37, v38
  v_max3_f32 v109, v109, -v37, -v38
  v_max3_f32 v108, v108, v39, v40
  v_max3_f32 v109, v109, -v39, -v40
  v_max_f32 v108, v108, v41
  v_max_f32 v109, v109, -v41
  s_nop 1
  v_permlane16_swap_b32 v108, v109
  v_max_f32 v108, v108, v109
  v_mov_b32 v109, v108
  s_nop 1
  v_permlane16_swap_b32 v108, v109
  v_mul_f32 v110, v108, v252
  v_mul_f32 v112, v109, v252
  v_pk_fma_f32 v[88:89], v[32:33], v[252:253], v[110:111] op_sel_hi:[1,0,0] neg_lo:[0,0,1] neg_hi:[0,0,1]
  v_pk_fma_f32 v[98:99], v[32:33], v[252:253], v[112:113] op_sel_hi:[1,0,0] neg_lo:[1,0,1] neg_hi:[1,0,1]
  v_pk_fma_f32 v[90:91], v[34:35], v[252:253], v[110:111] op_sel_hi:[1,0,0] neg_lo:[0,0,1] neg_hi:[0,0,1]
  v_pk_fma_f32 v[100:101], v[34:35], v[252:253], v[112:113] op_sel_hi:[1,0,0] neg_lo:[1,0,1] neg_hi:[1,0,1]
  v_pk_fma_f32 v[92:93], v[36:37], v[252:253], v[110:111] op_sel_hi:[1,0,0] neg_lo:[0,0,1] neg_hi:[0,0,1]
  v_pk_fma_f32 v[102:103], v[36:37], v[252:253], v[112:113] op_sel_hi:[1,0,0] neg_lo:[1,0,1] neg_hi:[1,0,1]
  v_pk_fma_f32 v[94:95], v[38:39], v[252:253], v[110:111] op_sel_hi:[1,0,0] neg_lo:[0,0,1] neg_hi:[0,0,1]
  v_pk_fma_f32 v[104:105], v[38:39], v[252:253], v[112:113] op_sel_hi:[1,0,0] neg_lo:[1,0,1] neg_hi:[1,0,1]
  v_pk_fma_f32 v[96:97], v[40:41], v[252:253], v[110:111] op_sel_hi:[1,0,0] neg_lo:[0,0,1] neg_hi:[0,0,1]
  v_pk_fma_f32 v[106:107], v[40:41], v[252:253], v[112:113] op_sel_hi:[1,0,0] neg_lo:[1,0,1] neg_hi:[1,0,1]
  v_exp_f32 v88, v88
  v_exp_f32 v98, v98
  v_exp_f32 v89, v89
  v_exp_f32 v99, v99
  v_exp_f32 v90, v90
  v_exp_f32 v100, v100
  v_exp_f32 v91, v91
  v_exp_f32 v101, v101
  v_exp_f32 v92, v92
  v_exp_f32 v102, v102
  v_exp_f32 v93, v93
  v_exp_f32 v103, v103
  v_exp_f32 v94, v94
  v_exp_f32 v104, v104
  v_exp_f32 v95, v95
  v_exp_f32 v105, v105
  v_exp_f32 v96, v96
  v_exp_f32 v106, v106
  v_exp_f32 v97, v97
  v_exp_f32 v107, v107
  v_pk_add_f32 v[110:111], v[88:89], v[90:91]
  v_pk_add_f32 v[112:113], v[98:99], v[100:101]
  v_pk_add_f32 v[110:111], v[110:111], v[92:93]
  v_pk_add_f32 v[112:113], v[112:113], v[102:103]
  v_pk_add_f32 v[110:111], v[110:111], v[94:95]
  v_pk_add_f32 v[112:113], v[112:113], v[104:105]
  v_pk_add_f32 v[110:111], v[110:111], v[96:97]
  v_pk_add_f32 v[112:113], v[112:113], v[106:107]
  v_add_f32 v110, v110, v111
  v_add_f32 v112, v112, v113
  s_nop 1
  v_permlane16_swap_b32 v110, v112
  v_add_f32 v110, v110, v112
  v_mov_b32 v112, v110
  s_nop 1
  v_permlane16_swap_b32 v110, v112
  v_rcp_f32 v110, v110
  v_rcp_f32 v112, v112
  v_pk_mul_f32 v[88:89], v[88:89], v[110:111] op_sel_hi:[1,0]
  v_pk_mul_f32 v[98:99], v[98:99], v[112:113] op_sel_hi:[1,0]
  v_pk_mul_f32 v[90:91], v[90:91], v[110:111] op_sel_hi:[1,0]
  v_pk_mul_f32 v[100:101], v[100:101], v[112:113] op_sel_hi:[1,0]
  v_pk_mul_f32 v[92:93], v[92:93], v[110:111] op_sel_hi:[1,0]
  v_pk_mul_f32 v[102:103], v[102:103], v[112:113] op_sel_hi:[1,0]
  v_pk_mul_f32 v[94:95], v[94:95], v[110:111] op_sel_hi:[1,0]
  v_pk_mul_f32 v[104:105], v[104:105], v[112:113] op_sel_hi:[1,0]
  v_pk_mul_f32 v[96:97], v[96:97], v[110:111] op_sel_hi:[1,0]
  v_pk_mul_f32 v[106:107], v[106:107], v[112:113] op_sel_hi:[1,0]
  v_cvt_pk_bf16_f32 v148, v88, v89
  v_cvt_pk_bf16_f32 v149, v90, v91
  v_cvt_pk_bf16_f32 v150, v92, v93
  v_cvt_pk_bf16_f32 v151, v94, v95
  v_cvt_pk_bf16_f32 v152, v96, v97
  v_cvt_pk_bf16_f32 v153, v98, v99
  v_cvt_pk_bf16_f32 v154, v100, v101
  v_cvt_pk_bf16_f32 v155, v102, v103
  v_cvt_pk_bf16_f32 v156, v104, v105
  v_cvt_pk_bf16_f32 v157, v106, v107
  s_lshl_b32 s94, s10, 7
  s_add_u32 s94, s94, s57
  s_add_u32 s94, s94, 0
  s_mov_b64 exec, 1
  buffer_load_dword v165, off, s[4:7], s94 sc1
  s_mov_b64 exec, -1
  v_lshrrev_b32 v108, 2, v4
  v_and_b32 v109, 3, v4
  v_lshrrev_b32 v110, 1, v108
  v_mul_u32_u24 v112, 6144, v110
  v_lshl_add_u32 v112, v109, 8, v112
  v_lshrrev_b32 v111, 1, v5
  v_mov_b32 v109, 0x40000000
  v_cmp_eq_u32 vcc, v110, v111
  s_nop 1
  v_cndmask_b32 v112, v109, v112, vcc
  v_and_b32 v110, 1, v108
  v_and_b32 v111, 1, v5
  s_mul_i32 s20, s10, 12288
  s_add_u32 s20, s20, s56
  s_add_u32 s3, s8, 0
  s_min_u32 s3, s3, 8
  s_mul_i32 s35, s3, 43
  s_lshr_b32 s35, s35, 7
  s_mul_i32 s27, s35, 3
  s_sub_u32 s27, s3, s27
  s_lshl_b32 s24, s3, 10
  s_add_u32 s24, s24, 153600
  s_lshl_b32 s28, s35, 6
  s_add_u32 s35, s35, 3
  s_lshr_b32 s29, s35, 2
  s_mul_i32 s29, s29, 3072
  s_and_b32 s35, s35, 3
  s_lshl_b32 s35, s35, 6
  s_add_u32 s29, s29, s35
  s_sub_u32 s29, s29, s28
  v_mul_u32_u24 v160, s29, v110
  v_add3_u32 v160, v160, s28, v112
  s_lshr_b32 s28, s27, 1
  s_lshl_b32 s28, s28, 10
  s_and_b32 s35, s27, 1
  s_lshl_b32 s35, s35, 5
  s_add_u32 s28, s28, s35
  s_add_u32 s27, s27, 3
  s_lshr_b32 s29, s27, 1
  s_lshl_b32 s29, s29, 10
  s_and_b32 s35, s27, 1
  s_lshl_b32 s35, s35, 5
  s_add_u32 s29, s29, s35
  s_sub_u32 s29, s29, s28
  v_mul_u32_u24 v113, s29, v111
  v_add3_u32 v113, v113, s28, v160
  v_mov_b32 v160, v113
  s_add_u32 s3, s8, 4
  s_min_u32 s3, s3, 8
  s_mul_i32 s35, s3, 43
  s_lshr_b32 s35, s35, 7
  s_mul_i32 s27, s35, 3
  s_sub_u32 s27, s3, s27
  s_lshl_b32 s25, s3, 10
  s_add_u32 s25, s25, 153600
  s_lshl_b32 s28, s35, 6
  s_add_u32 s35, s35, 3
  s_lshr_b32 s29, s35, 2
  s_mul_i32 s29, s29, 3072
  s_and_b32 s35, s35, 3
  s_lshl_b32 s35, s35, 6
  s_add_u32 s29, s29, s35
  s_sub_u32 s29, s29, s28
  v_mul_u32_u24 v161, s29, v110
  v_add3_u32 v161, v161, s28, v112
  s_lshr_b32 s28, s27, 1
  s_lshl_b32 s28, s28, 10
  s_and_b32 s35, s27, 1
  s_lshl_b32 s35, s35, 5
  s_add_u32 s28, s28, s35
  s_add_u32 s27, s27, 3
  s_lshr_b32 s29, s27, 1
  s_lshl_b32 s29, s29, 10
  s_and_b32 s35, s27, 1
  s_lshl_b32 s35, s35, 5
  s_add_u32 s29, s29, s35
  s_sub_u32 s29, s29, s28
  v_mul_u32_u24 v113, s29, v111
  v_add3_u32 v113, v113, s28, v161
  v_mov_b32 v161, v113
  s_add_u32 s3, s8, 8
  s_min_u32 s3, s3, 8
  s_mul_i32 s35, s3, 43
  s_lshr_b32 s35, s35, 7
  s_mul_i32 s27, s35, 3
  s_sub_u32 s27, s3, s27
  s_lshl_b32 s26, s3, 10
  s_add_u32 s26, s26, 153600
  s_lshl_b32 s28, s35, 6
  s_add_u32 s35, s35, 3
  s_lshr_b32 s29, s35, 2
  s_mul_i32 s29, s29, 3072
  s_and_b32 s35, s35, 3
  s_lshl_b32 s35, s35, 6
  s_add_u32 s29, s29, s35
  s_sub_u32 s29, s29, s28
  v_mul_u32_u24 v162, s29, v110
  v_add3_u32 v162, v162, s28, v112
  s_lshr_b32 s28, s27, 1
  s_lshl_b32 s28, s28, 10
  s_and_b32 s35, s27, 1
  s_lshl_b32 s35, s35, 5
  s_add_u32 s28, s28, s35
  s_add_u32 s27, s27, 3
  s_lshr_b32 s29, s27, 1
  s_lshl_b32 s29, s29, 10
  s_and_b32 s35, s27, 1
  s_lshl_b32 s35, s35, 5
  s_add_u32 s29, s29, s35
  s_sub_u32 s29, s29, s28
  v_mul_u32_u24 v113, s29, v111
  v_add3_u32 v113, v113, s28, v162
  v_mov_b32 v162, v113
  s_mov_b32 s93, s20
  s_mul_i32 s20, s59, 20480
  s_add_u32 s20, s20, s54
  s_lshl_b32 s3, s10, 10
  s_add_u32 s21, s20, s3
  s_lshl_b32 s3, s10, 8
  s_add_u32 s22, s20, s3
  s_add_u32 s22, s22, 16384
  s_waitcnt vmcnt(0)
  v_readfirstlane_b32 s19, v165
  s_nop 3
  s_cmp_ge_u32 s19, 16
  s_cbranch_scc1 pdone_47
  s_cmp_lg_u32 s58, 0
  s_cbranch_scc1 pdone_47
  s_mov_b32 s18, 0
  s_mov_b64 exec, 1
poll_46:
  buffer_load_dword v165, off, s[4:7], s94 sc1
  s_waitcnt vmcnt(0)
  v_readfirstlane_b32 s19, v165
  s_nop 3
  s_cmp_ge_u32 s19, 16
  s_cbranch_scc1 pdone_47
  s_add_u32 s18, s18, 1
  s_cmp_lt_u32 s18, 0x20000
  s_cbranch_scc1 poll_46
  s_mov_b32 s58, 1
pdone_47:
  s_mov_b64 exec, -1
  buffer_load_dwordx4 v[168:171], v160, s[4:7], s93 offen sc1
  buffer_load_dwordx4 v[172:175], v160, s[4:7], s93 offen offset:16 sc1
  buffer_load_dwordx4 v[176:179], v161, s[4:7], s93 offen sc1
  buffer_load_dwordx4 v[180:183], v161, s[4:7], s93 offen offset:16 sc1
  buffer_load_dwordx4 v[184:187], v162, s[4:7], s93 offen sc1
  buffer_load_dwordx4 v[188:191], v162, s[4:7], s93 offen offset:16 sc1
  s_mul_i32 s34, s10, 143360
  s_add_u32 s34, s34, s61
  s_add_u32 s34, s34, 0x1200000
  s_add_u32 m0, s61, 102400
  s_add_u32 s17, s34, 0
  buffer_load_dwordx4 v1, s[4:7], s17 offen lds
  s_add_u32 m0, s61, 106496
  s_add_u32 s17, s34, 4096
  buffer_load_dwordx4 v1, s[4:7], s17 offen lds
  s_add_u32 m0, s61, 110592
  s_add_u32 s17, s34, 8192
  buffer_load_dwordx4 v1, s[4:7], s17 offen lds
  s_add_u32 m0, s61, 114688
  s_add_u32 s17, s34, 12288
  buffer_load_dwordx4 v1, s[4:7], s17 offen lds
  s_add_u32 m0, s61, 118784
  s_add_u32 s17, s34, 16384
  buffer_load_dwordx4 v1, s[4:7], s17 offen lds
  s_add_u32 m0, s61, 122880
  s_add_u32 s17, s34, 20480
  buffer_load_dwordx4 v1, s[4:7], s17 offen lds
  s_add_u32 m0, s61, 126976
  s_add_u32 s17, s34, 24576
  buffer_load_dwordx4 v1, s[4:7], s17 offen lds
  s_add_u32 m0, s61, 131072
  s_add_u32 s17, s34, 28672
  buffer_load_dwordx4 v1, s[4:7], s17 offen lds
  s_add_u32 m0, s61, 135168
  s_add_u32 s17, s34, 32768
  buffer_load_dwordx4 v1, s[4:7], s17 offen lds
  s_add_u32 m0, s61, 139264
  s_add_u32 s17, s34, 36864
  buffer_load_dwordx4 v1, s[4:7], s17 offen lds
  s_add_u32 m0, s61, 143360
  s_add_u32 s17, s34, 40960
  buffer_load_dwordx4 v1, s[4:7], s17 offen lds
  s_add_u32 m0, s61, 147456
  s_add_u32 s17, s34, 45056
  buffer_load_dwordx4 v1, s[4:7], s17 offen lds
  s_mov_b32 m0, 151552
  s_sub_u32 s17, s34, s61
  s_add_u32 s17, s17, 49152
  buffer_load_dwordx4 v1, s[4:7], s17 offen lds
  v_add_u32 v7, s24, v1
  s_waitcnt vmcnt(17)
  v_cvt_pk_bf16_f32 v168, v168, v169
  v_cvt_pk_bf16_f32 v169, v170, v171
  v_cvt_pk_bf16_f32 v170, v172, v173
  v_cvt_pk_bf16_f32 v171, v174, v175
  ds_write_b128 v7, v[168:171]
  v_add_u32 v7, s25, v1
  s_waitcnt vmcnt(15)
  v_cvt_pk_bf16_f32 v176, v176, v177
  v_cvt_pk_bf16_f32 v177, v178, v179
  v_cvt_pk_bf16_f32 v178, v180, v181
  v_cvt_pk_bf16_f32 v179, v182, v183
  ds_write_b128 v7, v[176:179]
  v_add_u32 v7, s26, v1
  s_waitcnt vmcnt(13)
  v_cvt_pk_bf16_f32 v184, v184, v185
  v_cvt_pk_bf16_f32 v185, v186, v187
  v_cvt_pk_bf16_f32 v186, v188, v189
  v_cvt_pk_bf16_f32 v187, v190, v191
  ds_write_b128 v7, v[184:187]
  s_waitcnt lgkmcnt(0)
  s_barrier
  ds_read_b128 v[192:195], v3 offset:22528
  ds_read_b128 v[204:207], v3 offset:25600
  ds_read_b128 v[216:219], v3 offset:28672
  ds_read_b128 v[196:199], v3 offset:23552
  ds_read_b128 v[208:211], v3 offset:26624
  ds_read_b128 v[220:223], v3 offset:29696
  ds_read_b128 v[200:203], v3 offset:24576
  ds_read_b128 v[212:215], v3 offset:27648
  ds_read_b128 v[224:227], v3 offset:30720
  s_waitcnt lgkmcnt(6)
  v_mfma_f32_16x16x32_bf16 v[8:11], v[192:195], v[136:139], 0
  v_mfma_f32_16x16x32_bf16 v[12:15], v[204:207], v[136:139], 0
  v_mfma_f32_16x16x32_bf16 v[16:19], v[216:219], v[136:139], 0
  v_mfma_f32_16x16x32_bf16 v[20:23], v[192:195], v[148:151], 0
  v_mfma_f32_16x16x32_bf16 v[24:27], v[204:207], v[148:151], 0
  v_mfma_f32_16x16x32_bf16 v[28:31], v[216:219], v[148:151], 0
  s_waitcnt lgkmcnt(3)
  v_mfma_f32_16x16x32_bf16 v[8:11], v[196:199], v[140:143], v[8:11]
  v_mfma_f32_16x16x32_bf16 v[12:15], v[208:211], v[140:143], v[12:15]
  v_mfma_f32_16x16x32_bf16 v[16:19], v[220:223], v[140:143], v[16:19]
  v_mfma_f32_16x16x32_bf16 v[20:23], v[196:199], v[152:155], v[20:23]
  v_mfma_f32_16x16x32_bf16 v[24:27], v[208:211], v[152:155], v[24:27]
  v_mfma_f32_16x16x32_bf16 v[28:31], v[220:223], v[152:155], v[28:31]
  s_waitcnt lgkmcnt(0)
  v_mfma_f32_16x16x32_bf16 v[8:11], v[200:203], v[144:147], v[8:11]
  v_mfma_f32_16x16x32_bf16 v[12:15], v[212:215], v[144:147], v[12:15]
  v_mfma_f32_16x16x32_bf16 v[16:19], v[224:227], v[144:147], v[16:19]
  v_mfma_f32_16x16x32_bf16 v[20:23], v[200:203], v[156:159], v[20:23]
  v_mfma_f32_16x16x32_bf16 v[24:27], v[212:215], v[156:159], v[24:27]
  v_mfma_f32_16x16x32_bf16 v[28:31], v[224:227], v[156:159], v[28:31]
  s_nop 4
  v_add_f32 v108, 0x358637bd, v18
  v_rcp_f32 v108, v108
  s_nop 0
  v_pk_mul_f32 v[8:9], v[8:9], v[108:109] op_sel_hi:[1,0]
  v_pk_mul_f32 v[10:11], v[10:11], v[108:109] op_sel_hi:[1,0]
  v_pk_mul_f32 v[12:13], v[12:13], v[108:109] op_sel_hi:[1,0]
  v_pk_mul_f32 v[14:15], v[14:15], v[108:109] op_sel_hi:[1,0]
  v_pk_mul_f32 v[16:17], v[16:17], v[108:109] op_sel_hi:[1,0]
  v_cvt_pk_bf16_f32 v32, v8, v9
  v_cvt_pk_bf16_f32 v33, v10, v11
  v_cvt_pk_bf16_f32 v34, v12, v13
  v_cvt_pk_bf16_f32 v35, v14, v15
  v_cvt_pk_bf16_f32 v36, v16, v17
  buffer_store_dwordx4 v[32:35], v1, s[4:7], s21 offen sc1
  v_lshlrev_b32 v7, 2, v0
  buffer_store_dword v36, v7, s[4:7], s22 offen sc1
  v_add_f32 v108, 0x358637bd, v30
  v_rcp_f32 v108, v108
  s_nop 0
  v_pk_mul_f32 v[20:21], v[20:21], v[108:109] op_sel_hi:[1,0]
  v_pk_mul_f32 v[22:23], v[22:23], v[108:109] op_sel_hi:[1,0]
  v_pk_mul_f32 v[24:25], v[24:25], v[108:109] op_sel_hi:[1,0]
  v_pk_mul_f32 v[26:27], v[26:27], v[108:109] op_sel_hi:[1,0]
  v_pk_mul_f32 v[28:29], v[28:29], v[108:109] op_sel_hi:[1,0]
  v_cvt_pk_bf16_f32 v38, v20, v21
  v_cvt_pk_bf16_f32 v39, v22, v23
  v_cvt_pk_bf16_f32 v40, v24, v25
  v_cvt_pk_bf16_f32 v41, v26, v27
  v_cvt_pk_bf16_f32 v42, v28, v29
  s_add_u32 s21, s21, 20480
  s_add_u32 s22, s22, 20480
  buffer_store_dwordx4 v[38:41], v1, s[4:7], s21 offen sc1
  v_lshlrev_b32 v7, 2, v0
  buffer_store_dword v42, v7, s[4:7], s22 offen sc1
  s_mul_i32 s33, s13, 102400
  s_add_u32 s33, s33, s61
  s_add_u32 s33, s33, 0x1100000
  s_add_u32 m0, s61, 0
  s_add_u32 s17, s33, 0
  buffer_load_dwordx4 v1, s[4:7], s17 offen lds
  s_add_u32 m0, s61, 4096
  s_add_u32 s17, s33, 4096
  buffer_load_dwordx4 v1, s[4:7], s17 offen lds
  s_add_u32 m0, s61, 8192
  s_add_u32 s17, s33, 8192
  buffer_load_dwordx4 v1, s[4:7], s17 offen lds
  s_add_u32 m0, s61, 12288
  s_add_u32 s17, s33, 12288
  buffer_load_dwordx4 v1, s[4:7], s17 offen lds
  s_add_u32 m0, s61, 16384
  s_add_u32 s17, s33, 16384
  buffer_load_dwordx4 v1, s[4:7], s17 offen lds
  s_add_u32 m0, s61, 20480
  s_add_u32 s17, s33, 20480
  buffer_load_dwordx4 v1, s[4:7], s17 offen lds
  s_add_u32 m0, s61, 24576
  s_add_u32 s17, s33, 24576
  buffer_load_dwordx4 v1, s[4:7], s17 offen lds
  s_add_u32 m0, s61, 28672
  s_add_u32 s17, s33, 28672
  buffer_load_dwordx4 v1, s[4:7], s17 offen lds
  s_add_u32 m0, s61, 32768
  s_add_u32 s17, s33, 32768
  buffer_load_dwordx4 v1, s[4:7], s17 offen lds
  s_add_u32 m0, s61, 36864
  s_add_u32 s17, s33, 36864
  buffer_load_dwordx4 v1, s[4:7], s17 offen lds
  s_add_u32 m0, s61, 40960
  s_add_u32 s17, s33, 40960
  buffer_load_dwordx4 v1, s[4:7], s17 offen lds
  s_add_u32 m0, s61, 45056
  s_add_u32 s17, s33, 45056
  buffer_load_dwordx4 v1, s[4:7], s17 offen lds
  s_mul_i32 s25, s60, 20480
  s_lshl_b32 s3, s13, 11
  s_add_u32 s28, s25, s3
  s_lshl_b32 s3, s13, 9
  s_add_u32 s29, s25, s3
  s_add_u32 s29, s29, 16384
  s_waitcnt vmcnt(12)
  s_barrier
  s_cmp_lg_u32 s8, 0
  s_cbranch_scc1 sig_48
  s_lshl_b32 s17, s9, 7
  s_add_u32 s17, s17, s57
  s_add_u32 s17, s17, 2048
  s_mov_b64 exec, 1
  v_mov_b32 v7, 1
  buffer_atomic_add v7, off, s[4:7], s17
  s_mov_b64 exec, -1
sig_48:
  s_add_u32 m0, s61, 49152
  s_add_u32 s17, s33, 49152
  buffer_load_dwordx4 v1, s[4:7], s17 offen lds
  s_add_u32 m0, s61, 53248
  s_add_u32 s17, s33, 53248
  buffer_load_dwordx4 v1, s[4:7], s17 offen lds
  s_add_u32 m0, s61, 57344
  s_add_u32 s17, s33, 57344
  buffer_load_dwordx4 v1, s[4:7], s17 offen lds
  s_add_u32 m0, s61, 61440
  s_add_u32 s17, s33, 61440
  buffer_load_dwordx4 v1, s[4:7], s17 offen lds
  s_add_u32 m0, s61, 65536
  s_add_u32 s17, s33, 65536
  buffer_load_dwordx4 v1, s[4:7], s17 offen lds
  s_add_u32 m0, s61, 69632
  s_add_u32 s17, s33, 69632
  buffer_load_dwordx4 v1, s[4:7], s17 offen lds
  s_add_u32 m0, s61, 73728
  s_add_u32 s17, s33, 73728
  buffer_load_dwordx4 v1, s[4:7], s17 offen lds
  s_add_u32 m0, s61, 77824
  s_add_u32 s17, s33, 77824
  buffer_load_dwordx4 v1, s[4:7], s17 offen lds
  s_add_u32 m0, s61, 81920
  s_add_u32 s17, s33, 81920
  buffer_load_dwordx4 v1, s[4:7], s17 offen lds
  s_add_u32 m0, s61, 86016
  s_add_u32 s17, s33, 86016
  buffer_load_dwordx4 v1, s[4:7], s17 offen lds
  s_add_u32 m0, s61, 90112
  s_add_u32 s17, s33, 90112
  buffer_load_dwordx4 v1, s[4:7], s17 offen lds
  s_add_u32 m0, s61, 94208
  s_add_u32 s17, s33, 94208
  buffer_load_dwordx4 v1, s[4:7], s17 offen lds
  s_add_u32 m0, s61, 98304
  s_add_u32 s17, s33, 98304
  buffer_load_dwordx4 v1, s[4:7], s17 offen lds
  s_mul_i32 s20, s60, 20480
  s_add_u32 s20, s20, s54
  s_add_u32 s17, s28, s48
  buffer_load_dwordx4 v[8:11], v1, s[4:7], s17 offen offset:0 sc1
  buffer_load_dwordx4 v[12:15], v1, s[4:7], s17 offen offset:1024 sc1
  s_add_u32 s17, s29, s48
  v_lshlrev_b32 v7, 3, v0
  buffer_load_dwordx2 v[16:17], v7, s[4:7], s17 offen sc1
  s_cmp_lg_u32 s8, 0
  s_cbranch_scc1 wbar_49
  s_cmp_lg_u32 s58, 0
  s_cbranch_scc1 wbar_49
  s_lshl_b32 s17, s9, 7
  s_add_u32 s17, s17, s57
  s_add_u32 s17, s17, 2048
  s_mov_b32 s18, 0
  s_mov_b64 exec, 1
poll_50:
  buffer_load_dword v7, off, s[4:7], s17 sc1
  s_waitcnt vmcnt(0)
  v_readfirstlane_b32 s19, v7
  s_nop 3
  s_cmp_ge_u32 s19, 16
  s_cbranch_scc1 pdone_51
  s_add_u32 s18, s18, 1
  s_cmp_lt_u32 s18, 0x20000
  s_cbranch_scc1 poll_50
  s_mov_b32 s58, 1
pdone_51:
  s_mov_b64 exec, -1
wbar_49:
  s_waitcnt vmcnt(0)
  s_barrier
  buffer_load_dwordx4 v[40:43], v1, s[4:7], s20 offen offset:0 sc1
  buffer_load_dwordx4 v[44:47], v1, s[4:7], s20 offen offset:1024 sc1
  buffer_load_dwordx4 v[48:51], v1, s[4:7], s20 offen offset:2048 sc1
  buffer_load_dwordx4 v[52:55], v1, s[4:7], s20 offen offset:3072 sc1
  s_add_u32 s20, s20, 4096
  buffer_load_dwordx4 v[56:59], v1, s[4:7], s20 offen offset:0 sc1
  buffer_load_dwordx4 v[60:63], v1, s[4:7], s20 offen offset:1024 sc1
  buffer_load_dwordx4 v[64:67], v1, s[4:7], s20 offen offset:2048 sc1
  buffer_load_dwordx4 v[68:71], v1, s[4:7], s20 offen offset:3072 sc1
  s_add_u32 s20, s20, 4096
  buffer_load_dwordx4 v[72:75], v1, s[4:7], s20 offen offset:0 sc1
  buffer_load_dwordx4 v[76:79], v1, s[4:7], s20 offen offset:1024 sc1
  buffer_load_dwordx4 v[80:83], v1, s[4:7], s20 offen offset:2048 sc1
  buffer_load_dwordx4 v[84:87], v1, s[4:7], s20 offen offset:3072 sc1
  s_add_u32 s20, s20, 4096
  buffer_load_dwordx4 v[88:91], v1, s[4:7], s20 offen offset:0 sc1
  buffer_load_dwordx4 v[92:95], v1, s[4:7], s20 offen offset:1024 sc1
  buffer_load_dwordx4 v[96:99], v1, s[4:7], s20 offen offset:2048 sc1
  buffer_load_dwordx4 v[100:103], v1, s[4:7], s20 offen offset:3072 sc1
  ds_read_b128 v[136:139], v1 offset:0
  ds_read_b128 v[140:143], v1 offset:1024
  ds_read_b128 v[144:147], v1 offset:2048
  ds_read_b128 v[148:151], v1 offset:3072
  ds_read_b128 v[152:155], v1 offset:4096
  ds_read_b128 v[156:159], v1 offset:5120
  ds_read_b128 v[160:163], v1 offset:6144
  ds_read_b128 v[164:167], v1 offset:7168
  ds_read_b128 v[168:171], v1 offset:8192
  ds_read_b128 v[172:175], v1 offset:9216
  s_waitcnt vmcnt(15) lgkmcnt(9)
  v_mfma_f32_16x16x32_bf16 v[20:23], v[136:139], v[40:43], 0
  ds_read_b128 v[176:179], v1 offset:10240
  s_waitcnt lgkmcnt(9)
  v_mfma_f32_16x16x32_bf16 v[24:27], v[140:143], v[40:43], 0
  ds_read_b128 v[180:183], v1 offset:11264
  s_add_u32 s20, s20, 4096
  v_lshlrev_b32 v7, 2, v0
  buffer_load_dword v104, v7, s[4:7], s20 offen offset:0 sc1
  buffer_load_dword v105, v7, s[4:7], s20 offen offset:256 sc1
  buffer_load_dword v106, v7, s[4:7], s20 offen offset:512 sc1
  buffer_load_dword v107, v7, s[4:7], s20 offen offset:768 sc1
  s_waitcnt lgkmcnt(9)
  v_mfma_f32_16x16x32_bf16 v[28:31], v[144:147], v[40:43], 0
  ds_read_b128 v[184:187], v1 offset:12288
  s_waitcnt lgkmcnt(9)
  v_mfma_f32_16x16x32_bf16 v[32:35], v[148:151], v[40:43], 0
  ds_read_b128 v[188:191], v1 offset:13312
  s_waitcnt lgkmcnt(9)
  v_mfma_f32_16x16x32_bf16 v[36:39], v[152:155], v[40:43], 0
  ds_read_b128 v[192:195], v1 offset:14336
  s_waitcnt vmcnt(18) lgkmcnt(9)
  v_mfma_f32_16x16x32_bf16 v[20:23], v[156:159], v[44:47], v[20:23]
  ds_read_b128 v[136:139], v1 offset:15360
  s_waitcnt lgkmcnt(9)
  v_mfma_f32_16x16x32_bf16 v[24:27], v[160:163], v[44:47], v[24:27]
  ds_read_b128 v[140:143], v1 offset:16384
  v_lshlrev_b32 v7, 2, v0
  buffer_load_dword v108, v7, s[4:7], s20 offen offset:1024 sc1
  buffer_load_dword v109, v7, s[4:7], s20 offen offset:1280 sc1
  buffer_load_dword v110, v7, s[4:7], s20 offen offset:1536 sc1
  buffer_load_dword v111, v7, s[4:7], s20 offen offset:1792 sc1
  s_waitcnt lgkmcnt(9)
  v_mfma_f32_16x16x32_bf16 v[28:31], v[164:167], v[44:47], v[28:31]
  ds_read_b128 v[144:147], v1 offset:17408
  s_waitcnt lgkmcnt(9)
  v_mfma_f32_16x16x32_bf16 v[32:35], v[168:171], v[44:47], v[32:35]
  ds_read_b128 v[148:151], v1 offset:18432
  s_waitcnt lgkmcnt(9)
  v_mfma_f32_16x16x32_bf16 v[36:39], v[172:175], v[44:47], v[36:39]
  ds_read_b128 v[152:155], v1 offset:19456
  s_waitcnt vmcnt(21) lgkmcnt(9)
  v_mfma_f32_16x16x32_bf16 v[20:23], v[176:179], v[48:51], v[20:23]
  ds_read_b128 v[156:159], v1 offset:20480
  s_waitcnt lgkmcnt(9)
  v_mfma_f32_16x16x32_bf16 v[24:27], v[180:183], v[48:51], v[24:27]
  ds_read_b128 v[160:163], v1 offset:21504
  v_lshlrev_b32 v7, 2, v0
  buffer_load_dword v112, v7, s[4:7], s20 offen offset:2048 sc1
  buffer_load_dword v113, v7, s[4:7], s20 offen offset:2304 sc1
  buffer_load_dword v114, v7, s[4:7], s20 offen offset:2560 sc1
  buffer_load_dword v115, v7, s[4:7], s20 offen offset:2816 sc1
  s_waitcnt lgkmcnt(9)
  v_mfma_f32_16x16x32_bf16 v[28:31], v[184:187], v[48:51], v[28:31]
  ds_read_b128 v[164:167], v1 offset:22528
  s_waitcnt lgkmcnt(9)
  v_mfma_f32_16x16x32_bf16 v[32:35], v[188:191], v[48:51], v[32:35]
  ds_read_b128 v[168:171], v1 offset:23552
  s_waitcnt lgkmcnt(9)
  v_mfma_f32_16x16x32_bf16 v[36:39], v[192:195], v[48:51], v[36:39]
  ds_read_b128 v[172:175], v1 offset:24576
  s_waitcnt vmcnt(24) lgkmcnt(9)
  v_mfma_f32_16x16x32_bf16 v[20:23], v[136:139], v[52:55], v[20:23]
  ds_read_b128 v[176:179], v1 offset:25600
  s_waitcnt lgkmcnt(9)
  v_mfma_f32_16x16x32_bf16 v[24:27], v[140:143], v[52:55], v[24:27]
  ds_read_b128 v[180:183], v1 offset:26624
  v_lshlrev_b32 v7, 2, v0
  buffer_load_dword v116, v7, s[4:7], s20 offen offset:3072 sc1
  buffer_load_dword v117, v7, s[4:7], s20 offen offset:3328 sc1
  buffer_load_dword v118, v7, s[4:7], s20 offen offset:3584 sc1
  buffer_load_dword v119, v7, s[4:7], s20 offen offset:3840 sc1
  s_waitcnt lgkmcnt(9)
  v_mfma_f32_16x16x32_bf16 v[28:31], v[144:147], v[52:55], v[28:31]
  ds_read_b128 v[184:187], v1 offset:27648
  s_waitcnt lgkmcnt(9)
  v_mfma_f32_16x16x32_bf16 v[32:35], v[148:151], v[52:55], v[32:35]
  ds_read_b128 v[188:191], v1 offset:28672
  s_waitcnt lgkmcnt(9)
  v_mfma_f32_16x16x32_bf16 v[36:39], v[152:155], v[52:55], v[36:39]
  ds_read_b128 v[192:195], v1 offset:29696
  s_waitcnt vmcnt(27) lgkmcnt(9)
  v_mfma_f32_16x16x32_bf16 v[20:23], v[156:159], v[56:59], v[20:23]
  ds_read_b128 v[136:139], v1 offset:30720
  s_waitcnt lgkmcnt(9)
  v_mfma_f32_16x16x32_bf16 v[24:27], v[160:163], v[56:59], v[24:27]
  ds_read_b128 v[140:143], v1 offset:31744
  s_waitcnt lgkmcnt(9)
  v_mfma_f32_16x16x32_bf16 v[28:31], v[164:167], v[56:59], v[28:31]
  ds_read_b128 v[144:147], v1 offset:32768
  s_waitcnt lgkmcnt(9)
  v_mfma_f32_16x16x32_bf16 v[32:35], v[168:171], v[56:59], v[32:35]
  ds_read_b128 v[148:151], v1 offset:33792
  s_waitcnt lgkmcnt(9)
  v_mfma_f32_16x16x32_bf16 v[36:39], v[172:175], v[56:59], v[36:39]
  ds_read_b128 v[152:155], v1 offset:34816
  s_waitcnt vmcnt(26) lgkmcnt(9)
  v_mfma_f32_16x16x32_bf16 v[20:23], v[176:179], v[60:63], v[20:23]
  ds_read_b128 v[156:159], v1 offset:35840
  s_waitcnt lgkmcnt(9)
  v_mfma_f32_16x16x32_bf16 v[24:27], v[180:183], v[60:63], v[24:27]
  ds_read_b128 v[160:163], v1 offset:36864
  s_waitcnt lgkmcnt(9)
  v_mfma_f32_16x16x32_bf16 v[28:31], v[184:187], v[60:63], v[28:31]
  ds_read_b128 v[164:167], v1 offset:37888
  s_waitcnt lgkmcnt(9)
  v_mfma_f32_16x16x32_bf16 v[32:35], v[188:191], v[60:63], v[32:35]
  ds_read_b128 v[168:171], v1 offset:38912
  s_waitcnt lgkmcnt(9)
  v_mfma_f32_16x16x32_bf16 v[36:39], v[192:195], v[60:63], v[36:39]
  ds_read_b128 v[172:175], v1 offset:39936
  s_waitcnt vmcnt(25) lgkmcnt(9)
  v_mfma_f32_16x16x32_bf16 v[20:23], v[136:139], v[64:67], v[20:23]
  ds_read_b128 v[176:179], v1 offset:40960
  s_waitcnt lgkmcnt(9)
  v_mfma_f32_16x16x32_bf16 v[24:27], v[140:143], v[64:67], v[24:27]
  ds_read_b128 v[180:183], v1 offset:41984
  s_waitcnt lgkmcnt(9)
  v_mfma_f32_16x16x32_bf16 v[28:31], v[144:147], v[64:67], v[28:31]
  ds_read_b128 v[184:187], v1 offset:43008
  s_waitcnt lgkmcnt(9)
  v_mfma_f32_16x16x32_bf16 v[32:35], v[148:151], v[64:67], v[32:35]
  ds_read_b128 v[188:191], v1 offset:44032
  s_waitcnt lgkmcnt(9)
  v_mfma_f32_16x16x32_bf16 v[36:39], v[152:155], v[64:67], v[36:39]
  ds_read_b128 v[192:195], v1 offset:45056
  s_waitcnt vmcnt(24) lgkmcnt(9)
  v_mfma_f32_16x16x32_bf16 v[20:23], v[156:159], v[68:71], v[20:23]
  ds_read_b128 v[136:139], v1 offset:46080
  s_waitcnt lgkmcnt(9)
  v_mfma_f32_16x16x32_bf16 v[24:27], v[160:163], v[68:71], v[24:27]
  ds_read_b128 v[140:143], v1 offset:47104
  s_waitcnt lgkmcnt(9)
  v_mfma_f32_16x16x32_bf16 v[28:31], v[164:167], v[68:71], v[28:31]
  ds_read_b128 v[144:147], v1 offset:48128
  s_waitcnt lgkmcnt(9)
  v_mfma_f32_16x16x32_bf16 v[32:35], v[168:171], v[68:71], v[32:35]
  ds_read_b128 v[148:151], v1 offset:49152
  s_waitcnt lgkmcnt(9)
  v_mfma_f32_16x16x32_bf16 v[36:39], v[172:175], v[68:71], v[36:39]
  ds_read_b128 v[152:155], v1 offset:50176
  s_waitcnt vmcnt(23) lgkmcnt(9)
  v_mfma_f32_16x16x32_bf16 v[20:23], v[176:179], v[72:75], v[20:23]
  ds_read_b128 v[156:159], v1 offset:51200
  s_waitcnt lgkmcnt(9)
  v_mfma_f32_16x16x32_bf16 v[24:27], v[180:183], v[72:75], v[24:27]
  ds_read_b128 v[160:163], v1 offset:52224
  s_waitcnt lgkmcnt(9)
  v_mfma_f32_16x16x32_bf16 v[28:31], v[184:187], v[72:75], v[28:31]
  ds_read_b128 v[164:167], v1 offset:53248
  s_waitcnt lgkmcnt(9)
  v_mfma_f32_16x16x32_bf16 v[32:35], v[188:191], v[72:75], v[32:35]
  ds_read_b128 v[168:171], v1 offset:54272
  s_waitcnt lgkmcnt(9)
  v_mfma_f32_16x16x32_bf16 v[36:39], v[192:195], v[72:75], v[36:39]
  ds_read_b128 v[172:175], v1 offset:55296
  s_waitcnt vmcnt(22) lgkmcnt(9)
  v_mfma_f32_16x16x32_bf16 v[20:23], v[136:139], v[76:79], v[20:23]
  ds_read_b128 v[176:179], v1 offset:56320
  s_waitcnt lgkmcnt(9)
  v_mfma_f32_16x16x32_bf16 v[24:27], v[140:143], v[76:79], v[24:27]
  ds_read_b128 v[180:183], v1 offset:57344
  s_waitcnt lgkmcnt(9)
  v_mfma_f32_16x16x32_bf16 v[28:31], v[144:147], v[76:79], v[28:31]
  ds_read_b128 v[184:187], v1 offset:58368
  s_waitcnt lgkmcnt(9)
  v_mfma_f32_16x16x32_bf16 v[32:35], v[148:151], v[76:79], v[32:35]
  ds_read_b128 v[188:191], v1 offset:59392
  s_waitcnt lgkmcnt(9)
  v_mfma_f32_16x16x32_bf16 v[36:39], v[152:155], v[76:79], v[36:39]
  ds_read_b128 v[192:195], v1 offset:60416
  s_waitcnt lgkmcnt(9)
  s_barrier
  s_waitcnt vmcnt(21) lgkmcnt(9)
  v_mfma_f32_16x16x32_bf16 v[20:23], v[156:159], v[80:83], v[20:23]
  ds_read_b128 v[136:139], v1 offset:61440
  s_waitcnt lgkmcnt(9)
  v_mfma_f32_16x16x32_bf16 v[24:27], v[160:163], v[80:83], v[24:27]
  ds_read_b128 v[140:143], v1 offset:62464
  s_waitcnt lgkmcnt(9)
  v_mfma_f32_16x16x32_bf16 v[28:31], v[164:167], v[80:83], v[28:31]
  ds_read_b128 v[144:147], v1 offset:63488
  s_waitcnt lgkmcnt(9)
  v_mfma_f32_16x16x32_bf16 v[32:35], v[168:171], v[80:83], v[32:35]
  ds_read_b128 v[148:151], v1 offset:64512
  s_add_u32 m0, s61, 0
  s_add_u32 s17, s34, 50176
  buffer_load_dwordx4 v1, s[4:7], s17 offen lds
  s_waitcnt lgkmcnt(9)
  v_mfma_f32_16x16x32_bf16 v[36:39], v[172:175], v[80:83], v[36:39]
  ds_read_b128 v[152:155], v2 offset:0
  s_waitcnt vmcnt(21) lgkmcnt(9)
  v_mfma_f32_16x16x32_bf16 v[20:23], v[176:179], v[84:87], v[20:23]
  ds_read_b128 v[156:159], v2 offset:1024
  s_waitcnt lgkmcnt(9)
  v_mfma_f32_16x16x32_bf16 v[24:27], v[180:183], v[84:87], v[24:27]
  ds_read_b128 v[160:163], v2 offset:2048
  s_waitcnt lgkmcnt(9)
  v_mfma_f32_16x16x32_bf16 v[28:31], v[184:187], v[84:87], v[28:31]
  ds_read_b128 v[164:167], v2 offset:3072
  s_waitcnt lgkmcnt(9)
  v_mfma_f32_16x16x32_bf16 v[32:35], v[188:191], v[84:87], v[32:35]
  ds_read_b128 v[168:171], v2 offset:4096
  s_add_u32 m0, s61, 4096
  s_add_u32 s17, s34, 54272
  buffer_load_dwordx4 v1, s[4:7], s17 offen lds
  s_waitcnt lgkmcnt(9)
  v_mfma_f32_16x16x32_bf16 v[36:39], v[192:195], v[84:87], v[36:39]
  ds_read_b128 v[172:175], v2 offset:5120
  s_waitcnt vmcnt(21) lgkmcnt(9)
  v_mfma_f32_16x16x32_bf16 v[20:23], v[136:139], v[88:91], v[20:23]
  ds_read_b128 v[176:179], v2 offset:6144
  s_waitcnt lgkmcnt(9)
  v_mfma_f32_16x16x32_bf16 v[24:27], v[140:143], v[88:91], v[24:27]
  ds_read_b128 v[180:183], v2 offset:7168
  s_waitcnt lgkmcnt(9)
  v_mfma_f32_16x16x32_bf16 v[28:31], v[144:147], v[88:91], v[28:31]
  ds_read_b128 v[184:187], v2 offset:8192
  s_waitcnt lgkmcnt(9)
  v_mfma_f32_16x16x32_bf16 v[32:35], v[148:151], v[88:91], v[32:35]
  ds_read_b128 v[188:191], v2 offset:9216
  s_add_u32 m0, s61, 8192
  s_add_u32 s17, s34, 58368
  buffer_load_dwordx4 v1, s[4:7], s17 offen lds
  s_waitcnt lgkmcnt(9)
  v_mfma_f32_16x16x32_bf16 v[36:39], v[152:155], v[88:91], v[36:39]
  ds_read_b128 v[192:195], v2 offset:10240
  s_waitcnt vmcnt(21) lgkmcnt(9)
  v_mfma_f32_16x16x32_bf16 v[20:23], v[156:159], v[92:95], v[20:23]
  ds_read_b128 v[136:139], v2 offset:11264
  s_waitcnt lgkmcnt(9)
  v_mfma_f32_16x16x32_bf16 v[24:27], v[160:163], v[92:95], v[24:27]
  ds_read_b128 v[140:143], v2 offset:12288
  s_waitcnt lgkmcnt(9)
  v_mfma_f32_16x16x32_bf16 v[28:31], v[164:167], v[92:95], v[28:31]
  ds_read_b128 v[144:147], v2 offset:13312
  s_waitcnt lgkmcnt(9)
  v_mfma_f32_16x16x32_bf16 v[32:35], v[168:171], v[92:95], v[32:35]
  ds_read_b128 v[148:151], v2 offset:14336
  s_add_u32 m0, s61, 12288
  s_add_u32 s17, s34, 62464
  buffer_load_dwordx4 v1, s[4:7], s17 offen lds
  s_waitcnt lgkmcnt(9)
  v_mfma_f32_16x16x32_bf16 v[36:39], v[172:175], v[92:95], v[36:39]
  ds_read_b128 v[152:155], v2 offset:15360
  s_waitcnt vmcnt(21) lgkmcnt(9)
  v_mfma_f32_16x16x32_bf16 v[20:23], v[176:179], v[96:99], v[20:23]
  ds_read_b128 v[156:159], v2 offset:16384
  s_waitcnt lgkmcnt(9)
  v_mfma_f32_16x16x32_bf16 v[24:27], v[180:183], v[96:99], v[24:27]
  ds_read_b128 v[160:163], v2 offset:17408
  s_waitcnt lgkmcnt(9)
  v_mfma_f32_16x16x32_bf16 v[28:31], v[184:187], v[96:99], v[28:31]
  ds_read_b128 v[164:167], v2 offset:18432
  s_waitcnt lgkmcnt(9)
  v_mfma_f32_16x16x32_bf16 v[32:35], v[188:191], v[96:99], v[32:35]
  ds_read_b128 v[168:171], v2 offset:19456
  s_add_u32 m0, s61, 16384
  s_add_u32 s17, s34, 66560
  buffer_load_dwordx4 v1, s[4:7], s17 offen lds
  s_waitcnt lgkmcnt(9)
  v_mfma_f32_16x16x32_bf16 v[36:39], v[192:195], v[96:99], v[36:39]
  ds_read_b128 v[172:175], v2 offset:20480
  s_waitcnt vmcnt(21) lgkmcnt(9)
  v_mfma_f32_16x16x32_bf16 v[20:23], v[136:139], v[100:103], v[20:23]
  ds_read_b128 v[176:179], v2 offset:21504
  s_waitcnt lgkmcnt(9)
  v_mfma_f32_16x16x32_bf16 v[24:27], v[140:143], v[100:103], v[24:27]
  ds_read_b128 v[180:183], v2 offset:22528
  s_waitcnt lgkmcnt(9)
  v_mfma_f32_16x16x32_bf16 v[28:31], v[144:147], v[100:103], v[28:31]
  ds_read_b128 v[184:187], v2 offset:23552
  s_waitcnt lgkmcnt(9)
  v_mfma_f32_16x16x32_bf16 v[32:35], v[148:151], v[100:103], v[32:35]
  ds_read_b128 v[188:191], v2 offset:24576
  s_add_u32 m0, s61, 20480
  s_add_u32 s17, s34, 70656
  buffer_load_dwordx4 v1, s[4:7], s17 offen lds
  s_waitcnt lgkmcnt(9)
  v_mfma_f32_16x16x32_bf16 v[36:39], v[152:155], v[100:103], v[36:39]
  ds_read_b128 v[192:195], v2 offset:25600
  s_waitcnt vmcnt(18) lgkmcnt(9)
  v_mfma_f32_16x16x32_bf16 v[20:23], v[156:159], v[104:107], v[20:23]
  ds_read_b128 v[136:139], v2 offset:26624
  s_waitcnt lgkmcnt(9)
  v_mfma_f32_16x16x32_bf16 v[24:27], v[160:163], v[104:107], v[24:27]
  ds_read_b128 v[140:143], v2 offset:27648
  s_waitcnt lgkmcnt(9)
  v_mfma_f32_16x16x32_bf16 v[28:31], v[164:167], v[104:107], v[28:31]
  ds_read_b128 v[144:147], v2 offset:28672
  s_waitcnt lgkmcnt(9)
  v_mfma_f32_16x16x32_bf16 v[32:35], v[168:171], v[104:107], v[32:35]
  ds_read_b128 v[148:151], v2 offset:29696
  s_add_u32 m0, s61, 24576
  s_add_u32 s17, s34, 74752
  buffer_load_dwordx4 v1, s[4:7], s17 offen lds
  s_waitcnt lgkmcnt(9)
  v_mfma_f32_16x16x32_bf16 v[36:39], v[172:175], v[104:107], v[36:39]
  ds_read_b128 v[152:155], v2 offset:30720
  s_waitcnt vmcnt(15) lgkmcnt(9)
  v_mfma_f32_16x16x32_bf16 v[20:23], v[176:179], v[108:111], v[20:23]
  ds_read_b128 v[156:159], v2 offset:31744
  s_waitcnt lgkmcnt(9)
  v_mfma_f32_16x16x32_bf16 v[24:27], v[180:183], v[108:111], v[24:27]
  ds_read_b128 v[160:163], v2 offset:32768
  s_waitcnt lgkmcnt(9)
  v_mfma_f32_16x16x32_bf16 v[28:31], v[184:187], v[108:111], v[28:31]
  ds_read_b128 v[164:167], v2 offset:33792
  s_waitcnt lgkmcnt(9)
  v_mfma_f32_16x16x32_bf16 v[32:35], v[188:191], v[108:111], v[32:35]
  ds_read_b128 v[168:171], v2 offset:34816
  s_add_u32 m0, s61, 28672
  s_add_u32 s17, s34, 78848
  buffer_load_dwordx4 v1, s[4:7], s17 offen lds
  s_waitcnt lgkmcnt(9)
  v_mfma_f32_16x16x32_bf16 v[36:39], v[192:195], v[108:111], v[36:39]
  ds_read_b128 v[172:175], v2 offset:35840
  s_waitcnt vmcnt(12) lgkmcnt(9)
  v_mfma_f32_16x16x32_bf16 v[20:23], v[136:139], v[112:115], v[20:23]
  s_waitcnt lgkmcnt(8)
  v_mfma_f32_16x16x32_bf16 v[24:27], v[140:143], v[112:115], v[24:27]
  s_waitcnt lgkmcnt(7)
  v_mfma_f32_16x16x32_bf16 v[28:31], v[144:147], v[112:115], v[28:31]
  s_waitcnt lgkmcnt(6)
  v_mfma_f32_16x16x32_bf16 v[32:35], v[148:151], v[112:115], v[32:35]
  s_add_u32 m0, s61, 32768
  s_add_u32 s17, s34, 82944
  buffer_load_dwordx4 v1, s[4:7], s17 offen lds
  s_waitcnt lgkmcnt(5)
  v_mfma_f32_16x16x32_bf16 v[36:39], v[152:155], v[112:115], v[36:39]
  s_waitcnt vmcnt(9) lgkmcnt(4)
  v_mfma_f32_16x16x32_bf16 v[20:23], v[156:159], v[116:119], v[20:23]
  s_waitcnt lgkmcnt(3)
  v_mfma_f32_16x16x32_bf16 v[24:27], v[160:163], v[116:119], v[24:27]
  s_waitcnt lgkmcnt(2)
  v_mfma_f32_16x16x32_bf16 v[28:31], v[164:167], v[116:119], v[28:31]
  s_waitcnt lgkmcnt(1)
  v_mfma_f32_16x16x32_bf16 v[32:35], v[168:171], v[116:119], v[32:35]
  s_add_u32 m0, s61, 36864
  s_add_u32 s17, s34, 87040
  buffer_load_dwordx4 v1, s[4:7], s17 offen lds
  s_waitcnt lgkmcnt(0)
  v_mfma_f32_16x16x32_bf16 v[36:39], v[172:175], v[116:119], v[36:39]
  v_lshlrev_b32 v132, 16, v8
  v_and_b32 v133, 0xffff0000, v8
  v_pk_add_f32 v[20:21], v[20:21], v[132:133]
  v_lshlrev_b32 v132, 16, v9
  v_and_b32 v133, 0xffff0000, v9
  v_pk_add_f32 v[22:23], v[22:23], v[132:133]
  v_lshlrev_b32 v132, 16, v10
  v_and_b32 v133, 0xffff0000, v10
  v_pk_add_f32 v[24:25], v[24:25], v[132:133]
  v_lshlrev_b32 v132, 16, v11
  v_and_b32 v133, 0xffff0000, v11
  v_pk_add_f32 v[26:27], v[26:27], v[132:133]
  v_lshlrev_b32 v132, 16, v12
  v_and_b32 v133, 0xffff0000, v12
  v_pk_add_f32 v[28:29], v[28:29], v[132:133]
  v_lshlrev_b32 v132, 16, v13
  v_and_b32 v133, 0xffff0000, v13
  v_pk_add_f32 v[30:31], v[30:31], v[132:133]
  v_lshlrev_b32 v132, 16, v14
  v_and_b32 v133, 0xffff0000, v14
  v_pk_add_f32 v[32:33], v[32:33], v[132:133]
  v_lshlrev_b32 v132, 16, v15
  v_and_b32 v133, 0xffff0000, v15
  v_pk_add_f32 v[34:35], v[34:35], v[132:133]
  v_lshlrev_b32 v132, 16, v16
  v_and_b32 v133, 0xffff0000, v16
  v_pk_add_f32 v[36:37], v[36:37], v[132:133]
  v_lshlrev_b32 v132, 16, v17
  v_and_b32 v133, 0xffff0000, v17
  v_pk_add_f32 v[38:39], v[38:39], v[132:133]
  v_cvt_pk_bf16_f32 v120, v20, v21
  v_cvt_pk_bf16_f32 v121, v22, v23
  v_cvt_pk_bf16_f32 v122, v24, v25
  v_cvt_pk_bf16_f32 v123, v26, v27
  v_cvt_pk_bf16_f32 v124, v28, v29
  v_cvt_pk_bf16_f32 v125, v30, v31
  v_cvt_pk_bf16_f32 v126, v32, v33
  v_cvt_pk_bf16_f32 v127, v34, v35
  v_cvt_pk_bf16_f32 v128, v36, v37
  v_cvt_pk_bf16_f32 v129, v38, v39
  s_add_u32 s17, s28, s49
  buffer_store_dwordx4 v[120:123], v1, s[4:7], s17 offen offset:0 sc1
  buffer_store_dwordx4 v[124:127], v1, s[4:7], s17 offen offset:1024 sc1
  s_add_u32 s17, s29, s49
  v_lshlrev_b32 v7, 3, v0
  buffer_store_dwordx2 v[128:129], v7, s[4:7], s17 offen sc1
  v_pk_add_f32 v[132:133], v[20:21], v[22:23]
  v_pk_mul_f32 v[130:131], v[20:21], v[20:21]
  v_pk_fma_f32 v[130:131], v[22:23], v[22:23], v[130:131]
  v_pk_add_f32 v[132:133], v[132:133], v[24:25]
  v_pk_fma_f32 v[130:131], v[24:25], v[24:25], v[130:131]
  v_pk_add_f32 v[132:133], v[132:133], v[26:27]
  v_pk_fma_f32 v[130:131], v[26:27], v[26:27], v[130:131]
  v_pk_add_f32 v[132:133], v[132:133], v[28:29]
  v_pk_fma_f32 v[130:131], v[28:29], v[28:29], v[130:131]
  v_pk_add_f32 v[132:133], v[132:133], v[30:31]
  v_pk_fma_f32 v[130:131], v[30:31], v[30:31], v[130:131]
  v_pk_add_f32 v[132:133], v[132:133], v[32:33]
  v_pk_fma_f32 v[130:131], v[32:33], v[32:33], v[130:131]
  v_pk_add_f32 v[132:133], v[132:133], v[34:35]
  v_pk_fma_f32 v[130:131], v[34:35], v[34:35], v[130:131]
  v_pk_add_f32 v[132:133], v[132:133], v[36:37]
  v_pk_fma_f32 v[130:131], v[36:37], v[36:37], v[130:131]
  v_pk_add_f32 v[132:133], v[132:133], v[38:39]
  v_pk_fma_f32 v[130:131], v[38:39], v[38:39], v[130:131]
  v_add_f32 v131, v130, v131
  v_add_f32 v130, v132, v133
  s_nop 1
  v_permlane16_swap_b32 v130, v131
  v_add_f32 v130, v130, v131
  v_mov_b32 v131, v130
  s_nop 1
  v_permlane32_swap_b32 v130, v131
  v_add_f32 v130, v130, v131
  v_mov_b32 v131, v130
  s_nop 1
  v_permlane16_swap_b32 v130, v131
  s_lshl_b32 s17, s60, 10
  s_lshl_b32 s18, s13, 7
  s_add_u32 s17, s17, s18
  s_add_u32 s17, s17, s52
  s_mov_b64 exec, 0xffff
  buffer_store_dwordx2 v[130:131], v7, s[4:7], s17 offen sc1
  s_mov_b64 exec, -1
  s_waitcnt vmcnt(0)
  s_barrier
  s_cmp_lg_u32 s8, 0
  s_cbranch_scc1 sig_52
  s_lshl_b32 s17, s9, 7
  s_add_u32 s17, s17, s57
  s_add_u32 s17, s17, 4096
  s_mov_b64 exec, 1
  v_mov_b32 v7, 1
  buffer_atomic_add v7, off, s[4:7], s17
  s_mov_b64 exec, -1
sig_52:
  s_add_u32 m0, s61, 40960
  s_add_u32 s17, s34, 91136
  buffer_load_dwordx4 v1, s[4:7], s17 offen lds
  s_add_u32 m0, s61, 45056
  s_add_u32 s17, s34, 95232
  buffer_load_dwordx4 v1, s[4:7], s17 offen lds
  s_add_u32 m0, s61, 49152
  s_add_u32 s17, s34, 99328
  buffer_load_dwordx4 v1, s[4:7], s17 offen lds
  s_add_u32 m0, s61, 53248
  s_add_u32 s17, s34, 103424
  buffer_load_dwordx4 v1, s[4:7], s17 offen lds
  s_add_u32 m0, s61, 57344
  s_add_u32 s17, s34, 107520
  buffer_load_dwordx4 v1, s[4:7], s17 offen lds
  s_add_u32 m0, s61, 61440
  s_add_u32 s17, s34, 111616
  buffer_load_dwordx4 v1, s[4:7], s17 offen lds
  s_add_u32 m0, s61, 65536
  s_add_u32 s17, s34, 115712
  buffer_load_dwordx4 v1, s[4:7], s17 offen lds
  s_add_u32 m0, s61, 69632
  s_add_u32 s17, s34, 119808
  buffer_load_dwordx4 v1, s[4:7], s17 offen lds
  s_add_u32 m0, s61, 73728
  s_add_u32 s17, s34, 123904
  buffer_load_dwordx4 v1, s[4:7], s17 offen lds
  s_add_u32 m0, s61, 77824
  s_add_u32 s17, s34, 128000
  buffer_load_dwordx4 v1, s[4:7], s17 offen lds
  s_add_u32 m0, s61, 81920
  s_add_u32 s17, s34, 132096
  buffer_load_dwordx4 v1, s[4:7], s17 offen lds
  s_add_u32 m0, s61, 86016
  s_add_u32 s17, s34, 136192
  buffer_load_dwordx4 v1, s[4:7], s17 offen lds
  s_add_u32 m0, s61, 90112
  s_add_u32 s17, s34, 140288
  buffer_load_dwordx4 v1, s[4:7], s17 offen lds
  s_and_b32 s17, s10, 7
  s_mul_i32 s26, s17, 7
  s_cmp_eq_u32 s17, 7
  s_cselect_b32 s26, 48, s26
  s_lshr_b32 s3, s10, 3
  s_mul_i32 s3, s3, 54
  s_add_u32 s26, s26, s3
  v_lshlrev_b32 v7, 3, v5
  s_lshl_b32 s17, s26, 5
  buffer_load_dwordx2 v[72:73], v7, s[36:39], s17 offen offset:0
  buffer_load_dwordx2 v[74:75], v7, s[36:39], s17 offen offset:32
  buffer_load_dwordx2 v[76:77], v7, s[36:39], s17 offen offset:64
  buffer_load_dwordx2 v[78:79], v7, s[36:39], s17 offen offset:96
  buffer_load_dwordx2 v[80:81], v7, s[36:39], s17 offen offset:128
  buffer_load_dwordx2 v[82:83], v7, s[36:39], s17 offen offset:160
  buffer_load_dwordx2 v[84:85], v7, s[36:39], s17 offen offset:192
  s_mul_i32 s21, s59, 20480
  s_add_u32 s21, s21, s49
  s_add_u32 s22, s21, 20480
  s_cmp_lg_u32 s8, 0
  s_cbranch_scc1 wbar_53
  s_cmp_lg_u32 s58, 0
  s_cbranch_scc1 wbar_53
  s_lshl_b32 s17, s9, 7
  s_add_u32 s17, s17, s57
  s_add_u32 s17, s17, 4096
  s_mov_b32 s18, 0
  s_mov_b64 exec, 1
poll_54:
  buffer_load_dword v7, off, s[4:7], s17 sc1
  s_waitcnt vmcnt(0)
  v_readfirstlane_b32 s19, v7
  s_nop 3
  s_cmp_ge_u32 s19, 16
  s_cbranch_scc1 pdone_55
  s_add_u32 s18, s18, 1
  s_cmp_lt_u32 s18, 0x20000
  s_cbranch_scc1 poll_54
  s_mov_b32 s58, 1
pdone_55:
  s_mov_b64 exec, -1
wbar_53:
  s_barrier
  buffer_load_dwordx4 v[144:147], v1, s[4:7], s21 offen offset:0 sc1
  buffer_load_dwordx4 v[148:151], v1, s[4:7], s22 offen offset:0 sc1
  buffer_load_dwordx4 v[152:155], v1, s[4:7], s21 offen offset:1024 sc1
  buffer_load_dwordx4 v[156:159], v1, s[4:7], s22 offen offset:1024 sc1
  v_lshlrev_b32 v7, 3, v4
  v_lshl_add_u32 v7, v5, 8, v7
  s_lshl_b32 s17, s59, 10
  s_add_u32 s17, s17, s52
  buffer_load_dwordx2 v[64:65], v7, s[4:7], s17 offen offset:0 sc1
  buffer_load_dwordx2 v[66:67], v7, s[4:7], s17 offen offset:128 sc1
  buffer_load_dwordx2 v[68:69], v7, s[4:7], s17 offen offset:1024 sc1
  buffer_load_dwordx2 v[70:71], v7, s[4:7], s17 offen offset:1152 sc1
  buffer_load_dwordx4 v[160:163], v1, s[4:7], s21 offen offset:2048 sc1
  buffer_load_dwordx4 v[164:167], v1, s[4:7], s22 offen offset:2048 sc1
  buffer_load_dwordx4 v[168:171], v1, s[4:7], s21 offen offset:3072 sc1
  buffer_load_dwordx4 v[172:175], v1, s[4:7], s22 offen offset:3072 sc1
  s_add_u32 s21, s21, 4096
  buffer_load_dwordx4 v[176:179], v1, s[4:7], s21 offen offset:0 sc1
  s_add_u32 s22, s22, 4096
  buffer_load_dwordx4 v[180:183], v1, s[4:7], s22 offen offset:0 sc1
  buffer_load_dwordx4 v[184:187], v1, s[4:7], s21 offen offset:1024 sc1
  buffer_load_dwordx4 v[188:191], v1, s[4:7], s22 offen offset:1024 sc1
  buffer_load_dwordx4 v[192:195], v1, s[4:7], s21 offen offset:2048 sc1
  buffer_load_dwordx4 v[196:199], v1, s[4:7], s22 offen offset:2048 sc1
  buffer_load_dwordx4 v[200:203], v1, s[4:7], s21 offen offset:3072 sc1
  buffer_load_dwordx4 v[204:207], v1, s[4:7], s22 offen offset:3072 sc1
  ds_read_b128 v[88:91], v2 offset:36864
  ds_read_b128 v[92:95], v2 offset:37888
  ds_read_b128 v[96:99], v2 offset:38912
  ds_read_b128 v[100:103], v2 offset:39936
  ds_read_b128 v[104:107], v2 offset:40960
  ds_read_b128 v[108:111], v2 offset:41984
  ds_read_b128 v[112:115], v2 offset:43008
  s_waitcnt vmcnt(18) lgkmcnt(6)
  v_mfma_f32_16x16x32_bf16 v[8:11], v[88:91], v[144:147], 0
  ds_read_b128 v[116:119], v2 offset:44032
  v_mfma_f32_16x16x32_bf16 v[36:39], v[88:91], v[148:151], 0
  ds_read_b128 v[120:123], v2 offset:45056
  s_waitcnt lgkmcnt(7)
  v_mfma_f32_16x16x32_bf16 v[12:15], v[92:95], v[144:147], 0
  ds_read_b128 v[124:127], v2 offset:46080
  v_mfma_f32_16x16x32_bf16 v[40:43], v[92:95], v[148:151], 0
  ds_read_b128 v[128:131], v2 offset:47104
  s_add_u32 s21, s21, 4096
  buffer_load_dwordx4 v[208:211], v1, s[4:7], s21 offen offset:0 sc1
  s_waitcnt lgkmcnt(8)
  v_mfma_f32_16x16x32_bf16 v[16:19], v[96:99], v[144:147], 0
  ds_read_b128 v[132:135], v2 offset:48128
  v_mfma_f32_16x16x32_bf16 v[44:47], v[96:99], v[148:151], 0
  ds_read_b128 v[136:139], v2 offset:49152
  s_waitcnt lgkmcnt(9)
  v_mfma_f32_16x16x32_bf16 v[20:23], v[100:103], v[144:147], 0
  ds_read_b128 v[140:143], v2 offset:50176
  v_mfma_f32_16x16x32_bf16 v[48:51], v[100:103], v[148:151], 0
  s_waitcnt lgkmcnt(9)
  v_mfma_f32_16x16x32_bf16 v[24:27], v[104:107], v[144:147], 0
  v_mfma_f32_16x16x32_bf16 v[52:55], v[104:107], v[148:151], 0
  s_waitcnt lgkmcnt(8)
  v_mfma_f32_16x16x32_bf16 v[28:31], v[108:111], v[144:147], 0
  s_add_u32 s22, s22, 4096
  buffer_load_dwordx4 v[212:215], v1, s[4:7], s22 offen offset:0 sc1
  v_mfma_f32_16x16x32_bf16 v[56:59], v[108:111], v[148:151], 0
  s_waitcnt lgkmcnt(7)
  v_mfma_f32_16x16x32_bf16 v[32:35], v[112:115], v[144:147], 0
  v_mfma_f32_16x16x32_bf16 v[60:63], v[112:115], v[148:151], 0
  s_waitcnt vmcnt(18) lgkmcnt(6)
  v_mfma_f32_16x16x32_bf16 v[8:11], v[116:119], v[152:155], v[8:11]
  ds_read_b128 v[88:91], v2 offset:51200
  v_mfma_f32_16x16x32_bf16 v[36:39], v[116:119], v[156:159], v[36:39]
  ds_read_b128 v[92:95], v2 offset:52224
  s_waitcnt lgkmcnt(7)
  v_mfma_f32_16x16x32_bf16 v[12:15], v[120:123], v[152:155], v[12:15]
  ds_read_b128 v[96:99], v2 offset:53248
  v_mfma_f32_16x16x32_bf16 v[40:43], v[120:123], v[156:159], v[40:43]
  ds_read_b128 v[100:103], v2 offset:54272
  buffer_load_dwordx4 v[216:219], v1, s[4:7], s21 offen offset:1024 sc1
  s_waitcnt lgkmcnt(8)
  v_mfma_f32_16x16x32_bf16 v[16:19], v[124:127], v[152:155], v[16:19]
  ds_read_b128 v[104:107], v2 offset:55296
  v_mfma_f32_16x16x32_bf16 v[44:47], v[124:127], v[156:159], v[44:47]
  ds_read_b128 v[108:111], v2 offset:56320
  s_waitcnt lgkmcnt(9)
  v_mfma_f32_16x16x32_bf16 v[20:23], v[128:131], v[152:155], v[20:23]
  ds_read_b128 v[112:115], v2 offset:57344
  v_mfma_f32_16x16x32_bf16 v[48:51], v[128:131], v[156:159], v[48:51]
  s_waitcnt lgkmcnt(9)
  v_mfma_f32_16x16x32_bf16 v[24:27], v[132:135], v[152:155], v[24:27]
  v_mfma_f32_16x16x32_bf16 v[52:55], v[132:135], v[156:159], v[52:55]
  s_waitcnt lgkmcnt(8)
  v_mfma_f32_16x16x32_bf16 v[28:31], v[136:139], v[152:155], v[28:31]
  buffer_load_dwordx4 v[220:223], v1, s[4:7], s22 offen offset:1024 sc1
  v_mfma_f32_16x16x32_bf16 v[56:59], v[136:139], v[156:159], v[56:59]
  s_waitcnt lgkmcnt(7)
  v_mfma_f32_16x16x32_bf16 v[32:35], v[140:143], v[152:155], v[32:35]
  v_mfma_f32_16x16x32_bf16 v[60:63], v[140:143], v[156:159], v[60:63]
  s_waitcnt vmcnt(14) lgkmcnt(6)
  v_mfma_f32_16x16x32_bf16 v[8:11], v[88:91], v[160:163], v[8:11]
  ds_read_b128 v[116:119], v2 offset:58368
  v_mfma_f32_16x16x32_bf16 v[36:39], v[88:91], v[164:167], v[36:39]
  ds_read_b128 v[120:123], v2 offset:59392
  s_waitcnt lgkmcnt(7)
  v_mfma_f32_16x16x32_bf16 v[12:15], v[92:95], v[160:163], v[12:15]
  ds_read_b128 v[124:127], v2 offset:60416
  v_mfma_f32_16x16x32_bf16 v[40:43], v[92:95], v[164:167], v[40:43]
  ds_read_b128 v[128:131], v2 offset:61440
  buffer_load_dwordx4 v[224:227], v1, s[4:7], s21 offen offset:2048 sc1
  s_waitcnt lgkmcnt(8)
  v_mfma_f32_16x16x32_bf16 v[16:19], v[96:99], v[160:163], v[16:19]
  ds_read_b128 v[132:135], v2 offset:62464
  v_mfma_f32_16x16x32_bf16 v[44:47], v[96:99], v[164:167], v[44:47]
  ds_read_b128 v[136:139], v2 offset:63488
  s_waitcnt lgkmcnt(9)
  v_mfma_f32_16x16x32_bf16 v[20:23], v[100:103], v[160:163], v[20:23]
  ds_read_b128 v[140:143], v2 offset:64512
  v_mfma_f32_16x16x32_bf16 v[48:51], v[100:103], v[164:167], v[48:51]
  s_waitcnt lgkmcnt(9)
  v_mfma_f32_16x16x32_bf16 v[24:27], v[104:107], v[160:163], v[24:27]
  v_mfma_f32_16x16x32_bf16 v[52:55], v[104:107], v[164:167], v[52:55]
  s_waitcnt lgkmcnt(8)
  v_mfma_f32_16x16x32_bf16 v[28:31], v[108:111], v[160:163], v[28:31]
  buffer_load_dwordx4 v[228:231], v1, s[4:7], s22 offen offset:2048 sc1
  v_mfma_f32_16x16x32_bf16 v[56:59], v[108:111], v[164:167], v[56:59]
  s_waitcnt lgkmcnt(7)
  v_mfma_f32_16x16x32_bf16 v[32:35], v[112:115], v[160:163], v[32:35]
  v_mfma_f32_16x16x32_bf16 v[60:63], v[112:115], v[164:167], v[60:63]
  s_waitcnt vmcnt(14) lgkmcnt(6)
  v_mfma_f32_16x16x32_bf16 v[8:11], v[116:119], v[168:171], v[8:11]
  ds_read_b128 v[88:91], v3 offset:0
  v_mfma_f32_16x16x32_bf16 v[36:39], v[116:119], v[172:175], v[36:39]
  ds_read_b128 v[92:95], v3 offset:1024
  s_waitcnt lgkmcnt(7)
  v_mfma_f32_16x16x32_bf16 v[12:15], v[120:123], v[168:171], v[12:15]
  ds_read_b128 v[96:99], v3 offset:2048
  v_mfma_f32_16x16x32_bf16 v[40:43], v[120:123], v[172:175], v[40:43]
  ds_read_b128 v[100:103], v3 offset:3072
  buffer_load_dwordx4 v[232:235], v1, s[4:7], s21 offen offset:3072 sc1
  s_waitcnt lgkmcnt(8)
  v_mfma_f32_16x16x32_bf16 v[16:19], v[124:127], v[168:171], v[16:19]
  ds_read_b128 v[104:107], v3 offset:4096
  v_mfma_f32_16x16x32_bf16 v[44:47], v[124:127], v[172:175], v[44:47]
  ds_read_b128 v[108:111], v3 offset:5120
  s_waitcnt lgkmcnt(9)
  v_mfma_f32_16x16x32_bf16 v[20:23], v[128:131], v[168:171], v[20:23]
  ds_read_b128 v[112:115], v3 offset:6144
  v_mfma_f32_16x16x32_bf16 v[48:51], v[128:131], v[172:175], v[48:51]
  s_waitcnt lgkmcnt(9)
  v_mfma_f32_16x16x32_bf16 v[24:27], v[132:135], v[168:171], v[24:27]
  v_mfma_f32_16x16x32_bf16 v[52:55], v[132:135], v[172:175], v[52:55]
  s_waitcnt lgkmcnt(8)
  v_mfma_f32_16x16x32_bf16 v[28:31], v[136:139], v[168:171], v[28:31]
  buffer_load_dwordx4 v[236:239], v1, s[4:7], s22 offen offset:3072 sc1
  v_mfma_f32_16x16x32_bf16 v[56:59], v[136:139], v[172:175], v[56:59]
  s_waitcnt lgkmcnt(7)
  v_mfma_f32_16x16x32_bf16 v[32:35], v[140:143], v[168:171], v[32:35]
  v_mfma_f32_16x16x32_bf16 v[60:63], v[140:143], v[172:175], v[60:63]
  s_waitcnt vmcnt(14) lgkmcnt(6)
  v_mfma_f32_16x16x32_bf16 v[8:11], v[88:91], v[176:179], v[8:11]
  ds_read_b128 v[116:119], v3 offset:7168
  v_mfma_f32_16x16x32_bf16 v[36:39], v[88:91], v[180:183], v[36:39]
  ds_read_b128 v[120:123], v3 offset:8192
  s_waitcnt lgkmcnt(7)
  v_mfma_f32_16x16x32_bf16 v[12:15], v[92:95], v[176:179], v[12:15]
  ds_read_b128 v[124:127], v3 offset:9216
  v_mfma_f32_16x16x32_bf16 v[40:43], v[92:95], v[180:183], v[40:43]
  ds_read_b128 v[128:131], v3 offset:10240
  s_add_u32 s21, s21, 4096
  buffer_load_dwordx4 v[144:147], v1, s[4:7], s21 offen offset:0 sc1
  s_waitcnt lgkmcnt(8)
  v_mfma_f32_16x16x32_bf16 v[16:19], v[96:99], v[176:179], v[16:19]
  ds_read_b128 v[132:135], v3 offset:11264
  v_mfma_f32_16x16x32_bf16 v[44:47], v[96:99], v[180:183], v[44:47]
  ds_read_b128 v[136:139], v3 offset:12288
  s_waitcnt lgkmcnt(9)
  v_mfma_f32_16x16x32_bf16 v[20:23], v[100:103], v[176:179], v[20:23]
  ds_read_b128 v[140:143], v3 offset:13312
  v_mfma_f32_16x16x32_bf16 v[48:51], v[100:103], v[180:183], v[48:51]
  s_waitcnt lgkmcnt(9)
  v_mfma_f32_16x16x32_bf16 v[24:27], v[104:107], v[176:179], v[24:27]
  v_mfma_f32_16x16x32_bf16 v[52:55], v[104:107], v[180:183], v[52:55]
  s_waitcnt lgkmcnt(8)
  v_mfma_f32_16x16x32_bf16 v[28:31], v[108:111], v[176:179], v[28:31]
  s_add_u32 s22, s22, 4096
  buffer_load_dwordx4 v[148:151], v1, s[4:7], s22 offen offset:0 sc1
  v_mfma_f32_16x16x32_bf16 v[56:59], v[108:111], v[180:183], v[56:59]
  s_waitcnt lgkmcnt(7)
  v_mfma_f32_16x16x32_bf16 v[32:35], v[112:115], v[176:179], v[32:35]
  v_mfma_f32_16x16x32_bf16 v[60:63], v[112:115], v[180:183], v[60:63]
  s_waitcnt vmcnt(14) lgkmcnt(6)
  v_mfma_f32_16x16x32_bf16 v[8:11], v[116:119], v[184:187], v[8:11]
  ds_read_b128 v[88:91], v3 offset:14336
  v_mfma_f32_16x16x32_bf16 v[36:39], v[116:119], v[188:191], v[36:39]
  ds_read_b128 v[92:95], v3 offset:15360
  s_waitcnt lgkmcnt(7)
  v_mfma_f32_16x16x32_bf16 v[12:15], v[120:123], v[184:187], v[12:15]
  ds_read_b128 v[96:99], v3 offset:16384
  v_mfma_f32_16x16x32_bf16 v[40:43], v[120:123], v[188:191], v[40:43]
  ds_read_b128 v[100:103], v3 offset:17408
  buffer_load_dwordx4 v[152:155], v1, s[4:7], s21 offen offset:1024 sc1
  s_waitcnt lgkmcnt(8)
  v_mfma_f32_16x16x32_bf16 v[16:19], v[124:127], v[184:187], v[16:19]
  ds_read_b128 v[104:107], v3 offset:18432
  v_mfma_f32_16x16x32_bf16 v[44:47], v[124:127], v[188:191], v[44:47]
  ds_read_b128 v[108:111], v3 offset:19456
  s_waitcnt lgkmcnt(9)
  v_mfma_f32_16x16x32_bf16 v[20:23], v[128:131], v[184:187], v[20:23]
  ds_read_b128 v[112:115], v3 offset:20480
  v_mfma_f32_16x16x32_bf16 v[48:51], v[128:131], v[188:191], v[48:51]
  s_waitcnt lgkmcnt(9)
  v_mfma_f32_16x16x32_bf16 v[24:27], v[132:135], v[184:187], v[24:27]
  v_mfma_f32_16x16x32_bf16 v[52:55], v[132:135], v[188:191], v[52:55]
  s_waitcnt lgkmcnt(8)
  v_mfma_f32_16x16x32_bf16 v[28:31], v[136:139], v[184:187], v[28:31]
  buffer_load_dwordx4 v[156:159], v1, s[4:7], s22 offen offset:1024 sc1
  v_mfma_f32_16x16x32_bf16 v[56:59], v[136:139], v[188:191], v[56:59]
  s_waitcnt lgkmcnt(7)
  v_mfma_f32_16x16x32_bf16 v[32:35], v[140:143], v[184:187], v[32:35]
  v_mfma_f32_16x16x32_bf16 v[60:63], v[140:143], v[188:191], v[60:63]
  s_waitcnt vmcnt(32)
  s_barrier
  s_waitcnt vmcnt(14) lgkmcnt(6)
  v_mfma_f32_16x16x32_bf16 v[8:11], v[88:91], v[192:195], v[8:11]
  ds_read_b128 v[116:119], v1 offset:0
  v_mfma_f32_16x16x32_bf16 v[36:39], v[88:91], v[196:199], v[36:39]
  ds_read_b128 v[120:123], v1 offset:1024
  s_waitcnt lgkmcnt(7)
  v_mfma_f32_16x16x32_bf16 v[12:15], v[92:95], v[192:195], v[12:15]
  ds_read_b128 v[124:127], v1 offset:2048
  v_mfma_f32_16x16x32_bf16 v[40:43], v[92:95], v[196:199], v[40:43]
  ds_read_b128 v[128:131], v1 offset:3072
  buffer_load_dwordx4 v[160:163], v1, s[4:7], s21 offen offset:2048 sc1
  s_waitcnt lgkmcnt(8)
  v_mfma_f32_16x16x32_bf16 v[16:19], v[96:99], v[192:195], v[16:19]
  ds_read_b128 v[132:135], v1 offset:4096
  v_mfma_f32_16x16x32_bf16 v[44:47], v[96:99], v[196:199], v[44:47]
  ds_read_b128 v[136:139], v1 offset:5120
  s_waitcnt lgkmcnt(9)
  v_mfma_f32_16x16x32_bf16 v[20:23], v[100:103], v[192:195], v[20:23]
  ds_read_b128 v[140:143], v1 offset:6144
  v_mfma_f32_16x16x32_bf16 v[48:51], v[100:103], v[196:199], v[48:51]
  s_waitcnt lgkmcnt(9)
  v_mfma_f32_16x16x32_bf16 v[24:27], v[104:107], v[192:195], v[24:27]
  v_mfma_f32_16x16x32_bf16 v[52:55], v[104:107], v[196:199], v[52:55]
  s_waitcnt lgkmcnt(8)
  v_mfma_f32_16x16x32_bf16 v[28:31], v[108:111], v[192:195], v[28:31]
  buffer_load_dwordx4 v[164:167], v1, s[4:7], s22 offen offset:2048 sc1
  v_mfma_f32_16x16x32_bf16 v[56:59], v[108:111], v[196:199], v[56:59]
  s_waitcnt lgkmcnt(7)
  v_mfma_f32_16x16x32_bf16 v[32:35], v[112:115], v[192:195], v[32:35]
  v_mfma_f32_16x16x32_bf16 v[60:63], v[112:115], v[196:199], v[60:63]
  s_waitcnt vmcnt(14) lgkmcnt(6)
  v_mfma_f32_16x16x32_bf16 v[8:11], v[116:119], v[200:203], v[8:11]
  ds_read_b128 v[88:91], v1 offset:7168
  v_mfma_f32_16x16x32_bf16 v[36:39], v[116:119], v[204:207], v[36:39]
  ds_read_b128 v[92:95], v1 offset:8192
  s_waitcnt lgkmcnt(7)
  v_mfma_f32_16x16x32_bf16 v[12:15], v[120:123], v[200:203], v[12:15]
  ds_read_b128 v[96:99], v1 offset:9216
  v_mfma_f32_16x16x32_bf16 v[40:43], v[120:123], v[204:207], v[40:43]
  ds_read_b128 v[100:103], v1 offset:10240
  buffer_load_dwordx4 v[168:171], v1, s[4:7], s21 offen offset:3072 sc1
  s_waitcnt lgkmcnt(8)
  v_mfma_f32_16x16x32_bf16 v[16:19], v[124:127], v[200:203], v[16:19]
  ds_read_b128 v[104:107], v1 offset:11264
  v_mfma_f32_16x16x32_bf16 v[44:47], v[124:127], v[204:207], v[44:47]
  ds_read_b128 v[108:111], v1 offset:12288
  s_waitcnt lgkmcnt(9)
  v_mfma_f32_16x16x32_bf16 v[20:23], v[128:131], v[200:203], v[20:23]
  ds_read_b128 v[112:115], v1 offset:13312
  v_mfma_f32_16x16x32_bf16 v[48:51], v[128:131], v[204:207], v[48:51]
  s_waitcnt lgkmcnt(9)
  v_mfma_f32_16x16x32_bf16 v[24:27], v[132:135], v[200:203], v[24:27]
  v_mfma_f32_16x16x32_bf16 v[52:55], v[132:135], v[204:207], v[52:55]
  s_waitcnt lgkmcnt(8)
  v_mfma_f32_16x16x32_bf16 v[28:31], v[136:139], v[200:203], v[28:31]
  buffer_load_dwordx4 v[172:175], v1, s[4:7], s22 offen offset:3072 sc1
  v_mfma_f32_16x16x32_bf16 v[56:59], v[136:139], v[204:207], v[56:59]
  s_waitcnt lgkmcnt(7)
  v_mfma_f32_16x16x32_bf16 v[32:35], v[140:143], v[200:203], v[32:35]
  v_mfma_f32_16x16x32_bf16 v[60:63], v[140:143], v[204:207], v[60:63]
  s_waitcnt vmcnt(14) lgkmcnt(6)
  v_mfma_f32_16x16x32_bf16 v[8:11], v[88:91], v[208:211], v[8:11]
  ds_read_b128 v[116:119], v1 offset:14336
  v_mfma_f32_16x16x32_bf16 v[36:39], v[88:91], v[212:215], v[36:39]
  ds_read_b128 v[120:123], v1 offset:15360
  s_waitcnt lgkmcnt(7)
  v_mfma_f32_16x16x32_bf16 v[12:15], v[92:95], v[208:211], v[12:15]
  ds_read_b128 v[124:127], v1 offset:16384
  v_mfma_f32_16x16x32_bf16 v[40:43], v[92:95], v[212:215], v[40:43]
  ds_read_b128 v[128:131], v1 offset:17408
  s_add_u32 s21, s21, 4096
  v_lshlrev_b32 v7, 3, v0
  buffer_load_dwordx2 v[176:177], v7, s[4:7], s21 offen offset:0 sc1
  buffer_load_dwordx2 v[178:179], v7, s[4:7], s21 offen offset:512 sc1
  s_waitcnt lgkmcnt(8)
  v_mfma_f32_16x16x32_bf16 v[16:19], v[96:99], v[208:211], v[16:19]
  ds_read_b128 v[132:135], v1 offset:18432
  v_mfma_f32_16x16x32_bf16 v[44:47], v[96:99], v[212:215], v[44:47]
  ds_read_b128 v[136:139], v1 offset:19456
  s_waitcnt lgkmcnt(9)
  v_mfma_f32_16x16x32_bf16 v[20:23], v[100:103], v[208:211], v[20:23]
  ds_read_b128 v[140:143], v1 offset:20480
  v_mfma_f32_16x16x32_bf16 v[48:51], v[100:103], v[212:215], v[48:51]
  s_waitcnt lgkmcnt(9)
  v_mfma_f32_16x16x32_bf16 v[24:27], v[104:107], v[208:211], v[24:27]
  v_mfma_f32_16x16x32_bf16 v[52:55], v[104:107], v[212:215], v[52:55]
  s_waitcnt lgkmcnt(8)
  v_mfma_f32_16x16x32_bf16 v[28:31], v[108:111], v[208:211], v[28:31]
  s_add_u32 s22, s22, 4096
  v_lshlrev_b32 v7, 3, v0
  buffer_load_dwordx2 v[180:181], v7, s[4:7], s22 offen offset:0 sc1
  buffer_load_dwordx2 v[182:183], v7, s[4:7], s22 offen offset:512 sc1
  v_mfma_f32_16x16x32_bf16 v[56:59], v[108:111], v[212:215], v[56:59]
  s_waitcnt lgkmcnt(7)
  v_mfma_f32_16x16x32_bf16 v[32:35], v[112:115], v[208:211], v[32:35]
  v_mfma_f32_16x16x32_bf16 v[60:63], v[112:115], v[212:215], v[60:63]
  s_waitcnt vmcnt(16) lgkmcnt(6)
  v_mfma_f32_16x16x32_bf16 v[8:11], v[116:119], v[216:219], v[8:11]
  ds_read_b128 v[88:91], v1 offset:21504
  v_mfma_f32_16x16x32_bf16 v[36:39], v[116:119], v[220:223], v[36:39]
  ds_read_b128 v[92:95], v1 offset:22528
  s_waitcnt lgkmcnt(7)
  v_mfma_f32_16x16x32_bf16 v[12:15], v[120:123], v[216:219], v[12:15]
  ds_read_b128 v[96:99], v1 offset:23552
  v_mfma_f32_16x16x32_bf16 v[40:43], v[120:123], v[220:223], v[40:43]
  ds_read_b128 v[100:103], v1 offset:24576
  v_lshlrev_b32 v7, 3, v0
  buffer_load_dwordx2 v[184:185], v7, s[4:7], s21 offen offset:1024 sc1
  buffer_load_dwordx2 v[186:187], v7, s[4:7], s21 offen offset:1536 sc1
  s_waitcnt lgkmcnt(8)
  v_mfma_f32_16x16x32_bf16 v[16:19], v[124:127], v[216:219], v[16:19]
  ds_read_b128 v[104:107], v1 offset:25600
  v_mfma_f32_16x16x32_bf16 v[44:47], v[124:127], v[220:223], v[44:47]
  ds_read_b128 v[108:111], v1 offset:26624
  s_waitcnt lgkmcnt(9)
  v_mfma_f32_16x16x32_bf16 v[20:23], v[128:131], v[216:219], v[20:23]
  ds_read_b128 v[112:115], v1 offset:27648
  v_mfma_f32_16x16x32_bf16 v[48:51], v[128:131], v[220:223], v[48:51]
  s_waitcnt lgkmcnt(9)
  v_mfma_f32_16x16x32_bf16 v[24:27], v[132:135], v[216:219], v[24:27]
  v_mfma_f32_16x16x32_bf16 v[52:55], v[132:135], v[220:223], v[52:55]
  s_waitcnt lgkmcnt(8)
  v_mfma_f32_16x16x32_bf16 v[28:31], v[136:139], v[216:219], v[28:31]
  v_lshlrev_b32 v7, 3, v0
  buffer_load_dwordx2 v[188:189], v7, s[4:7], s22 offen offset:1024 sc1
  buffer_load_dwordx2 v[190:191], v7, s[4:7], s22 offen offset:1536 sc1
  v_mfma_f32_16x16x32_bf16 v[56:59], v[136:139], v[220:223], v[56:59]
  s_waitcnt lgkmcnt(7)
  v_mfma_f32_16x16x32_bf16 v[32:35], v[140:143], v[216:219], v[32:35]
  v_mfma_f32_16x16x32_bf16 v[60:63], v[140:143], v[220:223], v[60:63]
  s_waitcnt vmcnt(18) lgkmcnt(6)
  v_mfma_f32_16x16x32_bf16 v[8:11], v[88:91], v[224:227], v[8:11]
  ds_read_b128 v[116:119], v1 offset:28672
  v_mfma_f32_16x16x32_bf16 v[36:39], v[88:91], v[228:231], v[36:39]
  ds_read_b128 v[120:123], v1 offset:29696
  s_waitcnt lgkmcnt(7)
  v_mfma_f32_16x16x32_bf16 v[12:15], v[92:95], v[224:227], v[12:15]
  ds_read_b128 v[124:127], v1 offset:30720
  v_mfma_f32_16x16x32_bf16 v[40:43], v[92:95], v[228:231], v[40:43]
  ds_read_b128 v[128:131], v1 offset:31744
  v_lshlrev_b32 v7, 3, v0
  buffer_load_dwordx2 v[192:193], v7, s[4:7], s21 offen offset:2048 sc1
  buffer_load_dwordx2 v[194:195], v7, s[4:7], s21 offen offset:2560 sc1
  s_waitcnt lgkmcnt(8)
  v_mfma_f32_16x16x32_bf16 v[16:19], v[96:99], v[224:227], v[16:19]
  ds_read_b128 v[132:135], v1 offset:32768
  v_mfma_f32_16x16x32_bf16 v[44:47], v[96:99], v[228:231], v[44:47]
  ds_read_b128 v[136:139], v1 offset:33792
  s_waitcnt lgkmcnt(9)
  v_mfma_f32_16x16x32_bf16 v[20:23], v[100:103], v[224:227], v[20:23]
  ds_read_b128 v[140:143], v1 offset:34816
  v_mfma_f32_16x16x32_bf16 v[48:51], v[100:103], v[228:231], v[48:51]
  s_waitcnt lgkmcnt(9)
  v_mfma_f32_16x16x32_bf16 v[24:27], v[104:107], v[224:227], v[24:27]
  v_mfma_f32_16x16x32_bf16 v[52:55], v[104:107], v[228:231], v[52:55]
  s_waitcnt lgkmcnt(8)
  v_mfma_f32_16x16x32_bf16 v[28:31], v[108:111], v[224:227], v[28:31]
  v_lshlrev_b32 v7, 3, v0
  buffer_load_dwordx2 v[196:197], v7, s[4:7], s22 offen offset:2048 sc1
  buffer_load_dwordx2 v[198:199], v7, s[4:7], s22 offen offset:2560 sc1
  v_mfma_f32_16x16x32_bf16 v[56:59], v[108:111], v[228:231], v[56:59]
  s_waitcnt lgkmcnt(7)
  v_mfma_f32_16x16x32_bf16 v[32:35], v[112:115], v[224:227], v[32:35]
  v_mfma_f32_16x16x32_bf16 v[60:63], v[112:115], v[228:231], v[60:63]
  s_waitcnt vmcnt(20) lgkmcnt(6)
  v_mfma_f32_16x16x32_bf16 v[8:11], v[116:119], v[232:235], v[8:11]
  ds_read_b128 v[88:91], v1 offset:35840
  v_mfma_f32_16x16x32_bf16 v[36:39], v[116:119], v[236:239], v[36:39]
  ds_read_b128 v[92:95], v1 offset:36864
  s_waitcnt lgkmcnt(7)
  v_mfma_f32_16x16x32_bf16 v[12:15], v[120:123], v[232:235], v[12:15]
  ds_read_b128 v[96:99], v1 offset:37888
  v_mfma_f32_16x16x32_bf16 v[40:43], v[120:123], v[236:239], v[40:43]
  ds_read_b128 v[100:103], v1 offset:38912
  v_lshlrev_b32 v7, 3, v0
  buffer_load_dwordx2 v[200:201], v7, s[4:7], s21 offen offset:3072 sc1
  buffer_load_dwordx2 v[202:203], v7, s[4:7], s21 offen offset:3584 sc1
  s_waitcnt lgkmcnt(8)
  v_mfma_f32_16x16x32_bf16 v[16:19], v[124:127], v[232:235], v[16:19]
  ds_read_b128 v[104:107], v1 offset:39936
  v_mfma_f32_16x16x32_bf16 v[44:47], v[124:127], v[236:239], v[44:47]
  ds_read_b128 v[108:111], v1 offset:40960
  s_waitcnt lgkmcnt(9)
  v_mfma_f32_16x16x32_bf16 v[20:23], v[128:131], v[232:235], v[20:23]
  ds_read_b128 v[112:115], v1 offset:41984
  v_mfma_f32_16x16x32_bf16 v[48:51], v[128:131], v[236:239], v[48:51]
  s_waitcnt lgkmcnt(9)
  v_mfma_f32_16x16x32_bf16 v[24:27], v[132:135], v[232:235], v[24:27]
  v_mfma_f32_16x16x32_bf16 v[52:55], v[132:135], v[236:239], v[52:55]
  s_waitcnt lgkmcnt(8)
  v_mfma_f32_16x16x32_bf16 v[28:31], v[136:139], v[232:235], v[28:31]
  v_lshlrev_b32 v7, 3, v0
  buffer_load_dwordx2 v[204:205], v7, s[4:7], s22 offen offset:3072 sc1
  buffer_load_dwordx2 v[206:207], v7, s[4:7], s22 offen offset:3584 sc1
  v_mfma_f32_16x16x32_bf16 v[56:59], v[136:139], v[236:239], v[56:59]
  s_waitcnt lgkmcnt(7)
  v_mfma_f32_16x16x32_bf16 v[32:35], v[140:143], v[232:235], v[32:35]
  v_mfma_f32_16x16x32_bf16 v[60:63], v[140:143], v[236:239], v[60:63]
  s_waitcnt vmcnt(22) lgkmcnt(6)
  v_mfma_f32_16x16x32_bf16 v[8:11], v[88:91], v[144:147], v[8:11]
  ds_read_b128 v[116:119], v1 offset:43008
  v_mfma_f32_16x16x32_bf16 v[36:39], v[88:91], v[148:151], v[36:39]
  ds_read_b128 v[120:123], v1 offset:44032
  s_waitcnt lgkmcnt(7)
  v_mfma_f32_16x16x32_bf16 v[12:15], v[92:95], v[144:147], v[12:15]
  ds_read_b128 v[124:127], v1 offset:45056
  v_mfma_f32_16x16x32_bf16 v[40:43], v[92:95], v[148:151], v[40:43]
  ds_read_b128 v[128:131], v1 offset:46080
  s_waitcnt lgkmcnt(8)
  v_mfma_f32_16x16x32_bf16 v[16:19], v[96:99], v[144:147], v[16:19]
  ds_read_b128 v[132:135], v1 offset:47104
  v_mfma_f32_16x16x32_bf16 v[44:47], v[96:99], v[148:151], v[44:47]
  ds_read_b128 v[136:139], v1 offset:48128
  s_waitcnt lgkmcnt(9)
  v_mfma_f32_16x16x32_bf16 v[20:23], v[100:103], v[144:147], v[20:23]
  ds_read_b128 v[140:143], v1 offset:49152
  v_mfma_f32_16x16x32_bf16 v[48:51], v[100:103], v[148:151], v[48:51]
  s_waitcnt lgkmcnt(9)
  v_mfma_f32_16x16x32_bf16 v[24:27], v[104:107], v[144:147], v[24:27]
  v_mfma_f32_16x16x32_bf16 v[52:55], v[104:107], v[148:151], v[52:55]
  s_waitcnt lgkmcnt(8)
  v_mfma_f32_16x16x32_bf16 v[28:31], v[108:111], v[144:147], v[28:31]
  v_mfma_f32_16x16x32_bf16 v[56:59], v[108:111], v[148:151], v[56:59]
  s_waitcnt lgkmcnt(7)
  v_mfma_f32_16x16x32_bf16 v[32:35], v[112:115], v[144:147], v[32:35]
  v_mfma_f32_16x16x32_bf16 v[60:63], v[112:115], v[148:151], v[60:63]
  s_waitcnt vmcnt(20) lgkmcnt(6)
  v_mfma_f32_16x16x32_bf16 v[8:11], v[116:119], v[152:155], v[8:11]
  ds_read_b128 v[88:91], v1 offset:50176
  v_mfma_f32_16x16x32_bf16 v[36:39], v[116:119], v[156:159], v[36:39]
  ds_read_b128 v[92:95], v1 offset:51200
  s_waitcnt lgkmcnt(7)
  v_mfma_f32_16x16x32_bf16 v[12:15], v[120:123], v[152:155], v[12:15]
  ds_read_b128 v[96:99], v1 offset:52224
  v_mfma_f32_16x16x32_bf16 v[40:43], v[120:123], v[156:159], v[40:43]
  ds_read_b128 v[100:103], v1 offset:53248
  s_waitcnt lgkmcnt(8)
  v_mfma_f32_16x16x32_bf16 v[16:19], v[124:127], v[152:155], v[16:19]
  ds_read_b128 v[104:107], v1 offset:54272
  v_mfma_f32_16x16x32_bf16 v[44:47], v[124:127], v[156:159], v[44:47]
  ds_read_b128 v[108:111], v1 offset:55296
  s_waitcnt lgkmcnt(9)
  v_mfma_f32_16x16x32_bf16 v[20:23], v[128:131], v[152:155], v[20:23]
  ds_read_b128 v[112:115], v1 offset:56320
  v_mfma_f32_16x16x32_bf16 v[48:51], v[128:131], v[156:159], v[48:51]
  s_waitcnt lgkmcnt(9)
  v_mfma_f32_16x16x32_bf16 v[24:27], v[132:135], v[152:155], v[24:27]
  v_mfma_f32_16x16x32_bf16 v[52:55], v[132:135], v[156:159], v[52:55]
  s_waitcnt lgkmcnt(8)
  v_mfma_f32_16x16x32_bf16 v[28:31], v[136:139], v[152:155], v[28:31]
  v_mfma_f32_16x16x32_bf16 v[56:59], v[136:139], v[156:159], v[56:59]
  s_waitcnt lgkmcnt(7)
  v_mfma_f32_16x16x32_bf16 v[32:35], v[140:143], v[152:155], v[32:35]
  v_mfma_f32_16x16x32_bf16 v[60:63], v[140:143], v[156:159], v[60:63]
  s_waitcnt vmcnt(18) lgkmcnt(6)
  v_mfma_f32_16x16x32_bf16 v[8:11], v[88:91], v[160:163], v[8:11]
  ds_read_b128 v[116:119], v1 offset:57344
  v_mfma_f32_16x16x32_bf16 v[36:39], v[88:91], v[164:167], v[36:39]
  ds_read_b128 v[120:123], v1 offset:58368
  s_waitcnt lgkmcnt(7)
  v_mfma_f32_16x16x32_bf16 v[12:15], v[92:95], v[160:163], v[12:15]
  ds_read_b128 v[124:127], v1 offset:59392
  v_mfma_f32_16x16x32_bf16 v[40:43], v[92:95], v[164:167], v[40:43]
  ds_read_b128 v[128:131], v1 offset:60416
  s_waitcnt lgkmcnt(8)
  v_mfma_f32_16x16x32_bf16 v[16:19], v[96:99], v[160:163], v[16:19]
  ds_read_b128 v[132:135], v1 offset:61440
  v_mfma_f32_16x16x32_bf16 v[44:47], v[96:99], v[164:167], v[44:47]
  ds_read_b128 v[136:139], v1 offset:62464
  s_waitcnt lgkmcnt(9)
  v_mfma_f32_16x16x32_bf16 v[20:23], v[100:103], v[160:163], v[20:23]
  ds_read_b128 v[140:143], v1 offset:63488
  v_mfma_f32_16x16x32_bf16 v[48:51], v[100:103], v[164:167], v[48:51]
  s_waitcnt lgkmcnt(9)
  v_mfma_f32_16x16x32_bf16 v[24:27], v[104:107], v[160:163], v[24:27]
  v_mfma_f32_16x16x32_bf16 v[52:55], v[104:107], v[164:167], v[52:55]
  s_waitcnt lgkmcnt(8)
  v_mfma_f32_16x16x32_bf16 v[28:31], v[108:111], v[160:163], v[28:31]
  v_mfma_f32_16x16x32_bf16 v[56:59], v[108:111], v[164:167], v[56:59]
  s_waitcnt lgkmcnt(7)
  v_mfma_f32_16x16x32_bf16 v[32:35], v[112:115], v[160:163], v[32:35]
  v_mfma_f32_16x16x32_bf16 v[60:63], v[112:115], v[164:167], v[60:63]
  s_waitcnt vmcnt(16) lgkmcnt(6)
  v_mfma_f32_16x16x32_bf16 v[8:11], v[116:119], v[168:171], v[8:11]
  ds_read_b128 v[88:91], v1 offset:64512
  v_mfma_f32_16x16x32_bf16 v[36:39], v[116:119], v[172:175], v[36:39]
  ds_read_b128 v[92:95], v2 offset:0
  s_waitcnt lgkmcnt(7)
  v_mfma_f32_16x16x32_bf16 v[12:15], v[120:123], v[168:171], v[12:15]
  ds_read_b128 v[96:99], v2 offset:1024
  v_mfma_f32_16x16x32_bf16 v[40:43], v[120:123], v[172:175], v[40:43]
  ds_read_b128 v[100:103], v2 offset:2048
  s_waitcnt lgkmcnt(8)
  v_mfma_f32_16x16x32_bf16 v[16:19], v[124:127], v[168:171], v[16:19]
  ds_read_b128 v[104:107], v2 offset:3072
  v_mfma_f32_16x16x32_bf16 v[44:47], v[124:127], v[172:175], v[44:47]
  ds_read_b128 v[108:111], v2 offset:4096
  s_waitcnt lgkmcnt(9)
  v_mfma_f32_16x16x32_bf16 v[20:23], v[128:131], v[168:171], v[20:23]
  ds_read_b128 v[112:115], v2 offset:5120
  v_mfma_f32_16x16x32_bf16 v[48:51], v[128:131], v[172:175], v[48:51]
  s_waitcnt lgkmcnt(9)
  v_mfma_f32_16x16x32_bf16 v[24:27], v[132:135], v[168:171], v[24:27]
  v_mfma_f32_16x16x32_bf16 v[52:55], v[132:135], v[172:175], v[52:55]
  s_waitcnt lgkmcnt(8)
  v_mfma_f32_16x16x32_bf16 v[28:31], v[136:139], v[168:171], v[28:31]
  v_mfma_f32_16x16x32_bf16 v[56:59], v[136:139], v[172:175], v[56:59]
  s_waitcnt lgkmcnt(7)
  v_mfma_f32_16x16x32_bf16 v[32:35], v[140:143], v[168:171], v[32:35]
  v_mfma_f32_16x16x32_bf16 v[60:63], v[140:143], v[172:175], v[60:63]
  s_waitcnt vmcnt(12) lgkmcnt(6)
  v_mfma_f32_16x16x32_bf16 v[8:11], v[88:91], v[176:179], v[8:11]
  ds_read_b128 v[116:119], v2 offset:6144
  v_mfma_f32_16x16x32_bf16 v[36:39], v[88:91], v[180:183], v[36:39]
  ds_read_b128 v[120:123], v2 offset:7168
  s_waitcnt lgkmcnt(7)
  v_mfma_f32_16x16x32_bf16 v[12:15], v[92:95], v[176:179], v[12:15]
  ds_read_b128 v[124:127], v2 offset:8192
  v_mfma_f32_16x16x32_bf16 v[40:43], v[92:95], v[180:183], v[40:43]
  ds_read_b128 v[128:131], v2 offset:9216
  s_waitcnt lgkmcnt(8)
  v_mfma_f32_16x16x32_bf16 v[16:19], v[96:99], v[176:179], v[16:19]
  ds_read_b128 v[132:135], v2 offset:10240
  v_mfma_f32_16x16x32_bf16 v[44:47], v[96:99], v[180:183], v[44:47]
  ds_read_b128 v[136:139], v2 offset:11264
  s_waitcnt lgkmcnt(9)
  v_mfma_f32_16x16x32_bf16 v[20:23], v[100:103], v[176:179], v[20:23]
  ds_read_b128 v[140:143], v2 offset:12288
  v_mfma_f32_16x16x32_bf16 v[48:51], v[100:103], v[180:183], v[48:51]
  s_waitcnt lgkmcnt(9)
  v_mfma_f32_16x16x32_bf16 v[24:27], v[104:107], v[176:179], v[24:27]
  v_mfma_f32_16x16x32_bf16 v[52:55], v[104:107], v[180:183], v[52:55]
  s_waitcnt lgkmcnt(8)
  v_mfma_f32_16x16x32_bf16 v[28:31], v[108:111], v[176:179], v[28:31]
  v_mfma_f32_16x16x32_bf16 v[56:59], v[108:111], v[180:183], v[56:59]
  s_waitcnt lgkmcnt(7)
  v_mfma_f32_16x16x32_bf16 v[32:35], v[112:115], v[176:179], v[32:35]
  v_mfma_f32_16x16x32_bf16 v[60:63], v[112:115], v[180:183], v[60:63]
  s_waitcnt vmcnt(8) lgkmcnt(6)
  v_mfma_f32_16x16x32_bf16 v[8:11], v[116:119], v[184:187], v[8:11]
  ds_read_b128 v[88:91], v2 offset:13312
  v_mfma_f32_16x16x32_bf16 v[36:39], v[116:119], v[188:191], v[36:39]
  ds_read_b128 v[92:95], v2 offset:14336
  s_waitcnt lgkmcnt(7)
  v_mfma_f32_16x16x32_bf16 v[12:15], v[120:123], v[184:187], v[12:15]
  ds_read_b128 v[96:99], v2 offset:15360
  v_mfma_f32_16x16x32_bf16 v[40:43], v[120:123], v[188:191], v[40:43]
  ds_read_b128 v[100:103], v2 offset:16384
  s_waitcnt lgkmcnt(8)
  v_mfma_f32_16x16x32_bf16 v[16:19], v[124:127], v[184:187], v[16:19]
  ds_read_b128 v[104:107], v2 offset:17408
  v_mfma_f32_16x16x32_bf16 v[44:47], v[124:127], v[188:191], v[44:47]
  ds_read_b128 v[108:111], v2 offset:18432
  s_waitcnt lgkmcnt(9)
  v_mfma_f32_16x16x32_bf16 v[20:23], v[128:131], v[184:187], v[20:23]
  ds_read_b128 v[112:115], v2 offset:19456
  v_mfma_f32_16x16x32_bf16 v[48:51], v[128:131], v[188:191], v[48:51]
  s_waitcnt lgkmcnt(9)
  v_mfma_f32_16x16x32_bf16 v[24:27], v[132:135], v[184:187], v[24:27]
  v_mfma_f32_16x16x32_bf16 v[52:55], v[132:135], v[188:191], v[52:55]
  s_waitcnt lgkmcnt(8)
  v_mfma_f32_16x16x32_bf16 v[28:31], v[136:139], v[184:187], v[28:31]
  v_mfma_f32_16x16x32_bf16 v[56:59], v[136:139], v[188:191], v[56:59]
  s_waitcnt lgkmcnt(7)
  v_mfma_f32_16x16x32_bf16 v[32:35], v[140:143], v[184:187], v[32:35]
  v_mfma_f32_16x16x32_bf16 v[60:63], v[140:143], v[188:191], v[60:63]
  s_waitcnt vmcnt(4) lgkmcnt(6)
  v_mfma_f32_16x16x32_bf16 v[8:11], v[88:91], v[192:195], v[8:11]
  ds_read_b128 v[116:119], v2 offset:20480
  v_mfma_f32_16x16x32_bf16 v[36:39], v[88:91], v[196:199], v[36:39]
  ds_read_b128 v[120:123], v2 offset:21504
  s_waitcnt lgkmcnt(7)
  v_mfma_f32_16x16x32_bf16 v[12:15], v[92:95], v[192:195], v[12:15]
  ds_read_b128 v[124:127], v2 offset:22528
  v_mfma_f32_16x16x32_bf16 v[40:43], v[92:95], v[196:199], v[40:43]
  ds_read_b128 v[128:131], v2 offset:23552
  s_waitcnt lgkmcnt(8)
  v_mfma_f32_16x16x32_bf16 v[16:19], v[96:99], v[192:195], v[16:19]
  ds_read_b128 v[132:135], v2 offset:24576
  v_mfma_f32_16x16x32_bf16 v[44:47], v[96:99], v[196:199], v[44:47]
  ds_read_b128 v[136:139], v2 offset:25600
  s_waitcnt lgkmcnt(9)
  v_mfma_f32_16x16x32_bf16 v[20:23], v[100:103], v[192:195], v[20:23]
  ds_read_b128 v[140:143], v2 offset:26624
  v_mfma_f32_16x16x32_bf16 v[48:51], v[100:103], v[196:199], v[48:51]
  s_waitcnt lgkmcnt(9)
  v_mfma_f32_16x16x32_bf16 v[24:27], v[104:107], v[192:195], v[24:27]
  v_mfma_f32_16x16x32_bf16 v[52:55], v[104:107], v[196:199], v[52:55]
  s_waitcnt lgkmcnt(8)
  v_mfma_f32_16x16x32_bf16 v[28:31], v[108:111], v[192:195], v[28:31]
  v_mfma_f32_16x16x32_bf16 v[56:59], v[108:111], v[196:199], v[56:59]
  s_waitcnt lgkmcnt(7)
  v_mfma_f32_16x16x32_bf16 v[32:35], v[112:115], v[192:195], v[32:35]
  v_mfma_f32_16x16x32_bf16 v[60:63], v[112:115], v[196:199], v[60:63]
  s_waitcnt vmcnt(0) lgkmcnt(6)
  v_mfma_f32_16x16x32_bf16 v[8:11], v[116:119], v[200:203], v[8:11]
  v_mfma_f32_16x16x32_bf16 v[36:39], v[116:119], v[204:207], v[36:39]
  s_waitcnt lgkmcnt(5)
  v_mfma_f32_16x16x32_bf16 v[12:15], v[120:123], v[200:203], v[12:15]
  v_mfma_f32_16x16x32_bf16 v[40:43], v[120:123], v[204:207], v[40:43]
  s_waitcnt lgkmcnt(4)
  v_mfma_f32_16x16x32_bf16 v[16:19], v[124:127], v[200:203], v[16:19]
  v_mfma_f32_16x16x32_bf16 v[44:47], v[124:127], v[204:207], v[44:47]
  s_waitcnt lgkmcnt(3)
  v_mfma_f32_16x16x32_bf16 v[20:23], v[128:131], v[200:203], v[20:23]
  v_mfma_f32_16x16x32_bf16 v[48:51], v[128:131], v[204:207], v[48:51]
  s_waitcnt lgkmcnt(2)
  v_mfma_f32_16x16x32_bf16 v[24:27], v[132:135], v[200:203], v[24:27]
  v_mfma_f32_16x16x32_bf16 v[52:55], v[132:135], v[204:207], v[52:55]
  s_waitcnt lgkmcnt(1)
  v_mfma_f32_16x16x32_bf16 v[28:31], v[136:139], v[200:203], v[28:31]
  v_mfma_f32_16x16x32_bf16 v[56:59], v[136:139], v[204:207], v[56:59]
  s_waitcnt lgkmcnt(0)
  v_mfma_f32_16x16x32_bf16 v[32:35], v[140:143], v[200:203], v[32:35]
  v_mfma_f32_16x16x32_bf16 v[60:63], v[140:143], v[204:207], v[60:63]
  v_lshlrev_b32 v88, 16, v72
  v_and_b32 v89, 0xffff0000, v72
  v_lshlrev_b32 v90, 16, v73
  v_and_b32 v91, 0xffff0000, v73
  v_lshlrev_b32 v92, 16, v74
  v_and_b32 v93, 0xffff0000, v74
  v_lshlrev_b32 v94, 16, v75
  v_and_b32 v95, 0xffff0000, v75
  v_lshlrev_b32 v96, 16, v76
  v_and_b32 v97, 0xffff0000, v76
  v_lshlrev_b32 v98, 16, v77
  v_and_b32 v99, 0xffff0000, v77
  v_lshlrev_b32 v100, 16, v78
  v_and_b32 v101, 0xffff0000, v78
  v_lshlrev_b32 v102, 16, v79
  v_and_b32 v103, 0xffff0000, v79
  v_lshlrev_b32 v104, 16, v80
  v_and_b32 v105, 0xffff0000, v80
  v_lshlrev_b32 v106, 16, v81
  v_and_b32 v107, 0xffff0000, v81
  v_lshlrev_b32 v108, 16, v82
  v_and_b32 v109, 0xffff0000, v82
  v_lshlrev_b32 v110, 16, v83
  v_and_b32 v111, 0xffff0000, v83
  v_lshlrev_b32 v112, 16, v84
  v_and_b32 v113, 0xffff0000, v84
  v_lshlrev_b32 v114, 16, v85
  v_and_b32 v115, 0xffff0000, v85
  v_mov_b32 v164, 0xc0135761
  v_mov_b32 v166, 0xbdd2d3e8
  v_add_f32 v64, v64, v66
  v_add_f32 v65, v65, v67
  s_nop 1
  v_permlane16_swap_b32 v64, v65
  v_add_f32 v64, v64, v65
  v_mov_b32 v65, v64
  s_nop 1
  v_permlane32_swap_b32 v64, v65
  v_add_f32 v64, v64, v65
  v_mov_b32 v65, v64
  s_nop 1
  v_permlane16_swap_b32 v64, v65
  v_mul_f32 v64, 0x3acccccd, v64
  v_mul_f32 v116, 0x3acccccd, v65
  v_fma_f32 v116, -v64, v64, v116
  v_max_f32 v116, 0, v116
  v_add_f32 v120, 0x3727c5ac, v116
  v_rcp_f32 v121, v120
  v_rsq_f32 v120, v120
  v_mul_f32 v116, v116, v121
  v_add_f32 v116, 0x3727c5ac, v116
  v_rsq_f32 v116, v116
  s_nop 0
  v_mul_f32 v116, v116, v120
  v_add_f32 v68, v68, v70
  v_add_f32 v69, v69, v71
  s_nop 1
  v_permlane16_swap_b32 v68, v69
  v_add_f32 v68, v68, v69
  v_mov_b32 v69, v68
  s_nop 1
  v_permlane32_swap_b32 v68, v69
  v_add_f32 v68, v68, v69
  v_mov_b32 v69, v68
  s_nop 1
  v_permlane16_swap_b32 v68, v69
  v_mul_f32 v68, 0x3acccccd, v68
  v_mul_f32 v118, 0x3acccccd, v69
  v_fma_f32 v118, -v68, v68, v118
  v_max_f32 v118, 0, v118
  v_add_f32 v120, 0x3727c5ac, v118
  v_rcp_f32 v121, v120
  v_rsq_f32 v120, v120
  v_mul_f32 v118, v118, v121
  v_add_f32 v118, 0x3727c5ac, v118
  v_rsq_f32 v118, v118
  s_nop 0
  v_mul_f32 v118, v118, v120
  s_and_b32 s17, s10, 7
  s_cmp_ge_u32 s17, 6
  s_cselect_b32 s18, 0x40000000, 0
  v_lshlrev_b32 v168, 3, v0
  v_add_u32 v168, s18, v168
  s_lshl_b32 s17, s17, 9
  s_lshr_b32 s18, s10, 3
  s_mul_i32 s18, s18, 3072
  s_add_u32 s17, s17, s18
  s_mul_i32 s18, s10, 3072
  s_sub_u32 s22, s17, s18
  s_add_u32 s22, s22, 49152
  s_add_u32 s21, s59, 0
  s_mul_i32 s21, s21, 55296
  s_add_u32 s21, s21, s55
  s_mul_i32 s17, s10, 3072
  s_add_u32 s21, s21, s17
  v_pk_fma_f32 v[8:9], v[8:9], v[116:117], v[88:89] op_sel_hi:[1,0,1]
  v_pk_fma_f32 v[10:11], v[10:11], v[116:117], v[90:91] op_sel_hi:[1,0,1]
  v_pk_mul_f32 v[128:129], v[8:9], v[8:9]
  v_pk_mul_f32 v[130:131], v[10:11], v[10:11]
  v_pk_fma_f32 v[128:129], v[128:129], v[166:167], v[164:165] op_sel_hi:[1,0,0]
  v_pk_fma_f32 v[130:131], v[130:131], v[166:167], v[164:165] op_sel_hi:[1,0,0]
  v_pk_mul_f32 v[128:129], v[128:129], v[8:9]
  v_pk_mul_f32 v[130:131], v[130:131], v[10:11]
  v_exp_f32 v128, v128
  v_exp_f32 v129, v129
  v_exp_f32 v130, v130
  v_exp_f32 v131, v131
  v_pk_add_f32 v[128:129], v[128:129], 1.0 op_sel_hi:[1,0]
  v_pk_add_f32 v[130:131], v[130:131], 1.0 op_sel_hi:[1,0]
  v_rcp_f32 v128, v128
  v_rcp_f32 v129, v129
  v_rcp_f32 v130, v130
  v_rcp_f32 v131, v131
  v_pk_mul_f32 v[128:129], v[128:129], v[8:9]
  v_pk_mul_f32 v[130:131], v[130:131], v[10:11]
  v_cvt_pk_bf16_f32 v136, v128, v129
  v_cvt_pk_bf16_f32 v137, v130, v131
  v_pk_fma_f32 v[12:13], v[12:13], v[116:117], v[92:93] op_sel_hi:[1,0,1]
  v_pk_fma_f32 v[14:15], v[14:15], v[116:117], v[94:95] op_sel_hi:[1,0,1]
  v_pk_mul_f32 v[128:129], v[12:13], v[12:13]
  v_pk_mul_f32 v[130:131], v[14:15], v[14:15]
  v_pk_fma_f32 v[128:129], v[128:129], v[166:167], v[164:165] op_sel_hi:[1,0,0]
  v_pk_fma_f32 v[130:131], v[130:131], v[166:167], v[164:165] op_sel_hi:[1,0,0]
  v_pk_mul_f32 v[128:129], v[128:129], v[12:13]
  v_pk_mul_f32 v[130:131], v[130:131], v[14:15]
  v_exp_f32 v128, v128
  v_exp_f32 v129, v129
  v_exp_f32 v130, v130
  v_exp_f32 v131, v131
  v_pk_add_f32 v[128:129], v[128:129], 1.0 op_sel_hi:[1,0]
  v_pk_add_f32 v[130:131], v[130:131], 1.0 op_sel_hi:[1,0]
  v_rcp_f32 v128, v128
  v_rcp_f32 v129, v129
  v_rcp_f32 v130, v130
  v_rcp_f32 v131, v131
  v_pk_mul_f32 v[128:129], v[128:129], v[12:13]
  v_pk_mul_f32 v[130:131], v[130:131], v[14:15]
  v_cvt_pk_bf16_f32 v138, v128, v129
  v_cvt_pk_bf16_f32 v139, v130, v131
  buffer_store_dwordx4 v[136:139], v1, s[4:7], s21 offen offset:0 sc1
  v_pk_fma_f32 v[16:17], v[16:17], v[116:117], v[96:97] op_sel_hi:[1,0,1]
  v_pk_fma_f32 v[18:19], v[18:19], v[116:117], v[98:99] op_sel_hi:[1,0,1]
  v_pk_mul_f32 v[128:129], v[16:17], v[16:17]
  v_pk_mul_f32 v[130:131], v[18:19], v[18:19]
  v_pk_fma_f32 v[128:129], v[128:129], v[166:167], v[164:165] op_sel_hi:[1,0,0]
  v_pk_fma_f32 v[130:131], v[130:131], v[166:167], v[164:165] op_sel_hi:[1,0,0]
  v_pk_mul_f32 v[128:129], v[128:129], v[16:17]
  v_pk_mul_f32 v[130:131], v[130:131], v[18:19]
  v_exp_f32 v128, v128
  v_exp_f32 v129, v129
  v_exp_f32 v130, v130
  v_exp_f32 v131, v131
  v_pk_add_f32 v[128:129], v[128:129], 1.0 op_sel_hi:[1,0]
  v_pk_add_f32 v[130:131], v[130:131], 1.0 op_sel_hi:[1,0]
  v_rcp_f32 v128, v128
  v_rcp_f32 v129, v129
  v_rcp_f32 v130, v130
  v_rcp_f32 v131, v131
  v_pk_mul_f32 v[128:129], v[128:129], v[16:17]
  v_pk_mul_f32 v[130:131], v[130:131], v[18:19]
  v_cvt_pk_bf16_f32 v140, v128, v129
  v_cvt_pk_bf16_f32 v141, v130, v131
  v_pk_fma_f32 v[20:21], v[20:21], v[116:117], v[100:101] op_sel_hi:[1,0,1]
  v_pk_fma_f32 v[22:23], v[22:23], v[116:117], v[102:103] op_sel_hi:[1,0,1]
  v_pk_mul_f32 v[128:129], v[20:21], v[20:21]
  v_pk_mul_f32 v[130:131], v[22:23], v[22:23]
  v_pk_fma_f32 v[128:129], v[128:129], v[166:167], v[164:165] op_sel_hi:[1,0,0]
  v_pk_fma_f32 v[130:131], v[130:131], v[166:167], v[164:165] op_sel_hi:[1,0,0]
  v_pk_mul_f32 v[128:129], v[128:129], v[20:21]
  v_pk_mul_f32 v[130:131], v[130:131], v[22:23]
  v_exp_f32 v128, v128
  v_exp_f32 v129, v129
  v_exp_f32 v130, v130
  v_exp_f32 v131, v131
  v_pk_add_f32 v[128:129], v[128:129], 1.0 op_sel_hi:[1,0]
  v_pk_add_f32 v[130:131], v[130:131], 1.0 op_sel_hi:[1,0]
  v_rcp_f32 v128, v128
  v_rcp_f32 v129, v129
  v_rcp_f32 v130, v130
  v_rcp_f32 v131, v131
  v_pk_mul_f32 v[128:129], v[128:129], v[20:21]
  v_pk_mul_f32 v[130:131], v[130:131], v[22:23]
  v_cvt_pk_bf16_f32 v142, v128, v129
  v_cvt_pk_bf16_f32 v143, v130, v131
  buffer_store_dwordx4 v[140:143], v1, s[4:7], s21 offen offset:1024 sc1
  v_pk_fma_f32 v[24:25], v[24:25], v[116:117], v[104:105] op_sel_hi:[1,0,1]
  v_pk_fma_f32 v[26:27], v[26:27], v[116:117], v[106:107] op_sel_hi:[1,0,1]
  v_pk_mul_f32 v[128:129], v[24:25], v[24:25]
  v_pk_mul_f32 v[130:131], v[26:27], v[26:27]
  v_pk_fma_f32 v[128:129], v[128:129], v[166:167], v[164:165] op_sel_hi:[1,0,0]
  v_pk_fma_f32 v[130:131], v[130:131], v[166:167], v[164:165] op_sel_hi:[1,0,0]
  v_pk_mul_f32 v[128:129], v[128:129], v[24:25]
  v_pk_mul_f32 v[130:131], v[130:131], v[26:27]
  v_exp_f32 v128, v128
  v_exp_f32 v129, v129
  v_exp_f32 v130, v130
  v_exp_f32 v131, v131
  v_pk_add_f32 v[128:129], v[128:129], 1.0 op_sel_hi:[1,0]
  v_pk_add_f32 v[130:131], v[130:131], 1.0 op_sel_hi:[1,0]
  v_rcp_f32 v128, v128
  v_rcp_f32 v129, v129
  v_rcp_f32 v130, v130
  v_rcp_f32 v131, v131
  v_pk_mul_f32 v[128:129], v[128:129], v[24:25]
  v_pk_mul_f32 v[130:131], v[130:131], v[26:27]
  v_cvt_pk_bf16_f32 v144, v128, v129
  v_cvt_pk_bf16_f32 v145, v130, v131
  v_pk_fma_f32 v[28:29], v[28:29], v[116:117], v[108:109] op_sel_hi:[1,0,1]
  v_pk_fma_f32 v[30:31], v[30:31], v[116:117], v[110:111] op_sel_hi:[1,0,1]
  v_pk_mul_f32 v[128:129], v[28:29], v[28:29]
  v_pk_mul_f32 v[130:131], v[30:31], v[30:31]
  v_pk_fma_f32 v[128:129], v[128:129], v[166:167], v[164:165] op_sel_hi:[1,0,0]
  v_pk_fma_f32 v[130:131], v[130:131], v[166:167], v[164:165] op_sel_hi:[1,0,0]
  v_pk_mul_f32 v[128:129], v[128:129], v[28:29]
  v_pk_mul_f32 v[130:131], v[130:131], v[30:31]
  v_exp_f32 v128, v128
  v_exp_f32 v129, v129
  v_exp_f32 v130, v130
  v_exp_f32 v131, v131
  v_pk_add_f32 v[128:129], v[128:129], 1.0 op_sel_hi:[1,0]
  v_pk_add_f32 v[130:131], v[130:131], 1.0 op_sel_hi:[1,0]
  v_rcp_f32 v128, v128
  v_rcp_f32 v129, v129
  v_rcp_f32 v130, v130
  v_rcp_f32 v131, v131
  v_pk_mul_f32 v[128:129], v[128:129], v[28:29]
  v_pk_mul_f32 v[130:131], v[130:131], v[30:31]
  v_cvt_pk_bf16_f32 v146, v128, v129
  v_cvt_pk_bf16_f32 v147, v130, v131
  buffer_store_dwordx4 v[144:147], v1, s[4:7], s21 offen offset:2048 sc1
  v_pk_fma_f32 v[32:33], v[32:33], v[116:117], v[112:113] op_sel_hi:[1,0,1]
  v_pk_fma_f32 v[34:35], v[34:35], v[116:117], v[114:115] op_sel_hi:[1,0,1]
  v_pk_mul_f32 v[128:129], v[32:33], v[32:33]
  v_pk_mul_f32 v[130:131], v[34:35], v[34:35]
  v_pk_fma_f32 v[128:129], v[128:129], v[166:167], v[164:165] op_sel_hi:[1,0,0]
  v_pk_fma_f32 v[130:131], v[130:131], v[166:167], v[164:165] op_sel_hi:[1,0,0]
  v_pk_mul_f32 v[128:129], v[128:129], v[32:33]
  v_pk_mul_f32 v[130:131], v[130:131], v[34:35]
  v_exp_f32 v128, v128
  v_exp_f32 v129, v129
  v_exp_f32 v130, v130
  v_exp_f32 v131, v131
  v_pk_add_f32 v[128:129], v[128:129], 1.0 op_sel_hi:[1,0]
  v_pk_add_f32 v[130:131], v[130:131], 1.0 op_sel_hi:[1,0]
  v_rcp_f32 v128, v128
  v_rcp_f32 v129, v129
  v_rcp_f32 v130, v130
  v_rcp_f32 v131, v131
  v_pk_mul_f32 v[128:129], v[128:129], v[32:33]
  v_pk_mul_f32 v[130:131], v[130:131], v[34:35]
  v_cvt_pk_bf16_f32 v148, v128, v129
  v_cvt_pk_bf16_f32 v149, v130, v131
  s_add_u32 s17, s21, s22
  buffer_store_dwordx2 v[148:149], v168, s[4:7], s17 offen sc1
  s_add_u32 s21, s59, 1
  s_mul_i32 s21, s21, 55296
  s_add_u32 s21, s21, s55
  s_mul_i32 s17, s10, 3072
  s_add_u32 s21, s21, s17
  v_pk_fma_f32 v[36:37], v[36:37], v[118:119], v[88:89] op_sel_hi:[1,0,1]
  v_pk_fma_f32 v[38:39], v[38:39], v[118:119], v[90:91] op_sel_hi:[1,0,1]
  v_pk_mul_f32 v[128:129], v[36:37], v[36:37]
  v_pk_mul_f32 v[130:131], v[38:39], v[38:39]
  v_pk_fma_f32 v[128:129], v[128:129], v[166:167], v[164:165] op_sel_hi:[1,0,0]
  v_pk_fma_f32 v[130:131], v[130:131], v[166:167], v[164:165] op_sel_hi:[1,0,0]
  v_pk_mul_f32 v[128:129], v[128:129], v[36:37]
  v_pk_mul_f32 v[130:131], v[130:131], v[38:39]
  v_exp_f32 v128, v128
  v_exp_f32 v129, v129
  v_exp_f32 v130, v130
  v_exp_f32 v131, v131
  v_pk_add_f32 v[128:129], v[128:129], 1.0 op_sel_hi:[1,0]
  v_pk_add_f32 v[130:131], v[130:131], 1.0 op_sel_hi:[1,0]
  v_rcp_f32 v128, v128
  v_rcp_f32 v129, v129
  v_rcp_f32 v130, v130
  v_rcp_f32 v131, v131
  v_pk_mul_f32 v[128:129], v[128:129], v[36:37]
  v_pk_mul_f32 v[130:131], v[130:131], v[38:39]
  v_cvt_pk_bf16_f32 v150, v128, v129
  v_cvt_pk_bf16_f32 v151, v130, v131
  v_pk_fma_f32 v[40:41], v[40:41], v[118:119], v[92:93] op_sel_hi:[1,0,1]
  v_pk_fma_f32 v[42:43], v[42:43], v[118:119], v[94:95] op_sel_hi:[1,0,1]
  v_pk_mul_f32 v[128:129], v[40:41], v[40:41]
  v_pk_mul_f32 v[130:131], v[42:43], v[42:43]
  v_pk_fma_f32 v[128:129], v[128:129], v[166:167], v[164:165] op_sel_hi:[1,0,0]
  v_pk_fma_f32 v[130:131], v[130:131], v[166:167], v[164:165] op_sel_hi:[1,0,0]
  v_pk_mul_f32 v[128:129], v[128:129], v[40:41]
  v_pk_mul_f32 v[130:131], v[130:131], v[42:43]
  v_exp_f32 v128, v128
  v_exp_f32 v129, v129
  v_exp_f32 v130, v130
  v_exp_f32 v131, v131
  v_pk_add_f32 v[128:129], v[128:129], 1.0 op_sel_hi:[1,0]
  v_pk_add_f32 v[130:131], v[130:131], 1.0 op_sel_hi:[1,0]
  v_rcp_f32 v128, v128
  v_rcp_f32 v129, v129
  v_rcp_f32 v130, v130
  v_rcp_f32 v131, v131
  v_pk_mul_f32 v[128:129], v[128:129], v[40:41]
  v_pk_mul_f32 v[130:131], v[130:131], v[42:43]
  v_cvt_pk_bf16_f32 v152, v128, v129
  v_cvt_pk_bf16_f32 v153, v130, v131
  buffer_store_dwordx4 v[150:153], v1, s[4:7], s21 offen offset:0 sc1
  v_pk_fma_f32 v[44:45], v[44:45], v[118:119], v[96:97] op_sel_hi:[1,0,1]
  v_pk_fma_f32 v[46:47], v[46:47], v[118:119], v[98:99] op_sel_hi:[1,0,1]
  v_pk_mul_f32 v[128:129], v[44:45], v[44:45]
  v_pk_mul_f32 v[130:131], v[46:47], v[46:47]
  v_pk_fma_f32 v[128:129], v[128:129], v[166:167], v[164:165] op_sel_hi:[1,0,0]
  v_pk_fma_f32 v[130:131], v[130:131], v[166:167], v[164:165] op_sel_hi:[1,0,0]
  v_pk_mul_f32 v[128:129], v[128:129], v[44:45]
  v_pk_mul_f32 v[130:131], v[130:131], v[46:47]
  v_exp_f32 v128, v128
  v_exp_f32 v129, v129
  v_exp_f32 v130, v130
  v_exp_f32 v131, v131
  v_pk_add_f32 v[128:129], v[128:129], 1.0 op_sel_hi:[1,0]
  v_pk_add_f32 v[130:131], v[130:131], 1.0 op_sel_hi:[1,0]
  v_rcp_f32 v128, v128
  v_rcp_f32 v129, v129
  v_rcp_f32 v130, v130
  v_rcp_f32 v131, v131
  v_pk_mul_f32 v[128:129], v[128:129], v[44:45]
  v_pk_mul_f32 v[130:131], v[130:131], v[46:47]
  v_cvt_pk_bf16_f32 v154, v128, v129
  v_cvt_pk_bf16_f32 v155, v130, v131
  v_pk_fma_f32 v[48:49], v[48:49], v[118:119], v[100:101] op_sel_hi:[1,0,1]
  v_pk_fma_f32 v[50:51], v[50:51], v[118:119], v[102:103] op_sel_hi:[1,0,1]
  v_pk_mul_f32 v[128:129], v[48:49], v[48:49]
  v_pk_mul_f32 v[130:131], v[50:51], v[50:51]
  v_pk_fma_f32 v[128:129], v[128:129], v[166:167], v[164:165] op_sel_hi:[1,0,0]
  v_pk_fma_f32 v[130:131], v[130:131], v[166:167], v[164:165] op_sel_hi:[1,0,0]
  v_pk_mul_f32 v[128:129], v[128:129], v[48:49]
  v_pk_mul_f32 v[130:131], v[130:131], v[50:51]
  v_exp_f32 v128, v128
  v_exp_f32 v129, v129
  v_exp_f32 v130, v130
  v_exp_f32 v131, v131
  v_pk_add_f32 v[128:129], v[128:129], 1.0 op_sel_hi:[1,0]
  v_pk_add_f32 v[130:131], v[130:131], 1.0 op_sel_hi:[1,0]
  v_rcp_f32 v128, v128
  v_rcp_f32 v129, v129
  v_rcp_f32 v130, v130
  v_rcp_f32 v131, v131
  v_pk_mul_f32 v[128:129], v[128:129], v[48:49]
  v_pk_mul_f32 v[130:131], v[130:131], v[50:51]
  v_cvt_pk_bf16_f32 v156, v128, v129
  v_cvt_pk_bf16_f32 v157, v130, v131
  buffer_store_dwordx4 v[154:157], v1, s[4:7], s21 offen offset:1024 sc1
  v_pk_fma_f32 v[52:53], v[52:53], v[118:119], v[104:105] op_sel_hi:[1,0,1]
  v_pk_fma_f32 v[54:55], v[54:55], v[118:119], v[106:107] op_sel_hi:[1,0,1]
  v_pk_mul_f32 v[128:129], v[52:53], v[52:53]
  v_pk_mul_f32 v[130:131], v[54:55], v[54:55]
  v_pk_fma_f32 v[128:129], v[128:129], v[166:167], v[164:165] op_sel_hi:[1,0,0]
  v_pk_fma_f32 v[130:131], v[130:131], v[166:167], v[164:165] op_sel_hi:[1,0,0]
  v_pk_mul_f32 v[128:129], v[128:129], v[52:53]
  v_pk_mul_f32 v[130:131], v[130:131], v[54:55]
  v_exp_f32 v128, v128
  v_exp_f32 v129, v129
  v_exp_f32 v130, v130
  v_exp_f32 v131, v131
  v_pk_add_f32 v[128:129], v[128:129], 1.0 op_sel_hi:[1,0]
  v_pk_add_f32 v[130:131], v[130:131], 1.0 op_sel_hi:[1,0]
  v_rcp_f32 v128, v128
  v_rcp_f32 v129, v129
  v_rcp_f32 v130, v130
  v_rcp_f32 v131, v131
  v_pk_mul_f32 v[128:129], v[128:129], v[52:53]
  v_pk_mul_f32 v[130:131], v[130:131], v[54:55]
  v_cvt_pk_bf16_f32 v158, v128, v129
  v_cvt_pk_bf16_f32 v159, v130, v131
  v_pk_fma_f32 v[56:57], v[56:57], v[118:119], v[108:109] op_sel_hi:[1,0,1]
  v_pk_fma_f32 v[58:59], v[58:59], v[118:119], v[110:111] op_sel_hi:[1,0,1]
  v_pk_mul_f32 v[128:129], v[56:57], v[56:57]
  v_pk_mul_f32 v[130:131], v[58:59], v[58:59]
  v_pk_fma_f32 v[128:129], v[128:129], v[166:167], v[164:165] op_sel_hi:[1,0,0]
  v_pk_fma_f32 v[130:131], v[130:131], v[166:167], v[164:165] op_sel_hi:[1,0,0]
  v_pk_mul_f32 v[128:129], v[128:129], v[56:57]
  v_pk_mul_f32 v[130:131], v[130:131], v[58:59]
  v_exp_f32 v128, v128
  v_exp_f32 v129, v129
  v_exp_f32 v130, v130
  v_exp_f32 v131, v131
  v_pk_add_f32 v[128:129], v[128:129], 1.0 op_sel_hi:[1,0]
  v_pk_add_f32 v[130:131], v[130:131], 1.0 op_sel_hi:[1,0]
  v_rcp_f32 v128, v128
  v_rcp_f32 v129, v129
  v_rcp_f32 v130, v130
  v_rcp_f32 v131, v131
  v_pk_mul_f32 v[128:129], v[128:129], v[56:57]
  v_pk_mul_f32 v[130:131], v[130:131], v[58:59]
  v_cvt_pk_bf16_f32 v160, v128, v129
  v_cvt_pk_bf16_f32 v161, v130, v131
  buffer_store_dwordx4 v[158:161], v1, s[4:7], s21 offen offset:2048 sc1
  v_pk_fma_f32 v[60:61], v[60:61], v[118:119], v[112:113] op_sel_hi:[1,0,1]
  v_pk_fma_f32 v[62:63], v[62:63], v[118:119], v[114:115] op_sel_hi:[1,0,1]
  v_pk_mul_f32 v[128:129], v[60:61], v[60:61]
  v_pk_mul_f32 v[130:131], v[62:63], v[62:63]
  v_pk_fma_f32 v[128:129], v[128:129], v[166:167], v[164:165] op_sel_hi:[1,0,0]
  v_pk_fma_f32 v[130:131], v[130:131], v[166:167], v[164:165] op_sel_hi:[1,0,0]
  v_pk_mul_f32 v[128:129], v[128:129], v[60:61]
  v_pk_mul_f32 v[130:131], v[130:131], v[62:63]
  v_exp_f32 v128, v128
  v_exp_f32 v129, v129
  v_exp_f32 v130, v130
  v_exp_f32 v131, v131
  v_pk_add_f32 v[128:129], v[128:129], 1.0 op_sel_hi:[1,0]
  v_pk_add_f32 v[130:131], v[130:131], 1.0 op_sel_hi:[1,0]
  v_rcp_f32 v128, v128
  v_rcp_f32 v129, v129
  v_rcp_f32 v130, v130
  v_rcp_f32 v131, v131
  v_pk_mul_f32 v[128:129], v[128:129], v[60:61]
  v_pk_mul_f32 v[130:131], v[130:131], v[62:63]
  v_cvt_pk_bf16_f32 v162, v128, v129
  v_cvt_pk_bf16_f32 v163, v130, v131
  s_add_u32 s17, s21, s22
  buffer_store_dwordx2 v[162:163], v168, s[4:7], s17 offen sc1
  s_mul_i32 s25, s60, 20480
  s_lshl_b32 s3, s13, 11
  s_add_u32 s28, s25, s3
  s_lshl_b32 s3, s13, 9
  s_add_u32 s29, s25, s3
  s_add_u32 s29, s29, 16384
  s_waitcnt vmcnt(0)
  s_barrier
  s_cmp_lg_u32 s8, 0
  s_cbranch_scc1 sig_56
  s_lshl_b32 s17, s9, 7
  s_add_u32 s17, s17, s57
  s_add_u32 s17, s17, 6144
  s_mov_b64 exec, 1
  v_mov_b32 v7, 1
  buffer_atomic_add v7, off, s[4:7], s17
  s_mov_b64 exec, -1
sig_56:
  s_add_u32 s17, s8, 0
  s_and_b32 s17, s17, 3
  s_lshl_b32 s18, s12, 2
  s_add_u32 s17, s17, s18
  s_mul_i32 s17, s17, 55296
  s_add_u32 s17, s17, s55
  s_add_u32 s20, s17, s61
  s_add_u32 s17, s8, 1
  s_and_b32 s17, s17, 3
  s_lshl_b32 s18, s12, 2
  s_add_u32 s17, s17, s18
  s_mul_i32 s17, s17, 55296
  s_add_u32 s17, s17, s55
  s_add_u32 s21, s17, s61
  s_add_u32 s17, s8, 2
  s_and_b32 s17, s17, 3
  s_lshl_b32 s18, s12, 2
  s_add_u32 s17, s17, s18
  s_mul_i32 s17, s17, 55296
  s_add_u32 s17, s17, s55
  s_add_u32 s22, s17, s61
  s_add_u32 s17, s8, 3
  s_and_b32 s17, s17, 3
  s_lshl_b32 s18, s12, 2
  s_add_u32 s17, s17, s18
  s_mul_i32 s17, s17, 55296
  s_add_u32 s17, s17, s55
  s_add_u32 s23, s17, s61
  s_cmp_lt_u32 s8, 2
  s_cselect_b32 s24, 0, 4096
  s_add_u32 s17, s62, 249856
  buffer_load_dwordx4 v[220:223], v1, s[4:7], s17 offen offset:0 sc1
  s_add_u32 s17, s62, 266240
  buffer_load_dwordx4 v[224:227], v1, s[4:7], s17 offen offset:0 sc1
  s_add_u32 s17, s62, 266240
  buffer_load_dwordx4 v[228:231], v1, s[4:7], s17 offen offset:1024 sc1
  s_add_u32 s17, s62, 266240
  buffer_load_dwordx4 v[232:235], v1, s[4:7], s17 offen offset:2048 sc1
  s_add_u32 s17, s62, 266240
  buffer_load_dwordx4 v[236:239], v1, s[4:7], s17 offen offset:3072 sc1
  s_add_u32 s17, s62, 270336
  buffer_load_dwordx4 v[240:243], v1, s[4:7], s17 offen offset:0 sc1
  s_add_u32 s17, s28, s49
  buffer_load_dwordx4 v[184:187], v1, s[4:7], s17 offen offset:0 sc1
  buffer_load_dwordx4 v[188:191], v1, s[4:7], s17 offen offset:1024 sc1
  s_add_u32 s17, s29, s49
  v_lshlrev_b32 v7, 3, v0
  buffer_load_dwordx2 v[192:193], v7, s[4:7], s17 offen sc1
  v_lshlrev_b32 v7, 3, v5
  s_mul_i32 s17, s13, 160
  buffer_load_dwordx2 v[194:195], v7, s[40:43], s17 offen offset:0
  buffer_load_dwordx2 v[196:197], v7, s[40:43], s17 offen offset:32
  buffer_load_dwordx2 v[198:199], v7, s[40:43], s17 offen offset:64
  buffer_load_dwordx2 v[200:201], v7, s[40:43], s17 offen offset:96
  buffer_load_dwordx2 v[202:203], v7, s[40:43], s17 offen offset:128
  s_cmp_lg_u32 s8, 0
  s_cbranch_scc1 wbar_57
  s_cmp_lg_u32 s58, 0
  s_cbranch_scc1 wbar_57
  s_lshl_b32 s17, s9, 7
  s_add_u32 s17, s17, s57
  s_add_u32 s17, s17, 6144
  s_mov_b32 s18, 0
  s_mov_b64 exec, 1
poll_58:
  buffer_load_dword v7, off, s[4:7], s17 sc1
  s_waitcnt vmcnt(0)
  v_readfirstlane_b32 s19, v7
  s_nop 3
  s_cmp_ge_u32 s19, 16
  s_cbranch_scc1 pdone_59
  s_add_u32 s18, s18, 1
  s_cmp_lt_u32 s18, 0x20000
  s_cbranch_scc1 poll_58
  s_mov_b32 s58, 1
pdone_59:
  s_mov_b64 exec, -1
wbar_57:
  s_waitcnt vmcnt(0)
  s_barrier
  s_add_u32 s17, s20, 0
  buffer_load_dwordx4 v[88:91], v1, s[4:7], s17 offen sc1
  s_add_u32 s17, s21, 0
  buffer_load_dwordx4 v[92:95], v1, s[4:7], s17 offen sc1
  s_add_u32 s17, s22, 0
  buffer_load_dwordx4 v[96:99], v1, s[4:7], s17 offen sc1
  s_add_u32 s17, s23, 0
  buffer_load_dwordx4 v[100:103], v1, s[4:7], s17 offen sc1
  s_add_u32 s17, s20, 4096
  buffer_load_dwordx4 v[104:107], v1, s[4:7], s17 offen sc1
  s_add_u32 s17, s21, 4096
  buffer_load_dwordx4 v[108:111], v1, s[4:7], s17 offen sc1
  s_add_u32 s17, s22, 4096
  buffer_load_dwordx4 v[112:115], v1, s[4:7], s17 offen sc1
  s_add_u32 s17, s23, 4096
  buffer_load_dwordx4 v[116:119], v1, s[4:7], s17 offen sc1
  s_add_u32 s17, s20, 8192
  buffer_load_dwordx4 v[120:123], v1, s[4:7], s17 offen sc1
  s_add_u32 s17, s21, 8192
  buffer_load_dwordx4 v[124:127], v1, s[4:7], s17 offen sc1
  s_add_u32 s17, s22, 8192
  buffer_load_dwordx4 v[128:131], v1, s[4:7], s17 offen sc1
  s_add_u32 s17, s23, 8192
  buffer_load_dwordx4 v[132:135], v1, s[4:7], s17 offen sc1
  s_add_u32 s17, s20, 12288
  buffer_load_dwordx4 v[136:139], v1, s[4:7], s17 offen sc1
  s_add_u32 s17, s21, 12288
  buffer_load_dwordx4 v[140:143], v1, s[4:7], s17 offen sc1
  s_add_u32 s17, s22, 12288
  buffer_load_dwordx4 v[144:147], v1, s[4:7], s17 offen sc1
  s_add_u32 s17, s23, 12288
  buffer_load_dwordx4 v[148:151], v1, s[4:7], s17 offen sc1
  s_waitcnt vmcnt(12)
  v_mfma_f32_16x16x32_bf16 v[8:11], a[0:3], v[88:91], 0
  v_mfma_f32_16x16x32_bf16 v[28:31], a[0:3], v[92:95], 0
  s_add_u32 s17, s20, 16384
  buffer_load_dwordx4 v[152:155], v1, s[4:7], s17 offen sc1
  v_mfma_f32_16x16x32_bf16 v[48:51], a[0:3], v[96:99], 0
  v_mfma_f32_16x16x32_bf16 v[68:71], a[0:3], v[100:103], 0
  v_mfma_f32_16x16x32_bf16 v[12:15], a[4:7], v[88:91], 0
  v_mfma_f32_16x16x32_bf16 v[32:35], a[4:7], v[92:95], 0
  v_mfma_f32_16x16x32_bf16 v[52:55], a[4:7], v[96:99], 0
  s_add_u32 s17, s21, 16384
  buffer_load_dwordx4 v[156:159], v1, s[4:7], s17 offen sc1
  v_mfma_f32_16x16x32_bf16 v[72:75], a[4:7], v[100:103], 0
  v_mfma_f32_16x16x32_bf16 v[16:19], a[8:11], v[88:91], 0
  v_mfma_f32_16x16x32_bf16 v[36:39], a[8:11], v[92:95], 0
  v_mfma_f32_16x16x32_bf16 v[56:59], a[8:11], v[96:99], 0
  v_mfma_f32_16x16x32_bf16 v[76:79], a[8:11], v[100:103], 0
  s_add_u32 s17, s22, 16384
  buffer_load_dwordx4 v[160:163], v1, s[4:7], s17 offen sc1
  v_mfma_f32_16x16x32_bf16 v[20:23], a[12:15], v[88:91], 0
  v_mfma_f32_16x16x32_bf16 v[40:43], a[12:15], v[92:95], 0
  v_mfma_f32_16x16x32_bf16 v[60:63], a[12:15], v[96:99], 0
  v_mfma_f32_16x16x32_bf16 v[80:83], a[12:15], v[100:103], 0
  v_mfma_f32_16x16x32_bf16 v[24:27], a[16:19], v[88:91], 0
  s_add_u32 s17, s23, 16384
  buffer_load_dwordx4 v[164:167], v1, s[4:7], s17 offen sc1
  v_mfma_f32_16x16x32_bf16 v[44:47], a[16:19], v[92:95], 0
  v_mfma_f32_16x16x32_bf16 v[64:67], a[16:19], v[96:99], 0
  v_mfma_f32_16x16x32_bf16 v[84:87], a[16:19], v[100:103], 0
  s_waitcnt vmcnt(12)
  v_mfma_f32_16x16x32_bf16 v[8:11], a[20:23], v[104:107], v[8:11]
  v_mfma_f32_16x16x32_bf16 v[28:31], a[20:23], v[108:111], v[28:31]
  s_add_u32 s17, s20, 20480
  buffer_load_dwordx4 v[168:171], v1, s[4:7], s17 offen sc1
  v_mfma_f32_16x16x32_bf16 v[48:51], a[20:23], v[112:115], v[48:51]
  v_mfma_f32_16x16x32_bf16 v[68:71], a[20:23], v[116:119], v[68:71]
  v_mfma_f32_16x16x32_bf16 v[12:15], a[24:27], v[104:107], v[12:15]
  v_mfma_f32_16x16x32_bf16 v[32:35], a[24:27], v[108:111], v[32:35]
  v_mfma_f32_16x16x32_bf16 v[52:55], a[24:27], v[112:115], v[52:55]
  s_add_u32 s17, s21, 20480
  buffer_load_dwordx4 v[172:175], v1, s[4:7], s17 offen sc1
  v_mfma_f32_16x16x32_bf16 v[72:75], a[24:27], v[116:119], v[72:75]
  v_mfma_f32_16x16x32_bf16 v[16:19], a[28:31], v[104:107], v[16:19]
  v_mfma_f32_16x16x32_bf16 v[36:39], a[28:31], v[108:111], v[36:39]
  v_mfma_f32_16x16x32_bf16 v[56:59], a[28:31], v[112:115], v[56:59]
  v_mfma_f32_16x16x32_bf16 v[76:79], a[28:31], v[116:119], v[76:79]
  s_add_u32 s17, s22, 20480
  buffer_load_dwordx4 v[176:179], v1, s[4:7], s17 offen sc1
  v_mfma_f32_16x16x32_bf16 v[20:23], a[32:35], v[104:107], v[20:23]
  v_mfma_f32_16x16x32_bf16 v[40:43], a[32:35], v[108:111], v[40:43]
  v_mfma_f32_16x16x32_bf16 v[60:63], a[32:35], v[112:115], v[60:63]
  v_mfma_f32_16x16x32_bf16 v[80:83], a[32:35], v[116:119], v[80:83]
  v_mfma_f32_16x16x32_bf16 v[24:27], a[36:39], v[104:107], v[24:27]
  s_add_u32 s17, s23, 20480
  buffer_load_dwordx4 v[180:183], v1, s[4:7], s17 offen sc1
  v_mfma_f32_16x16x32_bf16 v[44:47], a[36:39], v[108:111], v[44:47]
  v_mfma_f32_16x16x32_bf16 v[64:67], a[36:39], v[112:115], v[64:67]
  v_mfma_f32_16x16x32_bf16 v[84:87], a[36:39], v[116:119], v[84:87]
  s_waitcnt vmcnt(12)
  v_mfma_f32_16x16x32_bf16 v[8:11], a[40:43], v[120:123], v[8:11]
  v_mfma_f32_16x16x32_bf16 v[28:31], a[40:43], v[124:127], v[28:31]
  s_add_u32 s17, s20, 24576
  buffer_load_dwordx4 v[88:91], v1, s[4:7], s17 offen sc1
  v_mfma_f32_16x16x32_bf16 v[48:51], a[40:43], v[128:131], v[48:51]
  v_mfma_f32_16x16x32_bf16 v[68:71], a[40:43], v[132:135], v[68:71]
  v_mfma_f32_16x16x32_bf16 v[12:15], a[44:47], v[120:123], v[12:15]
  v_mfma_f32_16x16x32_bf16 v[32:35], a[44:47], v[124:127], v[32:35]
  v_mfma_f32_16x16x32_bf16 v[52:55], a[44:47], v[128:131], v[52:55]
  s_add_u32 s17, s21, 24576
  buffer_load_dwordx4 v[92:95], v1, s[4:7], s17 offen sc1
  v_mfma_f32_16x16x32_bf16 v[72:75], a[44:47], v[132:135], v[72:75]
  v_mfma_f32_16x16x32_bf16 v[16:19], a[48:51], v[120:123], v[16:19]
  v_mfma_f32_16x16x32_bf16 v[36:39], a[48:51], v[124:127], v[36:39]
  v_mfma_f32_16x16x32_bf16 v[56:59], a[48:51], v[128:131], v[56:59]
  v_mfma_f32_16x16x32_bf16 v[76:79], a[48:51], v[132:135], v[76:79]
  s_add_u32 s17, s22, 24576
  buffer_load_dwordx4 v[96:99], v1, s[4:7], s17 offen sc1
  v_mfma_f32_16x16x32_bf16 v[20:23], a[52:55], v[120:123], v[20:23]
  v_mfma_f32_16x16x32_bf16 v[40:43], a[52:55], v[124:127], v[40:43]
  v_mfma_f32_16x16x32_bf16 v[60:63], a[52:55], v[128:131], v[60:63]
  v_mfma_f32_16x16x32_bf16 v[80:83], a[52:55], v[132:135], v[80:83]
  v_mfma_f32_16x16x32_bf16 v[24:27], a[56:59], v[120:123], v[24:27]
  s_add_u32 s17, s23, 24576
  buffer_load_dwordx4 v[100:103], v1, s[4:7], s17 offen sc1
  v_mfma_f32_16x16x32_bf16 v[44:47], a[56:59], v[124:127], v[44:47]
  v_mfma_f32_16x16x32_bf16 v[64:67], a[56:59], v[128:131], v[64:67]
  v_mfma_f32_16x16x32_bf16 v[84:87], a[56:59], v[132:135], v[84:87]
  s_waitcnt vmcnt(12)
  v_mfma_f32_16x16x32_bf16 v[8:11], a[60:63], v[136:139], v[8:11]
  v_mfma_f32_16x16x32_bf16 v[28:31], a[60:63], v[140:143], v[28:31]
  s_add_u32 s17, s20, 28672
  buffer_load_dwordx4 v[104:107], v1, s[4:7], s17 offen sc1
  v_mfma_f32_16x16x32_bf16 v[48:51], a[60:63], v[144:147], v[48:51]
  v_mfma_f32_16x16x32_bf16 v[68:71], a[60:63], v[148:151], v[68:71]
  v_mfma_f32_16x16x32_bf16 v[12:15], a[64:67], v[136:139], v[12:15]
  v_mfma_f32_16x16x32_bf16 v[32:35], a[64:67], v[140:143], v[32:35]
  v_mfma_f32_16x16x32_bf16 v[52:55], a[64:67], v[144:147], v[52:55]
  s_add_u32 s17, s21, 28672
  buffer_load_dwordx4 v[108:111], v1, s[4:7], s17 offen sc1
  v_mfma_f32_16x16x32_bf16 v[72:75], a[64:67], v[148:151], v[72:75]
  v_mfma_f32_16x16x32_bf16 v[16:19], a[68:71], v[136:139], v[16:19]
  v_mfma_f32_16x16x32_bf16 v[36:39], a[68:71], v[140:143], v[36:39]
  v_mfma_f32_16x16x32_bf16 v[56:59], a[68:71], v[144:147], v[56:59]
  v_mfma_f32_16x16x32_bf16 v[76:79], a[68:71], v[148:151], v[76:79]
  s_add_u32 s17, s22, 28672
  buffer_load_dwordx4 v[112:115], v1, s[4:7], s17 offen sc1
  v_mfma_f32_16x16x32_bf16 v[20:23], a[72:75], v[136:139], v[20:23]
  v_mfma_f32_16x16x32_bf16 v[40:43], a[72:75], v[140:143], v[40:43]
  v_mfma_f32_16x16x32_bf16 v[60:63], a[72:75], v[144:147], v[60:63]
  v_mfma_f32_16x16x32_bf16 v[80:83], a[72:75], v[148:151], v[80:83]
  v_mfma_f32_16x16x32_bf16 v[24:27], a[76:79], v[136:139], v[24:27]
  s_add_u32 s17, s23, 28672
  buffer_load_dwordx4 v[116:119], v1, s[4:7], s17 offen sc1
  v_mfma_f32_16x16x32_bf16 v[44:47], a[76:79], v[140:143], v[44:47]
  v_mfma_f32_16x16x32_bf16 v[64:67], a[76:79], v[144:147], v[64:67]
  v_mfma_f32_16x16x32_bf16 v[84:87], a[76:79], v[148:151], v[84:87]
  s_waitcnt vmcnt(12)
  v_mfma_f32_16x16x32_bf16 v[8:11], a[80:83], v[152:155], v[8:11]
  v_mfma_f32_16x16x32_bf16 v[28:31], a[80:83], v[156:159], v[28:31]
  s_add_u32 s17, s20, 32768
  buffer_load_dwordx4 v[120:123], v1, s[4:7], s17 offen sc1
  v_mfma_f32_16x16x32_bf16 v[48:51], a[80:83], v[160:163], v[48:51]
  v_mfma_f32_16x16x32_bf16 v[68:71], a[80:83], v[164:167], v[68:71]
  v_mfma_f32_16x16x32_bf16 v[12:15], a[84:87], v[152:155], v[12:15]
  v_mfma_f32_16x16x32_bf16 v[32:35], a[84:87], v[156:159], v[32:35]
  v_mfma_f32_16x16x32_bf16 v[52:55], a[84:87], v[160:163], v[52:55]
  s_add_u32 s17, s21, 32768
  buffer_load_dwordx4 v[124:127], v1, s[4:7], s17 offen sc1
  v_mfma_f32_16x16x32_bf16 v[72:75], a[84:87], v[164:167], v[72:75]
  v_mfma_f32_16x16x32_bf16 v[16:19], a[88:91], v[152:155], v[16:19]
  v_mfma_f32_16x16x32_bf16 v[36:39], a[88:91], v[156:159], v[36:39]
  v_mfma_f32_16x16x32_bf16 v[56:59], a[88:91], v[160:163], v[56:59]
  v_mfma_f32_16x16x32_bf16 v[76:79], a[88:91], v[164:167], v[76:79]
  s_add_u32 s17, s22, 32768
  buffer_load_dwordx4 v[128:131], v1, s[4:7], s17 offen sc1
  v_mfma_f32_16x16x32_bf16 v[20:23], a[92:95], v[152:155], v[20:23]
  v_mfma_f32_16x16x32_bf16 v[40:43], a[92:95], v[156:159], v[40:43]
  v_mfma_f32_16x16x32_bf16 v[60:63], a[92:95], v[160:163], v[60:63]
  v_mfma_f32_16x16x32_bf16 v[80:83], a[92:95], v[164:167], v[80:83]
  v_mfma_f32_16x16x32_bf16 v[24:27], a[96:99], v[152:155], v[24:27]
  s_add_u32 s17, s23, 32768
  buffer_load_dwordx4 v[132:135], v1, s[4:7], s17 offen sc1
  v_mfma_f32_16x16x32_bf16 v[44:47], a[96:99], v[156:159], v[44:47]
  v_mfma_f32_16x16x32_bf16 v[64:67], a[96:99], v[160:163], v[64:67]
  v_mfma_f32_16x16x32_bf16 v[84:87], a[96:99], v[164:167], v[84:87]
  s_waitcnt vmcnt(12)
  v_mfma_f32_16x16x32_bf16 v[8:11], a[100:103], v[168:171], v[8:11]
  v_mfma_f32_16x16x32_bf16 v[28:31], a[100:103], v[172:175], v[28:31]
  s_add_u32 s17, s20, 36864
  buffer_load_dwordx4 v[136:139], v1, s[4:7], s17 offen sc1
  v_mfma_f32_16x16x32_bf16 v[48:51], a[100:103], v[176:179], v[48:51]
  v_mfma_f32_16x16x32_bf16 v[68:71], a[100:103], v[180:183], v[68:71]
  v_mfma_f32_16x16x32_bf16 v[12:15], a[104:107], v[168:171], v[12:15]
  v_mfma_f32_16x16x32_bf16 v[32:35], a[104:107], v[172:175], v[32:35]
  v_mfma_f32_16x16x32_bf16 v[52:55], a[104:107], v[176:179], v[52:55]
  s_add_u32 s17, s21, 36864
  buffer_load_dwordx4 v[140:143], v1, s[4:7], s17 offen sc1
  v_mfma_f32_16x16x32_bf16 v[72:75], a[104:107], v[180:183], v[72:75]
  v_mfma_f32_16x16x32_bf16 v[16:19], a[108:111], v[168:171], v[16:19]
  v_mfma_f32_16x16x32_bf16 v[36:39], a[108:111], v[172:175], v[36:39]
  v_mfma_f32_16x16x32_bf16 v[56:59], a[108:111], v[176:179], v[56:59]
  v_mfma_f32_16x16x32_bf16 v[76:79], a[108:111], v[180:183], v[76:79]
  s_add_u32 s17, s22, 36864
  buffer_load_dwordx4 v[144:147], v1, s[4:7], s17 offen sc1
  v_mfma_f32_16x16x32_bf16 v[20:23], a[112:115], v[168:171], v[20:23]
  v_mfma_f32_16x16x32_bf16 v[40:43], a[112:115], v[172:175], v[40:43]
  v_mfma_f32_16x16x32_bf16 v[60:63], a[112:115], v[176:179], v[60:63]
  v_mfma_f32_16x16x32_bf16 v[80:83], a[112:115], v[180:183], v[80:83]
  v_mfma_f32_16x16x32_bf16 v[24:27], a[116:119], v[168:171], v[24:27]
  s_add_u32 s17, s23, 36864
  buffer_load_dwordx4 v[148:151], v1, s[4:7], s17 offen sc1
  v_mfma_f32_16x16x32_bf16 v[44:47], a[116:119], v[172:175], v[44:47]
  v_mfma_f32_16x16x32_bf16 v[64:67], a[116:119], v[176:179], v[64:67]
  v_mfma_f32_16x16x32_bf16 v[84:87], a[116:119], v[180:183], v[84:87]
  s_waitcnt vmcnt(12)
  v_mfma_f32_16x16x32_bf16 v[8:11], a[120:123], v[88:91], v[8:11]
  v_mfma_f32_16x16x32_bf16 v[28:31], a[120:123], v[92:95], v[28:31]
  s_add_u32 s17, s20, 40960
  buffer_load_dwordx4 v[152:155], v1, s[4:7], s17 offen sc1
  v_mfma_f32_16x16x32_bf16 v[48:51], a[120:123], v[96:99], v[48:51]
  v_mfma_f32_16x16x32_bf16 v[68:71], a[120:123], v[100:103], v[68:71]
  v_mfma_f32_16x16x32_bf16 v[12:15], a[124:127], v[88:91], v[12:15]
  v_mfma_f32_16x16x32_bf16 v[32:35], a[124:127], v[92:95], v[32:35]
  v_mfma_f32_16x16x32_bf16 v[52:55], a[124:127], v[96:99], v[52:55]
  s_add_u32 s17, s21, 40960
  buffer_load_dwordx4 v[156:159], v1, s[4:7], s17 offen sc1
  v_mfma_f32_16x16x32_bf16 v[72:75], a[124:127], v[100:103], v[72:75]
  v_mfma_f32_16x16x32_bf16 v[16:19], a[128:131], v[88:91], v[16:19]
  v_mfma_f32_16x16x32_bf16 v[36:39], a[128:131], v[92:95], v[36:39]
  v_mfma_f32_16x16x32_bf16 v[56:59], a[128:131], v[96:99], v[56:59]
  v_mfma_f32_16x16x32_bf16 v[76:79], a[128:131], v[100:103], v[76:79]
  s_add_u32 s17, s22, 40960
  buffer_load_dwordx4 v[160:163], v1, s[4:7], s17 offen sc1
  v_mfma_f32_16x16x32_bf16 v[20:23], a[132:135], v[88:91], v[20:23]
  v_mfma_f32_16x16x32_bf16 v[40:43], a[132:135], v[92:95], v[40:43]
  v_mfma_f32_16x16x32_bf16 v[60:63], a[132:135], v[96:99], v[60:63]
  v_mfma_f32_16x16x32_bf16 v[80:83], a[132:135], v[100:103], v[80:83]
  v_mfma_f32_16x16x32_bf16 v[24:27], a[136:139], v[88:91], v[24:27]
  s_add_u32 s17, s23, 40960
  buffer_load_dwordx4 v[164:167], v1, s[4:7], s17 offen sc1
  v_mfma_f32_16x16x32_bf16 v[44:47], a[136:139], v[92:95], v[44:47]
  v_mfma_f32_16x16x32_bf16 v[64:67], a[136:139], v[96:99], v[64:67]
  v_mfma_f32_16x16x32_bf16 v[84:87], a[136:139], v[100:103], v[84:87]
  s_waitcnt vmcnt(12)
  v_mfma_f32_16x16x32_bf16 v[8:11], a[140:143], v[104:107], v[8:11]
  v_mfma_f32_16x16x32_bf16 v[28:31], a[140:143], v[108:111], v[28:31]
  s_add_u32 s17, s20, 45056
  buffer_load_dwordx4 v[168:171], v1, s[4:7], s17 offen sc1
  v_mfma_f32_16x16x32_bf16 v[48:51], a[140:143], v[112:115], v[48:51]
  v_mfma_f32_16x16x32_bf16 v[68:71], a[140:143], v[116:119], v[68:71]
  v_mfma_f32_16x16x32_bf16 v[12:15], a[144:147], v[104:107], v[12:15]
  v_mfma_f32_16x16x32_bf16 v[32:35], a[144:147], v[108:111], v[32:35]
  v_mfma_f32_16x16x32_bf16 v[52:55], a[144:147], v[112:115], v[52:55]
  s_add_u32 s17, s21, 45056
  buffer_load_dwordx4 v[172:175], v1, s[4:7], s17 offen sc1
  v_mfma_f32_16x16x32_bf16 v[72:75], a[144:147], v[116:119], v[72:75]
  v_mfma_f32_16x16x32_bf16 v[16:19], a[148:151], v[104:107], v[16:19]
  v_mfma_f32_16x16x32_bf16 v[36:39], a[148:151], v[108:111], v[36:39]
  v_mfma_f32_16x16x32_bf16 v[56:59], a[148:151], v[112:115], v[56:59]
  v_mfma_f32_16x16x32_bf16 v[76:79], a[148:151], v[116:119], v[76:79]
  s_add_u32 s17, s22, 45056
  buffer_load_dwordx4 v[176:179], v1, s[4:7], s17 offen sc1
  v_mfma_f32_16x16x32_bf16 v[20:23], a[152:155], v[104:107], v[20:23]
  v_mfma_f32_16x16x32_bf16 v[40:43], a[152:155], v[108:111], v[40:43]
  v_mfma_f32_16x16x32_bf16 v[60:63], a[152:155], v[112:115], v[60:63]
  v_mfma_f32_16x16x32_bf16 v[80:83], a[152:155], v[116:119], v[80:83]
  v_mfma_f32_16x16x32_bf16 v[24:27], a[156:159], v[104:107], v[24:27]
  s_add_u32 s17, s23, 45056
  buffer_load_dwordx4 v[180:183], v1, s[4:7], s17 offen sc1
  v_mfma_f32_16x16x32_bf16 v[44:47], a[156:159], v[108:111], v[44:47]
  v_mfma_f32_16x16x32_bf16 v[64:67], a[156:159], v[112:115], v[64:67]
  v_mfma_f32_16x16x32_bf16 v[84:87], a[156:159], v[116:119], v[84:87]
  s_waitcnt vmcnt(12)
  v_mfma_f32_16x16x32_bf16 v[8:11], a[160:163], v[120:123], v[8:11]
  v_mfma_f32_16x16x32_bf16 v[28:31], a[160:163], v[124:127], v[28:31]
  s_add_u32 s17, s20, 49152
  v_lshlrev_b32 v7, 3, v0
  buffer_load_dwordx2 v[88:89], v7, s[4:7], s17 offen sc1
  buffer_load_dwordx2 v[90:91], v7, s[4:7], s17 offen offset:512 sc1
  v_mfma_f32_16x16x32_bf16 v[48:51], a[160:163], v[128:131], v[48:51]
  v_mfma_f32_16x16x32_bf16 v[68:71], a[160:163], v[132:135], v[68:71]
  v_mfma_f32_16x16x32_bf16 v[12:15], a[164:167], v[120:123], v[12:15]
  v_mfma_f32_16x16x32_bf16 v[32:35], a[164:167], v[124:127], v[32:35]
  v_mfma_f32_16x16x32_bf16 v[52:55], a[164:167], v[128:131], v[52:55]
  s_add_u32 s17, s21, 49152
  v_lshlrev_b32 v7, 3, v0
  buffer_load_dwordx2 v[92:93], v7, s[4:7], s17 offen sc1
  buffer_load_dwordx2 v[94:95], v7, s[4:7], s17 offen offset:512 sc1
  v_mfma_f32_16x16x32_bf16 v[72:75], a[164:167], v[132:135], v[72:75]
  v_mfma_f32_16x16x32_bf16 v[16:19], a[168:171], v[120:123], v[16:19]
  v_mfma_f32_16x16x32_bf16 v[36:39], a[168:171], v[124:127], v[36:39]
  v_mfma_f32_16x16x32_bf16 v[56:59], a[168:171], v[128:131], v[56:59]
  v_mfma_f32_16x16x32_bf16 v[76:79], a[168:171], v[132:135], v[76:79]
  s_add_u32 s17, s22, 49152
  v_lshlrev_b32 v7, 3, v0
  buffer_load_dwordx2 v[96:97], v7, s[4:7], s17 offen sc1
  buffer_load_dwordx2 v[98:99], v7, s[4:7], s17 offen offset:512 sc1
  v_mfma_f32_16x16x32_bf16 v[20:23], a[172:175], v[120:123], v[20:23]
  v_mfma_f32_16x16x32_bf16 v[40:43], a[172:175], v[124:127], v[40:43]
  v_mfma_f32_16x16x32_bf16 v[60:63], a[172:175], v[128:131], v[60:63]
  v_mfma_f32_16x16x32_bf16 v[80:83], a[172:175], v[132:135], v[80:83]
  v_mfma_f32_16x16x32_bf16 v[24:27], a[176:179], v[120:123], v[24:27]
  s_add_u32 s17, s23, 49152
  v_lshlrev_b32 v7, 3, v0
  buffer_load_dwordx2 v[100:101], v7, s[4:7], s17 offen sc1
  buffer_load_dwordx2 v[102:103], v7, s[4:7], s17 offen offset:512 sc1
  v_mfma_f32_16x16x32_bf16 v[44:47], a[176:179], v[124:127], v[44:47]
  v_mfma_f32_16x16x32_bf16 v[64:67], a[176:179], v[128:131], v[64:67]
  v_mfma_f32_16x16x32_bf16 v[84:87], a[176:179], v[132:135], v[84:87]
  s_waitcnt vmcnt(16)
  v_mfma_f32_16x16x32_bf16 v[8:11], a[180:183], v[136:139], v[8:11]
  v_mfma_f32_16x16x32_bf16 v[28:31], a[180:183], v[140:143], v[28:31]
  s_add_u32 s17, s20, 53248
  s_sub_u32 s17, s17, s24
  v_lshlrev_b32 v7, 3, v0
  buffer_load_dwordx2 v[104:105], v7, s[4:7], s17 offen sc1
  buffer_load_dwordx2 v[106:107], v7, s[4:7], s17 offen offset:512 sc1
  v_mfma_f32_16x16x32_bf16 v[48:51], a[180:183], v[144:147], v[48:51]
  v_mfma_f32_16x16x32_bf16 v[68:71], a[180:183], v[148:151], v[68:71]
  v_mfma_f32_16x16x32_bf16 v[12:15], a[184:187], v[136:139], v[12:15]
  v_mfma_f32_16x16x32_bf16 v[32:35], a[184:187], v[140:143], v[32:35]
  v_mfma_f32_16x16x32_bf16 v[52:55], a[184:187], v[144:147], v[52:55]
  s_add_u32 s17, s21, 53248
  s_sub_u32 s17, s17, s24
  v_lshlrev_b32 v7, 3, v0
  buffer_load_dwordx2 v[108:109], v7, s[4:7], s17 offen sc1
  buffer_load_dwordx2 v[110:111], v7, s[4:7], s17 offen offset:512 sc1
  v_mfma_f32_16x16x32_bf16 v[72:75], a[184:187], v[148:151], v[72:75]
  v_mfma_f32_16x16x32_bf16 v[16:19], a[188:191], v[136:139], v[16:19]
  v_mfma_f32_16x16x32_bf16 v[36:39], a[188:191], v[140:143], v[36:39]
  v_mfma_f32_16x16x32_bf16 v[56:59], a[188:191], v[144:147], v[56:59]
  v_mfma_f32_16x16x32_bf16 v[76:79], a[188:191], v[148:151], v[76:79]
  s_add_u32 s17, s22, 53248
  s_sub_u32 s17, s17, s24
  v_lshlrev_b32 v7, 3, v0
  buffer_load_dwordx2 v[112:113], v7, s[4:7], s17 offen sc1
  buffer_load_dwordx2 v[114:115], v7, s[4:7], s17 offen offset:512 sc1
  v_mfma_f32_16x16x32_bf16 v[20:23], a[192:195], v[136:139], v[20:23]
  v_mfma_f32_16x16x32_bf16 v[40:43], a[192:195], v[140:143], v[40:43]
  v_mfma_f32_16x16x32_bf16 v[60:63], a[192:195], v[144:147], v[60:63]
  v_mfma_f32_16x16x32_bf16 v[80:83], a[192:195], v[148:151], v[80:83]
  v_mfma_f32_16x16x32_bf16 v[24:27], a[196:199], v[136:139], v[24:27]
  s_add_u32 s17, s23, 53248
  s_sub_u32 s17, s17, s24
  v_lshlrev_b32 v7, 3, v0
  buffer_load_dwordx2 v[116:117], v7, s[4:7], s17 offen sc1
  buffer_load_dwordx2 v[118:119], v7, s[4:7], s17 offen offset:512 sc1
  v_mfma_f32_16x16x32_bf16 v[44:47], a[196:199], v[140:143], v[44:47]
  v_mfma_f32_16x16x32_bf16 v[64:67], a[196:199], v[144:147], v[64:67]
  v_mfma_f32_16x16x32_bf16 v[84:87], a[196:199], v[148:151], v[84:87]
  s_waitcnt vmcnt(20)
  v_mfma_f32_16x16x32_bf16 v[8:11], a[200:203], v[152:155], v[8:11]
  v_mfma_f32_16x16x32_bf16 v[28:31], a[200:203], v[156:159], v[28:31]
  v_mfma_f32_16x16x32_bf16 v[48:51], a[200:203], v[160:163], v[48:51]
  v_mfma_f32_16x16x32_bf16 v[68:71], a[200:203], v[164:167], v[68:71]
  v_mfma_f32_16x16x32_bf16 v[12:15], a[204:207], v[152:155], v[12:15]
  v_mfma_f32_16x16x32_bf16 v[32:35], a[204:207], v[156:159], v[32:35]
  v_mfma_f32_16x16x32_bf16 v[52:55], a[204:207], v[160:163], v[52:55]
  v_mfma_f32_16x16x32_bf16 v[72:75], a[204:207], v[164:167], v[72:75]
  v_mfma_f32_16x16x32_bf16 v[16:19], a[208:211], v[152:155], v[16:19]
  v_mfma_f32_16x16x32_bf16 v[36:39], a[208:211], v[156:159], v[36:39]
  v_mfma_f32_16x16x32_bf16 v[56:59], a[208:211], v[160:163], v[56:59]
  v_mfma_f32_16x16x32_bf16 v[76:79], a[208:211], v[164:167], v[76:79]
  v_mfma_f32_16x16x32_bf16 v[20:23], a[212:215], v[152:155], v[20:23]
  v_mfma_f32_16x16x32_bf16 v[40:43], a[212:215], v[156:159], v[40:43]
  v_mfma_f32_16x16x32_bf16 v[60:63], a[212:215], v[160:163], v[60:63]
  v_mfma_f32_16x16x32_bf16 v[80:83], a[212:215], v[164:167], v[80:83]
  v_mfma_f32_16x16x32_bf16 v[24:27], a[216:219], v[152:155], v[24:27]
  v_mfma_f32_16x16x32_bf16 v[44:47], a[216:219], v[156:159], v[44:47]
  v_mfma_f32_16x16x32_bf16 v[64:67], a[216:219], v[160:163], v[64:67]
  v_mfma_f32_16x16x32_bf16 v[84:87], a[216:219], v[164:167], v[84:87]
  s_waitcnt vmcnt(16)
  v_mfma_f32_16x16x32_bf16 v[8:11], a[220:223], v[168:171], v[8:11]
  v_mfma_f32_16x16x32_bf16 v[28:31], a[220:223], v[172:175], v[28:31]
  v_mfma_f32_16x16x32_bf16 v[48:51], a[220:223], v[176:179], v[48:51]
  v_mfma_f32_16x16x32_bf16 v[68:71], a[220:223], v[180:183], v[68:71]
  v_mfma_f32_16x16x32_bf16 v[12:15], a[224:227], v[168:171], v[12:15]
  v_mfma_f32_16x16x32_bf16 v[32:35], a[224:227], v[172:175], v[32:35]
  v_mfma_f32_16x16x32_bf16 v[52:55], a[224:227], v[176:179], v[52:55]
  v_mfma_f32_16x16x32_bf16 v[72:75], a[224:227], v[180:183], v[72:75]
  v_mfma_f32_16x16x32_bf16 v[16:19], a[228:231], v[168:171], v[16:19]
  v_mfma_f32_16x16x32_bf16 v[36:39], a[228:231], v[172:175], v[36:39]
  v_mfma_f32_16x16x32_bf16 v[56:59], a[228:231], v[176:179], v[56:59]
  v_mfma_f32_16x16x32_bf16 v[76:79], a[228:231], v[180:183], v[76:79]
  v_mfma_f32_16x16x32_bf16 v[20:23], a[232:235], v[168:171], v[20:23]
  v_mfma_f32_16x16x32_bf16 v[40:43], a[232:235], v[172:175], v[40:43]
  v_mfma_f32_16x16x32_bf16 v[60:63], a[232:235], v[176:179], v[60:63]
  v_mfma_f32_16x16x32_bf16 v[80:83], a[232:235], v[180:183], v[80:83]
  v_mfma_f32_16x16x32_bf16 v[24:27], a[236:239], v[168:171], v[24:27]
  v_mfma_f32_16x16x32_bf16 v[44:47], a[236:239], v[172:175], v[44:47]
  v_mfma_f32_16x16x32_bf16 v[64:67], a[236:239], v[176:179], v[64:67]
  v_mfma_f32_16x16x32_bf16 v[84:87], a[236:239], v[180:183], v[84:87]
  s_waitcnt vmcnt(8)
  v_mfma_f32_16x16x32_bf16 v[8:11], a[240:243], v[88:91], v[8:11]
  v_mfma_f32_16x16x32_bf16 v[28:31], a[240:243], v[92:95], v[28:31]
  v_mfma_f32_16x16x32_bf16 v[48:51], a[240:243], v[96:99], v[48:51]
  v_mfma_f32_16x16x32_bf16 v[68:71], a[240:243], v[100:103], v[68:71]
  v_mfma_f32_16x16x32_bf16 v[12:15], a[244:247], v[88:91], v[12:15]
  v_mfma_f32_16x16x32_bf16 v[32:35], a[244:247], v[92:95], v[32:35]
  v_mfma_f32_16x16x32_bf16 v[52:55], a[244:247], v[96:99], v[52:55]
  v_mfma_f32_16x16x32_bf16 v[72:75], a[244:247], v[100:103], v[72:75]
  v_mfma_f32_16x16x32_bf16 v[16:19], a[248:251], v[88:91], v[16:19]
  v_mfma_f32_16x16x32_bf16 v[36:39], a[248:251], v[92:95], v[36:39]
  v_mfma_f32_16x16x32_bf16 v[56:59], a[248:251], v[96:99], v[56:59]
  v_mfma_f32_16x16x32_bf16 v[76:79], a[248:251], v[100:103], v[76:79]
  v_mfma_f32_16x16x32_bf16 v[20:23], a[252:255], v[88:91], v[20:23]
  v_mfma_f32_16x16x32_bf16 v[40:43], a[252:255], v[92:95], v[40:43]
  v_mfma_f32_16x16x32_bf16 v[60:63], a[252:255], v[96:99], v[60:63]
  v_mfma_f32_16x16x32_bf16 v[80:83], a[252:255], v[100:103], v[80:83]
  v_mfma_f32_16x16x32_bf16 v[24:27], v[220:223], v[88:91], v[24:27]
  v_mfma_f32_16x16x32_bf16 v[44:47], v[220:223], v[92:95], v[44:47]
  v_mfma_f32_16x16x32_bf16 v[64:67], v[220:223], v[96:99], v[64:67]
  v_mfma_f32_16x16x32_bf16 v[84:87], v[220:223], v[100:103], v[84:87]
  s_waitcnt vmcnt(0)
  v_mfma_f32_16x16x32_bf16 v[8:11], v[224:227], v[104:107], v[8:11]
  v_mfma_f32_16x16x32_bf16 v[28:31], v[224:227], v[108:111], v[28:31]
  v_mfma_f32_16x16x32_bf16 v[48:51], v[224:227], v[112:115], v[48:51]
  v_mfma_f32_16x16x32_bf16 v[68:71], v[224:227], v[116:119], v[68:71]
  v_mfma_f32_16x16x32_bf16 v[12:15], v[228:231], v[104:107], v[12:15]
  v_mfma_f32_16x16x32_bf16 v[32:35], v[228:231], v[108:111], v[32:35]
  v_mfma_f32_16x16x32_bf16 v[52:55], v[228:231], v[112:115], v[52:55]
  v_mfma_f32_16x16x32_bf16 v[72:75], v[228:231], v[116:119], v[72:75]
  v_mfma_f32_16x16x32_bf16 v[16:19], v[232:235], v[104:107], v[16:19]
  v_mfma_f32_16x16x32_bf16 v[36:39], v[232:235], v[108:111], v[36:39]
  v_mfma_f32_16x16x32_bf16 v[56:59], v[232:235], v[112:115], v[56:59]
  v_mfma_f32_16x16x32_bf16 v[76:79], v[232:235], v[116:119], v[76:79]
  v_mfma_f32_16x16x32_bf16 v[20:23], v[236:239], v[104:107], v[20:23]
  v_mfma_f32_16x16x32_bf16 v[40:43], v[236:239], v[108:111], v[40:43]
  v_mfma_f32_16x16x32_bf16 v[60:63], v[236:239], v[112:115], v[60:63]
  v_mfma_f32_16x16x32_bf16 v[80:83], v[236:239], v[116:119], v[80:83]
  v_mfma_f32_16x16x32_bf16 v[24:27], v[240:243], v[104:107], v[24:27]
  v_mfma_f32_16x16x32_bf16 v[44:47], v[240:243], v[108:111], v[44:47]
  v_mfma_f32_16x16x32_bf16 v[64:67], v[240:243], v[112:115], v[64:67]
  v_mfma_f32_16x16x32_bf16 v[84:87], v[240:243], v[116:119], v[84:87]
  s_add_u32 s17, s8, 1
  s_and_b32 s17, s17, 3
  s_mul_i32 s17, s17, 15360
  s_add_u32 s17, s17, 102400
  v_add_u32 v7, s17, v1
  ds_write_b128 v7, v[28:31] offset:0
  ds_write_b128 v7, v[32:35] offset:1024
  ds_write_b128 v7, v[36:39] offset:2048
  ds_write_b128 v7, v[40:43] offset:3072
  ds_write_b128 v7, v[44:47] offset:4096
  s_add_u32 s17, s8, 2
  s_and_b32 s17, s17, 3
  s_mul_i32 s17, s17, 15360
  s_add_u32 s17, s17, 107520
  v_add_u32 v7, s17, v1
  ds_write_b128 v7, v[48:51] offset:0
  ds_write_b128 v7, v[52:55] offset:1024
  ds_write_b128 v7, v[56:59] offset:2048
  ds_write_b128 v7, v[60:63] offset:3072
  ds_write_b128 v7, v[64:67] offset:4096
  s_add_u32 s17, s8, 3
  s_and_b32 s17, s17, 3
  s_mul_i32 s17, s17, 15360
  s_add_u32 s17, s17, 112640
  v_add_u32 v7, s17, v1
  ds_write_b128 v7, v[68:71] offset:0
  ds_write_b128 v7, v[72:75] offset:1024
  ds_write_b128 v7, v[76:79] offset:2048
  ds_write_b128 v7, v[80:83] offset:3072
  ds_write_b128 v7, v[84:87] offset:4096
  s_mul_i32 s17, s8, 15360
  s_add_u32 s17, s17, 102400
  v_add_u32 v7, s17, v1
  s_waitcnt lgkmcnt(0)
  s_barrier
  ds_read_b128 v[88:91], v7 offset:0
  ds_read_b128 v[92:95], v7 offset:1024
  ds_read_b128 v[96:99], v7 offset:2048
  ds_read_b128 v[100:103], v7 offset:3072
  ds_read_b128 v[104:107], v7 offset:4096
  ds_read_b128 v[108:111], v7 offset:5120
  ds_read_b128 v[112:115], v7 offset:6144
  ds_read_b128 v[116:119], v7 offset:7168
  ds_read_b128 v[120:123], v7 offset:8192
  ds_read_b128 v[124:127], v7 offset:9216
  ds_read_b128 v[128:131], v7 offset:10240
  ds_read_b128 v[132:135], v7 offset:11264
  ds_read_b128 v[136:139], v7 offset:12288
  ds_read_b128 v[140:143], v7 offset:13312
  ds_read_b128 v[144:147], v7 offset:14336
  s_waitcnt lgkmcnt(10)
  v_pk_add_f32 v[8:9], v[8:9], v[88:89]
  v_pk_add_f32 v[10:11], v[10:11], v[90:91]
  v_pk_add_f32 v[12:13], v[12:13], v[92:93]
  v_pk_add_f32 v[14:15], v[14:15], v[94:95]
  v_pk_add_f32 v[16:17], v[16:17], v[96:97]
  v_pk_add_f32 v[18:19], v[18:19], v[98:99]
  v_pk_add_f32 v[20:21], v[20:21], v[100:101]
  v_pk_add_f32 v[22:23], v[22:23], v[102:103]
  v_pk_add_f32 v[24:25], v[24:25], v[104:105]
  v_pk_add_f32 v[26:27], v[26:27], v[106:107]
  s_waitcnt lgkmcnt(5)
  v_pk_add_f32 v[8:9], v[8:9], v[108:109]
  v_pk_add_f32 v[10:11], v[10:11], v[110:111]
  v_pk_add_f32 v[12:13], v[12:13], v[112:113]
  v_pk_add_f32 v[14:15], v[14:15], v[114:115]
  v_pk_add_f32 v[16:17], v[16:17], v[116:117]
  v_pk_add_f32 v[18:19], v[18:19], v[118:119]
  v_pk_add_f32 v[20:21], v[20:21], v[120:121]
  v_pk_add_f32 v[22:23], v[22:23], v[122:123]
  v_pk_add_f32 v[24:25], v[24:25], v[124:125]
  v_pk_add_f32 v[26:27], v[26:27], v[126:127]
  s_waitcnt lgkmcnt(0)
  v_pk_add_f32 v[8:9], v[8:9], v[128:129]
  v_pk_add_f32 v[10:11], v[10:11], v[130:131]
  v_pk_add_f32 v[12:13], v[12:13], v[132:133]
  v_pk_add_f32 v[14:15], v[14:15], v[134:135]
  v_pk_add_f32 v[16:17], v[16:17], v[136:137]
  v_pk_add_f32 v[18:19], v[18:19], v[138:139]
  v_pk_add_f32 v[20:21], v[20:21], v[140:141]
  v_pk_add_f32 v[22:23], v[22:23], v[142:143]
  v_pk_add_f32 v[24:25], v[24:25], v[144:145]
  v_pk_add_f32 v[26:27], v[26:27], v[146:147]
  v_lshlrev_b32 v216, 16, v184
  v_and_b32 v217, 0xffff0000, v184
  v_pk_add_f32 v[8:9], v[8:9], v[216:217]
  v_lshlrev_b32 v216, 16, v194
  v_and_b32 v217, 0xffff0000, v194
  v_pk_add_f32 v[8:9], v[8:9], v[216:217]
  v_lshlrev_b32 v216, 16, v185
  v_and_b32 v217, 0xffff0000, v185
  v_pk_add_f32 v[10:11], v[10:11], v[216:217]
  v_lshlrev_b32 v216, 16, v195
  v_and_b32 v217, 0xffff0000, v195
  v_pk_add_f32 v[10:11], v[10:11], v[216:217]
  v_lshlrev_b32 v216, 16, v186
  v_and_b32 v217, 0xffff0000, v186
  v_pk_add_f32 v[12:13], v[12:13], v[216:217]
  v_lshlrev_b32 v216, 16, v196
  v_and_b32 v217, 0xffff0000, v196
  v_pk_add_f32 v[12:13], v[12:13], v[216:217]
  v_lshlrev_b32 v216, 16, v187
  v_and_b32 v217, 0xffff0000, v187
  v_pk_add_f32 v[14:15], v[14:15], v[216:217]
  v_lshlrev_b32 v216, 16, v197
  v_and_b32 v217, 0xffff0000, v197
  v_pk_add_f32 v[14:15], v[14:15], v[216:217]
  v_lshlrev_b32 v216, 16, v188
  v_and_b32 v217, 0xffff0000, v188
  v_pk_add_f32 v[16:17], v[16:17], v[216:217]
  v_lshlrev_b32 v216, 16, v198
  v_and_b32 v217, 0xffff0000, v198
  v_pk_add_f32 v[16:17], v[16:17], v[216:217]
  v_lshlrev_b32 v216, 16, v189
  v_and_b32 v217, 0xffff0000, v189
  v_pk_add_f32 v[18:19], v[18:19], v[216:217]
  v_lshlrev_b32 v216, 16, v199
  v_and_b32 v217, 0xffff0000, v199
  v_pk_add_f32 v[18:19], v[18:19], v[216:217]
  v_lshlrev_b32 v216, 16, v190
  v_and_b32 v217, 0xffff0000, v190
  v_pk_add_f32 v[20:21], v[20:21], v[216:217]
  v_lshlrev_b32 v216, 16, v200
  v_and_b32 v217, 0xffff0000, v200
  v_pk_add_f32 v[20:21], v[20:21], v[216:217]
  v_lshlrev_b32 v216, 16, v191
  v_and_b32 v217, 0xffff0000, v191
  v_pk_add_f32 v[22:23], v[22:23], v[216:217]
  v_lshlrev_b32 v216, 16, v201
  v_and_b32 v217, 0xffff0000, v201
  v_pk_add_f32 v[22:23], v[22:23], v[216:217]
  v_lshlrev_b32 v216, 16, v192
  v_and_b32 v217, 0xffff0000, v192
  v_pk_add_f32 v[24:25], v[24:25], v[216:217]
  v_lshlrev_b32 v216, 16, v202
  v_and_b32 v217, 0xffff0000, v202
  v_pk_add_f32 v[24:25], v[24:25], v[216:217]
  v_lshlrev_b32 v216, 16, v193
  v_and_b32 v217, 0xffff0000, v193
  v_pk_add_f32 v[26:27], v[26:27], v[216:217]
  v_lshlrev_b32 v216, 16, v203
  v_and_b32 v217, 0xffff0000, v203
  v_pk_add_f32 v[26:27], v[26:27], v[216:217]
  v_cvt_pk_bf16_f32 v204, v8, v9
  v_cvt_pk_bf16_f32 v205, v10, v11
  v_cvt_pk_bf16_f32 v206, v12, v13
  v_cvt_pk_bf16_f32 v207, v14, v15
  v_cvt_pk_bf16_f32 v208, v16, v17
  v_cvt_pk_bf16_f32 v209, v18, v19
  v_cvt_pk_bf16_f32 v210, v20, v21
  v_cvt_pk_bf16_f32 v211, v22, v23
  v_cvt_pk_bf16_f32 v212, v24, v25
  v_cvt_pk_bf16_f32 v213, v26, v27
  v_mul_u32_u24 v7, 1280, v4
  v_lshl_add_u32 v7, v5, 3, v7
  s_mul_i32 s17, s60, 20480
  s_mul_i32 s18, s13, 160
  s_add_u32 s17, s17, s18
  buffer_store_dwordx2 v[204:205], v7, s[44:47], s17 offen offset:0
  buffer_store_dwordx2 v[206:207], v7, s[44:47], s17 offen offset:32
  buffer_store_dwordx2 v[208:209], v7, s[44:47], s17 offen offset:64
  buffer_store_dwordx2 v[210:211], v7, s[44:47], s17 offen offset:96
  buffer_store_dwordx2 v[212:213], v7, s[44:47], s17 offen offset:128
  s_or_b32 s17, s2, s8
  s_cmp_lg_u32 s17, 0
  s_cbranch_scc1 ep_60
  s_mov_b32 s17, 0xda0000
  s_mov_b64 exec, 1
  v_mov_b32 v7, s68
  buffer_store_dword v7, off, s[4:7], s17 sc1
  s_mov_b64 exec, -1
ep_60:
  s_endpgm
main_end:
  s_endpgm
.section .rodata,"a"
.p2align 6
.amdhsa_kernel interleave_layers__linear_kernel_hedgehog__mixer_channel_mlp__prompt_kernel
  .amdhsa_next_free_vgpr 512
  .amdhsa_next_free_sgpr 102
  .amdhsa_accum_offset 256
  .amdhsa_group_segment_fixed_size 0
  .amdhsa_kernarg_size 96
  .amdhsa_user_sgpr_count 2
  .amdhsa_user_sgpr_kernarg_segment_ptr 1
  .amdhsa_system_sgpr_workgroup_id_x 1
  .amdhsa_float_denorm_mode_32 3
  .amdhsa_float_denorm_mode_16_64 3
.end_amdhsa_kernel
```
